```python
import torch

def _softmax(x, axis=-1):
    return torch.softmax(x, dim=axis)
def _gelu(x):
    return torch.nn.functional.gelu(x, approximate="tanh")
def _silu(x):
    return torch.nn.functional.silu(x)
def _sigmoid(x):
    return torch.sigmoid(x)
def _layernorm(x, axis=-1, eps=1e-5):
    m = x.mean(dim=axis, keepdim=True)
    v = x.var(dim=axis, keepdim=True, unbiased=False)
    return (x - m) / torch.sqrt(v + eps)
def _scatter_add(tgt, idx, src, axis=0):
    return tgt.clone().index_add_(axis, idx, src)
def _segment_sum(src, seg, n):
    out = torch.zeros((n,) + src.shape[1:], dtype=src.dtype)
    return out.index_add_(0, seg, src)
def _pad(x, pw):
    flat = tuple(v for pair in reversed(pw) for v in pair)
    return torch.nn.functional.pad(x, flat)

kernel_name = 'concat_heads__mha_block_cached__gqa_block_cached__near_ridge'

def setup_inputs():

    _w = (lambda a: (lambda t: t.to(torch.bfloat16) if t.is_floating_point() else t)(torch.as_tensor(a)))
    def _A_setup():
        B, Sq, D = 8, 176, 1024
        H, Sk, Dh = 32, 512, 128
        return {
            "x": _w((lambda *s: torch.randn(*s, dtype=torch.bfloat16) * 0.8)(B, Sq, D)),
            "k_cache": _w((lambda *s: torch.randn(*s, dtype=torch.bfloat16) * 0.8)(B, H, Sk, Dh)),
            "v_cache": _w((lambda *s: torch.randn(*s, dtype=torch.bfloat16) * 0.05)(B, H, Sk, Dh)),
            "wq": _w((lambda *s: torch.randn(*s, dtype=torch.bfloat16) * 0.8)(D, H * Dh) * (D ** -0.5)),
            "wo": _w((lambda *s: torch.randn(*s, dtype=torch.bfloat16) * 0.05)(H * Dh, D) * ((H * Dh) ** -0.5)),
        }
    _A_in = _A_setup()

    def _B_setup():
        B, Sq, D = 8, 176, 1024
        Hq, Hkv, Sk, Dh = 32, 32, 512, 128
        assert Hq % Hkv == 0, (Hq, Hkv)
        return {
            "x": _w((lambda *s: torch.randn(*s, dtype=torch.bfloat16) * 0.8)(B, Sq, D)),
            "k_cache": _w((lambda *s: torch.randn(*s, dtype=torch.bfloat16) * 0.8)(B, Hkv, Sk, Dh)),
            "v_cache": _w((lambda *s: torch.randn(*s, dtype=torch.bfloat16) * 0.05)(B, Hkv, Sk, Dh)),
            "wq": _w((lambda *s: torch.randn(*s, dtype=torch.bfloat16) * 0.8)(D, Hq * Dh) * (D ** -0.5)),
            "wo": _w((lambda *s: torch.randn(*s, dtype=torch.bfloat16) * 0.05)(Hq * Dh, D) * ((Hq * Dh) ** -0.5)),
        }
    _B_in = _B_setup()

    return {
        "A_x": _A_in["x"],
        "A_k_cache": _A_in["k_cache"],
        "A_v_cache": _A_in["v_cache"],
        "A_wq": _A_in["wq"],
        "A_wo": _A_in["wo"],
        "B_x": _B_in["x"],
        "B_k_cache": _B_in["k_cache"],
        "B_v_cache": _B_in["v_cache"],
        "B_wq": _B_in["wq"],
        "B_wo": _B_in["wo"],
    }

def reference(A_x, A_k_cache, A_v_cache, A_wq, A_wo, B_x, B_k_cache, B_v_cache, B_wq, B_wo):
    def _A_ref(x, k_cache, v_cache, wq, wo):
        B, Sq, D = x.shape
        H, Dh = 32, 128
        q = (lambda x, *d: x.permute(*d))((x @ wq).reshape(B, Sq, H, Dh), 0, 2, 1, 3)
        scores = torch.einsum("bhqd,bhkd->bhqk", q, k_cache) * (Dh ** -0.5)
        p = _softmax(scores, axis=-1)
        o = torch.einsum("bhqk,bhkd->bhqd", p, v_cache)
        return (lambda x, *d: x.permute(*d))(o, 0, 2, 1, 3).reshape(B, Sq, H * Dh) @ wo

    def _B_ref(x, k_cache, v_cache, wq, wo):
        B, Sq, D = x.shape
        Hq, Dh = 32, 128
        Hkv = k_cache.shape[1]
        rep = Hq // Hkv
        q = (lambda x, *d: x.permute(*d))((x @ wq).reshape(B, Sq, Hq, Dh), 0, 2, 1, 3)
        k = (lambda x, n, axis: torch.repeat_interleave(x, n, dim=axis))(k_cache, rep, axis=1)
        v = (lambda x, n, axis: torch.repeat_interleave(x, n, dim=axis))(v_cache, rep, axis=1)
        scores = torch.einsum("bhqd,bhkd->bhqk", q, k) * (Dh ** -0.5)
        p = _softmax(scores, axis=-1)
        o = torch.einsum("bhqk,bhkd->bhqd", p, v)
        return (lambda x, *d: x.permute(*d))(o, 0, 2, 1, 3).reshape(B, Sq, Hq * Dh) @ wo

    a = _A_ref(A_x, A_k_cache, A_v_cache, A_wq, A_wo)
    b = _B_ref(B_x, B_k_cache, B_v_cache, B_wq, B_wo)
    return torch.concatenate([a, b], axis=-1)
```

```asm
; @launch grid=(256,1,1) block=(256,1,1) lds=163840
.amdgcn_target "amdgcn-amd-amdhsa--gfx950"
.macro Cvaa d,a,b,c
v_mfma_f32_16x16x32_bf16 v[\d:\d+3], a[\a:\a+3], a[\b:\b+3], v[\c:\c+3]
.endm
.macro Cvav d,a,b,c
v_mfma_f32_16x16x32_bf16 v[\d:\d+3], a[\a:\a+3], v[\b:\b+3], v[\c:\c+3]
.endm
.macro Mvaa d,a,b
v_mfma_f32_16x16x32_bf16 v[\d:\d+3], a[\a:\a+3], a[\b:\b+3], v[\d:\d+3]
.endm
.macro Mvav d,a,b
v_mfma_f32_16x16x32_bf16 v[\d:\d+3], a[\a:\a+3], v[\b:\b+3], v[\d:\d+3]
.endm
.macro Mvvv d,a,b
v_mfma_f32_16x16x32_bf16 v[\d:\d+3], v[\a:\a+3], v[\b:\b+3], v[\d:\d+3]
.endm
.macro RD d,v,o
ds_read_b128 a[\d:\d+3], v\v offset:\o
.endm
.macro TR d,v,o
ds_read_b64_tr_b16 a[\d:\d+1], v\v offset:\o
.endm
.macro Zvaa d,a,b
v_mfma_f32_16x16x32_bf16 v[\d:\d+3], a[\a:\a+3], a[\b:\b+3], 0
.endm
.macro Zvav d,a,b
v_mfma_f32_16x16x32_bf16 v[\d:\d+3], a[\a:\a+3], v[\b:\b+3], 0
.endm
.macro Zvvv d,a,b
v_mfma_f32_16x16x32_bf16 v[\d:\d+3], v[\a:\a+3], v[\b:\b+3], 0
.endm
.text
.p2align 12
f_start:
s_bfe_u32 s47, s2, 0x10002
s_lshr_b32 s48, s2, 5
s_bfe_u32 s41, s2, 0x20003
s_and_b32 s49, s2, 3
s_lshl_b32 s49, s49, 2
s_add_u32 s49, s49, s41
s_bfe_u32 s50, s2, 0x10001
s_and_b32 s51, s2, 1
s_lshl_b32 s51, s51, 2
s_add_u32 s51, s51, s41
v_and_b32 v2, 15, v1
v_lshrrev_b32 v3, 4, v1
s_and_b32 s41, s40, 1
s_lshl_b32 s41, s41, 1
s_lshr_b32 s42, s40, 1
s_lshl_b32 s42, s42, 3
s_add_u32 s41, s41, s42
s_lshl_b32 s41, s41, 13
v_lshrrev_b32 v4, 5, v1
v_lshlrev_b32 v4, 15, v4
v_and_b32 v5, 31, v1
v_lshl_add_u32 v4, v5, 4, v4
v_add_u32 v6, s41, v4
v_add_u32 v7, 0x20000, v6
v_add_u32 v8, 0x2000, v6
v_add_u32 v9, 0x22000, v6
s_mul_i32 s45, s40, 0x1040
s_mul_i32 s41, s40, 0x18000
v_lshrrev_b32 v4, 3, v1
v_lshlrev_b32 v4, 11, v4
v_add_u32 v4, s41, v4
v_and_b32 v5, 7, v1
v_xor_b32 v5, v3, v5
v_lshl_add_u32 v40, v5, 4, v4
v_xor_b32 v41, 64, v40
v_add_u32 v41, 0x4000, v41
v_add_u32 v42, 0x8000, v40
v_add_u32 v43, 0x8000, v41
v_add_u32 v44, 0x10000, v40
v_add_u32 v45, 0x10000, v41
s_mul_i32 s46, s40, 0x3000
s_add_u32 s46, s46, 0x4200
s_waitcnt lgkmcnt(0)
s_cmp_eq_u32 s47, 0
s_cselect_b64 s[4:5], s[72:73], s[82:83]
s_cselect_b64 s[8:9], s[78:79], s[88:89]
s_cselect_b64 s[12:13], s[74:75], s[84:85]
s_cselect_b64 s[16:17], s[76:77], s[86:87]
s_cselect_b64 s[24:25], s[80:81], s[90:91]
s_lshl_b32 s41, s49, 9
s_add_u32 s8, s8, s41
s_addc_u32 s9, s9, 0
s_sub_u32 s10, 0x800000, s41
s_mov_b32 s11, 0x20000
s_mul_i32 s41, s48, 0x58000
s_add_u32 s4, s4, s41
s_addc_u32 s5, s5, 0
s_mov_b32 s6, 0x58000
s_mov_b32 s7, 0x20000
v_lshlrev_b32 v228, 18, v3
v_bfe_u32 v4, v1, 2, 2
v_lshl_add_u32 v228, v4, 13, v228
v_and_b32 v5, 3, v1
v_lshl_add_u32 v228, v5, 7, v228
s_lshl_b32 s41, s48, 15
v_add_u32 v228, s41, v228
v_lshrrev_b32 v4, 2, v1
v_min_u32 v4, 10, v4
v_lshlrev_b32 v229, 11, v4
v_lshl_add_u32 v229, v5, 7, v229
s_mul_i32 s41, s49, 0x5800
v_add_u32 v229, s41, v229
s_mov_b32 s63, 0
buffer_load_dword v224, v228, s[8:11], s63 offen
buffer_load_dword v224, v229, s[4:7], 0 offen
s_mov_b32 s44, 0
s_add_u32 m0, s45, 0x1ce00
s_nop 0
buffer_load_dwordx4 v6, s[8:11], s44 offen lds
s_add_u32 m0, s45, 0x1d200
s_nop 0
buffer_load_dwordx4 v7, s[8:11], s44 offen lds
s_add_u32 m0, s45, 0x1d608
s_nop 0
buffer_load_dwordx4 v8, s[8:11], s44 offen lds
s_add_u32 m0, s45, 0x1da08
s_nop 0
buffer_load_dwordx4 v9, s[8:11], s44 offen lds
s_add_u32 m0, s46, 0
s_nop 0
buffer_load_dwordx4 v40, s[4:7], 0 offen lds
s_add_u32 m0, s46, 0x400
s_nop 0
buffer_load_dwordx4 v41, s[4:7], 0 offen lds
s_add_u32 m0, s46, 0x800
s_nop 0
buffer_load_dwordx4 v42, s[4:7], 0 offen lds
s_add_u32 m0, s46, 0xc00
s_nop 0
buffer_load_dwordx4 v43, s[4:7], 0 offen lds
s_getpc_b64 s[98:99]
f_pc:
s_sub_u32 s98, s98, f_pc-f_start
s_subb_u32 s99, s99, 0
s_bfe_u32 s41, s2, 0x20003
s_lshl_b32 s41, s41, 11
v_lshlrev_b32 v227, 7, v2
v_add_u32 v227, s41, v227
s_lshr_b32 s41, s2, 3
s_mul_i32 s41, s41, 0x1800
v_min_u32 v4, 47, v1
v_lshlrev_b32 v4, 7, v4
v_add_u32 v226, s41, v4
v_min_u32 v226, f_end-f_start, v226
v_lshrrev_b32 v4, 5, v1
v_lshlrev_b32 v225, 19, v4
v_bfe_u32 v4, v1, 4, 1
v_lshl_add_u32 v225, v4, 17, v225
v_bfe_u32 v4, v1, 1, 3
v_lshl_add_u32 v225, v4, 11, v225
v_and_b32 v4, 1, v1
v_lshl_add_u32 v225, v4, 7, v225
s_lshl_b32 s41, s48, 14
v_add_u32 v225, s41, v225
v_lshlrev_b32 v232, 7, v1
v_bfe_u32 v5, v1, 1, 4
v_lshlrev_b32 v231, 11, v5
v_lshl_add_u32 v231, v4, 7, v231
s_lshl_b32 s41, s48, 15
v_add_u32 v231, s41, v231
v_lshrrev_b32 v4, 1, v2
v_xor_b32 v4, v3, v4
v_lshlrev_b32 v5, 7, v2
v_lshl_add_u32 v5, v4, 4, v5
v_add_u32 v46, s46, v5
v_xor_b32 v5, 64, v5
v_add_u32 v47, s46, v5
v_lshrrev_b32 v4, 2, v1
v_and_b32 v4, 7, v4
v_lshlrev_b32 v13, 11, v4
v_lshrrev_b32 v5, 1, v4
v_lshl_add_u32 v13, v5, 6, v13
v_and_b32 v5, 1, v4
v_lshl_add_u32 v13, v5, 3, v13
v_lshrrev_b32 v5, 5, v1
v_lshl_add_u32 v13, v5, 10, v13
v_mul_u32_u24 v17, 0x420, v4
v_lshl_add_u32 v17, v5, 8, v17
v_and_b32 v5, 3, v1
v_lshl_add_u32 v13, v5, 4, v13
v_lshl_add_u32 v17, v5, 3, v17
v_and_b32 v4, 7, v1
v_mul_u32_u24 v15, 0x420, v4
v_lshrrev_b32 v4, 3, v2
v_lshl_add_u32 v15, v4, 8, v15
v_lshl_add_u32 v15, v3, 4, v15
v_lshlrev_b32 v31, 11, v3
v_lshl_add_u32 v31, v2, 4, v31
v_lshlrev_b32 v20, 4, v1
v_add_u32 v12, 0x800, v20
v_add_u32 v21, 0x1000, v20
s_lshl_b32 s41, s40, 9
v_add_u32 v31, s41, v31
s_mul_i32 s52, s40, 0x840
v_add_u32 v0, s52, v20
v_add_u32 v23, 0xe000, v0
v_add_u32 v19, 0x1c000, v0
s_lshl_b32 s41, s50, 7
v_lshlrev_b32 v4, 4, v2
v_xor_b32 v4, s41, v4
v_lshl_add_u32 v4, v3, 14, v4
s_lshl_b32 s41, s40, 12
v_add_u32 v10, s41, v4
v_add_u32 v11, 0x800, v10
s_mul_i32 s41, s40, 0x30000
v_lshlrev_b32 v22, 12, v2
v_lshl_add_u32 v22, v3, 4, v22
v_add_u32 v22, s41, v22
v_mov_b32 v24, 0x3f803f80
v_mov_b32 v25, 0x3f803f80
v_mov_b32 v26, 0x3f803f80
v_mov_b32 v27, 0x3f803f80
v_lshlrev_b32 v28, 25, v1
v_mov_b32 v29, 1
v_mov_b32 v30, 0
s_lshl_b32 s41, s48, 4
s_add_u32 s41, s41, s49
s_lshl_b32 s41, s41, 18
s_add_u32 s12, s12, s41
s_addc_u32 s13, s13, 0
s_mov_b32 s14, 0x40000
s_mov_b32 s15, 0x20000
s_add_u32 s16, s16, s41
s_addc_u32 s17, s17, 0
s_mov_b32 s18, 0x40000
s_mov_b32 s19, 0x20000
s_lshl_b32 s41, s47, 3
s_add_u32 s41, s41, s48
s_lshl_b32 s41, s41, 21
s_add_u32 s20, s96, s41
s_addc_u32 s21, s97, 0
s_mov_b32 s22, 0x200000
s_mov_b32 s23, 0x20000
s_mul_i32 s56, s40, 0x1800
s_mul_i32 s41, s50, 0xb0000
s_add_u32 s56, s56, s41
s_lshl_b32 s86, s40, 20
s_lshl_b32 s41, s48, 14
s_add_u32 s86, s86, s41
s_and_b32 s41, s49, 3
s_and_b32 s42, s49, 4
s_and_b32 s72, s49, 7
s_cmp_ge_u32 0, s41
s_addc_u32 s73, s42, 0
s_cmp_ge_u32 1, s41
s_addc_u32 s74, s42, 1
s_cmp_ge_u32 2, s41
s_addc_u32 s75, s42, 2
s_xor_b32 s76, s42, 4
s_mul_i32 s78, s72, 0x16000
s_add_u32 s78, s78, s56
s_lshl_b32 s72, s72, 19
s_mul_i32 s79, s73, 0x16000
s_add_u32 s79, s79, s56
s_lshl_b32 s73, s73, 19
s_mul_i32 s80, s74, 0x16000
s_add_u32 s80, s80, s56
s_lshl_b32 s74, s74, 19
s_mul_i32 s81, s75, 0x16000
s_add_u32 s81, s81, s56
s_lshl_b32 s75, s75, 19
s_mul_i32 s82, s76, 0x16000
s_add_u32 s82, s82, s56
s_lshl_b32 s76, s76, 19
s_lshl_b32 s41, s50, 22
s_lshl_b32 s42, s51, 8
s_add_u32 s41, s41, s42
s_add_u32 s24, s24, s41
s_addc_u32 s25, s25, 0
s_sub_u32 s26, 0x800000, s41
s_mov_b32 s27, 0x20000
s_mul_i32 s41, s48, 0xb0000
s_add_u32 s41, s41, s42
s_lshl_b32 s42, s47, 11
s_add_u32 s41, s41, s42
s_lshl_b32 s42, s50, 7
s_add_u32 s41, s41, s42
s_add_u32 s28, s92, s41
s_addc_u32 s29, s93, 0
s_mov_b32 s30, 0xaf080
s_mov_b32 s31, 0x20000
s_mul_i32 s41, s40, 0x1800
s_add_u32 s41, s41, 0x160000
s_mul_i32 s59, s49, 0x6000
s_add_u32 s59, s59, s41
s_xor_b32 s42, s49, 8
s_mul_i32 s60, s42, 0x6000
s_add_u32 s60, s60, s41
s_lshl_b32 s61, s49, 7
s_add_u32 s61, s61, 0x1c0000
s_lshl_b32 s62, s42, 7
s_add_u32 s62, s62, 0x1c0000
s_mov_b32 s36, s94
s_mov_b32 s37, s95
s_mov_b32 s38, 0x100
s_mov_b32 s39, 0x20000
s_lshl_b32 s58, s48, 1
s_add_u32 s58, s58, s47
s_lshl_b32 s58, s58, 3
s_bfe_u32 s41, s2, 0x10003
s_lshl_b32 s84, s41, 30
s_xor_b32 s85, s84, 0x40000000
s_mov_b32 s32, 0x1c0800
s_cmp_eq_u32 s49, 0
s_cselect_b32 s33, s32, 0x1000000
s_cselect_b32 s34, s58, 0x1000000
s_mov_b32 s44, 0x40000
s_add_u32 m0, s45, 0x21000
s_nop 0
buffer_load_dwordx4 v6, s[8:11], s44 offen lds
s_add_u32 m0, s45, 0x21400
s_nop 0
buffer_load_dwordx4 v7, s[8:11], s44 offen lds
s_add_u32 m0, s45, 0x21808
s_nop 0
buffer_load_dwordx4 v8, s[8:11], s44 offen lds
s_add_u32 m0, s45, 0x21c08
s_nop 0
buffer_load_dwordx4 v9, s[8:11], s44 offen lds
s_add_u32 m0, s46, 0xf80
s_nop 0
buffer_load_dwordx4 v40, s[4:7], 0 offen offset:128 lds
s_add_u32 m0, s46, 0x1380
s_nop 0
buffer_load_dwordx4 v41, s[4:7], 0 offen offset:128 lds
s_add_u32 m0, s46, 0x1780
s_nop 0
buffer_load_dwordx4 v42, s[4:7], 0 offen offset:128 lds
s_add_u32 m0, s46, 0x1b80
s_nop 0
buffer_load_dwordx4 v43, s[4:7], 0 offen offset:128 lds
s_mov_b32 s63, 0x100000
buffer_load_dword v224, v228, s[8:11], s63 offen
s_mov_b32 s44, 0x80000
s_add_u32 m0, s45, 0x10800
s_nop 0
buffer_load_dwordx4 v6, s[8:11], s44 offen lds
s_add_u32 m0, s45, 0x10c00
s_nop 0
buffer_load_dwordx4 v7, s[8:11], s44 offen lds
s_add_u32 m0, s45, 0x11008
s_nop 0
buffer_load_dwordx4 v8, s[8:11], s44 offen lds
s_add_u32 m0, s45, 0x11408
s_nop 0
buffer_load_dwordx4 v9, s[8:11], s44 offen lds
s_mov_b32 s44, 0xc0000
s_add_u32 m0, s45, 0x14a00
s_nop 0
buffer_load_dwordx4 v6, s[8:11], s44 offen lds
s_add_u32 m0, s45, 0x14e00
s_nop 0
buffer_load_dwordx4 v7, s[8:11], s44 offen lds
s_add_u32 m0, s45, 0x15208
s_nop 0
buffer_load_dwordx4 v8, s[8:11], s44 offen lds
s_add_u32 m0, s45, 0x15608
s_nop 0
buffer_load_dwordx4 v9, s[8:11], s44 offen lds
buffer_load_dword v224, v229, s[4:7], 0 offen offset:512
s_mov_b32 s63, 0x200000
buffer_load_dword v224, v228, s[8:11], s63 offen
global_load_dword v224, v226, s[98:99]
buffer_store_dword v30, v28, s[20:23], s61 offen sc1
buffer_store_dword v30, v28, s[20:23], s33 offen sc1
buffer_store_dword v30, v28, s[20:23], s33 offen offset:128 sc1
v_add_u32 v14, 0x1ce00, v13
s_waitcnt vmcnt(23)
s_barrier
TR 48,14,0
TR 50,14,512
TR 52,14,8
TR 54,14,520
RD 0,46,0
RD 4,46,2048
RD 12,47,0
RD 16,47,2048
TR 56,14,64
TR 58,14,576
TR 60,14,72
TR 62,14,584
TR 64,14,128
TR 66,14,640
TR 68,14,136
TR 70,14,648
TR 72,14,192
TR 74,14,704
fl_q0:
s_waitcnt lgkmcnt(13)
Zvaa 64,48,0
s_waitcnt lgkmcnt(12)
s_mov_b32 s44, 0x100000
s_add_u32 m0, s45, 0x18c00
TR 76,14,200
TR 78,14,712
Zvaa 72,48,4
buffer_load_dwordx4 v6, s[8:11], s44 offen lds
Zvaa 76,52,4
s_waitcnt lgkmcnt(10)
s_add_u32 m0, s45, 0x19000
TR 48,14,256
TR 50,14,768
Zvaa 68,52,0
buffer_load_dwordx4 v7, s[8:11], s44 offen lds
Zvaa 80,56,0
s_waitcnt lgkmcnt(10)
s_add_u32 m0, s45, 0x19408
TR 52,14,264
TR 54,14,776
Zvaa 88,56,4
buffer_load_dwordx4 v8, s[8:11], s44 offen lds
Zvaa 92,60,4
s_waitcnt lgkmcnt(10)
s_add_u32 m0, s45, 0x19808
TR 56,14,320
TR 58,14,832
Zvaa 84,60,0
buffer_load_dwordx4 v9, s[8:11], s44 offen lds
Zvaa 96,64,0
s_waitcnt lgkmcnt(10)
s_add_u32 m0, s46, 0xffffff00
TR 60,14,328
TR 62,14,840
Zvaa 104,64,4
buffer_load_dwordx4 v40, s[4:7], 0 offen offset:256 lds
Zvaa 108,68,4
s_waitcnt lgkmcnt(10)
s_add_u32 m0, s46, 0x300
TR 64,14,384
TR 66,14,896
Zvaa 100,68,0
buffer_load_dwordx4 v41, s[4:7], 0 offen offset:256 lds
Zvaa 112,72,0
s_waitcnt lgkmcnt(10)
s_add_u32 m0, s46, 0x700
TR 68,14,392
TR 70,14,904
Zvaa 120,72,4
buffer_load_dwordx4 v42, s[4:7], 0 offen offset:256 lds
Zvaa 124,76,4
s_waitcnt lgkmcnt(10)
s_add_u32 m0, s46, 0xb00
TR 72,14,448
TR 74,14,960
Zvaa 116,76,0
buffer_load_dwordx4 v43, s[4:7], 0 offen offset:256 lds
Zvaa 128,48,0
TR 76,14,456
TR 78,14,968
Zvaa 136,48,4
s_waitcnt lgkmcnt(12)
Zvaa 140,52,4
Zvaa 132,52,0
s_waitcnt lgkmcnt(10)
Zvaa 144,56,0
Zvaa 152,56,4
s_waitcnt lgkmcnt(8)
Zvaa 156,60,4
v_add_u32 v14, 0x21000, v13
Zvaa 148,60,0
s_waitcnt vmcnt(27) lgkmcnt(0)
s_barrier
Zvaa 160,64,0
TR 48,14,0
TR 50,14,512
Zvaa 168,64,4
TR 52,14,8
TR 54,14,520
Zvaa 172,68,4
TR 56,14,64
TR 58,14,576
Zvaa 164,68,0
TR 60,14,72
TR 62,14,584
Zvaa 176,72,0
TR 64,14,128
TR 66,14,640
Zvaa 184,72,4
TR 68,14,136
TR 70,14,648
Zvaa 188,76,4
TR 72,14,192
TR 74,14,704
Zvaa 180,76,0
s_waitcnt lgkmcnt(12)
fl_q1:
Mvaa 64,48,12
s_waitcnt lgkmcnt(10)
s_mov_b32 s44, 0x140000
s_add_u32 m0, s45, 0x1ce00
TR 76,14,200
TR 78,14,712
Mvaa 72,48,16
buffer_load_dwordx4 v6, s[8:11], s44 offen lds
Mvaa 76,52,16
s_waitcnt lgkmcnt(10)
s_add_u32 m0, s45, 0x1d200
TR 48,14,256
TR 50,14,768
Mvaa 68,52,12
buffer_load_dwordx4 v7, s[8:11], s44 offen lds
Mvaa 80,56,12
s_waitcnt lgkmcnt(10)
s_add_u32 m0, s45, 0x1d608
TR 52,14,264
TR 54,14,776
Mvaa 88,56,16
buffer_load_dwordx4 v8, s[8:11], s44 offen lds
Mvaa 92,60,16
s_waitcnt lgkmcnt(10)
s_add_u32 m0, s45, 0x1da08
TR 56,14,320
TR 58,14,832
Mvaa 84,60,12
buffer_load_dwordx4 v9, s[8:11], s44 offen lds
Mvaa 96,64,12
TR 60,14,328
TR 62,14,840
Mvaa 104,64,16
s_waitcnt vmcnt(27) lgkmcnt(12)
RD 24,46,4096
Mvaa 108,68,16
TR 64,14,384
TR 66,14,896
Mvaa 100,68,12
s_waitcnt lgkmcnt(13)
RD 28,46,6144
Mvaa 112,72,12
TR 68,14,392
TR 70,14,904
Mvaa 120,72,16
s_waitcnt lgkmcnt(14)
RD 36,47,4096
Mvaa 124,76,16
TR 72,14,448
TR 74,14,960
Mvaa 116,76,12
s_waitcnt lgkmcnt(15)
RD 40,47,6144
Mvaa 128,48,12
TR 76,14,456
TR 78,14,968
Mvaa 136,48,16
s_waitcnt lgkmcnt(15)
Mvaa 140,52,16
Mvaa 132,52,12
s_waitcnt lgkmcnt(14)
Mvaa 144,56,12
Mvaa 152,56,16
s_waitcnt lgkmcnt(12)
Mvaa 156,60,16
v_add_u32 v14, 0x10800, v13
Mvaa 148,60,12
s_waitcnt vmcnt(22) lgkmcnt(0)
s_barrier
Mvaa 160,64,12
TR 48,14,0
TR 50,14,512
Mvaa 168,64,16
TR 52,14,8
TR 54,14,520
Mvaa 172,68,16
TR 56,14,64
TR 58,14,576
Mvaa 164,68,12
TR 60,14,72
TR 62,14,584
Mvaa 176,72,12
TR 64,14,128
TR 66,14,640
Mvaa 184,72,16
TR 68,14,136
TR 70,14,648
Mvaa 188,76,16
TR 72,14,192
TR 74,14,704
Mvaa 180,76,12
s_waitcnt lgkmcnt(12)
fl_q2:
Mvaa 64,48,24
s_waitcnt lgkmcnt(10)
TR 76,14,200
TR 78,14,712
v_add_u32 v226, ((fh_q2-f_start+5120)&0xffffff80), v227
v_min_u32 v226, f_end-f_start, v226
Mvaa 72,48,28
global_load_dword v224, v226, s[98:99]
Mvaa 76,52,28
s_waitcnt lgkmcnt(10)
TR 48,14,256
TR 50,14,768
v_add_u32 v226, ((fl_q2-f_start+5120)&0xffffff80), v227
v_min_u32 v226, f_end-f_start, v226
Mvaa 68,52,24
global_load_dword v224, v226, s[98:99]
Mvaa 80,56,24
s_waitcnt lgkmcnt(10)
s_mov_b32 s44, 0x180000
s_add_u32 m0, s45, 0x21000
TR 52,14,264
TR 54,14,776
Mvaa 88,56,28
buffer_load_dwordx4 v6, s[8:11], s44 offen lds
Mvaa 92,60,28
s_waitcnt lgkmcnt(10)
s_add_u32 m0, s45, 0x21400
TR 56,14,320
TR 58,14,832
Mvaa 84,60,24
buffer_load_dwordx4 v7, s[8:11], s44 offen lds
Mvaa 96,64,24
s_waitcnt lgkmcnt(10)
s_add_u32 m0, s45, 0x21808
TR 60,14,328
TR 62,14,840
Mvaa 104,64,28
buffer_load_dwordx4 v8, s[8:11], s44 offen lds
Mvaa 108,68,28
s_waitcnt lgkmcnt(10)
s_add_u32 m0, s45, 0x21c08
TR 64,14,384
TR 66,14,896
Mvaa 100,68,24
buffer_load_dwordx4 v9, s[8:11], s44 offen lds
Mvaa 112,72,24
s_waitcnt lgkmcnt(10)
s_add_u32 m0, s46, 0xe80
TR 68,14,392
TR 70,14,904
Mvaa 120,72,28
buffer_load_dwordx4 v40, s[4:7], 0 offen offset:384 lds
Mvaa 124,76,28
s_waitcnt lgkmcnt(10)
s_add_u32 m0, s46, 0x1280
TR 72,14,448
TR 74,14,960
Mvaa 116,76,24
buffer_load_dwordx4 v41, s[4:7], 0 offen offset:384 lds
Mvaa 128,48,24
s_waitcnt lgkmcnt(10)
s_add_u32 m0, s46, 0x1680
TR 76,14,456
TR 78,14,968
Mvaa 136,48,28
buffer_load_dwordx4 v42, s[4:7], 0 offen offset:384 lds
Mvaa 140,52,28
s_waitcnt lgkmcnt(10)
s_add_u32 m0, s46, 0x1a80
Mvaa 132,52,24
buffer_load_dwordx4 v43, s[4:7], 0 offen offset:384 lds
Mvaa 144,56,24
Mvaa 152,56,28
s_waitcnt lgkmcnt(8)
Mvaa 156,60,28
v_add_u32 v14, 0x14a00, v13
Mvaa 148,60,24
s_waitcnt vmcnt(28) lgkmcnt(0)
s_barrier
Mvaa 160,64,24
TR 48,14,0
TR 50,14,512
Mvaa 168,64,28
TR 52,14,8
TR 54,14,520
Mvaa 172,68,28
TR 56,14,64
TR 58,14,576
Mvaa 164,68,24
TR 60,14,72
TR 62,14,584
Mvaa 176,72,24
TR 64,14,128
TR 66,14,640
Mvaa 184,72,28
TR 68,14,136
TR 70,14,648
Mvaa 188,76,28
TR 72,14,192
TR 74,14,704
Mvaa 180,76,24
s_waitcnt lgkmcnt(12)
fl_q3:
Mvaa 64,48,36
s_waitcnt lgkmcnt(10)
s_mov_b32 s63, 0x300000
TR 76,14,200
TR 78,14,712
Mvaa 72,48,40
buffer_load_dword v224, v228, s[8:11], s63 offen
Mvaa 76,52,40
s_waitcnt lgkmcnt(10)
s_add_u32 m0, s52, 0x25200
TR 48,14,256
TR 50,14,768
Mvaa 68,52,36
buffer_load_dwordx4 v31, s[12:15], 0 offen nt lds
Mvaa 80,56,36
s_waitcnt lgkmcnt(10)
s_add_u32 m0, s52, 0x25520
TR 52,14,264
TR 54,14,776
Mvaa 88,56,40
buffer_load_dwordx4 v31, s[12:15], 0 offen offset:256 nt lds
Mvaa 92,60,40
s_waitcnt lgkmcnt(10)
s_mov_b32 s3, 0x2000
s_add_u32 m0, s52, 0
TR 56,14,320
TR 58,14,832
Mvaa 84,60,36
buffer_load_dwordx4 v31, s[12:15], s3 offen nt lds
Mvaa 96,64,36
s_waitcnt lgkmcnt(10)
s_add_u32 m0, s52, 0x320
TR 60,14,328
TR 62,14,840
Mvaa 104,64,40
buffer_load_dwordx4 v31, s[12:15], s3 offen offset:256 nt lds
Mvaa 108,68,40
s_waitcnt lgkmcnt(10)
s_mov_b32 s44, 0x1c0000
s_add_u32 m0, s45, 0x10800
TR 64,14,384
TR 66,14,896
Mvaa 100,68,36
buffer_load_dwordx4 v6, s[8:11], s44 offen lds
Mvaa 112,72,36
s_waitcnt lgkmcnt(10)
s_add_u32 m0, s45, 0x10c00
TR 68,14,392
TR 70,14,904
Mvaa 120,72,40
buffer_load_dwordx4 v7, s[8:11], s44 offen lds
Mvaa 124,76,40
s_waitcnt lgkmcnt(10)
s_add_u32 m0, s45, 0x11008
TR 72,14,448
TR 74,14,960
Mvaa 116,76,36
buffer_load_dwordx4 v8, s[8:11], s44 offen lds
Mvaa 128,48,36
s_waitcnt lgkmcnt(10)
s_add_u32 m0, s45, 0x11408
TR 76,14,456
TR 78,14,968
Mvaa 136,48,40
buffer_load_dwordx4 v9, s[8:11], s44 offen lds
Mvaa 140,52,40
s_waitcnt vmcnt(23)
RD 0,46,0
Mvaa 132,52,36
s_waitcnt lgkmcnt(11)
RD 4,46,2048
Mvaa 144,56,36
RD 12,47,0
Mvaa 152,56,40
s_waitcnt lgkmcnt(11)
RD 16,47,2048
Mvaa 156,60,40
v_add_u32 v14, 0x18c00, v13
Mvaa 148,60,36
s_waitcnt vmcnt(27) lgkmcnt(0)
s_barrier
Mvaa 160,64,36
TR 48,14,0
TR 50,14,512
Mvaa 168,64,40
TR 52,14,8
TR 54,14,520
Mvaa 172,68,40
TR 56,14,64
TR 58,14,576
Mvaa 164,68,36
TR 60,14,72
TR 62,14,584
Mvaa 176,72,36
TR 64,14,128
TR 66,14,640
Mvaa 184,72,40
TR 68,14,136
TR 70,14,648
Mvaa 188,76,40
TR 72,14,192
TR 74,14,704
Mvaa 180,76,36
s_waitcnt lgkmcnt(12)
fl_q4:
Mvaa 64,48,0
s_waitcnt lgkmcnt(10)
s_mov_b32 s44, 0x200000
s_add_u32 m0, s45, 0x14a00
TR 76,14,200
TR 78,14,712
Mvaa 72,48,4
buffer_load_dwordx4 v6, s[8:11], s44 offen lds
Mvaa 76,52,4
s_waitcnt lgkmcnt(10)
s_add_u32 m0, s45, 0x14e00
TR 48,14,256
TR 50,14,768
Mvaa 68,52,0
buffer_load_dwordx4 v7, s[8:11], s44 offen lds
Mvaa 80,56,0
s_waitcnt lgkmcnt(10)
s_add_u32 m0, s45, 0x15208
TR 52,14,264
TR 54,14,776
Mvaa 88,56,4
buffer_load_dwordx4 v8, s[8:11], s44 offen lds
Mvaa 92,60,4
s_waitcnt lgkmcnt(10)
s_add_u32 m0, s45, 0x15608
TR 56,14,320
TR 58,14,832
Mvaa 84,60,0
buffer_load_dwordx4 v9, s[8:11], s44 offen lds
Mvaa 96,64,0
s_waitcnt lgkmcnt(10)
s_add_u32 m0, s46, 0xfffffe00
TR 60,14,328
TR 62,14,840
Mvaa 104,64,4
buffer_load_dwordx4 v40, s[4:7], 0 offen offset:512 lds
Mvaa 108,68,4
s_waitcnt lgkmcnt(10)
s_add_u32 m0, s46, 0x200
TR 64,14,384
TR 66,14,896
Mvaa 100,68,0
buffer_load_dwordx4 v41, s[4:7], 0 offen offset:512 lds
Mvaa 112,72,0
s_waitcnt lgkmcnt(10)
s_add_u32 m0, s46, 0x600
TR 68,14,392
TR 70,14,904
Mvaa 120,72,4
buffer_load_dwordx4 v42, s[4:7], 0 offen offset:512 lds
Mvaa 124,76,4
s_waitcnt lgkmcnt(10)
s_add_u32 m0, s46, 0xa00
TR 72,14,448
TR 74,14,960
Mvaa 116,76,0
buffer_load_dwordx4 v43, s[4:7], 0 offen offset:512 lds
Mvaa 128,48,0
TR 76,14,456
TR 78,14,968
Mvaa 136,48,4
s_waitcnt lgkmcnt(12)
Mvaa 140,52,4
Mvaa 132,52,0
s_waitcnt lgkmcnt(10)
Mvaa 144,56,0
Mvaa 152,56,4
s_waitcnt lgkmcnt(8)
Mvaa 156,60,4
v_add_u32 v14, 0x1ce00, v13
Mvaa 148,60,0
s_waitcnt vmcnt(27) lgkmcnt(0)
s_barrier
s_waitcnt vmcnt(39)
buffer_store_dword v29, v28, s[36:39], s34 offen sc1
Mvaa 160,64,0
TR 48,14,0
TR 50,14,512
Mvaa 168,64,4
TR 52,14,8
TR 54,14,520
Mvaa 172,68,4
TR 56,14,64
TR 58,14,576
Mvaa 164,68,0
TR 60,14,72
TR 62,14,584
Mvaa 176,72,0
TR 64,14,128
TR 66,14,640
Mvaa 184,72,4
TR 68,14,136
TR 70,14,648
Mvaa 188,76,4
TR 72,14,192
TR 74,14,704
Mvaa 180,76,0
s_waitcnt lgkmcnt(12)
fl_q5:
Mvaa 64,48,12
s_waitcnt lgkmcnt(10)
TR 76,14,200
TR 78,14,712
Mvaa 72,48,16
buffer_load_dword v224, v229, s[4:7], 0 offen offset:1024
Mvaa 76,52,16
s_waitcnt lgkmcnt(10)
s_mov_b32 s3, 0
s_add_u32 m0, s52, 0x2100
TR 48,14,256
TR 50,14,768
Mvaa 68,52,12
buffer_load_dwordx4 v31, s[16:19], s3 offen nt lds
Mvaa 80,56,12
s_waitcnt lgkmcnt(10)
s_add_u32 m0, s52, 0x2420
TR 52,14,264
TR 54,14,776
Mvaa 88,56,16
buffer_load_dwordx4 v31, s[16:19], s3 offen offset:256 nt lds
Mvaa 92,60,16
s_waitcnt lgkmcnt(10)
s_mov_b32 s3, 0x4000
TR 56,14,320
TR 58,14,832
Mvaa 84,60,12
buffer_load_dwordx4 a[80:83], v31, s[12:15], s3 offen nt
Mvaa 96,64,12
s_waitcnt lgkmcnt(10)
TR 60,14,328
TR 62,14,840
Mvaa 104,64,16
buffer_load_dwordx4 a[84:87], v31, s[12:15], s3 offen offset:256 nt
Mvaa 108,68,16
s_waitcnt lgkmcnt(10)
s_mov_b32 s44, 0x240000
s_add_u32 m0, s45, 0x18c00
TR 64,14,384
TR 66,14,896
Mvaa 100,68,12
buffer_load_dwordx4 v6, s[8:11], s44 offen lds
Mvaa 112,72,12
s_waitcnt lgkmcnt(10)
s_add_u32 m0, s45, 0x19000
TR 68,14,392
TR 70,14,904
Mvaa 120,72,16
buffer_load_dwordx4 v7, s[8:11], s44 offen lds
Mvaa 124,76,16
s_waitcnt lgkmcnt(10)
s_add_u32 m0, s45, 0x19408
TR 72,14,448
TR 74,14,960
Mvaa 116,76,12
buffer_load_dwordx4 v8, s[8:11], s44 offen lds
Mvaa 128,48,12
s_waitcnt lgkmcnt(10)
s_add_u32 m0, s45, 0x19808
TR 76,14,456
TR 78,14,968
Mvaa 136,48,16
buffer_load_dwordx4 v9, s[8:11], s44 offen lds
Mvaa 140,52,16
s_waitcnt vmcnt(27)
RD 24,46,4096
Mvaa 132,52,12
s_waitcnt lgkmcnt(11)
RD 28,46,6144
Mvaa 144,56,12
RD 36,47,4096
Mvaa 152,56,16
s_waitcnt lgkmcnt(11)
RD 40,47,6144
Mvaa 156,60,16
v_add_u32 v14, 0x21000, v13
Mvaa 148,60,12
s_waitcnt vmcnt(31) lgkmcnt(0)
s_barrier
Mvaa 160,64,12
TR 48,14,0
TR 50,14,512
Mvaa 168,64,16
TR 52,14,8
TR 54,14,520
Mvaa 172,68,16
TR 56,14,64
TR 58,14,576
Mvaa 164,68,12
TR 60,14,72
TR 62,14,584
Mvaa 176,72,12
TR 64,14,128
TR 66,14,640
Mvaa 184,72,16
TR 68,14,136
TR 70,14,648
Mvaa 188,76,16
TR 72,14,192
TR 74,14,704
Mvaa 180,76,12
s_waitcnt lgkmcnt(12)
fl_q6:
Mvaa 64,48,24
s_waitcnt lgkmcnt(10)
s_mov_b32 s44, 0x280000
s_add_u32 m0, s45, 0x1ce00
TR 76,14,200
TR 78,14,712
Mvaa 72,48,28
buffer_load_dwordx4 v6, s[8:11], s44 offen lds
Mvaa 76,52,28
s_waitcnt lgkmcnt(10)
s_add_u32 m0, s45, 0x1d200
TR 48,14,256
TR 50,14,768
Mvaa 68,52,24
buffer_load_dwordx4 v7, s[8:11], s44 offen lds
Mvaa 80,56,24
s_waitcnt lgkmcnt(10)
s_add_u32 m0, s45, 0x1d608
TR 52,14,264
TR 54,14,776
Mvaa 88,56,28
buffer_load_dwordx4 v8, s[8:11], s44 offen lds
Mvaa 92,60,28
s_waitcnt lgkmcnt(10)
s_add_u32 m0, s45, 0x1da08
TR 56,14,320
TR 58,14,832
Mvaa 84,60,24
buffer_load_dwordx4 v9, s[8:11], s44 offen lds
Mvaa 96,64,24
s_waitcnt lgkmcnt(10)
s_add_u32 m0, s46, 0xd80
TR 60,14,328
TR 62,14,840
Mvaa 104,64,28
buffer_load_dwordx4 v40, s[4:7], 0 offen offset:640 lds
Mvaa 108,68,28
s_waitcnt lgkmcnt(10)
s_add_u32 m0, s46, 0x1180
TR 64,14,384
TR 66,14,896
Mvaa 100,68,24
buffer_load_dwordx4 v41, s[4:7], 0 offen offset:640 lds
Mvaa 112,72,24
s_waitcnt lgkmcnt(10)
s_add_u32 m0, s46, 0x1580
TR 68,14,392
TR 70,14,904
Mvaa 120,72,28
buffer_load_dwordx4 v42, s[4:7], 0 offen offset:640 lds
Mvaa 124,76,28
s_waitcnt lgkmcnt(10)
s_add_u32 m0, s46, 0x1980
TR 72,14,448
TR 74,14,960
Mvaa 116,76,24
buffer_load_dwordx4 v43, s[4:7], 0 offen offset:640 lds
Mvaa 128,48,24
TR 76,14,456
TR 78,14,968
Mvaa 136,48,28
s_waitcnt lgkmcnt(12)
Mvaa 140,52,28
Mvaa 132,52,24
s_waitcnt lgkmcnt(10)
Mvaa 144,56,24
Mvaa 152,56,28
s_waitcnt lgkmcnt(8)
Mvaa 156,60,28
v_add_u32 v14, 0x10800, v13
Mvaa 148,60,24
s_waitcnt vmcnt(26) lgkmcnt(0)
s_barrier
Mvaa 160,64,24
TR 48,14,0
TR 50,14,512
Mvaa 168,64,28
TR 52,14,8
TR 54,14,520
Mvaa 172,68,28
TR 56,14,64
TR 58,14,576
Mvaa 164,68,24
TR 60,14,72
TR 62,14,584
Mvaa 176,72,24
TR 64,14,128
TR 66,14,640
Mvaa 184,72,28
TR 68,14,136
TR 70,14,648
Mvaa 188,76,28
TR 72,14,192
TR 74,14,704
Mvaa 180,76,24
s_waitcnt lgkmcnt(12)
fl_q7:
Mvaa 64,48,36
s_waitcnt lgkmcnt(10)
s_mov_b32 s63, 0x400000
TR 76,14,200
TR 78,14,712
Mvaa 72,48,40
buffer_load_dword v224, v228, s[8:11], s63 offen
Mvaa 76,52,40
s_waitcnt lgkmcnt(10)
s_mov_b32 s3, 0x2000
TR 48,14,256
TR 50,14,768
Mvaa 68,52,36
buffer_load_dwordx4 a[88:91], v31, s[16:19], s3 offen nt
Mvaa 80,56,36
s_waitcnt lgkmcnt(10)
TR 52,14,264
TR 54,14,776
Mvaa 88,56,40
buffer_load_dwordx4 a[92:95], v31, s[16:19], s3 offen offset:256 nt
Mvaa 92,60,40
s_waitcnt lgkmcnt(10)
s_mov_b32 s3, 0x6000
TR 56,14,320
TR 58,14,832
Mvaa 84,60,36
buffer_load_dwordx4 a[96:99], v31, s[12:15], s3 offen nt
Mvaa 96,64,36
s_waitcnt lgkmcnt(10)
TR 60,14,328
TR 62,14,840
Mvaa 104,64,40
buffer_load_dwordx4 a[100:103], v31, s[12:15], s3 offen offset:256 nt
Mvaa 108,68,40
s_waitcnt lgkmcnt(10)
s_mov_b32 s44, 0x2c0000
s_add_u32 m0, s45, 0x21000
TR 64,14,384
TR 66,14,896
Mvaa 100,68,36
buffer_load_dwordx4 v6, s[8:11], s44 offen lds
Mvaa 112,72,36
s_waitcnt lgkmcnt(10)
s_add_u32 m0, s45, 0x21400
TR 68,14,392
TR 70,14,904
Mvaa 120,72,40
buffer_load_dwordx4 v7, s[8:11], s44 offen lds
Mvaa 124,76,40
s_waitcnt lgkmcnt(10)
s_add_u32 m0, s45, 0x21808
TR 72,14,448
TR 74,14,960
Mvaa 116,76,36
buffer_load_dwordx4 v8, s[8:11], s44 offen lds
Mvaa 128,48,36
s_waitcnt lgkmcnt(10)
s_add_u32 m0, s45, 0x21c08
TR 76,14,456
TR 78,14,968
Mvaa 136,48,40
buffer_load_dwordx4 v9, s[8:11], s44 offen lds
Mvaa 140,52,40
s_waitcnt vmcnt(27)
RD 0,46,0
Mvaa 132,52,36
s_waitcnt lgkmcnt(11)
RD 4,46,2048
Mvaa 144,56,36
RD 12,47,0
Mvaa 152,56,40
s_waitcnt lgkmcnt(11)
RD 16,47,2048
Mvaa 156,60,40
v_add_u32 v14, 0x14a00, v13
Mvaa 148,60,36
s_waitcnt vmcnt(31) lgkmcnt(0)
s_barrier
Mvaa 160,64,36
TR 48,14,0
TR 50,14,512
Mvaa 168,64,40
TR 52,14,8
TR 54,14,520
Mvaa 172,68,40
TR 56,14,64
TR 58,14,576
Mvaa 164,68,36
TR 60,14,72
TR 62,14,584
Mvaa 176,72,36
TR 64,14,128
TR 66,14,640
Mvaa 184,72,40
TR 68,14,136
TR 70,14,648
Mvaa 188,76,40
TR 72,14,192
TR 74,14,704
Mvaa 180,76,36
s_waitcnt lgkmcnt(12)
fl_q8:
Mvaa 64,48,0
s_waitcnt lgkmcnt(10)
s_mov_b32 s44, 0x300000
s_add_u32 m0, s45, 0x10800
TR 76,14,200
TR 78,14,712
Mvaa 72,48,4
buffer_load_dwordx4 v6, s[8:11], s44 offen lds
Mvaa 76,52,4
s_waitcnt lgkmcnt(10)
s_add_u32 m0, s45, 0x10c00
TR 48,14,256
TR 50,14,768
Mvaa 68,52,0
buffer_load_dwordx4 v7, s[8:11], s44 offen lds
Mvaa 80,56,0
s_waitcnt lgkmcnt(10)
s_add_u32 m0, s45, 0x11008
TR 52,14,264
TR 54,14,776
Mvaa 88,56,4
buffer_load_dwordx4 v8, s[8:11], s44 offen lds
Mvaa 92,60,4
s_waitcnt lgkmcnt(10)
s_add_u32 m0, s45, 0x11408
TR 56,14,320
TR 58,14,832
Mvaa 84,60,0
buffer_load_dwordx4 v9, s[8:11], s44 offen lds
Mvaa 96,64,0
s_waitcnt lgkmcnt(10)
s_add_u32 m0, s46, 0xfffffd00
TR 60,14,328
TR 62,14,840
Mvaa 104,64,4
buffer_load_dwordx4 v40, s[4:7], 0 offen offset:768 lds
Mvaa 108,68,4
s_waitcnt lgkmcnt(10)
s_add_u32 m0, s46, 0x100
TR 64,14,384
TR 66,14,896
Mvaa 100,68,0
buffer_load_dwordx4 v41, s[4:7], 0 offen offset:768 lds
Mvaa 112,72,0
s_waitcnt lgkmcnt(10)
s_add_u32 m0, s46, 0x500
TR 68,14,392
TR 70,14,904
Mvaa 120,72,4
buffer_load_dwordx4 v42, s[4:7], 0 offen offset:768 lds
Mvaa 124,76,4
s_waitcnt lgkmcnt(10)
s_add_u32 m0, s46, 0x900
TR 72,14,448
TR 74,14,960
Mvaa 116,76,0
buffer_load_dwordx4 v43, s[4:7], 0 offen offset:768 lds
Mvaa 128,48,0
TR 76,14,456
TR 78,14,968
Mvaa 136,48,4
s_waitcnt lgkmcnt(12)
Mvaa 140,52,4
Mvaa 132,52,0
s_waitcnt lgkmcnt(10)
Mvaa 144,56,0
Mvaa 152,56,4
s_waitcnt lgkmcnt(8)
Mvaa 156,60,4
v_add_u32 v14, 0x18c00, v13
Mvaa 148,60,0
s_waitcnt vmcnt(25) lgkmcnt(0)
s_barrier
Mvaa 160,64,0
TR 48,14,0
TR 50,14,512
Mvaa 168,64,4
TR 52,14,8
TR 54,14,520
Mvaa 172,68,4
TR 56,14,64
TR 58,14,576
Mvaa 164,68,0
TR 60,14,72
TR 62,14,584
Mvaa 176,72,0
TR 64,14,128
TR 66,14,640
Mvaa 184,72,4
TR 68,14,136
TR 70,14,648
Mvaa 188,76,4
TR 72,14,192
TR 74,14,704
Mvaa 180,76,0
s_waitcnt lgkmcnt(12)
fl_q9:
Mvaa 64,48,12
s_waitcnt lgkmcnt(10)
s_mov_b32 s63, 0
TR 76,14,200
TR 78,14,712
Mvaa 72,48,16
buffer_load_dword v224, v225, s[24:27], s63 offen
Mvaa 76,52,16
s_waitcnt lgkmcnt(10)
s_mov_b32 s3, 0x4000
TR 48,14,256
TR 50,14,768
Mvaa 68,52,12
buffer_load_dwordx4 a[104:107], v31, s[16:19], s3 offen nt
Mvaa 80,56,12
s_waitcnt lgkmcnt(10)
TR 52,14,264
TR 54,14,776
Mvaa 88,56,16
buffer_load_dwordx4 a[108:111], v31, s[16:19], s3 offen offset:256 nt
Mvaa 92,60,16
s_waitcnt lgkmcnt(10)
s_mov_b32 s3, 0x8000
TR 56,14,320
TR 58,14,832
Mvaa 84,60,12
buffer_load_dwordx4 a[112:115], v31, s[12:15], s3 offen nt
Mvaa 96,64,12
s_waitcnt lgkmcnt(10)
TR 60,14,328
TR 62,14,840
Mvaa 104,64,16
buffer_load_dwordx4 a[116:119], v31, s[12:15], s3 offen offset:256 nt
Mvaa 108,68,16
s_waitcnt lgkmcnt(10)
s_mov_b32 s44, 0x340000
s_add_u32 m0, s45, 0x14a00
TR 64,14,384
TR 66,14,896
Mvaa 100,68,12
buffer_load_dwordx4 v6, s[8:11], s44 offen lds
Mvaa 112,72,12
s_waitcnt lgkmcnt(10)
s_add_u32 m0, s45, 0x14e00
TR 68,14,392
TR 70,14,904
Mvaa 120,72,16
buffer_load_dwordx4 v7, s[8:11], s44 offen lds
Mvaa 124,76,16
s_waitcnt lgkmcnt(10)
s_add_u32 m0, s45, 0x15208
TR 72,14,448
TR 74,14,960
Mvaa 116,76,12
buffer_load_dwordx4 v8, s[8:11], s44 offen lds
Mvaa 128,48,12
s_waitcnt lgkmcnt(10)
s_add_u32 m0, s45, 0x15608
TR 76,14,456
TR 78,14,968
Mvaa 136,48,16
buffer_load_dwordx4 v9, s[8:11], s44 offen lds
Mvaa 140,52,16
s_waitcnt vmcnt(26)
RD 24,46,4096
Mvaa 132,52,12
s_waitcnt lgkmcnt(11)
RD 28,46,6144
Mvaa 144,56,12
RD 36,47,4096
Mvaa 152,56,16
s_waitcnt lgkmcnt(11)
RD 40,47,6144
Mvaa 156,60,16
v_add_u32 v14, 0x1ce00, v13
Mvaa 148,60,12
s_waitcnt vmcnt(30) lgkmcnt(0)
s_barrier
Mvaa 160,64,12
TR 48,14,0
TR 50,14,512
Mvaa 168,64,16
TR 52,14,8
TR 54,14,520
Mvaa 172,68,16
TR 56,14,64
TR 58,14,576
Mvaa 164,68,12
TR 60,14,72
TR 62,14,584
Mvaa 176,72,12
TR 64,14,128
TR 66,14,640
Mvaa 184,72,16
TR 68,14,136
TR 70,14,648
Mvaa 188,76,16
TR 72,14,192
TR 74,14,704
Mvaa 180,76,12
s_waitcnt lgkmcnt(12)
fl_q10:
Mvaa 64,48,24
s_waitcnt lgkmcnt(10)
TR 76,14,200
TR 78,14,712
v_add_u32 v226, ((fh_q10-f_start+5120)&0xffffff80), v227
v_min_u32 v226, f_end-f_start, v226
Mvaa 72,48,28
global_load_dword v224, v226, s[98:99]
Mvaa 76,52,28
s_waitcnt lgkmcnt(10)
TR 48,14,256
TR 50,14,768
v_add_u32 v226, ((fl_q10-f_start+5120)&0xffffff80), v227
v_min_u32 v226, f_end-f_start, v226
Mvaa 68,52,24
global_load_dword v224, v226, s[98:99]
Mvaa 80,56,24
s_waitcnt lgkmcnt(10)
s_mov_b32 s44, 0x380000
s_add_u32 m0, s45, 0x18c00
TR 52,14,264
TR 54,14,776
Mvaa 88,56,28
buffer_load_dwordx4 v6, s[8:11], s44 offen lds
Mvaa 92,60,28
s_waitcnt lgkmcnt(10)
s_add_u32 m0, s45, 0x19000
TR 56,14,320
TR 58,14,832
Mvaa 84,60,24
buffer_load_dwordx4 v7, s[8:11], s44 offen lds
Mvaa 96,64,24
s_waitcnt lgkmcnt(10)
s_add_u32 m0, s45, 0x19408
TR 60,14,328
TR 62,14,840
Mvaa 104,64,28
buffer_load_dwordx4 v8, s[8:11], s44 offen lds
Mvaa 108,68,28
s_waitcnt lgkmcnt(10)
s_add_u32 m0, s45, 0x19808
TR 64,14,384
TR 66,14,896
Mvaa 100,68,24
buffer_load_dwordx4 v9, s[8:11], s44 offen lds
Mvaa 112,72,24
s_waitcnt lgkmcnt(10)
s_add_u32 m0, s46, 0xc80
TR 68,14,392
TR 70,14,904
Mvaa 120,72,28
buffer_load_dwordx4 v40, s[4:7], 0 offen offset:896 lds
Mvaa 124,76,28
s_waitcnt lgkmcnt(10)
s_add_u32 m0, s46, 0x1080
TR 72,14,448
TR 74,14,960
Mvaa 116,76,24
buffer_load_dwordx4 v41, s[4:7], 0 offen offset:896 lds
Mvaa 128,48,24
s_waitcnt lgkmcnt(10)
s_add_u32 m0, s46, 0x1480
TR 76,14,456
TR 78,14,968
Mvaa 136,48,28
buffer_load_dwordx4 v42, s[4:7], 0 offen offset:896 lds
Mvaa 140,52,28
s_waitcnt lgkmcnt(10)
s_add_u32 m0, s46, 0x1880
Mvaa 132,52,24
buffer_load_dwordx4 v43, s[4:7], 0 offen offset:896 lds
Mvaa 144,56,24
Mvaa 152,56,28
s_waitcnt lgkmcnt(8)
Mvaa 156,60,28
v_add_u32 v14, 0x21000, v13
Mvaa 148,60,24
s_waitcnt vmcnt(27) lgkmcnt(0)
s_barrier
Mvaa 160,64,24
TR 48,14,0
TR 50,14,512
Mvaa 168,64,28
TR 52,14,8
TR 54,14,520
Mvaa 172,68,28
TR 56,14,64
TR 58,14,576
Mvaa 164,68,24
TR 60,14,72
TR 62,14,584
Mvaa 176,72,24
TR 64,14,128
TR 66,14,640
Mvaa 184,72,28
TR 68,14,136
TR 70,14,648
Mvaa 188,76,28
TR 72,14,192
TR 74,14,704
Mvaa 180,76,24
s_waitcnt lgkmcnt(12)
fl_q11:
Mvaa 64,48,36
s_waitcnt lgkmcnt(10)
s_mov_b32 s63, 0x500000
TR 76,14,200
TR 78,14,712
Mvaa 72,48,40
buffer_load_dword v224, v228, s[8:11], s63 offen
Mvaa 76,52,40
s_waitcnt lgkmcnt(10)
s_mov_b32 s3, 0x6000
TR 48,14,256
TR 50,14,768
Mvaa 68,52,36
buffer_load_dwordx4 a[120:123], v31, s[16:19], s3 offen nt
Mvaa 80,56,36
s_waitcnt lgkmcnt(10)
TR 52,14,264
TR 54,14,776
Mvaa 88,56,40
buffer_load_dwordx4 a[124:127], v31, s[16:19], s3 offen offset:256 nt
Mvaa 92,60,40
s_waitcnt lgkmcnt(10)
s_mov_b32 s3, 0xa000
TR 56,14,320
TR 58,14,832
Mvaa 84,60,36
buffer_load_dwordx4 a[128:131], v31, s[12:15], s3 offen nt
Mvaa 96,64,36
s_waitcnt lgkmcnt(10)
TR 60,14,328
TR 62,14,840
Mvaa 104,64,40
buffer_load_dwordx4 a[132:135], v31, s[12:15], s3 offen offset:256 nt
Mvaa 108,68,40
s_waitcnt lgkmcnt(10)
s_mov_b32 s44, 0x3c0000
s_add_u32 m0, s45, 0x1ce00
TR 64,14,384
TR 66,14,896
Mvaa 100,68,36
buffer_load_dwordx4 v6, s[8:11], s44 offen lds
Mvaa 112,72,36
s_waitcnt lgkmcnt(10)
s_add_u32 m0, s45, 0x1d200
TR 68,14,392
TR 70,14,904
Mvaa 120,72,40
buffer_load_dwordx4 v7, s[8:11], s44 offen lds
Mvaa 124,76,40
s_waitcnt lgkmcnt(10)
s_add_u32 m0, s45, 0x1d608
TR 72,14,448
TR 74,14,960
Mvaa 116,76,36
buffer_load_dwordx4 v8, s[8:11], s44 offen lds
Mvaa 128,48,36
s_waitcnt lgkmcnt(10)
s_add_u32 m0, s45, 0x1da08
TR 76,14,456
TR 78,14,968
Mvaa 136,48,40
buffer_load_dwordx4 v9, s[8:11], s44 offen lds
Mvaa 140,52,40
s_waitcnt vmcnt(28)
RD 0,46,0
Mvaa 132,52,36
s_waitcnt lgkmcnt(11)
RD 4,46,2048
Mvaa 144,56,36
RD 12,47,0
Mvaa 152,56,40
s_waitcnt lgkmcnt(11)
RD 16,47,2048
Mvaa 156,60,40
v_add_u32 v14, 0x10800, v13
Mvaa 148,60,36
s_waitcnt vmcnt(32) lgkmcnt(0)
s_barrier
Mvaa 160,64,36
TR 48,14,0
TR 50,14,512
Mvaa 168,64,40
TR 52,14,8
TR 54,14,520
Mvaa 172,68,40
TR 56,14,64
TR 58,14,576
Mvaa 164,68,36
TR 60,14,72
TR 62,14,584
Mvaa 176,72,36
TR 64,14,128
TR 66,14,640
Mvaa 184,72,40
TR 68,14,136
TR 70,14,648
Mvaa 188,76,40
TR 72,14,192
TR 74,14,704
Mvaa 180,76,36
s_waitcnt lgkmcnt(12)
fl_q12:
Mvaa 64,48,0
s_waitcnt lgkmcnt(10)
s_mov_b32 s44, 0x400000
s_add_u32 m0, s45, 0x21000
TR 76,14,200
TR 78,14,712
Mvaa 72,48,4
buffer_load_dwordx4 v6, s[8:11], s44 offen lds
Mvaa 76,52,4
s_waitcnt lgkmcnt(10)
s_add_u32 m0, s45, 0x21400
TR 48,14,256
TR 50,14,768
Mvaa 68,52,0
buffer_load_dwordx4 v7, s[8:11], s44 offen lds
Mvaa 80,56,0
s_waitcnt lgkmcnt(10)
s_add_u32 m0, s45, 0x21808
TR 52,14,264
TR 54,14,776
Mvaa 88,56,4
buffer_load_dwordx4 v8, s[8:11], s44 offen lds
Mvaa 92,60,4
s_waitcnt lgkmcnt(10)
s_add_u32 m0, s45, 0x21c08
TR 56,14,320
TR 58,14,832
Mvaa 84,60,0
buffer_load_dwordx4 v9, s[8:11], s44 offen lds
Mvaa 96,64,0
s_waitcnt lgkmcnt(10)
s_add_u32 m0, s46, 0xfffffc00
TR 60,14,328
TR 62,14,840
Mvaa 104,64,4
buffer_load_dwordx4 v40, s[4:7], 0 offen offset:1024 lds
Mvaa 108,68,4
s_waitcnt lgkmcnt(10)
s_add_u32 m0, s46, 0
TR 64,14,384
TR 66,14,896
Mvaa 100,68,0
buffer_load_dwordx4 v41, s[4:7], 0 offen offset:1024 lds
Mvaa 112,72,0
s_waitcnt lgkmcnt(10)
s_add_u32 m0, s46, 0x400
TR 68,14,392
TR 70,14,904
Mvaa 120,72,4
buffer_load_dwordx4 v42, s[4:7], 0 offen offset:1024 lds
Mvaa 124,76,4
s_waitcnt lgkmcnt(10)
s_add_u32 m0, s46, 0x800
TR 72,14,448
TR 74,14,960
Mvaa 116,76,0
buffer_load_dwordx4 v43, s[4:7], 0 offen offset:1024 lds
Mvaa 128,48,0
TR 76,14,456
TR 78,14,968
Mvaa 136,48,4
s_waitcnt lgkmcnt(12)
Mvaa 140,52,4
Mvaa 132,52,0
s_waitcnt lgkmcnt(10)
Mvaa 144,56,0
Mvaa 152,56,4
s_waitcnt lgkmcnt(8)
Mvaa 156,60,4
v_add_u32 v14, 0x14a00, v13
Mvaa 148,60,0
s_waitcnt vmcnt(27) lgkmcnt(0)
s_barrier
Mvaa 160,64,0
TR 48,14,0
TR 50,14,512
Mvaa 168,64,4
TR 52,14,8
TR 54,14,520
Mvaa 172,68,4
TR 56,14,64
TR 58,14,576
Mvaa 164,68,0
TR 60,14,72
TR 62,14,584
Mvaa 176,72,0
TR 64,14,128
TR 66,14,640
Mvaa 184,72,4
TR 68,14,136
TR 70,14,648
Mvaa 188,76,4
TR 72,14,192
TR 74,14,704
Mvaa 180,76,0
s_waitcnt lgkmcnt(12)
fl_q13:
Mvaa 64,48,12
s_waitcnt lgkmcnt(10)
TR 76,14,200
TR 78,14,712
Mvaa 72,48,16
buffer_load_dword v224, v229, s[4:7], 0 offen offset:1536
Mvaa 76,52,16
s_waitcnt lgkmcnt(10)
s_mov_b32 s3, 0x8000
TR 48,14,256
TR 50,14,768
Mvaa 68,52,12
buffer_load_dwordx4 a[136:139], v31, s[16:19], s3 offen nt
Mvaa 80,56,12
s_waitcnt lgkmcnt(10)
TR 52,14,264
TR 54,14,776
Mvaa 88,56,16
buffer_load_dwordx4 a[140:143], v31, s[16:19], s3 offen offset:256 nt
Mvaa 92,60,16
s_waitcnt lgkmcnt(10)
s_mov_b32 s3, 0xc000
TR 56,14,320
TR 58,14,832
Mvaa 84,60,12
buffer_load_dwordx4 a[144:147], v31, s[12:15], s3 offen nt
Mvaa 96,64,12
s_waitcnt lgkmcnt(10)
TR 60,14,328
TR 62,14,840
Mvaa 104,64,16
buffer_load_dwordx4 a[148:151], v31, s[12:15], s3 offen offset:256 nt
Mvaa 108,68,16
s_waitcnt lgkmcnt(10)
s_mov_b32 s44, 0x440000
s_add_u32 m0, s45, 0x10800
TR 64,14,384
TR 66,14,896
Mvaa 100,68,12
buffer_load_dwordx4 v6, s[8:11], s44 offen lds
Mvaa 112,72,12
s_waitcnt lgkmcnt(10)
s_add_u32 m0, s45, 0x10c00
TR 68,14,392
TR 70,14,904
Mvaa 120,72,16
buffer_load_dwordx4 v7, s[8:11], s44 offen lds
Mvaa 124,76,16
s_waitcnt lgkmcnt(10)
s_add_u32 m0, s45, 0x11008
TR 72,14,448
TR 74,14,960
Mvaa 116,76,12
buffer_load_dwordx4 v8, s[8:11], s44 offen lds
Mvaa 128,48,12
s_waitcnt lgkmcnt(10)
s_add_u32 m0, s45, 0x11408
TR 76,14,456
TR 78,14,968
Mvaa 136,48,16
buffer_load_dwordx4 v9, s[8:11], s44 offen lds
Mvaa 140,52,16
s_waitcnt vmcnt(26)
RD 24,46,4096
Mvaa 132,52,12
s_waitcnt lgkmcnt(11)
RD 28,46,6144
Mvaa 144,56,12
RD 36,47,4096
Mvaa 152,56,16
s_waitcnt lgkmcnt(11)
RD 40,47,6144
Mvaa 156,60,16
v_add_u32 v14, 0x18c00, v13
Mvaa 148,60,12
s_waitcnt vmcnt(30) lgkmcnt(0)
s_barrier
Mvaa 160,64,12
TR 48,14,0
TR 50,14,512
Mvaa 168,64,16
TR 52,14,8
TR 54,14,520
Mvaa 172,68,16
TR 56,14,64
TR 58,14,576
Mvaa 164,68,12
TR 60,14,72
TR 62,14,584
Mvaa 176,72,12
TR 64,14,128
TR 66,14,640
Mvaa 184,72,16
TR 68,14,136
TR 70,14,648
Mvaa 188,76,16
TR 72,14,192
TR 74,14,704
Mvaa 180,76,12
s_waitcnt lgkmcnt(12)
fl_q14:
Mvaa 64,48,24
s_waitcnt lgkmcnt(10)
s_mov_b32 s44, 0x480000
s_add_u32 m0, s45, 0x14a00
TR 76,14,200
TR 78,14,712
Mvaa 72,48,28
buffer_load_dwordx4 v6, s[8:11], s44 offen lds
Mvaa 76,52,28
s_waitcnt lgkmcnt(10)
s_add_u32 m0, s45, 0x14e00
TR 48,14,256
TR 50,14,768
Mvaa 68,52,24
buffer_load_dwordx4 v7, s[8:11], s44 offen lds
Mvaa 80,56,24
s_waitcnt lgkmcnt(10)
s_add_u32 m0, s45, 0x15208
TR 52,14,264
TR 54,14,776
Mvaa 88,56,28
buffer_load_dwordx4 v8, s[8:11], s44 offen lds
Mvaa 92,60,28
s_waitcnt lgkmcnt(10)
s_add_u32 m0, s45, 0x15608
TR 56,14,320
TR 58,14,832
Mvaa 84,60,24
buffer_load_dwordx4 v9, s[8:11], s44 offen lds
Mvaa 96,64,24
s_waitcnt lgkmcnt(10)
s_add_u32 m0, s46, 0xb80
TR 60,14,328
TR 62,14,840
Mvaa 104,64,28
buffer_load_dwordx4 v40, s[4:7], 0 offen offset:1152 lds
Mvaa 108,68,28
s_waitcnt lgkmcnt(10)
s_add_u32 m0, s46, 0xf80
TR 64,14,384
TR 66,14,896
Mvaa 100,68,24
buffer_load_dwordx4 v41, s[4:7], 0 offen offset:1152 lds
Mvaa 112,72,24
s_waitcnt lgkmcnt(10)
s_add_u32 m0, s46, 0x1380
TR 68,14,392
TR 70,14,904
Mvaa 120,72,28
buffer_load_dwordx4 v42, s[4:7], 0 offen offset:1152 lds
Mvaa 124,76,28
s_waitcnt lgkmcnt(10)
s_add_u32 m0, s46, 0x1780
TR 72,14,448
TR 74,14,960
Mvaa 116,76,24
buffer_load_dwordx4 v43, s[4:7], 0 offen offset:1152 lds
Mvaa 128,48,24
TR 76,14,456
TR 78,14,968
Mvaa 136,48,28
s_waitcnt lgkmcnt(12)
Mvaa 140,52,28
Mvaa 132,52,24
s_waitcnt lgkmcnt(10)
Mvaa 144,56,24
Mvaa 152,56,28
s_waitcnt lgkmcnt(8)
Mvaa 156,60,28
v_add_u32 v14, 0x1ce00, v13
Mvaa 148,60,24
s_waitcnt vmcnt(25) lgkmcnt(0)
s_barrier
Mvaa 160,64,24
TR 48,14,0
TR 50,14,512
Mvaa 168,64,28
TR 52,14,8
TR 54,14,520
Mvaa 172,68,28
TR 56,14,64
TR 58,14,576
Mvaa 164,68,24
TR 60,14,72
TR 62,14,584
Mvaa 176,72,24
TR 64,14,128
TR 66,14,640
Mvaa 184,72,28
TR 68,14,136
TR 70,14,648
Mvaa 188,76,28
TR 72,14,192
TR 74,14,704
Mvaa 180,76,24
s_waitcnt lgkmcnt(12)
fl_q15:
Mvaa 64,48,36
s_waitcnt lgkmcnt(10)
s_mov_b32 s63, 0x600000
TR 76,14,200
TR 78,14,712
Mvaa 72,48,40
buffer_load_dword v224, v228, s[8:11], s63 offen
Mvaa 76,52,40
s_waitcnt lgkmcnt(10)
s_mov_b32 s3, 0xa000
TR 48,14,256
TR 50,14,768
Mvaa 68,52,36
buffer_load_dwordx4 a[152:155], v31, s[16:19], s3 offen nt
Mvaa 80,56,36
s_waitcnt lgkmcnt(10)
TR 52,14,264
TR 54,14,776
Mvaa 88,56,40
buffer_load_dwordx4 a[156:159], v31, s[16:19], s3 offen offset:256 nt
Mvaa 92,60,40
s_waitcnt lgkmcnt(10)
s_mov_b32 s3, 0xe000
TR 56,14,320
TR 58,14,832
Mvaa 84,60,36
buffer_load_dwordx4 a[160:163], v31, s[12:15], s3 offen nt
Mvaa 96,64,36
s_waitcnt lgkmcnt(10)
s_mov_b32 s44, 0x4c0000
s_add_u32 m0, s45, 0x18c00
TR 60,14,328
TR 62,14,840
Mvaa 104,64,40
buffer_load_dwordx4 v6, s[8:11], s44 offen lds
Mvaa 108,68,40
s_waitcnt lgkmcnt(10)
s_add_u32 m0, s45, 0x19000
TR 64,14,384
TR 66,14,896
Mvaa 100,68,36
buffer_load_dwordx4 v7, s[8:11], s44 offen lds
Mvaa 112,72,36
s_waitcnt lgkmcnt(10)
s_add_u32 m0, s45, 0x19408
TR 68,14,392
TR 70,14,904
Mvaa 120,72,40
buffer_load_dwordx4 v8, s[8:11], s44 offen lds
Mvaa 124,76,40
s_waitcnt lgkmcnt(10)
s_add_u32 m0, s45, 0x19808
TR 72,14,448
TR 74,14,960
Mvaa 116,76,36
buffer_load_dwordx4 v9, s[8:11], s44 offen lds
Mvaa 128,48,36
TR 76,14,456
TR 78,14,968
Mvaa 136,48,40
s_waitcnt vmcnt(25) lgkmcnt(12)
RD 0,46,0
Mvaa 140,52,40
RD 4,46,2048
Mvaa 132,52,36
s_waitcnt lgkmcnt(12)
RD 12,47,0
Mvaa 144,56,36
Mvaa 152,56,40
s_waitcnt lgkmcnt(11)
RD 16,47,2048
Mvaa 156,60,40
v_add_u32 v14, 0x21000, v13
Mvaa 148,60,36
s_waitcnt vmcnt(29) lgkmcnt(0)
s_barrier
Mvaa 160,64,36
TR 48,14,0
TR 50,14,512
Mvaa 168,64,40
TR 52,14,8
TR 54,14,520
Mvaa 172,68,40
TR 56,14,64
TR 58,14,576
Mvaa 164,68,36
TR 60,14,72
TR 62,14,584
Mvaa 176,72,36
TR 64,14,128
TR 66,14,640
Mvaa 184,72,40
TR 68,14,136
TR 70,14,648
Mvaa 188,76,40
TR 72,14,192
TR 74,14,704
Mvaa 180,76,36
s_waitcnt lgkmcnt(12)
fl_q16:
Mvaa 64,48,0
s_waitcnt lgkmcnt(10)
s_mov_b32 s44, 0x500000
s_add_u32 m0, s45, 0x1ce00
TR 76,14,200
TR 78,14,712
Mvaa 72,48,4
buffer_load_dwordx4 v6, s[8:11], s44 offen lds
Mvaa 76,52,4
s_waitcnt lgkmcnt(10)
s_add_u32 m0, s45, 0x1d200
TR 48,14,256
TR 50,14,768
Mvaa 68,52,0
buffer_load_dwordx4 v7, s[8:11], s44 offen lds
Mvaa 80,56,0
s_waitcnt lgkmcnt(10)
s_add_u32 m0, s45, 0x1d608
TR 52,14,264
TR 54,14,776
Mvaa 88,56,4
buffer_load_dwordx4 v8, s[8:11], s44 offen lds
Mvaa 92,60,4
s_waitcnt lgkmcnt(10)
s_add_u32 m0, s45, 0x1da08
TR 56,14,320
TR 58,14,832
Mvaa 84,60,0
buffer_load_dwordx4 v9, s[8:11], s44 offen lds
Mvaa 96,64,0
s_waitcnt lgkmcnt(10)
s_add_u32 m0, s46, 0xfffffb00
TR 60,14,328
TR 62,14,840
Mvaa 104,64,4
buffer_load_dwordx4 v40, s[4:7], 0 offen offset:1280 lds
Mvaa 108,68,4
s_waitcnt lgkmcnt(10)
s_add_u32 m0, s46, 0xffffff00
TR 64,14,384
TR 66,14,896
Mvaa 100,68,0
buffer_load_dwordx4 v41, s[4:7], 0 offen offset:1280 lds
Mvaa 112,72,0
s_waitcnt lgkmcnt(10)
s_add_u32 m0, s46, 0x300
TR 68,14,392
TR 70,14,904
Mvaa 120,72,4
buffer_load_dwordx4 v42, s[4:7], 0 offen offset:1280 lds
Mvaa 124,76,4
s_waitcnt lgkmcnt(10)
s_add_u32 m0, s46, 0x700
TR 72,14,448
TR 74,14,960
Mvaa 116,76,0
buffer_load_dwordx4 v43, s[4:7], 0 offen offset:1280 lds
Mvaa 128,48,0
TR 76,14,456
TR 78,14,968
Mvaa 136,48,4
s_waitcnt lgkmcnt(12)
Mvaa 140,52,4
Mvaa 132,52,0
s_waitcnt lgkmcnt(10)
Mvaa 144,56,0
Mvaa 152,56,4
s_waitcnt lgkmcnt(8)
Mvaa 156,60,4
v_add_u32 v14, 0x10800, v13
Mvaa 148,60,0
s_waitcnt vmcnt(24) lgkmcnt(0)
s_barrier
Mvaa 160,64,0
TR 48,14,0
TR 50,14,512
Mvaa 168,64,4
TR 52,14,8
TR 54,14,520
Mvaa 172,68,4
TR 56,14,64
TR 58,14,576
Mvaa 164,68,0
TR 60,14,72
TR 62,14,584
Mvaa 176,72,0
TR 64,14,128
TR 66,14,640
Mvaa 184,72,4
TR 68,14,136
TR 70,14,648
Mvaa 188,76,4
TR 72,14,192
TR 74,14,704
Mvaa 180,76,0
s_waitcnt lgkmcnt(12)
fl_q17:
Mvaa 64,48,12
s_waitcnt lgkmcnt(10)
s_mov_b32 s63, 0x100000
TR 76,14,200
TR 78,14,712
Mvaa 72,48,16
buffer_load_dword v224, v225, s[24:27], s63 offen
Mvaa 76,52,16
s_waitcnt lgkmcnt(10)
TR 48,14,256
TR 50,14,768
Mvaa 68,52,12
buffer_load_dwordx4 a[164:167], v31, s[12:15], s3 offen offset:256 nt
Mvaa 80,56,12
s_waitcnt lgkmcnt(10)
s_mov_b32 s3, 0xc000
TR 52,14,264
TR 54,14,776
Mvaa 88,56,16
buffer_load_dwordx4 a[168:171], v31, s[16:19], s3 offen nt
Mvaa 92,60,16
s_waitcnt lgkmcnt(10)
TR 56,14,320
TR 58,14,832
Mvaa 84,60,12
buffer_load_dwordx4 a[172:175], v31, s[16:19], s3 offen offset:256 nt
Mvaa 96,64,12
s_waitcnt lgkmcnt(10)
s_mov_b32 s3, 0x10000
TR 60,14,328
TR 62,14,840
Mvaa 104,64,16
buffer_load_dwordx4 a[176:179], v31, s[12:15], s3 offen nt
Mvaa 108,68,16
s_waitcnt lgkmcnt(10)
s_mov_b32 s44, 0x540000
s_add_u32 m0, s45, 0x21000
TR 64,14,384
TR 66,14,896
Mvaa 100,68,12
buffer_load_dwordx4 v6, s[8:11], s44 offen lds
Mvaa 112,72,12
s_waitcnt lgkmcnt(10)
s_add_u32 m0, s45, 0x21400
TR 68,14,392
TR 70,14,904
Mvaa 120,72,16
buffer_load_dwordx4 v7, s[8:11], s44 offen lds
Mvaa 124,76,16
s_waitcnt lgkmcnt(10)
s_add_u32 m0, s45, 0x21808
TR 72,14,448
TR 74,14,960
Mvaa 116,76,12
buffer_load_dwordx4 v8, s[8:11], s44 offen lds
Mvaa 128,48,12
s_waitcnt lgkmcnt(10)
s_add_u32 m0, s45, 0x21c08
TR 76,14,456
TR 78,14,968
Mvaa 136,48,16
buffer_load_dwordx4 v9, s[8:11], s44 offen lds
Mvaa 140,52,16
s_waitcnt vmcnt(25)
RD 24,46,4096
Mvaa 132,52,12
s_waitcnt lgkmcnt(11)
RD 28,46,6144
Mvaa 144,56,12
RD 36,47,4096
Mvaa 152,56,16
s_waitcnt lgkmcnt(11)
RD 40,47,6144
Mvaa 156,60,16
v_add_u32 v14, 0x14a00, v13
Mvaa 148,60,12
s_waitcnt vmcnt(29) lgkmcnt(0)
s_barrier
Mvaa 160,64,12
TR 48,14,0
TR 50,14,512
Mvaa 168,64,16
TR 52,14,8
TR 54,14,520
Mvaa 172,68,16
TR 56,14,64
TR 58,14,576
Mvaa 164,68,12
TR 60,14,72
TR 62,14,584
Mvaa 176,72,12
TR 64,14,128
TR 66,14,640
Mvaa 184,72,16
TR 68,14,136
TR 70,14,648
Mvaa 188,76,16
TR 72,14,192
TR 74,14,704
Mvaa 180,76,12
s_waitcnt lgkmcnt(12)
fl_q18:
Mvaa 64,48,24
s_waitcnt lgkmcnt(10)
TR 76,14,200
TR 78,14,712
v_add_u32 v226, ((fh_q18-f_start+5120)&0xffffff80), v227
v_min_u32 v226, f_end-f_start, v226
Mvaa 72,48,28
global_load_dword v224, v226, s[98:99]
Mvaa 76,52,28
s_waitcnt lgkmcnt(10)
TR 48,14,256
TR 50,14,768
v_add_u32 v226, ((fl_q18-f_start+5120)&0xffffff80), v227
v_min_u32 v226, f_end-f_start, v226
Mvaa 68,52,24
global_load_dword v224, v226, s[98:99]
Mvaa 80,56,24
s_waitcnt lgkmcnt(10)
s_mov_b32 s44, 0x580000
s_add_u32 m0, s45, 0x10800
TR 52,14,264
TR 54,14,776
Mvaa 88,56,28
buffer_load_dwordx4 v6, s[8:11], s44 offen lds
Mvaa 92,60,28
s_waitcnt lgkmcnt(10)
s_add_u32 m0, s45, 0x10c00
TR 56,14,320
TR 58,14,832
Mvaa 84,60,24
buffer_load_dwordx4 v7, s[8:11], s44 offen lds
Mvaa 96,64,24
s_waitcnt lgkmcnt(10)
s_add_u32 m0, s45, 0x11008
TR 60,14,328
TR 62,14,840
Mvaa 104,64,28
buffer_load_dwordx4 v8, s[8:11], s44 offen lds
Mvaa 108,68,28
s_waitcnt lgkmcnt(10)
s_add_u32 m0, s45, 0x11408
TR 64,14,384
TR 66,14,896
Mvaa 100,68,24
buffer_load_dwordx4 v9, s[8:11], s44 offen lds
Mvaa 112,72,24
s_waitcnt lgkmcnt(10)
s_add_u32 m0, s46, 0xa80
TR 68,14,392
TR 70,14,904
Mvaa 120,72,28
buffer_load_dwordx4 v40, s[4:7], 0 offen offset:1408 lds
Mvaa 124,76,28
s_waitcnt lgkmcnt(10)
s_add_u32 m0, s46, 0xe80
TR 72,14,448
TR 74,14,960
Mvaa 116,76,24
buffer_load_dwordx4 v41, s[4:7], 0 offen offset:1408 lds
Mvaa 128,48,24
s_waitcnt lgkmcnt(10)
s_add_u32 m0, s46, 0x1280
TR 76,14,456
TR 78,14,968
Mvaa 136,48,28
buffer_load_dwordx4 v42, s[4:7], 0 offen offset:1408 lds
Mvaa 140,52,28
s_waitcnt lgkmcnt(10)
s_add_u32 m0, s46, 0x1680
Mvaa 132,52,24
buffer_load_dwordx4 v43, s[4:7], 0 offen offset:1408 lds
Mvaa 144,56,24
Mvaa 152,56,28
s_waitcnt lgkmcnt(8)
Mvaa 156,60,28
v_add_u32 v14, 0x18c00, v13
Mvaa 148,60,24
s_waitcnt vmcnt(27) lgkmcnt(0)
s_barrier
Mvaa 160,64,24
TR 48,14,0
TR 50,14,512
Mvaa 168,64,28
TR 52,14,8
TR 54,14,520
Mvaa 172,68,28
TR 56,14,64
TR 58,14,576
Mvaa 164,68,24
TR 60,14,72
TR 62,14,584
Mvaa 176,72,24
TR 64,14,128
TR 66,14,640
Mvaa 184,72,28
TR 68,14,136
TR 70,14,648
Mvaa 188,76,28
TR 72,14,192
TR 74,14,704
Mvaa 180,76,24
s_waitcnt lgkmcnt(12)
fl_q19:
Mvaa 64,48,36
s_waitcnt lgkmcnt(10)
s_mov_b32 s63, 0x700000
TR 76,14,200
TR 78,14,712
Mvaa 72,48,40
buffer_load_dword v224, v228, s[8:11], s63 offen
Mvaa 76,52,40
s_waitcnt lgkmcnt(10)
TR 48,14,256
TR 50,14,768
Mvaa 68,52,36
buffer_load_dwordx4 a[180:183], v31, s[12:15], s3 offen offset:256 nt
Mvaa 80,56,36
s_waitcnt lgkmcnt(10)
s_mov_b32 s3, 0xe000
TR 52,14,264
TR 54,14,776
Mvaa 88,56,40
buffer_load_dwordx4 a[184:187], v31, s[16:19], s3 offen nt
Mvaa 92,60,40
s_waitcnt lgkmcnt(10)
TR 56,14,320
TR 58,14,832
Mvaa 84,60,36
buffer_load_dwordx4 a[188:191], v31, s[16:19], s3 offen offset:256 nt
Mvaa 96,64,36
s_waitcnt lgkmcnt(10)
s_mov_b32 s3, 0x12000
TR 60,14,328
TR 62,14,840
Mvaa 104,64,40
buffer_load_dwordx4 a[192:195], v31, s[12:15], s3 offen nt
Mvaa 108,68,40
s_waitcnt lgkmcnt(10)
s_mov_b32 s44, 0x5c0000
s_add_u32 m0, s45, 0x14a00
TR 64,14,384
TR 66,14,896
Mvaa 100,68,36
buffer_load_dwordx4 v6, s[8:11], s44 offen lds
Mvaa 112,72,36
s_waitcnt lgkmcnt(10)
s_add_u32 m0, s45, 0x14e00
TR 68,14,392
TR 70,14,904
Mvaa 120,72,40
buffer_load_dwordx4 v7, s[8:11], s44 offen lds
Mvaa 124,76,40
s_waitcnt lgkmcnt(10)
s_add_u32 m0, s45, 0x15208
TR 72,14,448
TR 74,14,960
Mvaa 116,76,36
buffer_load_dwordx4 v8, s[8:11], s44 offen lds
Mvaa 128,48,36
s_waitcnt lgkmcnt(10)
s_add_u32 m0, s45, 0x15608
TR 76,14,456
TR 78,14,968
Mvaa 136,48,40
buffer_load_dwordx4 v9, s[8:11], s44 offen lds
Mvaa 140,52,40
s_waitcnt vmcnt(28)
RD 0,46,0
Mvaa 132,52,36
s_waitcnt lgkmcnt(11)
RD 4,46,2048
Mvaa 144,56,36
RD 12,47,0
Mvaa 152,56,40
s_waitcnt lgkmcnt(11)
RD 16,47,2048
Mvaa 156,60,40
v_add_u32 v14, 0x1ce00, v13
Mvaa 148,60,36
s_waitcnt vmcnt(32) lgkmcnt(0)
s_barrier
Mvaa 160,64,36
TR 48,14,0
TR 50,14,512
Mvaa 168,64,40
TR 52,14,8
TR 54,14,520
Mvaa 172,68,40
TR 56,14,64
TR 58,14,576
Mvaa 164,68,36
TR 60,14,72
TR 62,14,584
Mvaa 176,72,36
TR 64,14,128
TR 66,14,640
Mvaa 184,72,40
TR 68,14,136
TR 70,14,648
Mvaa 188,76,40
TR 72,14,192
TR 74,14,704
Mvaa 180,76,36
s_waitcnt lgkmcnt(12)
fl_q20:
Mvaa 64,48,0
s_waitcnt lgkmcnt(10)
s_mov_b32 s44, 0x600000
s_add_u32 m0, s45, 0x18c00
TR 76,14,200
TR 78,14,712
Mvaa 72,48,4
buffer_load_dwordx4 v6, s[8:11], s44 offen lds
Mvaa 76,52,4
s_waitcnt lgkmcnt(10)
s_add_u32 m0, s45, 0x19000
TR 48,14,256
TR 50,14,768
Mvaa 68,52,0
buffer_load_dwordx4 v7, s[8:11], s44 offen lds
Mvaa 80,56,0
s_waitcnt lgkmcnt(10)
s_add_u32 m0, s45, 0x19408
TR 52,14,264
TR 54,14,776
Mvaa 88,56,4
buffer_load_dwordx4 v8, s[8:11], s44 offen lds
Mvaa 92,60,4
s_waitcnt lgkmcnt(10)
s_add_u32 m0, s45, 0x19808
TR 56,14,320
TR 58,14,832
Mvaa 84,60,0
buffer_load_dwordx4 v9, s[8:11], s44 offen lds
Mvaa 96,64,0
s_waitcnt lgkmcnt(10)
s_add_u32 m0, s46, 0xfffffa00
TR 60,14,328
TR 62,14,840
Mvaa 104,64,4
buffer_load_dwordx4 v40, s[4:7], 0 offen offset:1536 lds
Mvaa 108,68,4
s_waitcnt lgkmcnt(10)
s_add_u32 m0, s46, 0xfffffe00
TR 64,14,384
TR 66,14,896
Mvaa 100,68,0
buffer_load_dwordx4 v41, s[4:7], 0 offen offset:1536 lds
Mvaa 112,72,0
s_waitcnt lgkmcnt(10)
s_add_u32 m0, s46, 0x200
TR 68,14,392
TR 70,14,904
Mvaa 120,72,4
buffer_load_dwordx4 v42, s[4:7], 0 offen offset:1536 lds
Mvaa 124,76,4
s_waitcnt lgkmcnt(10)
s_add_u32 m0, s46, 0x600
TR 72,14,448
TR 74,14,960
Mvaa 116,76,0
buffer_load_dwordx4 v43, s[4:7], 0 offen offset:1536 lds
Mvaa 128,48,0
TR 76,14,456
TR 78,14,968
Mvaa 136,48,4
s_waitcnt lgkmcnt(12)
Mvaa 140,52,4
Mvaa 132,52,0
s_waitcnt lgkmcnt(10)
Mvaa 144,56,0
Mvaa 152,56,4
s_waitcnt lgkmcnt(8)
Mvaa 156,60,4
v_add_u32 v14, 0x21000, v13
Mvaa 148,60,0
s_waitcnt vmcnt(27) lgkmcnt(0)
s_barrier
Mvaa 160,64,0
TR 48,14,0
TR 50,14,512
Mvaa 168,64,4
TR 52,14,8
TR 54,14,520
Mvaa 172,68,4
TR 56,14,64
TR 58,14,576
Mvaa 164,68,0
TR 60,14,72
TR 62,14,584
Mvaa 176,72,0
TR 64,14,128
TR 66,14,640
Mvaa 184,72,4
TR 68,14,136
TR 70,14,648
Mvaa 188,76,4
TR 72,14,192
TR 74,14,704
Mvaa 180,76,0
s_waitcnt lgkmcnt(12)
fl_q21:
Mvaa 64,48,12
s_waitcnt lgkmcnt(10)
s_mov_b32 s63, 0x200000
TR 76,14,200
TR 78,14,712
Mvaa 72,48,16
buffer_load_dword v224, v225, s[24:27], s63 offen
Mvaa 76,52,16
s_waitcnt lgkmcnt(10)
TR 48,14,256
TR 50,14,768
Mvaa 68,52,12
buffer_load_dwordx4 a[196:199], v31, s[12:15], s3 offen offset:256 nt
Mvaa 80,56,12
s_waitcnt lgkmcnt(10)
s_mov_b32 s3, 0x10000
TR 52,14,264
TR 54,14,776
Mvaa 88,56,16
buffer_load_dwordx4 a[200:203], v31, s[16:19], s3 offen nt
Mvaa 92,60,16
s_waitcnt lgkmcnt(10)
TR 56,14,320
TR 58,14,832
Mvaa 84,60,12
buffer_load_dwordx4 a[204:207], v31, s[16:19], s3 offen offset:256 nt
Mvaa 96,64,12
s_waitcnt lgkmcnt(10)
s_mov_b32 s3, 0x14000
TR 60,14,328
TR 62,14,840
Mvaa 104,64,16
buffer_load_dwordx4 a[208:211], v31, s[12:15], s3 offen nt
Mvaa 108,68,16
s_waitcnt lgkmcnt(10)
s_mov_b32 s44, 0x640000
s_add_u32 m0, s45, 0x1ce00
TR 64,14,384
TR 66,14,896
Mvaa 100,68,12
buffer_load_dwordx4 v6, s[8:11], s44 offen lds
Mvaa 112,72,12
s_waitcnt lgkmcnt(10)
s_add_u32 m0, s45, 0x1d200
TR 68,14,392
TR 70,14,904
Mvaa 120,72,16
buffer_load_dwordx4 v7, s[8:11], s44 offen lds
Mvaa 124,76,16
s_waitcnt lgkmcnt(10)
s_add_u32 m0, s45, 0x1d608
TR 72,14,448
TR 74,14,960
Mvaa 116,76,12
buffer_load_dwordx4 v8, s[8:11], s44 offen lds
Mvaa 128,48,12
s_waitcnt lgkmcnt(10)
s_add_u32 m0, s45, 0x1da08
TR 76,14,456
TR 78,14,968
Mvaa 136,48,16
buffer_load_dwordx4 v9, s[8:11], s44 offen lds
Mvaa 140,52,16
s_waitcnt vmcnt(26)
RD 24,46,4096
Mvaa 132,52,12
s_waitcnt lgkmcnt(11)
RD 28,46,6144
Mvaa 144,56,12
RD 36,47,4096
Mvaa 152,56,16
s_waitcnt lgkmcnt(11)
RD 40,47,6144
Mvaa 156,60,16
v_add_u32 v14, 0x10800, v13
Mvaa 148,60,12
s_waitcnt vmcnt(30) lgkmcnt(0)
s_barrier
Mvaa 160,64,12
TR 48,14,0
TR 50,14,512
Mvaa 168,64,16
TR 52,14,8
TR 54,14,520
Mvaa 172,68,16
TR 56,14,64
TR 58,14,576
Mvaa 164,68,12
TR 60,14,72
TR 62,14,584
Mvaa 176,72,12
TR 64,14,128
TR 66,14,640
Mvaa 184,72,16
TR 68,14,136
TR 70,14,648
Mvaa 188,76,16
TR 72,14,192
TR 74,14,704
Mvaa 180,76,12
s_waitcnt lgkmcnt(12)
fl_q22:
Mvaa 64,48,24
s_waitcnt lgkmcnt(10)
s_mov_b32 s44, 0x680000
s_add_u32 m0, s45, 0x21000
TR 76,14,200
TR 78,14,712
Mvaa 72,48,28
buffer_load_dwordx4 v6, s[8:11], s44 offen lds
Mvaa 76,52,28
s_waitcnt lgkmcnt(10)
s_add_u32 m0, s45, 0x21400
TR 48,14,256
TR 50,14,768
Mvaa 68,52,24
buffer_load_dwordx4 v7, s[8:11], s44 offen lds
Mvaa 80,56,24
s_waitcnt lgkmcnt(10)
s_add_u32 m0, s45, 0x21808
TR 52,14,264
TR 54,14,776
Mvaa 88,56,28
buffer_load_dwordx4 v8, s[8:11], s44 offen lds
Mvaa 92,60,28
s_waitcnt lgkmcnt(10)
s_add_u32 m0, s45, 0x21c08
TR 56,14,320
TR 58,14,832
Mvaa 84,60,24
buffer_load_dwordx4 v9, s[8:11], s44 offen lds
Mvaa 96,64,24
s_waitcnt lgkmcnt(10)
s_add_u32 m0, s46, 0x980
TR 60,14,328
TR 62,14,840
Mvaa 104,64,28
buffer_load_dwordx4 v40, s[4:7], 0 offen offset:1664 lds
Mvaa 108,68,28
s_waitcnt lgkmcnt(10)
s_add_u32 m0, s46, 0xd80
TR 64,14,384
TR 66,14,896
Mvaa 100,68,24
buffer_load_dwordx4 v41, s[4:7], 0 offen offset:1664 lds
Mvaa 112,72,24
s_waitcnt lgkmcnt(10)
s_add_u32 m0, s46, 0x1180
TR 68,14,392
TR 70,14,904
Mvaa 120,72,28
buffer_load_dwordx4 v42, s[4:7], 0 offen offset:1664 lds
Mvaa 124,76,28
s_waitcnt lgkmcnt(10)
s_add_u32 m0, s46, 0x1580
TR 72,14,448
TR 74,14,960
Mvaa 116,76,24
buffer_load_dwordx4 v43, s[4:7], 0 offen offset:1664 lds
Mvaa 128,48,24
TR 76,14,456
TR 78,14,968
Mvaa 136,48,28
s_waitcnt lgkmcnt(12)
Mvaa 140,52,28
Mvaa 132,52,24
s_waitcnt lgkmcnt(10)
Mvaa 144,56,24
Mvaa 152,56,28
s_waitcnt lgkmcnt(8)
Mvaa 156,60,28
v_add_u32 v14, 0x14a00, v13
Mvaa 148,60,24
s_waitcnt vmcnt(25) lgkmcnt(0)
s_barrier
Mvaa 160,64,24
TR 48,14,0
TR 50,14,512
Mvaa 168,64,28
TR 52,14,8
TR 54,14,520
Mvaa 172,68,28
TR 56,14,64
TR 58,14,576
Mvaa 164,68,24
TR 60,14,72
TR 62,14,584
Mvaa 176,72,24
TR 64,14,128
TR 66,14,640
Mvaa 184,72,28
TR 68,14,136
TR 70,14,648
Mvaa 188,76,28
TR 72,14,192
TR 74,14,704
Mvaa 180,76,24
s_waitcnt lgkmcnt(12)
fl_q23:
Mvaa 64,48,36
s_waitcnt lgkmcnt(10)
s_mov_b32 s63, 0x300000
TR 76,14,200
TR 78,14,712
Mvaa 72,48,40
buffer_load_dword v224, v225, s[24:27], s63 offen
Mvaa 76,52,40
s_waitcnt lgkmcnt(10)
TR 48,14,256
TR 50,14,768
Mvaa 68,52,36
buffer_load_dwordx4 a[212:215], v31, s[12:15], s3 offen offset:256 nt
Mvaa 80,56,36
s_waitcnt lgkmcnt(10)
s_mov_b32 s3, 0x12000
TR 52,14,264
TR 54,14,776
Mvaa 88,56,40
buffer_load_dwordx4 a[216:219], v31, s[16:19], s3 offen nt
Mvaa 92,60,40
s_waitcnt lgkmcnt(10)
TR 56,14,320
TR 58,14,832
Mvaa 84,60,36
buffer_load_dwordx4 a[220:223], v31, s[16:19], s3 offen offset:256 nt
Mvaa 96,64,36
s_waitcnt lgkmcnt(10)
s_mov_b32 s3, 0x16000
TR 60,14,328
TR 62,14,840
Mvaa 104,64,40
buffer_load_dwordx4 a[224:227], v31, s[12:15], s3 offen nt
Mvaa 108,68,40
s_waitcnt lgkmcnt(10)
s_mov_b32 s44, 0x6c0000
s_add_u32 m0, s45, 0x10800
TR 64,14,384
TR 66,14,896
Mvaa 100,68,36
buffer_load_dwordx4 v6, s[8:11], s44 offen lds
Mvaa 112,72,36
s_waitcnt lgkmcnt(10)
s_add_u32 m0, s45, 0x10c00
TR 68,14,392
TR 70,14,904
Mvaa 120,72,40
buffer_load_dwordx4 v7, s[8:11], s44 offen lds
Mvaa 124,76,40
s_waitcnt lgkmcnt(10)
s_add_u32 m0, s45, 0x11008
TR 72,14,448
TR 74,14,960
Mvaa 116,76,36
buffer_load_dwordx4 v8, s[8:11], s44 offen lds
Mvaa 128,48,36
s_waitcnt lgkmcnt(10)
s_add_u32 m0, s45, 0x11408
TR 76,14,456
TR 78,14,968
Mvaa 136,48,40
buffer_load_dwordx4 v9, s[8:11], s44 offen lds
Mvaa 140,52,40
s_waitcnt vmcnt(26)
RD 0,46,0
Mvaa 132,52,36
s_waitcnt lgkmcnt(11)
RD 4,46,2048
Mvaa 144,56,36
RD 12,47,0
Mvaa 152,56,40
s_waitcnt lgkmcnt(11)
RD 16,47,2048
Mvaa 156,60,40
v_add_u32 v14, 0x18c00, v13
Mvaa 148,60,36
s_waitcnt vmcnt(30) lgkmcnt(0)
s_barrier
Mvaa 160,64,36
TR 48,14,0
TR 50,14,512
Mvaa 168,64,40
TR 52,14,8
TR 54,14,520
Mvaa 172,68,40
TR 56,14,64
TR 58,14,576
Mvaa 164,68,36
TR 60,14,72
TR 62,14,584
Mvaa 176,72,36
TR 64,14,128
TR 66,14,640
Mvaa 184,72,40
TR 68,14,136
TR 70,14,648
Mvaa 188,76,40
TR 72,14,192
TR 74,14,704
Mvaa 180,76,36
s_waitcnt lgkmcnt(12)
fl_q24:
Mvaa 64,48,0
s_waitcnt lgkmcnt(10)
s_mov_b32 s44, 0x700000
s_add_u32 m0, s45, 0x14a00
TR 76,14,200
TR 78,14,712
Mvaa 72,48,4
buffer_load_dwordx4 v6, s[8:11], s44 offen lds
Mvaa 76,52,4
s_waitcnt lgkmcnt(10)
s_add_u32 m0, s45, 0x14e00
TR 48,14,256
TR 50,14,768
Mvaa 68,52,0
buffer_load_dwordx4 v7, s[8:11], s44 offen lds
Mvaa 80,56,0
s_waitcnt lgkmcnt(10)
s_add_u32 m0, s45, 0x15208
TR 52,14,264
TR 54,14,776
Mvaa 88,56,4
buffer_load_dwordx4 v8, s[8:11], s44 offen lds
Mvaa 92,60,4
s_waitcnt lgkmcnt(10)
s_add_u32 m0, s45, 0x15608
TR 56,14,320
TR 58,14,832
Mvaa 84,60,0
buffer_load_dwordx4 v9, s[8:11], s44 offen lds
Mvaa 96,64,0
s_waitcnt lgkmcnt(10)
s_add_u32 m0, s46, 0xfffff900
TR 60,14,328
TR 62,14,840
Mvaa 104,64,4
buffer_load_dwordx4 v40, s[4:7], 0 offen offset:1792 lds
Mvaa 108,68,4
s_waitcnt lgkmcnt(10)
s_add_u32 m0, s46, 0xfffffd00
TR 64,14,384
TR 66,14,896
Mvaa 100,68,0
buffer_load_dwordx4 v41, s[4:7], 0 offen offset:1792 lds
Mvaa 112,72,0
s_waitcnt lgkmcnt(10)
s_add_u32 m0, s46, 0x100
TR 68,14,392
TR 70,14,904
Mvaa 120,72,4
buffer_load_dwordx4 v42, s[4:7], 0 offen offset:1792 lds
Mvaa 124,76,4
s_waitcnt lgkmcnt(10)
s_add_u32 m0, s46, 0x500
TR 72,14,448
TR 74,14,960
Mvaa 116,76,0
buffer_load_dwordx4 v43, s[4:7], 0 offen offset:1792 lds
Mvaa 128,48,0
TR 76,14,456
TR 78,14,968
Mvaa 136,48,4
s_waitcnt lgkmcnt(12)
Mvaa 140,52,4
Mvaa 132,52,0
s_waitcnt lgkmcnt(10)
Mvaa 144,56,0
Mvaa 152,56,4
s_waitcnt lgkmcnt(8)
Mvaa 156,60,4
v_add_u32 v14, 0x1ce00, v13
Mvaa 148,60,0
s_waitcnt vmcnt(25) lgkmcnt(0)
s_barrier
Mvaa 160,64,0
TR 48,14,0
TR 50,14,512
Mvaa 168,64,4
TR 52,14,8
TR 54,14,520
Mvaa 172,68,4
TR 56,14,64
TR 58,14,576
Mvaa 164,68,0
TR 60,14,72
TR 62,14,584
Mvaa 176,72,0
TR 64,14,128
TR 66,14,640
Mvaa 184,72,4
TR 68,14,136
TR 70,14,648
Mvaa 188,76,4
TR 72,14,192
TR 74,14,704
Mvaa 180,76,0
s_waitcnt lgkmcnt(12)
fl_q25:
Mvaa 64,48,12
s_waitcnt lgkmcnt(10)
s_mov_b32 s63, 0x40000
TR 76,14,200
TR 78,14,712
Mvaa 72,48,16
buffer_load_dword v224, v225, s[24:27], s63 offen
Mvaa 76,52,16
s_waitcnt lgkmcnt(10)
TR 48,14,256
TR 50,14,768
Mvaa 68,52,12
buffer_load_dwordx4 a[228:231], v31, s[12:15], s3 offen offset:256 nt
Mvaa 80,56,12
s_waitcnt lgkmcnt(10)
s_mov_b32 s3, 0x14000
TR 52,14,264
TR 54,14,776
Mvaa 88,56,16
buffer_load_dwordx4 a[232:235], v31, s[16:19], s3 offen nt
Mvaa 92,60,16
s_waitcnt lgkmcnt(10)
TR 56,14,320
TR 58,14,832
Mvaa 84,60,12
buffer_load_dwordx4 a[236:239], v31, s[16:19], s3 offen offset:256 nt
Mvaa 96,64,12
s_waitcnt lgkmcnt(10)
s_mov_b32 s3, 0x18000
TR 60,14,328
TR 62,14,840
Mvaa 104,64,16
buffer_load_dwordx4 a[240:243], v31, s[12:15], s3 offen nt
Mvaa 108,68,16
s_waitcnt lgkmcnt(10)
s_mov_b32 s44, 0x740000
s_add_u32 m0, s45, 0x18c00
TR 64,14,384
TR 66,14,896
Mvaa 100,68,12
buffer_load_dwordx4 v6, s[8:11], s44 offen lds
Mvaa 112,72,12
s_waitcnt lgkmcnt(10)
s_add_u32 m0, s45, 0x19000
TR 68,14,392
TR 70,14,904
Mvaa 120,72,16
buffer_load_dwordx4 v7, s[8:11], s44 offen lds
Mvaa 124,76,16
s_waitcnt lgkmcnt(10)
s_add_u32 m0, s45, 0x19408
TR 72,14,448
TR 74,14,960
Mvaa 116,76,12
buffer_load_dwordx4 v8, s[8:11], s44 offen lds
Mvaa 128,48,12
s_waitcnt lgkmcnt(10)
s_add_u32 m0, s45, 0x19808
TR 76,14,456
TR 78,14,968
Mvaa 136,48,16
buffer_load_dwordx4 v9, s[8:11], s44 offen lds
Mvaa 140,52,16
s_waitcnt vmcnt(26)
RD 24,46,4096
Mvaa 132,52,12
s_waitcnt lgkmcnt(11)
RD 28,46,6144
Mvaa 144,56,12
RD 36,47,4096
Mvaa 152,56,16
s_waitcnt lgkmcnt(11)
RD 40,47,6144
Mvaa 156,60,16
v_add_u32 v14, 0x21000, v13
Mvaa 148,60,12
s_waitcnt vmcnt(30) lgkmcnt(0)
s_barrier
Mvaa 160,64,12
TR 48,14,0
TR 50,14,512
Mvaa 168,64,16
TR 52,14,8
TR 54,14,520
Mvaa 172,68,16
TR 56,14,64
TR 58,14,576
Mvaa 164,68,12
TR 60,14,72
TR 62,14,584
Mvaa 176,72,12
TR 64,14,128
TR 66,14,640
Mvaa 184,72,16
TR 68,14,136
TR 70,14,648
Mvaa 188,76,16
TR 72,14,192
TR 74,14,704
Mvaa 180,76,12
s_waitcnt lgkmcnt(12)
fl_q26:
Mvaa 64,48,24
s_waitcnt lgkmcnt(10)
TR 76,14,200
TR 78,14,712
v_add_u32 v226, ((fh_q26-f_start+5120)&0xffffff80), v227
v_min_u32 v226, f_end-f_start, v226
Mvaa 72,48,28
global_load_dword v224, v226, s[98:99]
Mvaa 76,52,28
s_waitcnt lgkmcnt(10)
TR 48,14,256
TR 50,14,768
v_add_u32 v226, ((fl_q26-f_start+5120)&0xffffff80), v227
v_min_u32 v226, f_end-f_start, v226
Mvaa 68,52,24
global_load_dword v224, v226, s[98:99]
Mvaa 80,56,24
s_waitcnt lgkmcnt(10)
s_mov_b32 s44, 0x780000
s_add_u32 m0, s45, 0x1ce00
TR 52,14,264
TR 54,14,776
Mvaa 88,56,28
buffer_load_dwordx4 v6, s[8:11], s44 offen lds
Mvaa 92,60,28
s_waitcnt lgkmcnt(10)
s_add_u32 m0, s45, 0x1d200
TR 56,14,320
TR 58,14,832
Mvaa 84,60,24
buffer_load_dwordx4 v7, s[8:11], s44 offen lds
Mvaa 96,64,24
s_waitcnt lgkmcnt(10)
s_add_u32 m0, s45, 0x1d608
TR 60,14,328
TR 62,14,840
Mvaa 104,64,28
buffer_load_dwordx4 v8, s[8:11], s44 offen lds
Mvaa 108,68,28
s_waitcnt lgkmcnt(10)
s_add_u32 m0, s45, 0x1da08
TR 64,14,384
TR 66,14,896
Mvaa 100,68,24
buffer_load_dwordx4 v9, s[8:11], s44 offen lds
Mvaa 112,72,24
s_waitcnt lgkmcnt(10)
s_add_u32 m0, s46, 0x880
TR 68,14,392
TR 70,14,904
Mvaa 120,72,28
buffer_load_dwordx4 v40, s[4:7], 0 offen offset:1920 lds
Mvaa 124,76,28
s_waitcnt lgkmcnt(10)
s_add_u32 m0, s46, 0xc80
TR 72,14,448
TR 74,14,960
Mvaa 116,76,24
buffer_load_dwordx4 v41, s[4:7], 0 offen offset:1920 lds
Mvaa 128,48,24
s_waitcnt lgkmcnt(10)
s_add_u32 m0, s46, 0x1080
TR 76,14,456
TR 78,14,968
Mvaa 136,48,28
buffer_load_dwordx4 v42, s[4:7], 0 offen offset:1920 lds
Mvaa 140,52,28
s_waitcnt lgkmcnt(10)
s_add_u32 m0, s46, 0x1480
Mvaa 132,52,24
buffer_load_dwordx4 v43, s[4:7], 0 offen offset:1920 lds
Mvaa 144,56,24
Mvaa 152,56,28
s_waitcnt lgkmcnt(8)
Mvaa 156,60,28
v_add_u32 v14, 0x10800, v13
Mvaa 148,60,24
s_waitcnt vmcnt(27) lgkmcnt(0)
s_barrier
Mvaa 160,64,24
TR 48,14,0
TR 50,14,512
Mvaa 168,64,28
TR 52,14,8
TR 54,14,520
Mvaa 172,68,28
TR 56,14,64
TR 58,14,576
Mvaa 164,68,24
TR 60,14,72
TR 62,14,584
Mvaa 176,72,24
TR 64,14,128
TR 66,14,640
Mvaa 184,72,28
TR 68,14,136
TR 70,14,648
Mvaa 188,76,28
TR 72,14,192
TR 74,14,704
Mvaa 180,76,24
s_waitcnt lgkmcnt(12)
fl_q27:
Mvaa 64,48,36
s_waitcnt lgkmcnt(10)
s_mov_b32 s63, 0x140000
TR 76,14,200
TR 78,14,712
Mvaa 72,48,40
buffer_load_dword v224, v225, s[24:27], s63 offen
Mvaa 76,52,40
s_waitcnt lgkmcnt(10)
TR 48,14,256
TR 50,14,768
Mvaa 68,52,36
buffer_load_dwordx4 a[244:247], v31, s[12:15], s3 offen offset:256 nt
Mvaa 80,56,36
s_waitcnt lgkmcnt(10)
s_mov_b32 s3, 0x16000
TR 52,14,264
TR 54,14,776
Mvaa 88,56,40
buffer_load_dwordx4 a[248:251], v31, s[16:19], s3 offen nt
Mvaa 92,60,40
s_waitcnt lgkmcnt(10)
TR 56,14,320
TR 58,14,832
Mvaa 84,60,36
buffer_load_dwordx4 a[252:255], v31, s[16:19], s3 offen offset:256 nt
Mvaa 96,64,36
s_waitcnt lgkmcnt(10)
s_mov_b32 s44, 0x7c0000
s_add_u32 m0, s45, 0x21000
TR 60,14,328
TR 62,14,840
Mvaa 104,64,40
buffer_load_dwordx4 v6, s[8:11], s44 offen lds
Mvaa 108,68,40
s_waitcnt lgkmcnt(10)
s_add_u32 m0, s45, 0x21400
TR 64,14,384
TR 66,14,896
Mvaa 100,68,36
buffer_load_dwordx4 v7, s[8:11], s44 offen lds
Mvaa 112,72,36
s_waitcnt lgkmcnt(10)
s_add_u32 m0, s45, 0x21808
TR 68,14,392
TR 70,14,904
Mvaa 120,72,40
buffer_load_dwordx4 v8, s[8:11], s44 offen lds
Mvaa 124,76,40
s_waitcnt lgkmcnt(10)
s_add_u32 m0, s45, 0x21c08
TR 72,14,448
TR 74,14,960
Mvaa 116,76,36
buffer_load_dwordx4 v9, s[8:11], s44 offen lds
Mvaa 128,48,36
TR 76,14,456
TR 78,14,968
Mvaa 136,48,40
s_waitcnt vmcnt(27) lgkmcnt(12)
RD 0,46,0
Mvaa 140,52,40
RD 4,46,2048
Mvaa 132,52,36
s_waitcnt lgkmcnt(12)
RD 12,47,0
Mvaa 144,56,36
Mvaa 152,56,40
s_waitcnt lgkmcnt(11)
RD 16,47,2048
Mvaa 156,60,40
v_add_u32 v14, 0x14a00, v13
Mvaa 148,60,36
s_waitcnt vmcnt(31) lgkmcnt(0)
s_barrier
Mvaa 160,64,36
TR 48,14,0
TR 50,14,512
Mvaa 168,64,40
TR 52,14,8
TR 54,14,520
Mvaa 172,68,40
TR 56,14,64
TR 58,14,576
Mvaa 164,68,36
TR 60,14,72
TR 62,14,584
Mvaa 176,72,36
TR 64,14,128
TR 66,14,640
Mvaa 184,72,40
TR 68,14,136
TR 70,14,648
Mvaa 188,76,40
TR 72,14,192
TR 74,14,704
Mvaa 180,76,36
s_waitcnt lgkmcnt(12)
fl_q28:
Mvaa 64,48,0
TR 76,14,200
TR 78,14,712
Mvaa 72,48,4
s_waitcnt lgkmcnt(12)
Mvaa 76,52,4
TR 48,14,256
TR 50,14,768
Mvaa 68,52,0
s_waitcnt lgkmcnt(12)
Mvaa 80,56,0
TR 52,14,264
TR 54,14,776
Mvaa 88,56,4
s_waitcnt lgkmcnt(12)
Mvaa 92,60,4
TR 56,14,320
TR 58,14,832
Mvaa 84,60,0
s_waitcnt lgkmcnt(12)
Mvaa 96,64,0
TR 60,14,328
TR 62,14,840
Mvaa 104,64,4
s_waitcnt lgkmcnt(12)
Mvaa 108,68,4
TR 64,14,384
TR 66,14,896
Mvaa 100,68,0
s_waitcnt lgkmcnt(12)
Mvaa 112,72,0
TR 68,14,392
TR 70,14,904
Mvaa 120,72,4
s_waitcnt lgkmcnt(12)
Mvaa 124,76,4
TR 72,14,448
TR 74,14,960
Mvaa 116,76,0
s_waitcnt lgkmcnt(12)
Mvaa 128,48,0
TR 76,14,456
TR 78,14,968
Mvaa 136,48,4
s_waitcnt lgkmcnt(12)
Mvaa 140,52,4
ds_write_b128 v23, a[128:131] offset:10240
Mvaa 132,52,0
s_waitcnt lgkmcnt(11)
ds_write_b128 v23, a[132:135] offset:11296
Mvaa 144,56,0
ds_write_b128 v23, a[136:139] offset:18688
Mvaa 152,56,4
s_waitcnt lgkmcnt(11)
ds_write_b128 v23, a[140:143] offset:19744
Mvaa 156,60,4
v_add_u32 v14, 0x18c00, v13
Mvaa 148,60,0
s_waitcnt vmcnt(18) lgkmcnt(0)
s_barrier
Mvaa 160,64,0
TR 48,14,0
TR 50,14,512
Mvaa 168,64,4
TR 52,14,8
TR 54,14,520
Mvaa 172,68,4
TR 56,14,64
TR 58,14,576
Mvaa 164,68,0
TR 60,14,72
TR 62,14,584
Mvaa 176,72,0
TR 64,14,128
TR 66,14,640
Mvaa 184,72,4
TR 68,14,136
TR 70,14,648
Mvaa 188,76,4
TR 72,14,192
TR 74,14,704
Mvaa 180,76,0
s_waitcnt lgkmcnt(12)
fl_q29:
Mvaa 64,48,12
s_waitcnt lgkmcnt(10)
s_mov_b32 s63, 0x240000
TR 76,14,200
TR 78,14,712
Mvaa 72,48,16
buffer_load_dword v224, v225, s[24:27], s63 offen
Mvaa 76,52,16
s_waitcnt lgkmcnt(10)
s_mov_b32 s3, 0x1a000
TR 48,14,256
TR 50,14,768
Mvaa 68,52,12
buffer_load_dwordx4 a[128:131], v31, s[12:15], s3 offen nt
Mvaa 80,56,12
s_waitcnt lgkmcnt(10)
TR 52,14,264
TR 54,14,776
Mvaa 88,56,16
buffer_load_dwordx4 a[132:135], v31, s[12:15], s3 offen offset:256 nt
Mvaa 92,60,16
TR 56,14,320
TR 58,14,832
Mvaa 84,60,12
s_waitcnt vmcnt(11) lgkmcnt(12)
RD 24,46,4096
Mvaa 96,64,12
TR 60,14,328
TR 62,14,840
Mvaa 104,64,16
s_waitcnt lgkmcnt(13)
RD 28,46,6144
Mvaa 108,68,16
TR 64,14,384
TR 66,14,896
Mvaa 100,68,12
s_waitcnt lgkmcnt(14)
RD 36,47,4096
Mvaa 112,72,12
TR 68,14,392
TR 70,14,904
Mvaa 120,72,16
s_waitcnt lgkmcnt(15)
RD 40,47,6144
Mvaa 124,76,16
TR 72,14,448
TR 74,14,960
Mvaa 116,76,12
s_waitcnt lgkmcnt(15)
Mvaa 128,48,12
TR 76,14,456
TR 78,14,968
Mvaa 136,48,16
s_waitcnt lgkmcnt(15)
Mvaa 140,52,16
ds_write_b128 v23, a[144:147] offset:27136
Mvaa 132,52,12
s_waitcnt lgkmcnt(15)
ds_write_b128 v23, a[148:151] offset:28192
Mvaa 144,56,12
ds_write_b128 v23, a[152:155] offset:35584
Mvaa 152,56,16
s_waitcnt lgkmcnt(14)
ds_write_b128 v23, a[156:159] offset:36640
Mvaa 156,60,16
v_add_u32 v14, 0x1ce00, v13
Mvaa 148,60,12
s_waitcnt vmcnt(15) lgkmcnt(0)
s_barrier
Mvaa 160,64,12
TR 48,14,0
TR 50,14,512
Mvaa 168,64,16
TR 52,14,8
TR 54,14,520
Mvaa 172,68,16
TR 56,14,64
TR 58,14,576
Mvaa 164,68,12
TR 60,14,72
TR 62,14,584
Mvaa 176,72,12
TR 64,14,128
TR 66,14,640
Mvaa 184,72,16
TR 68,14,136
TR 70,14,648
Mvaa 188,76,16
TR 72,14,192
TR 74,14,704
Mvaa 180,76,12
s_waitcnt lgkmcnt(12)
fl_q30:
Mvaa 64,48,24
s_waitcnt lgkmcnt(10)
s_mov_b32 s3, 0x18000
TR 76,14,200
TR 78,14,712
Mvaa 72,48,28
buffer_load_dwordx4 a[136:139], v31, s[16:19], s3 offen nt
Mvaa 76,52,28
s_waitcnt lgkmcnt(10)
TR 48,14,256
TR 50,14,768
Mvaa 68,52,24
buffer_load_dwordx4 a[140:143], v31, s[16:19], s3 offen offset:256 nt
Mvaa 80,56,24
TR 52,14,264
TR 54,14,776
Mvaa 88,56,28
s_waitcnt lgkmcnt(12)
Mvaa 92,60,28
TR 56,14,320
TR 58,14,832
Mvaa 84,60,24
s_waitcnt lgkmcnt(12)
Mvaa 96,64,24
TR 60,14,328
TR 62,14,840
Mvaa 104,64,28
s_waitcnt lgkmcnt(12)
Mvaa 108,68,28
TR 64,14,384
TR 66,14,896
Mvaa 100,68,24
s_waitcnt lgkmcnt(12)
Mvaa 112,72,24
TR 68,14,392
TR 70,14,904
Mvaa 120,72,28
s_waitcnt lgkmcnt(12)
Mvaa 124,76,28
TR 72,14,448
TR 74,14,960
Mvaa 116,76,24
s_waitcnt lgkmcnt(12)
Mvaa 128,48,24
TR 76,14,456
TR 78,14,968
Mvaa 136,48,28
s_waitcnt lgkmcnt(12)
Mvaa 140,52,28
ds_write_b128 v23, a[160:163] offset:44032
Mvaa 132,52,24
s_waitcnt lgkmcnt(11)
ds_write_b128 v23, a[164:167] offset:45088
Mvaa 144,56,24
ds_write_b128 v23, a[168:171] offset:52480
Mvaa 152,56,28
s_waitcnt lgkmcnt(11)
ds_write_b128 v23, a[172:175] offset:53536
Mvaa 156,60,28
v_add_u32 v14, 0x21000, v13
Mvaa 148,60,24
s_call_b64 s[70:71], f_pad7
s_waitcnt vmcnt(5) lgkmcnt(0)
s_barrier
Mvaa 160,64,24
TR 48,14,0
TR 50,14,512
Mvaa 168,64,28
TR 52,14,8
TR 54,14,520
Mvaa 172,68,28
TR 56,14,64
TR 58,14,576
Mvaa 164,68,24
TR 60,14,72
TR 62,14,584
Mvaa 176,72,24
TR 64,14,128
TR 66,14,640
Mvaa 184,72,28
TR 68,14,136
TR 70,14,648
Mvaa 188,76,28
TR 72,14,192
TR 74,14,704
Mvaa 180,76,24
s_waitcnt lgkmcnt(12)
fl_q31:
Mvaa 64,48,36
s_waitcnt lgkmcnt(10)
s_mov_b32 s63, 0x340000
TR 76,14,200
TR 78,14,712
Mvaa 72,48,40
buffer_load_dword v224, v225, s[24:27], s63 offen
Mvaa 76,52,40
s_waitcnt lgkmcnt(10)
s_mov_b32 s3, 0x1c000
TR 48,14,256
TR 50,14,768
Mvaa 68,52,36
buffer_load_dwordx4 a[144:147], v31, s[12:15], s3 offen nt
Mvaa 80,56,36
s_waitcnt lgkmcnt(10)
TR 52,14,264
TR 54,14,776
Mvaa 88,56,40
buffer_load_dwordx4 a[148:151], v31, s[12:15], s3 offen offset:256 nt
Mvaa 92,60,40
s_waitcnt lgkmcnt(10)
s_mov_b32 s3, 0x1a000
TR 56,14,320
TR 58,14,832
Mvaa 84,60,36
buffer_load_dwordx4 a[152:155], v31, s[16:19], s3 offen nt
Mvaa 96,64,36
TR 60,14,328
TR 62,14,840
Mvaa 104,64,40
s_waitcnt lgkmcnt(12)
Mvaa 108,68,40
TR 64,14,384
TR 66,14,896
Mvaa 100,68,36
s_waitcnt lgkmcnt(12)
Mvaa 112,72,36
TR 68,14,392
TR 70,14,904
Mvaa 120,72,40
s_waitcnt lgkmcnt(12)
Mvaa 124,76,40
TR 72,14,448
TR 74,14,960
Mvaa 116,76,36
s_waitcnt lgkmcnt(12)
Mvaa 128,48,36
TR 76,14,456
TR 78,14,968
Mvaa 136,48,40
s_waitcnt lgkmcnt(12)
Mvaa 140,52,40
ds_write_b128 v0, a[80:83] offset:16896
Mvaa 132,52,36
s_waitcnt lgkmcnt(11)
ds_write_b128 v0, a[84:87] offset:17952
Mvaa 144,56,36
ds_write_b128 v0, a[88:91] offset:25344
Mvaa 152,56,40
s_waitcnt lgkmcnt(11)
ds_write_b128 v0, a[92:95] offset:26400
Mvaa 156,60,40
Mvaa 148,60,36
s_call_b64 s[70:71], f_pad8
s_waitcnt lgkmcnt(0)
s_barrier
Mvaa 160,64,36
ds_write_b128 v0, a[96:99] offset:33792
Mvaa 168,64,40
ds_write_b128 v0, a[100:103] offset:34848
Mvaa 172,68,40
ds_write_b128 v0, a[104:107] offset:42240
Mvaa 164,68,36
ds_write_b128 v0, a[108:111] offset:43296
Mvaa 176,72,36
ds_write_b128 v0, a[112:115] offset:50688
Mvaa 184,72,40
ds_write_b128 v0, a[116:119] offset:51744
Mvaa 188,76,40
ds_write_b128 v23, a[120:123] offset:1792
Mvaa 180,76,36
ds_write_b128 v23, a[124:127] offset:2848
ds_write_b128 v19, a[176:179] offset:3584
ds_write_b128 v19, a[180:183] offset:4640
ds_write_b128 v19, a[184:187] offset:12032
ds_write_b128 v19, a[188:191] offset:13088
v_add_u32 v16, 0x25200, v15
RD 0,16,0
RD 4,16,64
RD 8,16,128
RD 12,16,192
RD 16,16,512
RD 20,16,576
RD 24,16,640
RD 28,16,704
s_mov_b32 s54, 0x3e0293ee
s_mov_b32 s55, 0x3e0293ee
v_pk_mul_f32 v[64:65], v[64:65], s[54:55]
v_pk_mul_f32 v[66:67], v[66:67], s[54:55]
v_pk_mul_f32 v[68:69], v[68:69], s[54:55]
v_pk_mul_f32 v[70:71], v[70:71], s[54:55]
v_cvt_pk_bf16_f32 v64, v64, v65
v_cvt_pk_bf16_f32 v65, v66, v67
v_cvt_pk_bf16_f32 v66, v68, v69
v_cvt_pk_bf16_f32 v67, v70, v71
v_pk_mul_f32 v[72:73], v[72:73], s[54:55]
v_pk_mul_f32 v[74:75], v[74:75], s[54:55]
v_pk_mul_f32 v[76:77], v[76:77], s[54:55]
v_pk_mul_f32 v[78:79], v[78:79], s[54:55]
v_cvt_pk_bf16_f32 v68, v72, v73
v_cvt_pk_bf16_f32 v69, v74, v75
v_cvt_pk_bf16_f32 v70, v76, v77
v_cvt_pk_bf16_f32 v71, v78, v79
v_pk_mul_f32 v[80:81], v[80:81], s[54:55]
v_pk_mul_f32 v[82:83], v[82:83], s[54:55]
v_pk_mul_f32 v[84:85], v[84:85], s[54:55]
v_pk_mul_f32 v[86:87], v[86:87], s[54:55]
v_cvt_pk_bf16_f32 v72, v80, v81
v_cvt_pk_bf16_f32 v73, v82, v83
v_cvt_pk_bf16_f32 v74, v84, v85
v_cvt_pk_bf16_f32 v75, v86, v87
v_pk_mul_f32 v[88:89], v[88:89], s[54:55]
v_pk_mul_f32 v[90:91], v[90:91], s[54:55]
v_pk_mul_f32 v[92:93], v[92:93], s[54:55]
v_pk_mul_f32 v[94:95], v[94:95], s[54:55]
v_cvt_pk_bf16_f32 v76, v88, v89
v_cvt_pk_bf16_f32 v77, v90, v91
v_cvt_pk_bf16_f32 v78, v92, v93
v_cvt_pk_bf16_f32 v79, v94, v95
v_pk_mul_f32 v[96:97], v[96:97], s[54:55]
v_pk_mul_f32 v[98:99], v[98:99], s[54:55]
v_pk_mul_f32 v[100:101], v[100:101], s[54:55]
v_pk_mul_f32 v[102:103], v[102:103], s[54:55]
v_cvt_pk_bf16_f32 v80, v96, v97
v_cvt_pk_bf16_f32 v81, v98, v99
v_cvt_pk_bf16_f32 v82, v100, v101
v_cvt_pk_bf16_f32 v83, v102, v103
v_pk_mul_f32 v[104:105], v[104:105], s[54:55]
v_pk_mul_f32 v[106:107], v[106:107], s[54:55]
v_pk_mul_f32 v[108:109], v[108:109], s[54:55]
v_pk_mul_f32 v[110:111], v[110:111], s[54:55]
v_cvt_pk_bf16_f32 v84, v104, v105
v_cvt_pk_bf16_f32 v85, v106, v107
v_cvt_pk_bf16_f32 v86, v108, v109
v_cvt_pk_bf16_f32 v87, v110, v111
v_pk_mul_f32 v[112:113], v[112:113], s[54:55]
v_pk_mul_f32 v[114:115], v[114:115], s[54:55]
v_pk_mul_f32 v[116:117], v[116:117], s[54:55]
v_pk_mul_f32 v[118:119], v[118:119], s[54:55]
v_cvt_pk_bf16_f32 v88, v112, v113
v_cvt_pk_bf16_f32 v89, v114, v115
v_cvt_pk_bf16_f32 v90, v116, v117
v_cvt_pk_bf16_f32 v91, v118, v119
v_pk_mul_f32 v[120:121], v[120:121], s[54:55]
v_pk_mul_f32 v[122:123], v[122:123], s[54:55]
v_pk_mul_f32 v[124:125], v[124:125], s[54:55]
v_pk_mul_f32 v[126:127], v[126:127], s[54:55]
v_cvt_pk_bf16_f32 v92, v120, v121
v_cvt_pk_bf16_f32 v93, v122, v123
v_cvt_pk_bf16_f32 v94, v124, v125
v_cvt_pk_bf16_f32 v95, v126, v127
v_pk_mul_f32 v[128:129], v[128:129], s[54:55]
v_pk_mul_f32 v[130:131], v[130:131], s[54:55]
v_pk_mul_f32 v[132:133], v[132:133], s[54:55]
v_pk_mul_f32 v[134:135], v[134:135], s[54:55]
v_cvt_pk_bf16_f32 v128, v128, v129
v_cvt_pk_bf16_f32 v129, v130, v131
v_cvt_pk_bf16_f32 v130, v132, v133
v_cvt_pk_bf16_f32 v131, v134, v135
v_accvgpr_write_b32 a80, v128
v_accvgpr_write_b32 a81, v129
v_accvgpr_write_b32 a82, v130
v_accvgpr_write_b32 a83, v131
v_pk_mul_f32 v[136:137], v[136:137], s[54:55]
v_pk_mul_f32 v[138:139], v[138:139], s[54:55]
v_pk_mul_f32 v[140:141], v[140:141], s[54:55]
v_pk_mul_f32 v[142:143], v[142:143], s[54:55]
v_cvt_pk_bf16_f32 v136, v136, v137
v_cvt_pk_bf16_f32 v137, v138, v139
v_cvt_pk_bf16_f32 v138, v140, v141
v_cvt_pk_bf16_f32 v139, v142, v143
v_accvgpr_write_b32 a84, v136
v_accvgpr_write_b32 a85, v137
v_accvgpr_write_b32 a86, v138
v_accvgpr_write_b32 a87, v139
v_pk_mul_f32 v[144:145], v[144:145], s[54:55]
v_pk_mul_f32 v[146:147], v[146:147], s[54:55]
v_pk_mul_f32 v[148:149], v[148:149], s[54:55]
v_pk_mul_f32 v[150:151], v[150:151], s[54:55]
v_cvt_pk_bf16_f32 v144, v144, v145
v_cvt_pk_bf16_f32 v145, v146, v147
v_cvt_pk_bf16_f32 v146, v148, v149
v_cvt_pk_bf16_f32 v147, v150, v151
v_accvgpr_write_b32 a88, v144
v_accvgpr_write_b32 a89, v145
v_accvgpr_write_b32 a90, v146
v_accvgpr_write_b32 a91, v147
v_pk_mul_f32 v[152:153], v[152:153], s[54:55]
v_pk_mul_f32 v[154:155], v[154:155], s[54:55]
v_pk_mul_f32 v[156:157], v[156:157], s[54:55]
v_pk_mul_f32 v[158:159], v[158:159], s[54:55]
v_cvt_pk_bf16_f32 v152, v152, v153
v_cvt_pk_bf16_f32 v153, v154, v155
v_cvt_pk_bf16_f32 v154, v156, v157
v_cvt_pk_bf16_f32 v155, v158, v159
v_accvgpr_write_b32 a92, v152
v_accvgpr_write_b32 a93, v153
v_accvgpr_write_b32 a94, v154
v_accvgpr_write_b32 a95, v155
v_pk_mul_f32 v[160:161], v[160:161], s[54:55]
v_pk_mul_f32 v[162:163], v[162:163], s[54:55]
v_pk_mul_f32 v[164:165], v[164:165], s[54:55]
v_pk_mul_f32 v[166:167], v[166:167], s[54:55]
v_cvt_pk_bf16_f32 v160, v160, v161
v_cvt_pk_bf16_f32 v161, v162, v163
v_cvt_pk_bf16_f32 v162, v164, v165
v_cvt_pk_bf16_f32 v163, v166, v167
v_accvgpr_write_b32 a96, v160
v_accvgpr_write_b32 a97, v161
v_accvgpr_write_b32 a98, v162
v_accvgpr_write_b32 a99, v163
v_pk_mul_f32 v[168:169], v[168:169], s[54:55]
v_pk_mul_f32 v[170:171], v[170:171], s[54:55]
v_pk_mul_f32 v[172:173], v[172:173], s[54:55]
v_pk_mul_f32 v[174:175], v[174:175], s[54:55]
v_cvt_pk_bf16_f32 v168, v168, v169
v_cvt_pk_bf16_f32 v169, v170, v171
v_cvt_pk_bf16_f32 v170, v172, v173
v_cvt_pk_bf16_f32 v171, v174, v175
v_accvgpr_write_b32 a100, v168
v_accvgpr_write_b32 a101, v169
v_accvgpr_write_b32 a102, v170
v_accvgpr_write_b32 a103, v171
v_pk_mul_f32 v[176:177], v[176:177], s[54:55]
v_pk_mul_f32 v[178:179], v[178:179], s[54:55]
v_pk_mul_f32 v[180:181], v[180:181], s[54:55]
v_pk_mul_f32 v[182:183], v[182:183], s[54:55]
v_cvt_pk_bf16_f32 v176, v176, v177
v_cvt_pk_bf16_f32 v177, v178, v179
v_cvt_pk_bf16_f32 v178, v180, v181
v_cvt_pk_bf16_f32 v179, v182, v183
v_accvgpr_write_b32 a104, v176
v_accvgpr_write_b32 a105, v177
v_accvgpr_write_b32 a106, v178
v_accvgpr_write_b32 a107, v179
v_pk_mul_f32 v[184:185], v[184:185], s[54:55]
v_pk_mul_f32 v[186:187], v[186:187], s[54:55]
v_pk_mul_f32 v[188:189], v[188:189], s[54:55]
v_pk_mul_f32 v[190:191], v[190:191], s[54:55]
v_cvt_pk_bf16_f32 v184, v184, v185
v_cvt_pk_bf16_f32 v185, v186, v187
v_cvt_pk_bf16_f32 v186, v188, v189
v_cvt_pk_bf16_f32 v187, v190, v191
v_accvgpr_write_b32 a108, v184
v_accvgpr_write_b32 a109, v185
v_accvgpr_write_b32 a110, v186
v_accvgpr_write_b32 a111, v187
s_waitcnt lgkmcnt(7)
Zvav 112,0,64
s_waitcnt lgkmcnt(6)
Zvav 120,0,68
buffer_load_dwordx4 a[156:159], v31, s[16:19], s3 offen offset:256 nt
Mvav 112,4,72
s_waitcnt lgkmcnt(5)
s_mov_b32 s3, 0x1e000
Mvav 120,4,76
buffer_load_dwordx4 a[160:163], v31, s[12:15], s3 offen nt
Mvav 112,8,80
s_waitcnt lgkmcnt(4)
Mvav 120,8,84
buffer_load_dwordx4 a[164:167], v31, s[12:15], s3 offen offset:256 nt
Mvav 112,12,88
s_waitcnt lgkmcnt(3)
s_mov_b32 s3, 0x1c000
Mvav 120,12,92
buffer_load_dwordx4 a[168:171], v31, s[16:19], s3 offen nt
Zvav 116,16,64
ds_write_b128 v19, a[192:195] offset:20480
Zvav 124,16,68
s_waitcnt lgkmcnt(3)
Mvav 116,20,72
ds_write_b128 v19, a[196:199] offset:21536
Mvav 124,20,76
s_waitcnt lgkmcnt(3)
Mvav 116,24,80
ds_write_b128 v19, a[200:203] offset:28928
Mvav 124,24,84
s_waitcnt lgkmcnt(3)
Mvav 116,28,88
ds_write_b128 v19, a[204:207] offset:29984
Mvav 124,28,92
v_add_u32 v16, 0, v15
v_add_u32 v18, 0, v17
RD 0,16,0
RD 4,16,64
RD 8,16,128
RD 12,16,192
v_max3_f32 v32, v112, v113, v114
v_max3_f32 v33, v120, v121, v122
v_max_f32 v32, v115, v32
v_max_f32 v33, v123, v33
v_max3_f32 v32, v32, v116, v117
v_max3_f32 v33, v33, v124, v125
v_max3_f32 v32, v32, v118, v119
v_max3_f32 v33, v33, v126, v127
v_mov_b32 v36, v32
v_mov_b32 v37, v33
s_nop 0
v_permlane32_swap_b32 v36, v32
v_permlane32_swap_b32 v37, v33
v_max_f32 v32, v36, v32
v_max_f32 v33, v37, v33
v_mov_b32 v36, v32
v_mov_b32 v37, v33
s_nop 0
v_permlane16_swap_b32 v36, v32
v_permlane16_swap_b32 v37, v33
v_max_f32 v32, v36, v32
v_max_f32 v33, v37, v33
v_sub_f32 v40, 0, v32
v_sub_f32 v44, 0, v33
v_sub_f32 v41, 0, v32
v_sub_f32 v45, 0, v33
v_sub_f32 v42, 0, v32
v_sub_f32 v46, 0, v33
v_sub_f32 v43, 0, v32
v_sub_f32 v47, 0, v33
v_sub_f32 v112, v112, v32
v_sub_f32 v120, v120, v33
v_sub_f32 v113, v113, v32
v_sub_f32 v121, v121, v33
v_sub_f32 v114, v114, v32
v_sub_f32 v122, v122, v33
v_sub_f32 v115, v115, v32
v_sub_f32 v123, v123, v33
v_sub_f32 v116, v116, v32
v_sub_f32 v124, v124, v33
v_sub_f32 v117, v117, v32
v_sub_f32 v125, v125, v33
v_sub_f32 v118, v118, v32
v_sub_f32 v126, v126, v33
v_sub_f32 v119, v119, v32
v_sub_f32 v127, v127, v33
v_exp_f32 v112, v112
v_exp_f32 v120, v120
v_exp_f32 v113, v113
v_exp_f32 v121, v121
v_exp_f32 v114, v114
v_exp_f32 v122, v122
v_exp_f32 v115, v115
v_exp_f32 v123, v123
v_exp_f32 v116, v116
v_exp_f32 v124, v124
v_exp_f32 v117, v117
v_exp_f32 v125, v125
v_exp_f32 v118, v118
v_exp_f32 v126, v126
v_exp_f32 v119, v119
v_exp_f32 v127, v127
fl_a0:
s_waitcnt lgkmcnt(3)
Cvav 136,0,64,40
RD 16,16,512
v_cvt_pk_bf16_f32 v115, v114, v115
Cvav 144,0,68,44
s_waitcnt lgkmcnt(3)
RD 20,16,576
v_cvt_pk_bf16_f32 v114, v112, v113
Mvav 136,4,72
RD 24,16,640
v_cvt_pk_bf16_f32 v116, v116, v117
Mvav 144,4,76
s_waitcnt lgkmcnt(4)
RD 28,16,704
v_cvt_pk_bf16_f32 v117, v118, v119
Mvav 136,8,80
TR 32,18,8448
v_cvt_pk_bf16_f32 v123, v122, v123
Mvav 144,8,84
s_waitcnt lgkmcnt(5)
TR 34,18,8960
v_cvt_pk_bf16_f32 v122, v120, v121
Mvav 136,12,88
TR 36,18,8480
v_cvt_pk_bf16_f32 v124, v124, v125
Mvav 144,12,92
s_waitcnt lgkmcnt(6)
TR 38,18,8992
v_cvt_pk_bf16_f32 v125, v126, v127
Cvav 140,16,64,40
s_waitcnt lgkmcnt(6)
TR 40,18,8512
v_exp_f32 v136, v136
Cvav 148,16,68,44
buffer_load_dwordx4 a[172:175], v31, s[16:19], s3 offen offset:256 nt
TR 42,18,9024
v_exp_f32 v137, v137
Mvav 140,20,72
s_waitcnt lgkmcnt(7)
s_mov_b32 s3, 0x20000
TR 44,18,8544
v_exp_f32 v138, v138
Mvav 148,20,76
buffer_load_dwordx4 a[176:179], v31, s[12:15], s3 offen nt
TR 46,18,9056
v_exp_f32 v139, v139
Mvav 140,24,80
s_waitcnt lgkmcnt(8)
v_exp_f32 v144, v144
Mvav 148,24,84
buffer_load_dwordx4 a[180:183], v31, s[12:15], s3 offen offset:256 nt
v_exp_f32 v145, v145
Mvav 140,28,88
s_waitcnt lgkmcnt(6)
v_exp_f32 v146, v146
v_add_u32 v226, ((fh_a0-f_start+5120)&0xffffff80), v227
v_min_u32 v226, f_end-f_start, v226
Mvav 148,28,92
global_load_dword v224, v226, s[98:99]
v_exp_f32 v147, v147
Zvav 160,32,114
s_waitcnt lgkmcnt(4)
TR 48,18,8576
TR 50,18,9088
v_add_u32 v226, ((fl_a0-f_start+5120)&0xffffff80), v227
v_min_u32 v226, f_end-f_start, v226
Zvav 168,32,122
global_load_dword v224, v226, s[98:99]
v_exp_f32 v140, v140
Zvav 172,36,122
TR 52,18,8608
TR 54,18,9120
Zvav 164,36,114
s_waitcnt lgkmcnt(6)
v_exp_f32 v141, v141
Zvav 176,40,114
TR 56,18,8640
TR 58,18,9152
Zvav 184,40,122
s_waitcnt lgkmcnt(6)
v_exp_f32 v142, v142
Zvav 188,44,122
TR 60,18,8672
TR 62,18,9184
Zvav 180,44,114
s_waitcnt lgkmcnt(6)
v_exp_f32 v143, v143
Zvav 192,48,114
v_exp_f32 v148, v148
Zvav 200,48,122
s_waitcnt lgkmcnt(4)
v_add_u32 v16, 0x4200, v15
v_add_u32 v18, 0x4200, v17
Zvav 204,52,122
v_exp_f32 v149, v149
Zvav 196,52,114
s_waitcnt lgkmcnt(0)
s_barrier
Zvav 208,56,114
RD 0,16,0
Zvav 216,56,122
RD 4,16,64
Zvav 220,60,122
RD 8,16,128
v_exp_f32 v150, v150
Zvav 212,60,114
RD 12,16,192
v_exp_f32 v151, v151
Zvvv 52,24,114
Zvvv 56,24,122
s_waitcnt lgkmcnt(3)
fl_a1:
Cvav 112,0,64,40
RD 16,16,512
v_cvt_pk_bf16_f32 v139, v138, v139
Cvav 120,0,68,44
s_waitcnt lgkmcnt(3)
RD 20,16,576
v_cvt_pk_bf16_f32 v138, v136, v137
Mvav 112,4,72
RD 24,16,640
v_cvt_pk_bf16_f32 v140, v140, v141
Mvav 120,4,76
s_waitcnt lgkmcnt(4)
RD 28,16,704
v_cvt_pk_bf16_f32 v141, v142, v143
Mvav 112,8,80
TR 32,18,8448
v_cvt_pk_bf16_f32 v147, v146, v147
Mvav 120,8,84
s_waitcnt lgkmcnt(5)
TR 34,18,8960
v_cvt_pk_bf16_f32 v146, v144, v145
Mvav 112,12,88
TR 36,18,8480
v_cvt_pk_bf16_f32 v148, v148, v149
Mvav 120,12,92
s_waitcnt lgkmcnt(6)
TR 38,18,8992
v_cvt_pk_bf16_f32 v149, v150, v151
Cvav 116,16,64,40
s_waitcnt lgkmcnt(6)
s_mov_b32 s3, 0x1e000
TR 40,18,8512
v_exp_f32 v112, v112
Cvav 124,16,68,44
buffer_load_dwordx4 a[184:187], v31, s[16:19], s3 offen nt
TR 42,18,9024
v_exp_f32 v113, v113
Mvav 116,20,72
s_waitcnt lgkmcnt(7)
TR 44,18,8544
v_exp_f32 v114, v114
Mvav 124,20,76
buffer_load_dwordx4 a[188:191], v31, s[16:19], s3 offen offset:256 nt
TR 46,18,9056
v_exp_f32 v115, v115
Mvav 116,24,80
s_waitcnt lgkmcnt(8)
v_exp_f32 v120, v120
Mvav 124,24,84
ds_write_b128 v0, a[208:211]
v_exp_f32 v121, v121
Mvav 116,28,88
s_waitcnt lgkmcnt(7)
v_exp_f32 v122, v122
Mvav 124,28,92
ds_write_b128 v0, a[212:215] offset:1056
v_exp_f32 v123, v123
Mvav 160,32,138
s_waitcnt lgkmcnt(6)
TR 48,18,8576
TR 50,18,9088
Mvav 168,32,146
ds_write_b128 v0, a[216:219] offset:8448
v_exp_f32 v116, v116
Mvav 172,36,146
s_waitcnt lgkmcnt(7)
TR 52,18,8608
TR 54,18,9120
Mvav 164,36,138
ds_write_b128 v0, a[220:223] offset:9504
v_exp_f32 v117, v117
Mvav 176,40,138
TR 56,18,8640
TR 58,18,9152
Mvav 184,40,146
s_waitcnt lgkmcnt(10)
v_exp_f32 v118, v118
Mvav 188,44,146
TR 60,18,8672
TR 62,18,9184
Mvav 180,44,138
s_waitcnt lgkmcnt(8)
v_exp_f32 v119, v119
Mvav 192,48,138
v_exp_f32 v124, v124
Mvav 200,48,146
s_waitcnt lgkmcnt(5)
v_add_u32 v16, 0x8400, v15
v_add_u32 v18, 0x8400, v17
Mvav 204,52,146
v_exp_f32 v125, v125
Mvav 196,52,138
s_waitcnt lgkmcnt(0)
s_barrier
Mvav 208,56,138
RD 0,16,0
Mvav 216,56,146
RD 4,16,64
Mvav 220,60,146
RD 8,16,128
v_exp_f32 v126, v126
Mvav 212,60,138
RD 12,16,192
v_exp_f32 v127, v127
Mvvv 52,24,138
Mvvv 56,24,146
s_waitcnt lgkmcnt(3)
fl_a2:
Cvav 136,0,64,40
RD 16,16,512
v_cvt_pk_bf16_f32 v115, v114, v115
Cvav 144,0,68,44
s_waitcnt lgkmcnt(3)
RD 20,16,576
v_cvt_pk_bf16_f32 v114, v112, v113
Mvav 136,4,72
RD 24,16,640
v_cvt_pk_bf16_f32 v116, v116, v117
Mvav 144,4,76
s_waitcnt lgkmcnt(4)
RD 28,16,704
v_cvt_pk_bf16_f32 v117, v118, v119
Mvav 136,8,80
TR 32,18,8448
v_cvt_pk_bf16_f32 v123, v122, v123
Mvav 144,8,84
s_waitcnt lgkmcnt(5)
TR 34,18,8960
v_cvt_pk_bf16_f32 v122, v120, v121
Mvav 136,12,88
TR 36,18,8480
v_cvt_pk_bf16_f32 v124, v124, v125
Mvav 144,12,92
s_waitcnt lgkmcnt(6)
TR 38,18,8992
v_cvt_pk_bf16_f32 v125, v126, v127
Cvav 140,16,64,40
s_waitcnt lgkmcnt(6)
s_mov_b32 s3, 0x22000
TR 40,18,8512
v_exp_f32 v136, v136
Cvav 148,16,68,44
buffer_load_dwordx4 a[192:195], v31, s[12:15], s3 offen nt
TR 42,18,9024
v_exp_f32 v137, v137
Mvav 140,20,72
s_waitcnt lgkmcnt(7)
TR 44,18,8544
v_exp_f32 v138, v138
Mvav 148,20,76
buffer_load_dwordx4 a[196:199], v31, s[12:15], s3 offen offset:256 nt
TR 46,18,9056
v_exp_f32 v139, v139
Mvav 140,24,80
s_waitcnt lgkmcnt(8)
s_mov_b32 s3, 0x20000
v_exp_f32 v144, v144
Mvav 148,24,84
buffer_load_dwordx4 a[200:203], v31, s[16:19], s3 offen nt
v_exp_f32 v145, v145
Mvav 140,28,88
s_waitcnt lgkmcnt(6)
v_exp_f32 v146, v146
Mvav 148,28,92
ds_write_b128 v0, a[224:227] offset:16896
v_exp_f32 v147, v147
Mvav 160,32,114
s_waitcnt lgkmcnt(5)
TR 48,18,8576
TR 50,18,9088
Mvav 168,32,122
ds_write_b128 v0, a[228:231] offset:17952
v_exp_f32 v140, v140
Mvav 172,36,122
s_waitcnt lgkmcnt(6)
TR 52,18,8608
TR 54,18,9120
Mvav 164,36,114
ds_write_b128 v0, a[232:235] offset:25344
v_exp_f32 v141, v141
Mvav 176,40,114
s_waitcnt lgkmcnt(7)
TR 56,18,8640
TR 58,18,9152
Mvav 184,40,122
ds_write_b128 v0, a[236:239] offset:26400
v_exp_f32 v142, v142
Mvav 188,44,122
TR 60,18,8672
TR 62,18,9184
Mvav 180,44,114
s_waitcnt lgkmcnt(9)
v_exp_f32 v143, v143
Mvav 192,48,114
v_exp_f32 v148, v148
Mvav 200,48,122
s_waitcnt lgkmcnt(6)
v_add_u32 v16, 0xc600, v15
v_add_u32 v18, 0xc600, v17
Mvav 204,52,122
v_exp_f32 v149, v149
Mvav 196,52,114
s_waitcnt lgkmcnt(0)
s_barrier
Mvav 208,56,114
RD 0,16,0
Mvav 216,56,122
RD 4,16,64
Mvav 220,60,122
RD 8,16,128
v_exp_f32 v150, v150
Mvav 212,60,114
RD 12,16,192
v_exp_f32 v151, v151
Mvvv 52,24,114
Mvvv 56,24,122
s_waitcnt lgkmcnt(3)
fl_a3:
Cvav 112,0,64,40
RD 16,16,512
v_cvt_pk_bf16_f32 v139, v138, v139
Cvav 120,0,68,44
s_waitcnt lgkmcnt(3)
RD 20,16,576
v_cvt_pk_bf16_f32 v138, v136, v137
Mvav 112,4,72
RD 24,16,640
v_cvt_pk_bf16_f32 v140, v140, v141
Mvav 120,4,76
s_waitcnt lgkmcnt(4)
RD 28,16,704
v_cvt_pk_bf16_f32 v141, v142, v143
Mvav 112,8,80
TR 32,18,8448
v_cvt_pk_bf16_f32 v147, v146, v147
Mvav 120,8,84
s_waitcnt lgkmcnt(5)
TR 34,18,8960
v_cvt_pk_bf16_f32 v146, v144, v145
Mvav 112,12,88
TR 36,18,8480
v_cvt_pk_bf16_f32 v148, v148, v149
Mvav 120,12,92
s_waitcnt lgkmcnt(6)
TR 38,18,8992
v_cvt_pk_bf16_f32 v149, v150, v151
Cvav 116,16,64,40
s_waitcnt lgkmcnt(6)
TR 40,18,8512
v_exp_f32 v112, v112
Cvav 124,16,68,44
buffer_load_dwordx4 a[204:207], v31, s[16:19], s3 offen offset:256 nt
TR 42,18,9024
v_exp_f32 v113, v113
Mvav 116,20,72
s_waitcnt lgkmcnt(7)
s_mov_b32 s3, 0x24000
TR 44,18,8544
v_exp_f32 v114, v114
Mvav 124,20,76
buffer_load_dwordx4 a[208:211], v31, s[12:15], s3 offen nt
TR 46,18,9056
v_exp_f32 v115, v115
Mvav 116,24,80
s_waitcnt lgkmcnt(8)
v_exp_f32 v120, v120
Mvav 124,24,84
ds_write_b128 v0, a[240:243] offset:33792
v_exp_f32 v121, v121
Mvav 116,28,88
s_waitcnt lgkmcnt(7)
v_exp_f32 v122, v122
Mvav 124,28,92
ds_write_b128 v0, a[244:247] offset:34848
v_exp_f32 v123, v123
Mvav 160,32,138
s_waitcnt lgkmcnt(6)
TR 48,18,8576
TR 50,18,9088
Mvav 168,32,146
ds_write_b128 v0, a[248:251] offset:42240
v_exp_f32 v116, v116
Mvav 172,36,146
s_waitcnt lgkmcnt(7)
TR 52,18,8608
TR 54,18,9120
Mvav 164,36,138
ds_write_b128 v0, a[252:255] offset:43296
v_exp_f32 v117, v117
Mvav 176,40,138
TR 56,18,8640
TR 58,18,9152
Mvav 184,40,146
s_waitcnt lgkmcnt(10)
v_exp_f32 v118, v118
Mvav 188,44,146
TR 60,18,8672
TR 62,18,9184
Mvav 180,44,138
s_waitcnt lgkmcnt(8)
v_exp_f32 v119, v119
Mvav 192,48,138
v_exp_f32 v124, v124
Mvav 200,48,146
s_waitcnt lgkmcnt(5)
v_add_u32 v16, 0x10800, v15
v_add_u32 v18, 0x10800, v17
Mvav 204,52,146
v_exp_f32 v125, v125
Mvav 196,52,138
s_waitcnt lgkmcnt(0)
s_barrier
Mvav 208,56,138
RD 0,16,0
Mvav 216,56,146
RD 4,16,64
Mvav 220,60,146
RD 8,16,128
v_exp_f32 v126, v126
Mvav 212,60,138
RD 12,16,192
v_exp_f32 v127, v127
Mvvv 52,24,138
Mvvv 56,24,146
s_waitcnt lgkmcnt(3)
fl_a4:
Cvav 136,0,64,40
RD 16,16,512
v_cvt_pk_bf16_f32 v115, v114, v115
Cvav 144,0,68,44
s_waitcnt lgkmcnt(3)
RD 20,16,576
v_cvt_pk_bf16_f32 v114, v112, v113
Mvav 136,4,72
RD 24,16,640
v_cvt_pk_bf16_f32 v116, v116, v117
Mvav 144,4,76
s_waitcnt lgkmcnt(4)
RD 28,16,704
v_cvt_pk_bf16_f32 v117, v118, v119
Mvav 136,8,80
TR 32,18,8448
v_cvt_pk_bf16_f32 v123, v122, v123
Mvav 144,8,84
s_waitcnt lgkmcnt(5)
TR 34,18,8960
v_cvt_pk_bf16_f32 v122, v120, v121
Mvav 136,12,88
TR 36,18,8480
v_cvt_pk_bf16_f32 v124, v124, v125
Mvav 144,12,92
s_waitcnt lgkmcnt(6)
TR 38,18,8992
v_cvt_pk_bf16_f32 v125, v126, v127
Cvav 140,16,64,40
s_waitcnt lgkmcnt(6)
TR 40,18,8512
v_exp_f32 v136, v136
Cvav 148,16,68,44
buffer_load_dwordx4 a[212:215], v31, s[12:15], s3 offen offset:256 nt
TR 42,18,9024
v_exp_f32 v137, v137
Mvav 140,20,72
s_waitcnt lgkmcnt(7)
s_mov_b32 s3, 0x22000
TR 44,18,8544
v_exp_f32 v138, v138
Mvav 148,20,76
buffer_load_dwordx4 a[216:219], v31, s[16:19], s3 offen nt
TR 46,18,9056
v_exp_f32 v139, v139
Mvav 140,24,80
s_waitcnt vmcnt(25) lgkmcnt(8)
v_exp_f32 v144, v144
Mvav 148,24,84
ds_write_b128 v0, a[128:131] offset:50688
v_exp_f32 v145, v145
Mvav 140,28,88
s_waitcnt vmcnt(24) lgkmcnt(7)
v_exp_f32 v146, v146
Mvav 148,28,92
ds_write_b128 v0, a[132:135] offset:51744
v_exp_f32 v147, v147
Mvav 160,32,114
s_waitcnt vmcnt(23) lgkmcnt(6)
TR 48,18,8576
TR 50,18,9088
Mvav 168,32,122
ds_write_b128 v23, a[136:139] offset:1792
v_exp_f32 v140, v140
Mvav 172,36,122
s_waitcnt vmcnt(22) lgkmcnt(7)
TR 52,18,8608
TR 54,18,9120
Mvav 164,36,114
ds_write_b128 v23, a[140:143] offset:2848
v_exp_f32 v141, v141
Mvav 176,40,114
TR 56,18,8640
TR 58,18,9152
Mvav 184,40,122
s_waitcnt lgkmcnt(10)
v_exp_f32 v142, v142
Mvav 188,44,122
TR 60,18,8672
TR 62,18,9184
Mvav 180,44,114
s_waitcnt lgkmcnt(8)
v_exp_f32 v143, v143
Mvav 192,48,114
v_exp_f32 v148, v148
Mvav 200,48,122
s_waitcnt lgkmcnt(5)
v_add_u32 v16, 0x14a00, v15
v_add_u32 v18, 0x14a00, v17
Mvav 204,52,122
v_exp_f32 v149, v149
Mvav 196,52,114
s_call_b64 s[70:71], f_pad9
s_waitcnt lgkmcnt(0)
s_barrier
buffer_load_dword v30, v28, s[36:39], s58 offen sc1
Mvav 208,56,114
RD 0,16,0
Mvav 216,56,122
RD 4,16,64
Mvav 220,60,122
RD 8,16,128
v_exp_f32 v150, v150
Mvav 212,60,114
RD 12,16,192
v_exp_f32 v151, v151
Mvvv 52,24,114
Mvvv 56,24,122
s_waitcnt lgkmcnt(3)
fl_a5:
Cvav 112,0,64,40
RD 16,16,512
v_cvt_pk_bf16_f32 v139, v138, v139
Cvav 120,0,68,44
s_waitcnt lgkmcnt(3)
RD 20,16,576
v_cvt_pk_bf16_f32 v138, v136, v137
Mvav 112,4,72
RD 24,16,640
v_cvt_pk_bf16_f32 v140, v140, v141
Mvav 120,4,76
s_waitcnt lgkmcnt(4)
RD 28,16,704
v_cvt_pk_bf16_f32 v141, v142, v143
Mvav 112,8,80
TR 32,18,8448
v_cvt_pk_bf16_f32 v147, v146, v147
Mvav 120,8,84
s_waitcnt lgkmcnt(5)
TR 34,18,8960
v_cvt_pk_bf16_f32 v146, v144, v145
Mvav 112,12,88
TR 36,18,8480
v_cvt_pk_bf16_f32 v148, v148, v149
Mvav 120,12,92
s_waitcnt lgkmcnt(6)
TR 38,18,8992
v_cvt_pk_bf16_f32 v149, v150, v151
Cvav 116,16,64,40
s_waitcnt lgkmcnt(6)
TR 40,18,8512
v_exp_f32 v112, v112
Cvav 124,16,68,44
buffer_load_dwordx4 a[220:223], v31, s[16:19], s3 offen offset:256 nt
TR 42,18,9024
v_exp_f32 v113, v113
Mvav 116,20,72
s_waitcnt lgkmcnt(7)
s_mov_b32 s3, 0x26000
TR 44,18,8544
v_exp_f32 v114, v114
Mvav 124,20,76
buffer_load_dwordx4 a[224:227], v31, s[12:15], s3 offen nt
TR 46,18,9056
v_exp_f32 v115, v115
Mvav 116,24,80
s_waitcnt lgkmcnt(8)
v_exp_f32 v120, v120
Mvav 124,24,84
buffer_load_dwordx4 a[228:231], v31, s[12:15], s3 offen offset:256 nt
v_exp_f32 v121, v121
Mvav 116,28,88
s_waitcnt vmcnt(24) lgkmcnt(6)
v_exp_f32 v122, v122
Mvav 124,28,92
ds_write_b128 v23, a[144:147] offset:10240
v_exp_f32 v123, v123
Mvav 160,32,138
s_waitcnt vmcnt(23) lgkmcnt(5)
TR 48,18,8576
TR 50,18,9088
Mvav 168,32,146
ds_write_b128 v23, a[148:151] offset:11296
v_exp_f32 v116, v116
Mvav 172,36,146
s_waitcnt vmcnt(22) lgkmcnt(6)
TR 52,18,8608
TR 54,18,9120
Mvav 164,36,138
ds_write_b128 v23, a[152:155] offset:18688
v_exp_f32 v117, v117
Mvav 176,40,138
s_waitcnt vmcnt(21) lgkmcnt(7)
TR 56,18,8640
TR 58,18,9152
Mvav 184,40,146
ds_write_b128 v23, a[156:159] offset:19744
v_exp_f32 v118, v118
Mvav 188,44,146
TR 60,18,8672
TR 62,18,9184
Mvav 180,44,138
s_waitcnt lgkmcnt(9)
v_exp_f32 v119, v119
Mvav 192,48,138
v_exp_f32 v124, v124
Mvav 200,48,146
s_waitcnt lgkmcnt(6)
v_add_u32 v16, 0x18c00, v15
v_add_u32 v18, 0x18c00, v17
Mvav 204,52,146
v_exp_f32 v125, v125
Mvav 196,52,138
s_waitcnt lgkmcnt(0)
s_barrier
Mvav 208,56,138
RD 0,16,0
Mvav 216,56,146
RD 4,16,64
Mvav 220,60,146
RD 8,16,128
v_exp_f32 v126, v126
Mvav 212,60,138
RD 12,16,192
v_exp_f32 v127, v127
Mvvv 52,24,138
Mvvv 56,24,146
s_waitcnt lgkmcnt(3)
fl_a6:
Cvav 136,0,64,40
RD 16,16,512
v_cvt_pk_bf16_f32 v115, v114, v115
Cvav 144,0,68,44
s_waitcnt lgkmcnt(3)
RD 20,16,576
v_cvt_pk_bf16_f32 v114, v112, v113
Mvav 136,4,72
RD 24,16,640
v_cvt_pk_bf16_f32 v116, v116, v117
Mvav 144,4,76
s_waitcnt lgkmcnt(4)
RD 28,16,704
v_cvt_pk_bf16_f32 v117, v118, v119
Mvav 136,8,80
TR 32,18,8448
v_cvt_pk_bf16_f32 v123, v122, v123
Mvav 144,8,84
s_waitcnt lgkmcnt(5)
TR 34,18,8960
v_cvt_pk_bf16_f32 v122, v120, v121
Mvav 136,12,88
TR 36,18,8480
v_cvt_pk_bf16_f32 v124, v124, v125
Mvav 144,12,92
s_waitcnt lgkmcnt(6)
TR 38,18,8992
v_cvt_pk_bf16_f32 v125, v126, v127
Cvav 140,16,64,40
s_waitcnt lgkmcnt(6)
s_mov_b32 s3, 0x24000
TR 40,18,8512
v_exp_f32 v136, v136
Cvav 148,16,68,44
buffer_load_dwordx4 a[232:235], v31, s[16:19], s3 offen nt
TR 42,18,9024
v_exp_f32 v137, v137
Mvav 140,20,72
s_waitcnt lgkmcnt(7)
TR 44,18,8544
v_exp_f32 v138, v138
Mvav 148,20,76
buffer_load_dwordx4 a[236:239], v31, s[16:19], s3 offen offset:256 nt
TR 46,18,9056
v_exp_f32 v139, v139
Mvav 140,24,80
s_waitcnt vmcnt(22) lgkmcnt(8)
v_exp_f32 v144, v144
Mvav 148,24,84
ds_write_b128 v23, a[160:163] offset:27136
v_exp_f32 v145, v145
Mvav 140,28,88
s_waitcnt vmcnt(21) lgkmcnt(7)
v_exp_f32 v146, v146
Mvav 148,28,92
ds_write_b128 v23, a[164:167] offset:28192
v_exp_f32 v147, v147
Mvav 160,32,114
s_waitcnt vmcnt(20) lgkmcnt(6)
TR 48,18,8576
TR 50,18,9088
Mvav 168,32,122
ds_write_b128 v23, a[168:171] offset:35584
v_exp_f32 v140, v140
Mvav 172,36,122
s_waitcnt vmcnt(19) lgkmcnt(7)
TR 52,18,8608
TR 54,18,9120
Mvav 164,36,114
ds_write_b128 v23, a[172:175] offset:36640
v_exp_f32 v141, v141
Mvav 176,40,114
s_waitcnt lgkmcnt(8)
TR 56,18,8640
TR 58,18,9152
v_add_u32 v226, ((fh_a6-f_start+5120)&0xffffff80), v227
v_min_u32 v226, f_end-f_start, v226
Mvav 184,40,122
global_load_dword v224, v226, s[98:99]
v_exp_f32 v142, v142
Mvav 188,44,122
s_waitcnt lgkmcnt(6)
TR 60,18,8672
TR 62,18,9184
v_add_u32 v226, ((fl_a6-f_start+5120)&0xffffff80), v227
v_min_u32 v226, f_end-f_start, v226
Mvav 180,44,114
global_load_dword v224, v226, s[98:99]
v_exp_f32 v143, v143
Mvav 192,48,114
v_exp_f32 v148, v148
Mvav 200,48,122
s_waitcnt lgkmcnt(5)
v_add_u32 v16, 0x1ce00, v15
v_add_u32 v18, 0x1ce00, v17
Mvav 204,52,122
v_exp_f32 v149, v149
Mvav 196,52,114
s_waitcnt lgkmcnt(0)
s_barrier
Mvav 208,56,114
RD 0,16,0
Mvav 216,56,122
RD 4,16,64
Mvav 220,60,122
RD 8,16,128
v_exp_f32 v150, v150
Mvav 212,60,114
RD 12,16,192
v_exp_f32 v151, v151
Mvvv 52,24,114
Mvvv 56,24,122
s_waitcnt lgkmcnt(3)
fl_a7:
Cvav 112,0,64,40
RD 16,16,512
v_cvt_pk_bf16_f32 v139, v138, v139
Cvav 120,0,68,44
s_waitcnt lgkmcnt(3)
RD 20,16,576
v_cvt_pk_bf16_f32 v138, v136, v137
Mvav 112,4,72
RD 24,16,640
v_cvt_pk_bf16_f32 v140, v140, v141
Mvav 120,4,76
s_waitcnt lgkmcnt(4)
RD 28,16,704
v_cvt_pk_bf16_f32 v141, v142, v143
Mvav 112,8,80
TR 32,18,8448
v_cvt_pk_bf16_f32 v147, v146, v147
Mvav 120,8,84
s_waitcnt lgkmcnt(5)
TR 34,18,8960
v_cvt_pk_bf16_f32 v146, v144, v145
Mvav 112,12,88
TR 36,18,8480
v_cvt_pk_bf16_f32 v148, v148, v149
Mvav 120,12,92
s_waitcnt lgkmcnt(6)
TR 38,18,8992
v_cvt_pk_bf16_f32 v149, v150, v151
Cvav 116,16,64,40
s_waitcnt lgkmcnt(6)
s_mov_b32 s3, 0x28000
TR 40,18,8512
v_exp_f32 v112, v112
Cvav 124,16,68,44
buffer_load_dwordx4 a[240:243], v31, s[12:15], s3 offen nt
TR 42,18,9024
v_exp_f32 v113, v113
Mvav 116,20,72
s_waitcnt lgkmcnt(7)
TR 44,18,8544
v_exp_f32 v114, v114
Mvav 124,20,76
buffer_load_dwordx4 a[244:247], v31, s[12:15], s3 offen offset:256 nt
TR 46,18,9056
v_exp_f32 v115, v115
Mvav 116,24,80
s_waitcnt lgkmcnt(8)
s_mov_b32 s3, 0x26000
v_exp_f32 v120, v120
Mvav 124,24,84
buffer_load_dwordx4 a[248:251], v31, s[16:19], s3 offen nt
v_exp_f32 v121, v121
Mvav 116,28,88
s_waitcnt vmcnt(23) lgkmcnt(6)
v_exp_f32 v122, v122
Mvav 124,28,92
ds_write_b128 v23, a[176:179] offset:44032
v_exp_f32 v123, v123
Mvav 160,32,138
s_waitcnt vmcnt(22) lgkmcnt(5)
TR 48,18,8576
TR 50,18,9088
Mvav 168,32,146
ds_write_b128 v23, a[180:183] offset:45088
v_exp_f32 v116, v116
Mvav 172,36,146
s_waitcnt vmcnt(19) lgkmcnt(6)
TR 52,18,8608
TR 54,18,9120
Mvav 164,36,138
ds_write_b128 v23, a[184:187] offset:52480
v_exp_f32 v117, v117
Mvav 176,40,138
s_waitcnt vmcnt(18) lgkmcnt(7)
TR 56,18,8640
TR 58,18,9152
Mvav 184,40,146
ds_write_b128 v23, a[188:191] offset:53536
v_exp_f32 v118, v118
Mvav 188,44,146
TR 60,18,8672
TR 62,18,9184
Mvav 180,44,138
s_waitcnt lgkmcnt(9)
v_exp_f32 v119, v119
Mvav 192,48,138
v_exp_f32 v124, v124
Mvav 200,48,146
s_waitcnt lgkmcnt(6)
v_add_u32 v16, 0x21000, v15
v_add_u32 v18, 0x21000, v17
Mvav 204,52,146
v_exp_f32 v125, v125
Mvav 196,52,138
s_waitcnt lgkmcnt(0)
s_barrier
Mvav 208,56,138
RD 0,16,0
Mvav 216,56,146
RD 4,16,64
Mvav 220,60,146
RD 8,16,128
v_exp_f32 v126, v126
Mvav 212,60,138
RD 12,16,192
v_exp_f32 v127, v127
Mvvv 52,24,138
Mvvv 56,24,146
s_waitcnt lgkmcnt(3)
fl_a8:
Cvav 136,0,64,40
RD 16,16,512
v_cvt_pk_bf16_f32 v115, v114, v115
Cvav 144,0,68,44
s_waitcnt lgkmcnt(3)
RD 20,16,576
v_cvt_pk_bf16_f32 v114, v112, v113
Mvav 136,4,72
RD 24,16,640
v_cvt_pk_bf16_f32 v116, v116, v117
Mvav 144,4,76
s_waitcnt lgkmcnt(4)
RD 28,16,704
v_cvt_pk_bf16_f32 v117, v118, v119
Mvav 136,8,80
TR 32,18,8448
v_cvt_pk_bf16_f32 v123, v122, v123
Mvav 144,8,84
s_waitcnt lgkmcnt(5)
TR 34,18,8960
v_cvt_pk_bf16_f32 v122, v120, v121
Mvav 136,12,88
TR 36,18,8480
v_cvt_pk_bf16_f32 v124, v124, v125
Mvav 144,12,92
s_waitcnt lgkmcnt(6)
TR 38,18,8992
v_cvt_pk_bf16_f32 v125, v126, v127
Cvav 140,16,64,40
s_waitcnt lgkmcnt(6)
TR 40,18,8512
v_exp_f32 v136, v136
Cvav 148,16,68,44
buffer_load_dwordx4 a[252:255], v31, s[16:19], s3 offen offset:256 nt
TR 42,18,9024
v_exp_f32 v137, v137
Mvav 140,20,72
s_waitcnt lgkmcnt(7)
s_mov_b32 s3, 0x2a000
TR 44,18,8544
v_exp_f32 v138, v138
Mvav 148,20,76
buffer_load_dwordx4 a[128:131], v31, s[12:15], s3 offen nt
TR 46,18,9056
v_exp_f32 v139, v139
Mvav 140,24,80
s_waitcnt vmcnt(19) lgkmcnt(8)
v_exp_f32 v144, v144
Mvav 148,24,84
ds_write_b128 v19, a[192:195] offset:3584
v_exp_f32 v145, v145
Mvav 140,28,88
s_waitcnt vmcnt(18) lgkmcnt(7)
v_exp_f32 v146, v146
Mvav 148,28,92
ds_write_b128 v19, a[196:199] offset:4640
v_exp_f32 v147, v147
Mvav 160,32,114
s_waitcnt vmcnt(17) lgkmcnt(6)
TR 48,18,8576
TR 50,18,9088
Mvav 168,32,122
ds_write_b128 v19, a[200:203] offset:12032
v_exp_f32 v140, v140
Mvav 172,36,122
s_waitcnt vmcnt(16) lgkmcnt(7)
TR 52,18,8608
TR 54,18,9120
Mvav 164,36,114
ds_write_b128 v19, a[204:207] offset:13088
v_exp_f32 v141, v141
Mvav 176,40,114
TR 56,18,8640
TR 58,18,9152
Mvav 184,40,122
s_waitcnt lgkmcnt(10)
v_exp_f32 v142, v142
Mvav 188,44,122
TR 60,18,8672
TR 62,18,9184
Mvav 180,44,114
s_waitcnt lgkmcnt(8)
v_exp_f32 v143, v143
Mvav 192,48,114
v_exp_f32 v148, v148
Mvav 200,48,122
s_waitcnt lgkmcnt(5)
v_add_u32 v16, 0, v15
v_add_u32 v18, 0, v17
Mvav 204,52,122
s_waitcnt vmcnt(12)
v_exp_f32 v149, v149
Mvav 196,52,114
v_readfirstlane_b32 s41, v30
s_nop 0
s_cmp_lt_u32 s41, 1
s_cbranch_scc1 fl_pr_spin
fl_pr_ok:
s_call_b64 s[70:71], f_pad10
s_waitcnt lgkmcnt(0)
s_barrier
Mvav 208,56,114
RD 0,16,0
Mvav 216,56,122
RD 4,16,64
Mvav 220,60,122
RD 8,16,128
v_exp_f32 v150, v150
Mvav 212,60,114
RD 12,16,192
v_exp_f32 v151, v151
Mvvv 52,24,114
Mvvv 56,24,122
s_waitcnt lgkmcnt(3)
fl_a9:
Cvav 112,0,64,40
RD 16,16,512
v_cvt_pk_bf16_f32 v139, v138, v139
Cvav 120,0,68,44
s_waitcnt lgkmcnt(3)
RD 20,16,576
v_cvt_pk_bf16_f32 v138, v136, v137
Mvav 112,4,72
RD 24,16,640
v_cvt_pk_bf16_f32 v140, v140, v141
Mvav 120,4,76
s_waitcnt lgkmcnt(4)
RD 28,16,704
v_cvt_pk_bf16_f32 v141, v142, v143
Mvav 112,8,80
TR 32,18,8448
v_cvt_pk_bf16_f32 v147, v146, v147
Mvav 120,8,84
s_waitcnt lgkmcnt(5)
TR 34,18,8960
v_cvt_pk_bf16_f32 v146, v144, v145
Mvav 112,12,88
TR 36,18,8480
v_cvt_pk_bf16_f32 v148, v148, v149
Mvav 120,12,92
s_waitcnt lgkmcnt(6)
TR 38,18,8992
v_cvt_pk_bf16_f32 v149, v150, v151
Cvav 116,16,64,40
s_waitcnt lgkmcnt(6)
TR 40,18,8512
v_exp_f32 v112, v112
Cvav 124,16,68,44
buffer_load_dwordx4 a[132:135], v31, s[12:15], s3 offen offset:256 nt
TR 42,18,9024
v_exp_f32 v113, v113
Mvav 116,20,72
s_waitcnt lgkmcnt(7)
s_mov_b32 s3, 0x28000
TR 44,18,8544
v_exp_f32 v114, v114
Mvav 124,20,76
buffer_load_dwordx4 a[136:139], v31, s[16:19], s3 offen nt
TR 46,18,9056
v_exp_f32 v115, v115
Mvav 116,24,80
s_waitcnt lgkmcnt(8)
v_exp_f32 v120, v120
Mvav 124,24,84
ds_write_b128 v19, a[208:211] offset:20480
v_exp_f32 v121, v121
Mvav 116,28,88
s_waitcnt lgkmcnt(7)
v_exp_f32 v122, v122
Mvav 124,28,92
ds_write_b128 v19, a[212:215] offset:21536
v_exp_f32 v123, v123
Mvav 160,32,138
s_waitcnt lgkmcnt(6)
TR 48,18,8576
TR 50,18,9088
Mvav 168,32,146
ds_write_b128 v19, a[216:219] offset:28928
v_exp_f32 v116, v116
Mvav 172,36,146
s_waitcnt vmcnt(13) lgkmcnt(7)
TR 52,18,8608
TR 54,18,9120
Mvav 164,36,138
ds_write_b128 v19, a[220:223] offset:29984
v_exp_f32 v117, v117
Mvav 176,40,138
TR 56,18,8640
TR 58,18,9152
Mvav 184,40,146
s_waitcnt lgkmcnt(10)
v_exp_f32 v118, v118
Mvav 188,44,146
TR 60,18,8672
TR 62,18,9184
Mvav 180,44,138
s_waitcnt lgkmcnt(8)
v_exp_f32 v119, v119
Mvav 192,48,138
v_exp_f32 v124, v124
Mvav 200,48,146
s_waitcnt lgkmcnt(5)
v_add_u32 v16, 0x4200, v15
v_add_u32 v18, 0x4200, v17
Mvav 204,52,146
v_exp_f32 v125, v125
Mvav 196,52,138
s_waitcnt lgkmcnt(0)
s_barrier
Mvav 208,56,138
RD 0,16,0
Mvav 216,56,146
RD 4,16,64
Mvav 220,60,146
RD 8,16,128
v_exp_f32 v126, v126
Mvav 212,60,138
RD 12,16,192
v_exp_f32 v127, v127
Mvvv 52,24,138
Mvvv 56,24,146
s_waitcnt lgkmcnt(3)
fl_a10:
Cvav 136,0,64,40
RD 16,16,512
v_cvt_pk_bf16_f32 v115, v114, v115
Cvav 144,0,68,44
s_waitcnt lgkmcnt(3)
RD 20,16,576
v_cvt_pk_bf16_f32 v114, v112, v113
Mvav 136,4,72
RD 24,16,640
v_cvt_pk_bf16_f32 v116, v116, v117
Mvav 144,4,76
s_waitcnt lgkmcnt(4)
RD 28,16,704
v_cvt_pk_bf16_f32 v117, v118, v119
Mvav 136,8,80
TR 32,18,8448
v_cvt_pk_bf16_f32 v123, v122, v123
Mvav 144,8,84
s_waitcnt lgkmcnt(5)
TR 34,18,8960
v_cvt_pk_bf16_f32 v122, v120, v121
Mvav 136,12,88
TR 36,18,8480
v_cvt_pk_bf16_f32 v124, v124, v125
Mvav 144,12,92
s_waitcnt lgkmcnt(6)
TR 38,18,8992
v_cvt_pk_bf16_f32 v125, v126, v127
Cvav 140,16,64,40
s_waitcnt lgkmcnt(6)
TR 40,18,8512
v_exp_f32 v136, v136
Cvav 148,16,68,44
buffer_load_dwordx4 a[140:143], v31, s[16:19], s3 offen offset:256 nt
TR 42,18,9024
v_exp_f32 v137, v137
Mvav 140,20,72
s_waitcnt lgkmcnt(7)
s_mov_b32 s3, 0x2c000
TR 44,18,8544
v_exp_f32 v138, v138
Mvav 148,20,76
buffer_load_dwordx4 a[144:147], v31, s[12:15], s3 offen nt
TR 46,18,9056
v_exp_f32 v139, v139
Mvav 140,24,80
s_waitcnt lgkmcnt(8)
v_exp_f32 v144, v144
Mvav 148,24,84
buffer_load_dwordx4 a[148:151], v31, s[12:15], s3 offen offset:256 nt
v_exp_f32 v145, v145
Mvav 140,28,88
s_waitcnt vmcnt(15) lgkmcnt(6)
v_exp_f32 v146, v146
Mvav 148,28,92
ds_write_b128 v0, a[224:227]
v_exp_f32 v147, v147
Mvav 160,32,114
s_waitcnt vmcnt(14) lgkmcnt(5)
TR 48,18,8576
TR 50,18,9088
Mvav 168,32,122
ds_write_b128 v0, a[228:231] offset:1056
v_exp_f32 v140, v140
Mvav 172,36,122
s_waitcnt vmcnt(13) lgkmcnt(6)
TR 52,18,8608
TR 54,18,9120
Mvav 164,36,114
ds_write_b128 v0, a[232:235] offset:8448
v_exp_f32 v141, v141
Mvav 176,40,114
s_waitcnt vmcnt(12) lgkmcnt(7)
TR 56,18,8640
TR 58,18,9152
Mvav 184,40,122
ds_write_b128 v0, a[236:239] offset:9504
v_exp_f32 v142, v142
Mvav 188,44,122
TR 60,18,8672
TR 62,18,9184
Mvav 180,44,114
s_waitcnt lgkmcnt(9)
v_exp_f32 v143, v143
Mvav 192,48,114
v_exp_f32 v148, v148
Mvav 200,48,122
s_waitcnt lgkmcnt(6)
v_add_u32 v16, 0x8400, v15
v_add_u32 v18, 0x8400, v17
Mvav 204,52,122
v_exp_f32 v149, v149
Mvav 196,52,114
s_waitcnt lgkmcnt(0)
s_barrier
Mvav 208,56,114
RD 0,16,0
Mvav 216,56,122
RD 4,16,64
Mvav 220,60,122
RD 8,16,128
v_exp_f32 v150, v150
Mvav 212,60,114
RD 12,16,192
v_exp_f32 v151, v151
Mvvv 52,24,114
Mvvv 56,24,122
s_waitcnt lgkmcnt(3)
fl_a11:
Cvav 112,0,64,40
RD 16,16,512
v_cvt_pk_bf16_f32 v139, v138, v139
Cvav 120,0,68,44
s_waitcnt lgkmcnt(3)
RD 20,16,576
v_cvt_pk_bf16_f32 v138, v136, v137
Mvav 112,4,72
RD 24,16,640
v_cvt_pk_bf16_f32 v140, v140, v141
Mvav 120,4,76
s_waitcnt lgkmcnt(4)
RD 28,16,704
v_cvt_pk_bf16_f32 v141, v142, v143
Mvav 112,8,80
TR 32,18,8448
v_cvt_pk_bf16_f32 v147, v146, v147
Mvav 120,8,84
s_waitcnt lgkmcnt(5)
TR 34,18,8960
v_cvt_pk_bf16_f32 v146, v144, v145
Mvav 112,12,88
TR 36,18,8480
v_cvt_pk_bf16_f32 v148, v148, v149
Mvav 120,12,92
s_waitcnt lgkmcnt(6)
TR 38,18,8992
v_cvt_pk_bf16_f32 v149, v150, v151
Cvav 116,16,64,40
s_waitcnt lgkmcnt(6)
s_mov_b32 s3, 0x2a000
TR 40,18,8512
v_exp_f32 v112, v112
Cvav 124,16,68,44
buffer_load_dwordx4 a[152:155], v31, s[16:19], s3 offen nt
TR 42,18,9024
v_exp_f32 v113, v113
Mvav 116,20,72
s_waitcnt lgkmcnt(7)
TR 44,18,8544
v_exp_f32 v114, v114
Mvav 124,20,76
buffer_load_dwordx4 a[156:159], v31, s[16:19], s3 offen offset:256 nt
TR 46,18,9056
v_exp_f32 v115, v115
Mvav 116,24,80
s_waitcnt vmcnt(11) lgkmcnt(8)
v_exp_f32 v120, v120
Mvav 124,24,84
ds_write_b128 v0, a[240:243] offset:16896
v_exp_f32 v121, v121
Mvav 116,28,88
s_waitcnt vmcnt(10) lgkmcnt(7)
v_exp_f32 v122, v122
Mvav 124,28,92
ds_write_b128 v0, a[244:247] offset:17952
v_exp_f32 v123, v123
Mvav 160,32,138
s_waitcnt vmcnt(9) lgkmcnt(6)
TR 48,18,8576
TR 50,18,9088
Mvav 168,32,146
ds_write_b128 v0, a[248:251] offset:25344
v_exp_f32 v116, v116
Mvav 172,36,146
s_waitcnt vmcnt(8) lgkmcnt(7)
TR 52,18,8608
TR 54,18,9120
Mvav 164,36,138
ds_write_b128 v0, a[252:255] offset:26400
v_exp_f32 v117, v117
Mvav 176,40,138
TR 56,18,8640
TR 58,18,9152
Mvav 184,40,146
s_waitcnt lgkmcnt(10)
v_exp_f32 v118, v118
Mvav 188,44,146
TR 60,18,8672
TR 62,18,9184
Mvav 180,44,138
s_waitcnt lgkmcnt(8)
v_exp_f32 v119, v119
Mvav 192,48,138
v_exp_f32 v124, v124
Mvav 200,48,146
s_waitcnt lgkmcnt(5)
v_add_u32 v16, 0xc600, v15
v_add_u32 v18, 0xc600, v17
Mvav 204,52,146
v_exp_f32 v125, v125
Mvav 196,52,138
s_waitcnt lgkmcnt(0)
s_barrier
Mvav 208,56,138
RD 0,16,0
Mvav 216,56,146
RD 4,16,64
Mvav 220,60,146
RD 8,16,128
v_exp_f32 v126, v126
Mvav 212,60,138
RD 12,16,192
v_exp_f32 v127, v127
Mvvv 52,24,138
Mvvv 56,24,146
s_waitcnt lgkmcnt(3)
fl_a12:
Cvav 136,0,64,40
RD 16,16,512
v_cvt_pk_bf16_f32 v115, v114, v115
Cvav 144,0,68,44
s_waitcnt lgkmcnt(3)
RD 20,16,576
v_cvt_pk_bf16_f32 v114, v112, v113
Mvav 136,4,72
RD 24,16,640
v_cvt_pk_bf16_f32 v116, v116, v117
Mvav 144,4,76
s_waitcnt lgkmcnt(4)
RD 28,16,704
v_cvt_pk_bf16_f32 v117, v118, v119
Mvav 136,8,80
TR 32,18,8448
v_cvt_pk_bf16_f32 v123, v122, v123
Mvav 144,8,84
s_waitcnt lgkmcnt(5)
TR 34,18,8960
v_cvt_pk_bf16_f32 v122, v120, v121
Mvav 136,12,88
TR 36,18,8480
v_cvt_pk_bf16_f32 v124, v124, v125
Mvav 144,12,92
s_waitcnt lgkmcnt(6)
TR 38,18,8992
v_cvt_pk_bf16_f32 v125, v126, v127
Cvav 140,16,64,40
s_waitcnt lgkmcnt(6)
s_mov_b32 s3, 0x2e000
TR 40,18,8512
v_exp_f32 v136, v136
Cvav 148,16,68,44
buffer_load_dwordx4 a[160:163], v31, s[12:15], s3 offen nt
TR 42,18,9024
v_exp_f32 v137, v137
Mvav 140,20,72
s_waitcnt lgkmcnt(7)
TR 44,18,8544
v_exp_f32 v138, v138
Mvav 148,20,76
buffer_load_dwordx4 a[164:167], v31, s[12:15], s3 offen offset:256 nt
TR 46,18,9056
v_exp_f32 v139, v139
Mvav 140,24,80
s_waitcnt lgkmcnt(8)
s_mov_b32 s3, 0x2c000
v_exp_f32 v144, v144
Mvav 148,24,84
buffer_load_dwordx4 a[168:171], v31, s[16:19], s3 offen nt
v_exp_f32 v145, v145
Mvav 140,28,88
s_waitcnt lgkmcnt(6)
v_exp_f32 v146, v146
v_add_u32 v226, ((fh_a12-f_start+5120)&0xffffff80), v227
v_min_u32 v226, f_end-f_start, v226
Mvav 148,28,92
global_load_dword v224, v226, s[98:99]
v_exp_f32 v147, v147
Mvav 160,32,114
s_waitcnt lgkmcnt(4)
TR 48,18,8576
TR 50,18,9088
v_add_u32 v226, ((fl_a12-f_start+5120)&0xffffff80), v227
v_min_u32 v226, f_end-f_start, v226
Mvav 168,32,122
global_load_dword v224, v226, s[98:99]
v_exp_f32 v140, v140
Mvav 172,36,122
TR 52,18,8608
TR 54,18,9120
Mvav 164,36,114
s_waitcnt lgkmcnt(6)
v_exp_f32 v141, v141
Mvav 176,40,114
TR 56,18,8640
TR 58,18,9152
Mvav 184,40,122
s_waitcnt lgkmcnt(6)
v_exp_f32 v142, v142
Mvav 188,44,122
TR 60,18,8672
TR 62,18,9184
Mvav 180,44,114
s_waitcnt lgkmcnt(6)
v_exp_f32 v143, v143
Mvav 192,48,114
v_exp_f32 v148, v148
Mvav 200,48,122
s_waitcnt lgkmcnt(4)
v_add_u32 v16, 0x10800, v15
v_add_u32 v18, 0x10800, v17
Mvav 204,52,122
v_exp_f32 v149, v149
Mvav 196,52,114
s_call_b64 s[70:71], f_pad11
s_waitcnt lgkmcnt(0)
s_barrier
Mvav 208,56,114
RD 0,16,0
Mvav 216,56,122
RD 4,16,64
Mvav 220,60,122
RD 8,16,128
v_exp_f32 v150, v150
Mvav 212,60,114
RD 12,16,192
v_exp_f32 v151, v151
Mvvv 52,24,114
Mvvv 56,24,122
s_waitcnt lgkmcnt(3)
fl_a13:
Cvav 112,0,64,40
RD 16,16,512
v_cvt_pk_bf16_f32 v139, v138, v139
Cvav 120,0,68,44
s_waitcnt lgkmcnt(3)
RD 20,16,576
v_cvt_pk_bf16_f32 v138, v136, v137
Mvav 112,4,72
RD 24,16,640
v_cvt_pk_bf16_f32 v140, v140, v141
Mvav 120,4,76
s_waitcnt lgkmcnt(4)
RD 28,16,704
v_cvt_pk_bf16_f32 v141, v142, v143
Mvav 112,8,80
TR 32,18,8448
v_cvt_pk_bf16_f32 v147, v146, v147
Mvav 120,8,84
s_waitcnt lgkmcnt(5)
TR 34,18,8960
v_cvt_pk_bf16_f32 v146, v144, v145
Mvav 112,12,88
TR 36,18,8480
v_cvt_pk_bf16_f32 v148, v148, v149
Mvav 120,12,92
s_waitcnt lgkmcnt(6)
TR 38,18,8992
v_cvt_pk_bf16_f32 v149, v150, v151
Cvav 116,16,64,40
s_waitcnt lgkmcnt(6)
TR 40,18,8512
v_exp_f32 v112, v112
Cvav 124,16,68,44
buffer_load_dwordx4 a[172:175], v31, s[16:19], s3 offen offset:256 nt
TR 42,18,9024
v_exp_f32 v113, v113
Mvav 116,20,72
s_waitcnt lgkmcnt(7)
s_mov_b32 s3, 0x30000
TR 44,18,8544
v_exp_f32 v114, v114
Mvav 124,20,76
buffer_load_dwordx4 a[176:179], v31, s[12:15], s3 offen nt
TR 46,18,9056
v_exp_f32 v115, v115
Mvav 116,24,80
s_waitcnt vmcnt(14) lgkmcnt(8)
v_exp_f32 v120, v120
Mvav 124,24,84
ds_write_b128 v0, a[128:131] offset:33792
v_exp_f32 v121, v121
Mvav 116,28,88
s_waitcnt vmcnt(13) lgkmcnt(7)
v_exp_f32 v122, v122
Mvav 124,28,92
ds_write_b128 v0, a[132:135] offset:34848
v_exp_f32 v123, v123
Mvav 160,32,138
s_waitcnt vmcnt(12) lgkmcnt(6)
TR 48,18,8576
TR 50,18,9088
Mvav 168,32,146
ds_write_b128 v0, a[136:139] offset:42240
v_exp_f32 v116, v116
Mvav 172,36,146
s_waitcnt vmcnt(11) lgkmcnt(7)
TR 52,18,8608
TR 54,18,9120
Mvav 164,36,138
ds_write_b128 v0, a[140:143] offset:43296
v_exp_f32 v117, v117
Mvav 176,40,138
TR 56,18,8640
TR 58,18,9152
Mvav 184,40,146
s_waitcnt lgkmcnt(10)
v_exp_f32 v118, v118
Mvav 188,44,146
TR 60,18,8672
TR 62,18,9184
Mvav 180,44,138
s_waitcnt lgkmcnt(8)
v_exp_f32 v119, v119
Mvav 192,48,138
v_exp_f32 v124, v124
Mvav 200,48,146
s_waitcnt lgkmcnt(5)
v_add_u32 v16, 0x14a00, v15
v_add_u32 v18, 0x14a00, v17
Mvav 204,52,146
v_exp_f32 v125, v125
Mvav 196,52,138
s_waitcnt lgkmcnt(0)
s_barrier
Mvav 208,56,138
RD 0,16,0
Mvav 216,56,146
RD 4,16,64
Mvav 220,60,146
RD 8,16,128
v_exp_f32 v126, v126
Mvav 212,60,138
RD 12,16,192
v_exp_f32 v127, v127
Mvvv 52,24,138
Mvvv 56,24,146
s_waitcnt lgkmcnt(3)
fl_a14:
Cvav 136,0,64,40
RD 16,16,512
v_cvt_pk_bf16_f32 v115, v114, v115
Cvav 144,0,68,44
s_waitcnt lgkmcnt(3)
RD 20,16,576
v_cvt_pk_bf16_f32 v114, v112, v113
Mvav 136,4,72
RD 24,16,640
v_cvt_pk_bf16_f32 v116, v116, v117
Mvav 144,4,76
s_waitcnt lgkmcnt(4)
RD 28,16,704
v_cvt_pk_bf16_f32 v117, v118, v119
Mvav 136,8,80
TR 32,18,8448
v_cvt_pk_bf16_f32 v123, v122, v123
Mvav 144,8,84
s_waitcnt lgkmcnt(5)
TR 34,18,8960
v_cvt_pk_bf16_f32 v122, v120, v121
Mvav 136,12,88
TR 36,18,8480
v_cvt_pk_bf16_f32 v124, v124, v125
Mvav 144,12,92
s_waitcnt lgkmcnt(6)
TR 38,18,8992
v_cvt_pk_bf16_f32 v125, v126, v127
Cvav 140,16,64,40
s_waitcnt lgkmcnt(6)
TR 40,18,8512
v_exp_f32 v136, v136
Cvav 148,16,68,44
buffer_load_dwordx4 a[180:183], v31, s[12:15], s3 offen offset:256 nt
TR 42,18,9024
v_exp_f32 v137, v137
Mvav 140,20,72
s_waitcnt lgkmcnt(7)
s_mov_b32 s3, 0x2e000
TR 44,18,8544
v_exp_f32 v138, v138
Mvav 148,20,76
buffer_load_dwordx4 a[184:187], v31, s[16:19], s3 offen nt
TR 46,18,9056
v_exp_f32 v139, v139
Mvav 140,24,80
s_waitcnt lgkmcnt(8)
v_exp_f32 v144, v144
Mvav 148,24,84
buffer_load_dwordx4 a[188:191], v31, s[16:19], s3 offen offset:256 nt
v_exp_f32 v145, v145
Mvav 140,28,88
s_waitcnt vmcnt(13) lgkmcnt(6)
v_exp_f32 v146, v146
Mvav 148,28,92
ds_write_b128 v0, a[144:147] offset:50688
v_exp_f32 v147, v147
Mvav 160,32,114
s_waitcnt vmcnt(12) lgkmcnt(5)
TR 48,18,8576
TR 50,18,9088
Mvav 168,32,122
ds_write_b128 v0, a[148:151] offset:51744
v_exp_f32 v140, v140
Mvav 172,36,122
s_waitcnt vmcnt(11) lgkmcnt(6)
TR 52,18,8608
TR 54,18,9120
Mvav 164,36,114
ds_write_b128 v23, a[152:155] offset:1792
v_exp_f32 v141, v141
Mvav 176,40,114
s_waitcnt vmcnt(10) lgkmcnt(7)
TR 56,18,8640
TR 58,18,9152
Mvav 184,40,122
ds_write_b128 v23, a[156:159] offset:2848
v_exp_f32 v142, v142
Mvav 188,44,122
TR 60,18,8672
TR 62,18,9184
Mvav 180,44,114
s_waitcnt lgkmcnt(9)
v_exp_f32 v143, v143
Mvav 192,48,114
v_exp_f32 v148, v148
Mvav 200,48,122
s_waitcnt lgkmcnt(6)
v_add_u32 v16, 0x18c00, v15
v_add_u32 v18, 0x18c00, v17
Mvav 204,52,122
v_exp_f32 v149, v149
Mvav 196,52,114
s_waitcnt lgkmcnt(0)
s_barrier
Mvav 208,56,114
RD 0,16,0
Mvav 216,56,122
RD 4,16,64
Mvav 220,60,122
RD 8,16,128
v_exp_f32 v150, v150
Mvav 212,60,114
RD 12,16,192
v_exp_f32 v151, v151
Mvvv 52,24,114
Mvvv 56,24,122
s_waitcnt lgkmcnt(3)
fl_a15:
Zvaa 112,0,80
RD 16,16,512
v_cvt_pk_bf16_f32 v139, v138, v139
Zvaa 120,0,84
s_waitcnt lgkmcnt(3)
RD 20,16,576
v_cvt_pk_bf16_f32 v138, v136, v137
Mvaa 112,4,88
RD 24,16,640
v_cvt_pk_bf16_f32 v140, v140, v141
Mvaa 120,4,92
s_waitcnt lgkmcnt(4)
RD 28,16,704
v_cvt_pk_bf16_f32 v141, v142, v143
Mvaa 112,8,96
TR 32,18,8448
v_cvt_pk_bf16_f32 v147, v146, v147
Mvaa 120,8,100
s_waitcnt lgkmcnt(5)
TR 34,18,8960
v_cvt_pk_bf16_f32 v146, v144, v145
Mvaa 112,12,104
TR 36,18,8480
v_cvt_pk_bf16_f32 v148, v148, v149
Mvaa 120,12,108
s_waitcnt lgkmcnt(6)
TR 38,18,8992
v_cvt_pk_bf16_f32 v149, v150, v151
Zvaa 116,16,80
s_waitcnt lgkmcnt(6)
s_mov_b32 s3, 0x32000
TR 40,18,8512
v_max3_f32 v32, v112, v113, v114
Zvaa 124,16,84
buffer_load_dwordx4 a[192:195], v31, s[12:15], s3 offen nt
TR 42,18,9024
v_max3_f32 v33, v120, v121, v122
Mvaa 116,20,88
s_waitcnt lgkmcnt(7)
TR 44,18,8544
v_max_f32 v32, v115, v32
Mvaa 124,20,92
buffer_load_dwordx4 a[196:199], v31, s[12:15], s3 offen offset:256 nt
TR 46,18,9056
v_max_f32 v33, v123, v33
Mvaa 116,24,96
s_waitcnt lgkmcnt(8)
s_mov_b32 s3, 0x30000
Mvaa 124,24,100
buffer_load_dwordx4 a[200:203], v31, s[16:19], s3 offen nt
Mvaa 116,28,104
s_waitcnt lgkmcnt(6)
Mvaa 124,28,108
buffer_load_dwordx4 a[204:207], v31, s[16:19], s3 offen offset:256 nt
Mvav 160,32,138
s_waitcnt lgkmcnt(4)
s_mov_b32 s3, 0x34000
TR 48,18,8576
TR 50,18,9088
Mvav 168,32,146
buffer_load_dwordx4 a[208:211], v31, s[12:15], s3 offen nt
v_max3_f32 v32, v32, v116, v117
v_max3_f32 v33, v33, v124, v125
Mvav 172,36,146
TR 52,18,8608
TR 54,18,9120
Mvav 164,36,138
s_waitcnt lgkmcnt(6)
v_max3_f32 v32, v32, v118, v119
v_max3_f32 v33, v33, v126, v127
Mvav 176,40,138
TR 56,18,8640
TR 58,18,9152
Mvav 184,40,146
s_waitcnt lgkmcnt(6)
v_mov_b32 v36, v32
v_mov_b32 v37, v33
Mvav 188,44,146
TR 60,18,8672
TR 62,18,9184
Mvav 180,44,138
s_waitcnt lgkmcnt(6)
v_permlane32_swap_b32 v36, v32
v_permlane32_swap_b32 v37, v33
Mvav 192,48,138
v_max_f32 v32, v36, v32
v_max_f32 v33, v37, v33
Mvav 200,48,146
s_waitcnt lgkmcnt(4)
v_add_u32 v16, 0x1ce00, v15
v_add_u32 v18, 0x1ce00, v17
Mvav 204,52,146
v_mov_b32 v36, v32
v_mov_b32 v37, v33
Mvav 196,52,138
s_call_b64 s[70:71], f_pad12
s_waitcnt lgkmcnt(0)
s_barrier
Mvav 208,56,138
RD 0,16,0
Mvav 216,56,146
RD 4,16,64
Mvav 220,60,146
RD 8,16,128
v_permlane16_swap_b32 v36, v32
v_permlane16_swap_b32 v37, v33
Mvav 212,60,138
RD 12,16,192
v_max_f32 v32, v36, v32
v_max_f32 v33, v37, v33
Mvvv 52,24,138
Mvvv 56,24,146
v_sub_f32 v40, 0, v32
v_sub_f32 v44, 0, v33
v_sub_f32 v41, 0, v32
v_sub_f32 v45, 0, v33
v_sub_f32 v42, 0, v32
v_sub_f32 v46, 0, v33
v_sub_f32 v43, 0, v32
v_sub_f32 v47, 0, v33
v_sub_f32 v112, v112, v32
v_sub_f32 v120, v120, v33
v_sub_f32 v113, v113, v32
v_sub_f32 v121, v121, v33
v_sub_f32 v114, v114, v32
v_sub_f32 v122, v122, v33
v_sub_f32 v115, v115, v32
v_sub_f32 v123, v123, v33
v_sub_f32 v116, v116, v32
v_sub_f32 v124, v124, v33
v_sub_f32 v117, v117, v32
v_sub_f32 v125, v125, v33
v_sub_f32 v118, v118, v32
v_sub_f32 v126, v126, v33
v_sub_f32 v119, v119, v32
v_sub_f32 v127, v127, v33
v_exp_f32 v112, v112
v_exp_f32 v120, v120
v_exp_f32 v113, v113
v_exp_f32 v121, v121
v_exp_f32 v114, v114
v_exp_f32 v122, v122
v_exp_f32 v115, v115
v_exp_f32 v123, v123
v_exp_f32 v116, v116
v_exp_f32 v124, v124
v_exp_f32 v117, v117
v_exp_f32 v125, v125
v_exp_f32 v118, v118
v_exp_f32 v126, v126
v_exp_f32 v119, v119
v_exp_f32 v127, v127
s_mov_b32 s41, 0x47800000
v_add_f32 v3, v52, v56
v_cmp_nge_f32 vcc, s41, v3
v_rcp_f32 v32, v52
v_rcp_f32 v34, v56
s_cbranch_vccnz fl_slow0
fl_norm0:
v_pk_mul_f32 v[160:161], v[160:161], v[32:33] op_sel_hi:[1,0]
v_pk_mul_f32 v[162:163], v[162:163], v[32:33] op_sel_hi:[1,0]
v_pk_mul_f32 v[164:165], v[164:165], v[32:33] op_sel_hi:[1,0]
v_pk_mul_f32 v[166:167], v[166:167], v[32:33] op_sel_hi:[1,0]
v_cvt_pk_bf16_f32 v64, v160, v161
v_cvt_pk_bf16_f32 v65, v162, v163
v_cvt_pk_bf16_f32 v66, v164, v165
v_cvt_pk_bf16_f32 v67, v166, v167
v_pk_mul_f32 v[176:177], v[176:177], v[32:33] op_sel_hi:[1,0]
v_pk_mul_f32 v[178:179], v[178:179], v[32:33] op_sel_hi:[1,0]
v_pk_mul_f32 v[180:181], v[180:181], v[32:33] op_sel_hi:[1,0]
v_pk_mul_f32 v[182:183], v[182:183], v[32:33] op_sel_hi:[1,0]
v_cvt_pk_bf16_f32 v72, v176, v177
v_cvt_pk_bf16_f32 v73, v178, v179
v_cvt_pk_bf16_f32 v74, v180, v181
v_cvt_pk_bf16_f32 v75, v182, v183
v_pk_mul_f32 v[192:193], v[192:193], v[32:33] op_sel_hi:[1,0]
v_pk_mul_f32 v[194:195], v[194:195], v[32:33] op_sel_hi:[1,0]
v_pk_mul_f32 v[196:197], v[196:197], v[32:33] op_sel_hi:[1,0]
v_pk_mul_f32 v[198:199], v[198:199], v[32:33] op_sel_hi:[1,0]
v_cvt_pk_bf16_f32 v80, v192, v193
v_cvt_pk_bf16_f32 v81, v194, v195
v_cvt_pk_bf16_f32 v82, v196, v197
v_cvt_pk_bf16_f32 v83, v198, v199
v_pk_mul_f32 v[208:209], v[208:209], v[32:33] op_sel_hi:[1,0]
v_pk_mul_f32 v[210:211], v[210:211], v[32:33] op_sel_hi:[1,0]
v_pk_mul_f32 v[212:213], v[212:213], v[32:33] op_sel_hi:[1,0]
v_pk_mul_f32 v[214:215], v[214:215], v[32:33] op_sel_hi:[1,0]
v_cvt_pk_bf16_f32 v88, v208, v209
v_cvt_pk_bf16_f32 v89, v210, v211
v_cvt_pk_bf16_f32 v90, v212, v213
v_cvt_pk_bf16_f32 v91, v214, v215
v_pk_mul_f32 v[168:169], v[168:169], v[34:35] op_sel_hi:[1,0]
v_pk_mul_f32 v[170:171], v[170:171], v[34:35] op_sel_hi:[1,0]
v_pk_mul_f32 v[172:173], v[172:173], v[34:35] op_sel_hi:[1,0]
v_pk_mul_f32 v[174:175], v[174:175], v[34:35] op_sel_hi:[1,0]
v_cvt_pk_bf16_f32 v68, v168, v169
v_cvt_pk_bf16_f32 v69, v170, v171
v_cvt_pk_bf16_f32 v70, v172, v173
v_cvt_pk_bf16_f32 v71, v174, v175
v_pk_mul_f32 v[184:185], v[184:185], v[34:35] op_sel_hi:[1,0]
v_pk_mul_f32 v[186:187], v[186:187], v[34:35] op_sel_hi:[1,0]
v_pk_mul_f32 v[188:189], v[188:189], v[34:35] op_sel_hi:[1,0]
v_pk_mul_f32 v[190:191], v[190:191], v[34:35] op_sel_hi:[1,0]
v_cvt_pk_bf16_f32 v76, v184, v185
v_cvt_pk_bf16_f32 v77, v186, v187
v_cvt_pk_bf16_f32 v78, v188, v189
v_cvt_pk_bf16_f32 v79, v190, v191
v_pk_mul_f32 v[200:201], v[200:201], v[34:35] op_sel_hi:[1,0]
v_pk_mul_f32 v[202:203], v[202:203], v[34:35] op_sel_hi:[1,0]
v_pk_mul_f32 v[204:205], v[204:205], v[34:35] op_sel_hi:[1,0]
v_pk_mul_f32 v[206:207], v[206:207], v[34:35] op_sel_hi:[1,0]
v_cvt_pk_bf16_f32 v84, v200, v201
v_cvt_pk_bf16_f32 v85, v202, v203
v_cvt_pk_bf16_f32 v86, v204, v205
v_cvt_pk_bf16_f32 v87, v206, v207
v_pk_mul_f32 v[216:217], v[216:217], v[34:35] op_sel_hi:[1,0]
v_pk_mul_f32 v[218:219], v[218:219], v[34:35] op_sel_hi:[1,0]
v_pk_mul_f32 v[220:221], v[220:221], v[34:35] op_sel_hi:[1,0]
v_pk_mul_f32 v[222:223], v[222:223], v[34:35] op_sel_hi:[1,0]
v_cvt_pk_bf16_f32 v92, v216, v217
v_cvt_pk_bf16_f32 v93, v218, v219
v_cvt_pk_bf16_f32 v94, v220, v221
v_cvt_pk_bf16_f32 v95, v222, v223
fl_a16:
s_waitcnt lgkmcnt(3)
Cvaa 136,0,80,40
RD 16,16,512
v_cvt_pk_bf16_f32 v115, v114, v115
Cvaa 144,0,84,44
s_waitcnt lgkmcnt(3)
RD 20,16,576
v_cvt_pk_bf16_f32 v114, v112, v113
Mvaa 136,4,88
RD 24,16,640
v_cvt_pk_bf16_f32 v116, v116, v117
Mvaa 144,4,92
s_waitcnt lgkmcnt(4)
RD 28,16,704
v_cvt_pk_bf16_f32 v117, v118, v119
Mvaa 136,8,96
TR 32,18,8448
v_cvt_pk_bf16_f32 v123, v122, v123
Mvaa 144,8,100
s_waitcnt lgkmcnt(5)
TR 34,18,8960
v_cvt_pk_bf16_f32 v122, v120, v121
Mvaa 136,12,104
TR 36,18,8480
v_cvt_pk_bf16_f32 v124, v124, v125
Mvaa 144,12,108
s_waitcnt lgkmcnt(6)
TR 38,18,8992
v_cvt_pk_bf16_f32 v125, v126, v127
Cvaa 140,16,80,40
s_waitcnt lgkmcnt(6)
s_add_u32 s44, s78, 0
TR 40,18,8512
v_exp_f32 v136, v136
Cvaa 148,16,84,44
buffer_store_dwordx4 v[64:67], v20, s[20:23], s44 offen sc1
TR 42,18,9024
v_exp_f32 v137, v137
Mvaa 140,20,88
s_waitcnt lgkmcnt(7)
TR 44,18,8544
v_exp_f32 v138, v138
Mvaa 148,20,92
buffer_store_dwordx4 v[72:75], v20, s[20:23], s44 offen offset:1024 sc1
TR 46,18,9056
v_exp_f32 v139, v139
Mvaa 140,24,96
s_waitcnt lgkmcnt(8)
v_exp_f32 v144, v144
Mvaa 148,24,100
buffer_load_dwordx4 a[212:215], v31, s[12:15], s3 offen offset:256 nt
v_exp_f32 v145, v145
Mvaa 140,28,104
s_waitcnt vmcnt(17) lgkmcnt(6)
v_exp_f32 v146, v146
Mvaa 148,28,108
ds_write_b128 v23, a[160:163] offset:10240
v_exp_f32 v147, v147
Zvav 160,32,114
s_waitcnt vmcnt(16) lgkmcnt(5)
TR 48,18,8576
TR 50,18,9088
Zvav 168,32,122
ds_write_b128 v23, a[164:167] offset:11296
v_exp_f32 v140, v140
Zvav 172,36,122
s_waitcnt vmcnt(15) lgkmcnt(6)
TR 52,18,8608
TR 54,18,9120
Zvav 164,36,114
ds_write_b128 v23, a[168:171] offset:18688
v_exp_f32 v141, v141
Zvav 176,40,114
s_waitcnt vmcnt(12) lgkmcnt(7)
TR 56,18,8640
TR 58,18,9152
Zvav 184,40,122
ds_write_b128 v23, a[172:175] offset:19744
v_exp_f32 v142, v142
Zvav 188,44,122
TR 60,18,8672
TR 62,18,9184
Zvav 180,44,114
s_waitcnt lgkmcnt(9)
v_exp_f32 v143, v143
Zvav 192,48,114
v_exp_f32 v148, v148
Zvav 200,48,122
s_waitcnt lgkmcnt(6)
v_add_u32 v16, 0x21000, v15
v_add_u32 v18, 0x21000, v17
Zvav 204,52,122
v_exp_f32 v149, v149
Zvav 196,52,114
s_waitcnt lgkmcnt(0)
s_barrier
Zvav 208,56,114
RD 0,16,0
Zvav 216,56,122
RD 4,16,64
Zvav 220,60,122
RD 8,16,128
v_exp_f32 v150, v150
Zvav 212,60,114
RD 12,16,192
v_exp_f32 v151, v151
Zvvv 52,24,114
Zvvv 56,24,122
s_waitcnt lgkmcnt(3)
fl_a17:
Cvaa 112,0,80,40
RD 16,16,512
v_cvt_pk_bf16_f32 v139, v138, v139
Cvaa 120,0,84,44
s_waitcnt lgkmcnt(3)
RD 20,16,576
v_cvt_pk_bf16_f32 v138, v136, v137
Mvaa 112,4,88
RD 24,16,640
v_cvt_pk_bf16_f32 v140, v140, v141
Mvaa 120,4,92
s_waitcnt lgkmcnt(4)
RD 28,16,704
v_cvt_pk_bf16_f32 v141, v142, v143
Mvaa 112,8,96
TR 32,18,8448
v_cvt_pk_bf16_f32 v147, v146, v147
Mvaa 120,8,100
s_waitcnt lgkmcnt(5)
TR 34,18,8960
v_cvt_pk_bf16_f32 v146, v144, v145
Mvaa 112,12,104
TR 36,18,8480
v_cvt_pk_bf16_f32 v148, v148, v149
Mvaa 120,12,108
s_waitcnt lgkmcnt(6)
TR 38,18,8992
v_cvt_pk_bf16_f32 v149, v150, v151
Cvaa 116,16,80,40
s_waitcnt lgkmcnt(6)
TR 40,18,8512
v_exp_f32 v112, v112
Cvaa 124,16,84,44
buffer_store_dwordx4 v[68:71], v12, s[20:23], s44 offen sc1
TR 42,18,9024
v_exp_f32 v113, v113
Mvaa 116,20,88
s_waitcnt lgkmcnt(7)
TR 44,18,8544
v_exp_f32 v114, v114
Mvaa 124,20,92
buffer_store_dwordx4 v[76:79], v12, s[20:23], s44 offen offset:1024 sc1
TR 46,18,9056
v_exp_f32 v115, v115
Mvaa 116,24,96
s_waitcnt lgkmcnt(8)
s_mov_b32 s3, 0x32000
v_exp_f32 v120, v120
Mvaa 124,24,100
buffer_load_dwordx4 a[216:219], v31, s[16:19], s3 offen nt
v_exp_f32 v121, v121
Mvaa 116,28,104
s_waitcnt vmcnt(14) lgkmcnt(6)
v_exp_f32 v122, v122
Mvaa 124,28,108
ds_write_b128 v23, a[176:179] offset:27136
v_exp_f32 v123, v123
Mvav 160,32,138
s_waitcnt vmcnt(13) lgkmcnt(5)
TR 48,18,8576
TR 50,18,9088
Mvav 168,32,146
ds_write_b128 v23, a[180:183] offset:28192
v_exp_f32 v116, v116
Mvav 172,36,146
s_waitcnt vmcnt(12) lgkmcnt(6)
TR 52,18,8608
TR 54,18,9120
Mvav 164,36,138
ds_write_b128 v23, a[184:187] offset:35584
v_exp_f32 v117, v117
Mvav 176,40,138
s_waitcnt vmcnt(11) lgkmcnt(7)
TR 56,18,8640
TR 58,18,9152
Mvav 184,40,146
ds_write_b128 v23, a[188:191] offset:36640
v_exp_f32 v118, v118
Mvav 188,44,146
TR 60,18,8672
TR 62,18,9184
Mvav 180,44,138
s_waitcnt lgkmcnt(9)
v_exp_f32 v119, v119
Mvav 192,48,138
v_exp_f32 v124, v124
Mvav 200,48,146
s_waitcnt lgkmcnt(6)
v_add_u32 v16, 0, v15
v_add_u32 v18, 0, v17
Mvav 204,52,146
v_exp_f32 v125, v125
Mvav 196,52,138
s_waitcnt lgkmcnt(0)
s_barrier
Mvav 208,56,138
RD 0,16,0
Mvav 216,56,146
RD 4,16,64
Mvav 220,60,146
RD 8,16,128
v_exp_f32 v126, v126
Mvav 212,60,138
RD 12,16,192
v_exp_f32 v127, v127
Mvvv 52,24,138
Mvvv 56,24,146
s_waitcnt lgkmcnt(3)
fl_a18:
Cvaa 136,0,80,40
s_waitcnt lgkmcnt(2)
s_add_u32 s44, s78, 0x5800
RD 16,16,512
v_cvt_pk_bf16_f32 v115, v114, v115
Cvaa 144,0,84,44
buffer_store_dwordx4 v[80:83], v20, s[20:23], s44 offen sc1
RD 20,16,576
v_cvt_pk_bf16_f32 v114, v112, v113
Mvaa 136,4,88
s_waitcnt lgkmcnt(3)
RD 24,16,640
v_cvt_pk_bf16_f32 v116, v116, v117
Mvaa 144,4,92
buffer_store_dwordx4 v[88:91], v20, s[20:23], s44 offen offset:1024 sc1
RD 28,16,704
v_cvt_pk_bf16_f32 v117, v118, v119
Mvaa 136,8,96
s_waitcnt lgkmcnt(4)
TR 32,18,8448
v_cvt_pk_bf16_f32 v123, v122, v123
Mvaa 144,8,100
buffer_load_dwordx4 a[220:223], v31, s[16:19], s3 offen offset:256 nt
TR 34,18,8960
v_cvt_pk_bf16_f32 v122, v120, v121
Mvaa 136,12,104
s_waitcnt lgkmcnt(5)
s_mov_b32 s3, 0x36000
s_add_u32 m0, s52, 0x21000
TR 36,18,8480
v_cvt_pk_bf16_f32 v124, v124, v125
Mvaa 144,12,108
buffer_load_dwordx4 v31, s[12:15], s3 offen nt lds
TR 38,18,8992
v_cvt_pk_bf16_f32 v125, v126, v127
Cvaa 140,16,80,40
s_waitcnt vmcnt(14) lgkmcnt(6)
TR 40,18,8512
v_exp_f32 v136, v136
Cvaa 148,16,84,44
ds_write_b128 v23, a[192:195] offset:44032
TR 42,18,9024
v_exp_f32 v137, v137
Mvaa 140,20,88
s_waitcnt vmcnt(11) lgkmcnt(5)
TR 44,18,8544
v_exp_f32 v138, v138
Mvaa 148,20,92
ds_write_b128 v23, a[196:199] offset:45088
TR 46,18,9056
v_exp_f32 v139, v139
Mvaa 140,24,96
ds_write_b128 v23, a[200:203] offset:52480
v_exp_f32 v144, v144
Mvaa 148,24,100
ds_write_b128 v23, a[204:207] offset:53536
v_exp_f32 v145, v145
Mvaa 140,28,104
v_add_u32 v226, ((fh_a18-f_start+5120)&0xffffff80), v227
v_min_u32 v226, f_end-f_start, v226
global_load_dword v224, v226, s[98:99]
v_exp_f32 v146, v146
Mvaa 148,28,108
v_add_u32 v226, ((fl_a18-f_start+5120)&0xffffff80), v227
v_min_u32 v226, f_end-f_start, v226
global_load_dword v224, v226, s[98:99]
v_exp_f32 v147, v147
Mvav 160,32,114
TR 48,18,8576
TR 50,18,9088
Mvav 168,32,122
s_waitcnt lgkmcnt(10)
v_exp_f32 v140, v140
Mvav 172,36,122
TR 52,18,8608
TR 54,18,9120
Mvav 164,36,114
s_waitcnt lgkmcnt(9)
v_exp_f32 v141, v141
Mvav 176,40,114
TR 56,18,8640
TR 58,18,9152
Mvav 184,40,122
s_waitcnt lgkmcnt(8)
v_exp_f32 v142, v142
Mvav 188,44,122
TR 60,18,8672
TR 62,18,9184
Mvav 180,44,114
s_waitcnt lgkmcnt(6)
v_exp_f32 v143, v143
Mvav 192,48,114
v_exp_f32 v148, v148
Mvav 200,48,122
s_waitcnt lgkmcnt(4)
v_add_u32 v16, 0x4200, v15
v_add_u32 v18, 0x4200, v17
Mvav 204,52,122
v_exp_f32 v149, v149
Mvav 196,52,114
s_waitcnt lgkmcnt(0)
s_barrier
Mvav 208,56,114
RD 0,16,0
Mvav 216,56,122
RD 4,16,64
Mvav 220,60,122
RD 8,16,128
v_exp_f32 v150, v150
Mvav 212,60,114
RD 12,16,192
v_exp_f32 v151, v151
Mvvv 52,24,114
Mvvv 56,24,122
s_waitcnt lgkmcnt(3)
fl_a19:
Cvaa 112,0,80,40
RD 16,16,512
v_cvt_pk_bf16_f32 v139, v138, v139
Cvaa 120,0,84,44
s_waitcnt lgkmcnt(3)
RD 20,16,576
v_cvt_pk_bf16_f32 v138, v136, v137
Mvaa 112,4,88
RD 24,16,640
v_cvt_pk_bf16_f32 v140, v140, v141
Mvaa 120,4,92
s_waitcnt lgkmcnt(4)
RD 28,16,704
v_cvt_pk_bf16_f32 v141, v142, v143
Mvaa 112,8,96
TR 32,18,8448
v_cvt_pk_bf16_f32 v147, v146, v147
Mvaa 120,8,100
s_waitcnt lgkmcnt(5)
TR 34,18,8960
v_cvt_pk_bf16_f32 v146, v144, v145
Mvaa 112,12,104
TR 36,18,8480
v_cvt_pk_bf16_f32 v148, v148, v149
Mvaa 120,12,108
s_waitcnt lgkmcnt(6)
TR 38,18,8992
v_cvt_pk_bf16_f32 v149, v150, v151
Cvaa 116,16,80,40
s_waitcnt lgkmcnt(6)
TR 40,18,8512
v_exp_f32 v112, v112
Cvaa 124,16,84,44
buffer_store_dwordx4 v[84:87], v12, s[20:23], s44 offen sc1
TR 42,18,9024
v_exp_f32 v113, v113
Mvaa 116,20,88
s_waitcnt lgkmcnt(7)
TR 44,18,8544
v_exp_f32 v114, v114
Mvaa 124,20,92
buffer_store_dwordx4 v[92:95], v12, s[20:23], s44 offen offset:1024 sc1
TR 46,18,9056
v_exp_f32 v115, v115
Mvaa 116,24,96
s_waitcnt lgkmcnt(8)
s_add_u32 m0, s52, 0x21320
v_exp_f32 v120, v120
Mvaa 124,24,100
buffer_load_dwordx4 v31, s[12:15], s3 offen offset:256 nt lds
v_exp_f32 v121, v121
Mvaa 116,28,104
v_exp_f32 v122, v122
Mvaa 124,28,108
s_waitcnt lgkmcnt(6)
v_exp_f32 v123, v123
Mvav 160,32,138
TR 48,18,8576
TR 50,18,9088
Mvav 168,32,146
s_waitcnt lgkmcnt(6)
v_exp_f32 v116, v116
Mvav 172,36,146
TR 52,18,8608
TR 54,18,9120
Mvav 164,36,138
s_waitcnt lgkmcnt(6)
v_exp_f32 v117, v117
Mvav 176,40,138
TR 56,18,8640
TR 58,18,9152
Mvav 184,40,146
s_waitcnt lgkmcnt(6)
v_exp_f32 v118, v118
Mvav 188,44,146
TR 60,18,8672
TR 62,18,9184
Mvav 180,44,138
s_waitcnt lgkmcnt(6)
v_exp_f32 v119, v119
Mvav 192,48,138
v_exp_f32 v124, v124
Mvav 200,48,146
s_waitcnt lgkmcnt(4)
v_add_u32 v16, 0x8400, v15
v_add_u32 v18, 0x8400, v17
Mvav 204,52,146
v_exp_f32 v125, v125
Mvav 196,52,138
s_waitcnt lgkmcnt(0)
s_barrier
Mvav 208,56,138
RD 0,16,0
Mvav 216,56,146
RD 4,16,64
Mvav 220,60,146
RD 8,16,128
v_exp_f32 v126, v126
Mvav 212,60,138
RD 12,16,192
v_exp_f32 v127, v127
Mvvv 52,24,138
Mvvv 56,24,146
s_waitcnt lgkmcnt(3)
fl_a20:
Cvaa 136,0,80,40
RD 16,16,512
v_cvt_pk_bf16_f32 v115, v114, v115
Cvaa 144,0,84,44
s_waitcnt lgkmcnt(3)
RD 20,16,576
v_cvt_pk_bf16_f32 v114, v112, v113
Mvaa 136,4,88
RD 24,16,640
v_cvt_pk_bf16_f32 v116, v116, v117
Mvaa 144,4,92
s_waitcnt lgkmcnt(4)
RD 28,16,704
v_cvt_pk_bf16_f32 v117, v118, v119
Mvaa 136,8,96
TR 32,18,8448
v_cvt_pk_bf16_f32 v123, v122, v123
Mvaa 144,8,100
s_waitcnt lgkmcnt(5)
TR 34,18,8960
v_cvt_pk_bf16_f32 v122, v120, v121
Mvaa 136,12,104
TR 36,18,8480
v_cvt_pk_bf16_f32 v124, v124, v125
Mvaa 144,12,108
s_waitcnt lgkmcnt(6)
TR 38,18,8992
v_cvt_pk_bf16_f32 v125, v126, v127
Cvaa 140,16,80,40
s_waitcnt lgkmcnt(6)
s_mov_b32 s3, 0x34000
s_add_u32 m0, s52, 0x23100
TR 40,18,8512
v_exp_f32 v136, v136
Cvaa 148,16,84,44
buffer_load_dwordx4 v31, s[16:19], s3 offen nt lds
TR 42,18,9024
v_exp_f32 v137, v137
Mvaa 140,20,88
s_waitcnt lgkmcnt(7)
s_add_u32 m0, s52, 0x23420
TR 44,18,8544
v_exp_f32 v138, v138
Mvaa 148,20,92
buffer_load_dwordx4 v31, s[16:19], s3 offen offset:256 nt lds
TR 46,18,9056
v_exp_f32 v139, v139
Mvaa 140,24,96
v_exp_f32 v144, v144
Mvaa 148,24,100
s_waitcnt lgkmcnt(8)
v_exp_f32 v145, v145
Mvaa 140,28,104
v_exp_f32 v146, v146
Mvaa 148,28,108
s_waitcnt lgkmcnt(6)
v_exp_f32 v147, v147
Mvav 160,32,114
TR 48,18,8576
TR 50,18,9088
Mvav 168,32,122
s_waitcnt lgkmcnt(6)
v_exp_f32 v140, v140
Mvav 172,36,122
TR 52,18,8608
TR 54,18,9120
Mvav 164,36,114
s_waitcnt lgkmcnt(6)
v_exp_f32 v141, v141
Mvav 176,40,114
TR 56,18,8640
TR 58,18,9152
Mvav 184,40,122
s_waitcnt lgkmcnt(6)
v_exp_f32 v142, v142
Mvav 188,44,122
TR 60,18,8672
TR 62,18,9184
Mvav 180,44,114
s_waitcnt lgkmcnt(6)
v_exp_f32 v143, v143
Mvav 192,48,114
v_exp_f32 v148, v148
Mvav 200,48,122
s_waitcnt lgkmcnt(4)
v_add_u32 v16, 0xc600, v15
v_add_u32 v18, 0xc600, v17
Mvav 204,52,122
v_exp_f32 v149, v149
Mvav 196,52,114
s_call_b64 s[70:71], f_pad13
s_waitcnt lgkmcnt(0)
s_barrier
Mvav 208,56,114
RD 0,16,0
Mvav 216,56,122
RD 4,16,64
Mvav 220,60,122
RD 8,16,128
v_exp_f32 v150, v150
Mvav 212,60,114
RD 12,16,192
v_exp_f32 v151, v151
Mvvv 52,24,114
Mvvv 56,24,122
s_waitcnt lgkmcnt(3)
fl_a21:
Cvaa 112,0,80,40
RD 16,16,512
v_cvt_pk_bf16_f32 v139, v138, v139
Cvaa 120,0,84,44
s_waitcnt lgkmcnt(3)
RD 20,16,576
v_cvt_pk_bf16_f32 v138, v136, v137
Mvaa 112,4,88
RD 24,16,640
v_cvt_pk_bf16_f32 v140, v140, v141
Mvaa 120,4,92
s_waitcnt lgkmcnt(4)
RD 28,16,704
v_cvt_pk_bf16_f32 v141, v142, v143
Mvaa 112,8,96
TR 32,18,8448
v_cvt_pk_bf16_f32 v147, v146, v147
Mvaa 120,8,100
s_waitcnt lgkmcnt(5)
TR 34,18,8960
v_cvt_pk_bf16_f32 v146, v144, v145
Mvaa 112,12,104
TR 36,18,8480
v_cvt_pk_bf16_f32 v148, v148, v149
Mvaa 120,12,108
s_waitcnt lgkmcnt(6)
TR 38,18,8992
v_cvt_pk_bf16_f32 v149, v150, v151
Cvaa 116,16,80,40
s_waitcnt lgkmcnt(6)
s_mov_b32 s3, 0x38000
s_add_u32 m0, s52, 0
TR 40,18,8512
v_exp_f32 v112, v112
Cvaa 124,16,84,44
buffer_load_dwordx4 v31, s[12:15], s3 offen nt lds
TR 42,18,9024
v_exp_f32 v113, v113
Mvaa 116,20,88
s_waitcnt vmcnt(18) lgkmcnt(7)
TR 44,18,8544
v_exp_f32 v114, v114
Mvaa 124,20,92
ds_write_b128 v19, a[208:211] offset:3584
TR 46,18,9056
v_exp_f32 v115, v115
Mvaa 116,24,96
s_waitcnt vmcnt(15) lgkmcnt(9)
v_exp_f32 v120, v120
Mvaa 124,24,100
ds_write_b128 v19, a[212:215] offset:4640
v_exp_f32 v121, v121
Mvaa 116,28,104
s_waitcnt vmcnt(12) lgkmcnt(8)
v_exp_f32 v122, v122
Mvaa 124,28,108
ds_write_b128 v19, a[216:219] offset:12032
v_exp_f32 v123, v123
Mvav 160,32,138
s_waitcnt vmcnt(9) lgkmcnt(7)
TR 48,18,8576
TR 50,18,9088
Mvav 168,32,146
ds_write_b128 v19, a[220:223] offset:13088
v_exp_f32 v116, v116
Mvav 172,36,146
TR 52,18,8608
TR 54,18,9120
Mvav 164,36,138
s_waitcnt lgkmcnt(10)
v_exp_f32 v117, v117
Mvav 176,40,138
TR 56,18,8640
TR 58,18,9152
Mvav 184,40,146
s_waitcnt lgkmcnt(9)
v_exp_f32 v118, v118
Mvav 188,44,146
TR 60,18,8672
TR 62,18,9184
Mvav 180,44,138
s_waitcnt lgkmcnt(7)
v_exp_f32 v119, v119
Mvav 192,48,138
v_exp_f32 v124, v124
Mvav 200,48,146
s_waitcnt lgkmcnt(4)
v_add_u32 v16, 0x10800, v15
v_add_u32 v18, 0x10800, v17
Mvav 204,52,146
v_exp_f32 v125, v125
Mvav 196,52,138
s_waitcnt lgkmcnt(0)
s_barrier
Mvav 208,56,138
RD 0,16,0
Mvav 216,56,146
RD 4,16,64
Mvav 220,60,146
RD 8,16,128
v_exp_f32 v126, v126
Mvav 212,60,138
RD 12,16,192
v_exp_f32 v127, v127
Mvvv 52,24,138
Mvvv 56,24,146
s_waitcnt lgkmcnt(3)
fl_a22:
Cvaa 136,0,80,40
RD 16,16,512
v_cvt_pk_bf16_f32 v115, v114, v115
Cvaa 144,0,84,44
s_waitcnt lgkmcnt(3)
RD 20,16,576
v_cvt_pk_bf16_f32 v114, v112, v113
Mvaa 136,4,88
RD 24,16,640
v_cvt_pk_bf16_f32 v116, v116, v117
Mvaa 144,4,92
s_waitcnt lgkmcnt(4)
RD 28,16,704
v_cvt_pk_bf16_f32 v117, v118, v119
Mvaa 136,8,96
TR 32,18,8448
v_cvt_pk_bf16_f32 v123, v122, v123
Mvaa 144,8,100
s_waitcnt lgkmcnt(5)
TR 34,18,8960
v_cvt_pk_bf16_f32 v122, v120, v121
Mvaa 136,12,104
TR 36,18,8480
v_cvt_pk_bf16_f32 v124, v124, v125
Mvaa 144,12,108
s_waitcnt lgkmcnt(6)
TR 38,18,8992
v_cvt_pk_bf16_f32 v125, v126, v127
Cvaa 140,16,80,40
s_waitcnt lgkmcnt(6)
s_add_u32 m0, s52, 0x320
TR 40,18,8512
v_exp_f32 v136, v136
Cvaa 148,16,84,44
buffer_load_dwordx4 v31, s[12:15], s3 offen offset:256 nt lds
TR 42,18,9024
v_exp_f32 v137, v137
Mvaa 140,20,88
s_waitcnt lgkmcnt(7)
s_mov_b32 s3, 0x36000
s_add_u32 m0, s52, 0x2100
TR 44,18,8544
v_exp_f32 v138, v138
Mvaa 148,20,92
buffer_load_dwordx4 v31, s[16:19], s3 offen nt lds
TR 46,18,9056
v_exp_f32 v139, v139
Mvaa 140,24,96
s_waitcnt lgkmcnt(8)
s_add_u32 m0, s52, 0x2420
v_exp_f32 v144, v144
Mvaa 148,24,100
buffer_load_dwordx4 v31, s[16:19], s3 offen offset:256 nt lds
v_exp_f32 v145, v145
Mvaa 140,28,104
v_exp_f32 v146, v146
Mvaa 148,28,108
s_waitcnt lgkmcnt(6)
v_exp_f32 v147, v147
Mvav 160,32,114
TR 48,18,8576
TR 50,18,9088
Mvav 168,32,122
s_waitcnt lgkmcnt(6)
v_exp_f32 v140, v140
Mvav 172,36,122
TR 52,18,8608
TR 54,18,9120
Mvav 164,36,114
s_waitcnt lgkmcnt(6)
v_exp_f32 v141, v141
Mvav 176,40,114
TR 56,18,8640
TR 58,18,9152
Mvav 184,40,122
s_waitcnt lgkmcnt(6)
v_exp_f32 v142, v142
Mvav 188,44,122
TR 60,18,8672
TR 62,18,9184
Mvav 180,44,114
s_waitcnt lgkmcnt(6)
v_exp_f32 v143, v143
Mvav 192,48,114
v_exp_f32 v148, v148
Mvav 200,48,122
s_waitcnt lgkmcnt(4)
v_add_u32 v16, 0x14a00, v15
v_add_u32 v18, 0x14a00, v17
Mvav 204,52,122
v_exp_f32 v149, v149
Mvav 196,52,114
s_waitcnt lgkmcnt(0)
s_barrier
Mvav 208,56,114
RD 0,16,0
Mvav 216,56,122
RD 4,16,64
Mvav 220,60,122
RD 8,16,128
v_exp_f32 v150, v150
Mvav 212,60,114
RD 12,16,192
v_exp_f32 v151, v151
Mvvv 52,24,114
Mvvv 56,24,122
s_waitcnt lgkmcnt(3)
fl_a23:
Cvaa 112,0,80,40
RD 16,16,512
v_cvt_pk_bf16_f32 v139, v138, v139
Cvaa 120,0,84,44
s_waitcnt lgkmcnt(3)
RD 20,16,576
v_cvt_pk_bf16_f32 v138, v136, v137
Mvaa 112,4,88
RD 24,16,640
v_cvt_pk_bf16_f32 v140, v140, v141
Mvaa 120,4,92
s_waitcnt lgkmcnt(4)
RD 28,16,704
v_cvt_pk_bf16_f32 v141, v142, v143
Mvaa 112,8,96
TR 32,18,8448
v_cvt_pk_bf16_f32 v147, v146, v147
Mvaa 120,8,100
s_waitcnt lgkmcnt(5)
TR 34,18,8960
v_cvt_pk_bf16_f32 v146, v144, v145
Mvaa 112,12,104
TR 36,18,8480
v_cvt_pk_bf16_f32 v148, v148, v149
Mvaa 120,12,108
s_waitcnt lgkmcnt(6)
TR 38,18,8992
v_cvt_pk_bf16_f32 v149, v150, v151
Cvaa 116,16,80,40
s_waitcnt lgkmcnt(6)
s_mov_b32 s3, 0x3a000
s_add_u32 m0, s52, 0x4200
TR 40,18,8512
v_exp_f32 v112, v112
Cvaa 124,16,84,44
buffer_load_dwordx4 v31, s[12:15], s3 offen nt lds
TR 42,18,9024
v_exp_f32 v113, v113
Mvaa 116,20,88
s_waitcnt lgkmcnt(7)
s_add_u32 m0, s52, 0x4520
TR 44,18,8544
v_exp_f32 v114, v114
Mvaa 124,20,92
buffer_load_dwordx4 v31, s[12:15], s3 offen offset:256 nt lds
TR 46,18,9056
v_exp_f32 v115, v115
Mvaa 116,24,96
v_exp_f32 v120, v120
Mvaa 124,24,100
s_waitcnt lgkmcnt(8)
v_exp_f32 v121, v121
Mvaa 116,28,104
v_exp_f32 v122, v122
Mvaa 124,28,108
s_waitcnt lgkmcnt(6)
v_exp_f32 v123, v123
Mvav 160,32,138
TR 48,18,8576
TR 50,18,9088
Mvav 168,32,146
s_waitcnt lgkmcnt(6)
v_exp_f32 v116, v116
Mvav 172,36,146
TR 52,18,8608
TR 54,18,9120
Mvav 164,36,138
s_waitcnt lgkmcnt(6)
v_exp_f32 v117, v117
Mvav 176,40,138
TR 56,18,8640
TR 58,18,9152
Mvav 184,40,146
s_waitcnt lgkmcnt(6)
v_exp_f32 v118, v118
Mvav 188,44,146
TR 60,18,8672
TR 62,18,9184
Mvav 180,44,138
s_waitcnt lgkmcnt(6)
v_exp_f32 v119, v119
Mvav 192,48,138
v_exp_f32 v124, v124
Mvav 200,48,146
s_waitcnt lgkmcnt(4)
v_add_u32 v16, 0x18c00, v15
v_add_u32 v18, 0x18c00, v17
Mvav 204,52,146
v_exp_f32 v125, v125
Mvav 196,52,138
s_waitcnt vmcnt(9) lgkmcnt(0)
s_barrier
buffer_atomic_add v29, v28, s[20:23], s32 offen offset:0 sc1
Mvav 208,56,138
RD 0,16,0
Mvav 216,56,146
RD 4,16,64
Mvav 220,60,146
RD 8,16,128
v_exp_f32 v126, v126
Mvav 212,60,138
RD 12,16,192
v_exp_f32 v127, v127
Mvvv 52,24,138
Mvvv 56,24,146
s_waitcnt lgkmcnt(3)
fl_a24:
Cvaa 136,0,80,40
RD 16,16,512
v_cvt_pk_bf16_f32 v115, v114, v115
Cvaa 144,0,84,44
s_waitcnt lgkmcnt(3)
RD 20,16,576
v_cvt_pk_bf16_f32 v114, v112, v113
Mvaa 136,4,88
RD 24,16,640
v_cvt_pk_bf16_f32 v116, v116, v117
Mvaa 144,4,92
s_waitcnt lgkmcnt(4)
RD 28,16,704
v_cvt_pk_bf16_f32 v117, v118, v119
Mvaa 136,8,96
TR 32,18,8448
v_cvt_pk_bf16_f32 v123, v122, v123
Mvaa 144,8,100
s_waitcnt lgkmcnt(5)
TR 34,18,8960
v_cvt_pk_bf16_f32 v122, v120, v121
Mvaa 136,12,104
TR 36,18,8480
v_cvt_pk_bf16_f32 v124, v124, v125
Mvaa 144,12,108
s_waitcnt lgkmcnt(6)
TR 38,18,8992
v_cvt_pk_bf16_f32 v125, v126, v127
Cvaa 140,16,80,40
s_waitcnt lgkmcnt(6)
s_mov_b32 s3, 0x38000
s_add_u32 m0, s52, 0x6300
TR 40,18,8512
v_exp_f32 v136, v136
Cvaa 148,16,84,44
buffer_load_dwordx4 v31, s[16:19], s3 offen nt lds
TR 42,18,9024
v_exp_f32 v137, v137
Mvaa 140,20,88
s_waitcnt lgkmcnt(7)
s_add_u32 m0, s52, 0x6620
TR 44,18,8544
v_exp_f32 v138, v138
Mvaa 148,20,92
buffer_load_dwordx4 v31, s[16:19], s3 offen offset:256 nt lds
TR 46,18,9056
v_exp_f32 v139, v139
Mvaa 140,24,96
s_waitcnt lgkmcnt(8)
s_add_u32 s50, s72, 0
s_add_u32 m0, s52, 0x14a00
v_exp_f32 v144, v144
Mvaa 148,24,100
buffer_load_dwordx4 v10, s[24:27], s50 offen lds
v_exp_f32 v145, v145
Mvaa 140,28,104
s_waitcnt lgkmcnt(6)
s_add_u32 m0, s52, 0x14e20
v_exp_f32 v146, v146
Mvaa 148,28,108
buffer_load_dwordx4 v11, s[24:27], s50 offen lds
v_exp_f32 v147, v147
Mvav 160,32,114
s_waitcnt lgkmcnt(4)
s_add_u32 s50, s72, 0x10000
s_add_u32 m0, s52, 0x16b00
TR 48,18,8576
TR 50,18,9088
Mvav 168,32,122
buffer_load_dwordx4 v10, s[24:27], s50 offen lds
v_exp_f32 v140, v140
Mvav 172,36,122
s_waitcnt lgkmcnt(4)
s_add_u32 m0, s52, 0x16f20
TR 52,18,8608
TR 54,18,9120
Mvav 164,36,114
buffer_load_dwordx4 v11, s[24:27], s50 offen lds
v_exp_f32 v141, v141
Mvav 176,40,114
s_waitcnt lgkmcnt(4)
TR 56,18,8640
TR 58,18,9152
v_add_u32 v226, ((fh_a24-f_start+5120)&0xffffff80), v227
v_min_u32 v226, f_end-f_start, v226
Mvav 184,40,122
global_load_dword v224, v226, s[98:99]
v_exp_f32 v142, v142
Mvav 188,44,122
s_waitcnt lgkmcnt(4)
TR 60,18,8672
TR 62,18,9184
v_add_u32 v226, ((fl_a24-f_start+5120)&0xffffff80), v227
v_min_u32 v226, f_end-f_start, v226
Mvav 180,44,114
global_load_dword v224, v226, s[98:99]
v_exp_f32 v143, v143
Mvav 192,48,114
v_exp_f32 v148, v148
Mvav 200,48,122
s_waitcnt lgkmcnt(4)
v_add_u32 v16, 0x1ce00, v15
v_add_u32 v18, 0x1ce00, v17
Mvav 204,52,122
v_exp_f32 v149, v149
Mvav 196,52,114
s_call_b64 s[70:71], f_pad14
s_waitcnt lgkmcnt(0)
s_barrier
Mvav 208,56,114
RD 0,16,0
Mvav 216,56,122
RD 4,16,64
Mvav 220,60,122
RD 8,16,128
v_exp_f32 v150, v150
Mvav 212,60,114
RD 12,16,192
v_exp_f32 v151, v151
Mvvv 52,24,114
Mvvv 56,24,122
s_waitcnt lgkmcnt(3)
fl_a25:
Cvaa 112,0,80,40
RD 16,16,512
v_cvt_pk_bf16_f32 v139, v138, v139
Cvaa 120,0,84,44
s_waitcnt lgkmcnt(3)
RD 20,16,576
v_cvt_pk_bf16_f32 v138, v136, v137
Mvaa 112,4,88
RD 24,16,640
v_cvt_pk_bf16_f32 v140, v140, v141
Mvaa 120,4,92
s_waitcnt lgkmcnt(4)
RD 28,16,704
v_cvt_pk_bf16_f32 v141, v142, v143
Mvaa 112,8,96
TR 32,18,8448
v_cvt_pk_bf16_f32 v147, v146, v147
Mvaa 120,8,100
s_waitcnt lgkmcnt(5)
TR 34,18,8960
v_cvt_pk_bf16_f32 v146, v144, v145
Mvaa 112,12,104
TR 36,18,8480
v_cvt_pk_bf16_f32 v148, v148, v149
Mvaa 120,12,108
s_waitcnt lgkmcnt(6)
TR 38,18,8992
v_cvt_pk_bf16_f32 v149, v150, v151
Cvaa 116,16,80,40
s_waitcnt lgkmcnt(6)
s_mov_b32 s3, 0x3c000
s_add_u32 m0, s52, 0x8400
TR 40,18,8512
v_exp_f32 v112, v112
Cvaa 124,16,84,44
buffer_load_dwordx4 v31, s[12:15], s3 offen nt lds
TR 42,18,9024
v_exp_f32 v113, v113
Mvaa 116,20,88
s_waitcnt lgkmcnt(7)
s_add_u32 m0, s52, 0x8720
TR 44,18,8544
v_exp_f32 v114, v114
Mvaa 124,20,92
buffer_load_dwordx4 v31, s[12:15], s3 offen offset:256 nt lds
TR 46,18,9056
v_exp_f32 v115, v115
Mvaa 116,24,96
s_waitcnt lgkmcnt(8)
s_mov_b32 s3, 0x3a000
s_add_u32 m0, s52, 0xa500
v_exp_f32 v120, v120
Mvaa 124,24,100
buffer_load_dwordx4 v31, s[16:19], s3 offen nt lds
v_exp_f32 v121, v121
Mvaa 116,28,104
s_waitcnt lgkmcnt(6)
s_add_u32 s50, s72, 0x20000
s_add_u32 m0, s52, 0x18c00
v_exp_f32 v122, v122
Mvaa 124,28,108
buffer_load_dwordx4 v10, s[24:27], s50 offen lds
v_exp_f32 v123, v123
Mvav 160,32,138
s_waitcnt lgkmcnt(4)
s_add_u32 m0, s52, 0x19020
TR 48,18,8576
TR 50,18,9088
Mvav 168,32,146
buffer_load_dwordx4 v11, s[24:27], s50 offen lds
v_exp_f32 v116, v116
Mvav 172,36,146
s_waitcnt lgkmcnt(4)
s_add_u32 s50, s72, 0x30000
s_add_u32 m0, s52, 0x1ad00
TR 52,18,8608
TR 54,18,9120
Mvav 164,36,138
buffer_load_dwordx4 v10, s[24:27], s50 offen lds
v_exp_f32 v117, v117
Mvav 176,40,138
s_waitcnt lgkmcnt(4)
s_add_u32 m0, s52, 0x1b120
TR 56,18,8640
TR 58,18,9152
Mvav 184,40,146
buffer_load_dwordx4 v11, s[24:27], s50 offen lds
v_exp_f32 v118, v118
Mvav 188,44,146
TR 60,18,8672
TR 62,18,9184
Mvav 180,44,138
s_waitcnt lgkmcnt(6)
v_exp_f32 v119, v119
Mvav 192,48,138
v_exp_f32 v124, v124
Mvav 200,48,146
s_waitcnt lgkmcnt(4)
v_add_u32 v16, 0x21000, v15
v_add_u32 v18, 0x21000, v17
Mvav 204,52,146
v_exp_f32 v125, v125
Mvav 196,52,138
s_waitcnt vmcnt(22) lgkmcnt(0)
s_barrier
Mvav 208,56,138
RD 0,16,0
Mvav 216,56,146
RD 4,16,64
Mvav 220,60,146
RD 8,16,128
v_exp_f32 v126, v126
Mvav 212,60,138
RD 12,16,192
v_exp_f32 v127, v127
Mvvv 52,24,138
Mvvv 56,24,146
s_waitcnt lgkmcnt(3)
fl_a26:
Cvaa 136,0,80,40
RD 16,16,512
v_cvt_pk_bf16_f32 v115, v114, v115
Cvaa 144,0,84,44
s_waitcnt lgkmcnt(3)
RD 20,16,576
v_cvt_pk_bf16_f32 v114, v112, v113
Mvaa 136,4,88
RD 24,16,640
v_cvt_pk_bf16_f32 v116, v116, v117
Mvaa 144,4,92
s_waitcnt lgkmcnt(4)
RD 28,16,704
v_cvt_pk_bf16_f32 v117, v118, v119
Mvaa 136,8,96
TR 32,18,8448
v_cvt_pk_bf16_f32 v123, v122, v123
Mvaa 144,8,100
s_waitcnt lgkmcnt(5)
TR 34,18,8960
v_cvt_pk_bf16_f32 v122, v120, v121
Mvaa 136,12,104
TR 36,18,8480
v_cvt_pk_bf16_f32 v124, v124, v125
Mvaa 144,12,108
s_waitcnt lgkmcnt(6)
TR 38,18,8992
v_cvt_pk_bf16_f32 v125, v126, v127
Cvaa 140,16,80,40
s_waitcnt lgkmcnt(6)
s_add_u32 m0, s52, 0xa820
TR 40,18,8512
v_exp_f32 v136, v136
Cvaa 148,16,84,44
buffer_load_dwordx4 v31, s[16:19], s3 offen offset:256 nt lds
TR 42,18,9024
v_exp_f32 v137, v137
Mvaa 140,20,88
s_waitcnt lgkmcnt(7)
s_mov_b32 s3, 0x3e000
s_add_u32 m0, s52, 0xc600
TR 44,18,8544
v_exp_f32 v138, v138
Mvaa 148,20,92
buffer_load_dwordx4 v31, s[12:15], s3 offen nt lds
TR 46,18,9056
v_exp_f32 v139, v139
Mvaa 140,24,96
s_waitcnt lgkmcnt(8)
s_add_u32 s50, s72, 0x40000
s_add_u32 m0, s52, 0x1ce00
v_exp_f32 v144, v144
Mvaa 148,24,100
buffer_load_dwordx4 v10, s[24:27], s50 offen lds
v_exp_f32 v145, v145
Mvaa 140,28,104
s_waitcnt lgkmcnt(6)
s_add_u32 m0, s52, 0x1d220
v_exp_f32 v146, v146
Mvaa 148,28,108
buffer_load_dwordx4 v11, s[24:27], s50 offen lds
v_exp_f32 v147, v147
Mvav 160,32,114
s_waitcnt lgkmcnt(4)
s_add_u32 s50, s72, 0x50000
s_add_u32 m0, s52, 0x1ef00
TR 48,18,8576
TR 50,18,9088
Mvav 168,32,122
buffer_load_dwordx4 v10, s[24:27], s50 offen lds
v_exp_f32 v140, v140
Mvav 172,36,122
s_waitcnt lgkmcnt(4)
s_add_u32 m0, s52, 0x1f320
TR 52,18,8608
TR 54,18,9120
Mvav 164,36,114
buffer_load_dwordx4 v11, s[24:27], s50 offen lds
v_exp_f32 v141, v141
Mvav 176,40,114
TR 56,18,8640
TR 58,18,9152
Mvav 184,40,122
s_waitcnt lgkmcnt(6)
v_exp_f32 v142, v142
Mvav 188,44,122
TR 60,18,8672
TR 62,18,9184
Mvav 180,44,114
s_waitcnt lgkmcnt(6)
v_exp_f32 v143, v143
Mvav 192,48,114
v_exp_f32 v148, v148
Mvav 200,48,122
s_waitcnt lgkmcnt(4)
v_add_u32 v16, 0, v15
v_add_u32 v18, 0, v17
Mvav 204,52,122
v_exp_f32 v149, v149
Mvav 196,52,114
s_waitcnt vmcnt(24) lgkmcnt(0)
s_barrier
buffer_load_dword v30, v28, s[20:23], s32 offen sc1
Mvav 208,56,114
RD 0,16,0
Mvav 216,56,122
RD 4,16,64
Mvav 220,60,122
RD 8,16,128
v_exp_f32 v150, v150
Mvav 212,60,114
RD 12,16,192
v_exp_f32 v151, v151
Mvvv 52,24,114
Mvvv 56,24,122
s_waitcnt lgkmcnt(3)
fl_a27:
Cvaa 112,0,80,40
RD 16,16,512
v_cvt_pk_bf16_f32 v139, v138, v139
Cvaa 120,0,84,44
s_waitcnt lgkmcnt(3)
RD 20,16,576
v_cvt_pk_bf16_f32 v138, v136, v137
Mvaa 112,4,88
RD 24,16,640
v_cvt_pk_bf16_f32 v140, v140, v141
Mvaa 120,4,92
s_waitcnt lgkmcnt(4)
RD 28,16,704
v_cvt_pk_bf16_f32 v141, v142, v143
Mvaa 112,8,96
TR 32,18,8448
v_cvt_pk_bf16_f32 v147, v146, v147
Mvaa 120,8,100
s_waitcnt lgkmcnt(5)
TR 34,18,8960
v_cvt_pk_bf16_f32 v146, v144, v145
Mvaa 112,12,104
TR 36,18,8480
v_cvt_pk_bf16_f32 v148, v148, v149
Mvaa 120,12,108
s_waitcnt lgkmcnt(6)
TR 38,18,8992
v_cvt_pk_bf16_f32 v149, v150, v151
Cvaa 116,16,80,40
s_waitcnt lgkmcnt(6)
s_add_u32 m0, s52, 0xc920
TR 40,18,8512
v_exp_f32 v112, v112
Cvaa 124,16,84,44
buffer_load_dwordx4 v31, s[12:15], s3 offen offset:256 nt lds
TR 42,18,9024
v_exp_f32 v113, v113
Mvaa 116,20,88
s_waitcnt lgkmcnt(7)
s_mov_b32 s3, 0x3c000
s_add_u32 m0, s52, 0xe700
TR 44,18,8544
v_exp_f32 v114, v114
Mvaa 124,20,92
buffer_load_dwordx4 v31, s[16:19], s3 offen nt lds
TR 46,18,9056
v_exp_f32 v115, v115
Mvaa 116,24,96
s_waitcnt lgkmcnt(8)
s_add_u32 m0, s52, 0xea20
v_exp_f32 v120, v120
Mvaa 124,24,100
buffer_load_dwordx4 v31, s[16:19], s3 offen offset:256 nt lds
v_exp_f32 v121, v121
Mvaa 116,28,104
s_waitcnt lgkmcnt(6)
s_add_u32 s50, s72, 0x60000
s_add_u32 m0, s52, 0x21000
v_exp_f32 v122, v122
Mvaa 124,28,108
buffer_load_dwordx4 v10, s[24:27], s50 offen lds
v_exp_f32 v123, v123
Mvav 160,32,138
s_waitcnt lgkmcnt(4)
s_add_u32 m0, s52, 0x21420
TR 48,18,8576
TR 50,18,9088
Mvav 168,32,146
buffer_load_dwordx4 v11, s[24:27], s50 offen lds
v_exp_f32 v116, v116
Mvav 172,36,146
s_waitcnt lgkmcnt(4)
s_add_u32 s50, s72, 0x70000
s_add_u32 m0, s52, 0x23100
TR 52,18,8608
TR 54,18,9120
Mvav 164,36,138
buffer_load_dwordx4 v10, s[24:27], s50 offen lds
v_exp_f32 v117, v117
Mvav 176,40,138
s_waitcnt lgkmcnt(4)
s_add_u32 m0, s52, 0x23520
TR 56,18,8640
TR 58,18,9152
Mvav 184,40,146
buffer_load_dwordx4 v11, s[24:27], s50 offen lds
v_exp_f32 v118, v118
Mvav 188,44,146
TR 60,18,8672
TR 62,18,9184
Mvav 180,44,138
s_waitcnt lgkmcnt(6)
v_exp_f32 v119, v119
Mvav 192,48,138
v_exp_f32 v124, v124
Mvav 200,48,146
s_waitcnt lgkmcnt(4)
v_add_u32 v16, 0x4200, v15
v_add_u32 v18, 0x4200, v17
Mvav 204,52,146
s_waitcnt vmcnt(7)
v_exp_f32 v125, v125
Mvav 196,52,138
v_readfirstlane_b32 s41, v30
s_nop 0
s_cmp_lt_u32 s41, 16
s_cbranch_scc1 fl_p0_spin
fl_p0_ok:
s_waitcnt vmcnt(27) lgkmcnt(0)
s_barrier
Mvav 208,56,138
RD 0,16,0
Mvav 216,56,146
RD 4,16,64
Mvav 220,60,146
RD 8,16,128
v_exp_f32 v126, v126
Mvav 212,60,138
RD 12,16,192
v_exp_f32 v127, v127
Mvvv 52,24,138
Mvvv 56,24,146
s_waitcnt lgkmcnt(3)
fl_a28:
Cvaa 136,0,80,40
RD 16,16,512
v_cvt_pk_bf16_f32 v115, v114, v115
Cvaa 144,0,84,44
s_waitcnt lgkmcnt(3)
RD 20,16,576
v_cvt_pk_bf16_f32 v114, v112, v113
Mvaa 136,4,88
RD 24,16,640
v_cvt_pk_bf16_f32 v116, v116, v117
Mvaa 144,4,92
s_waitcnt lgkmcnt(4)
RD 28,16,704
v_cvt_pk_bf16_f32 v117, v118, v119
Mvaa 136,8,96
TR 32,18,8448
v_cvt_pk_bf16_f32 v123, v122, v123
Mvaa 144,8,100
s_waitcnt lgkmcnt(5)
TR 34,18,8960
v_cvt_pk_bf16_f32 v122, v120, v121
Mvaa 136,12,104
TR 36,18,8480
v_cvt_pk_bf16_f32 v124, v124, v125
Mvaa 144,12,108
s_waitcnt lgkmcnt(6)
TR 38,18,8992
v_cvt_pk_bf16_f32 v125, v126, v127
Cvaa 140,16,80,40
s_waitcnt lgkmcnt(6)
s_mov_b32 s3, 0x3e000
s_add_u32 m0, s52, 0x12900
TR 40,18,8512
v_exp_f32 v136, v136
Cvaa 148,16,84,44
buffer_load_dwordx4 v31, s[16:19], s3 offen nt lds
TR 42,18,9024
v_exp_f32 v137, v137
Mvaa 140,20,88
s_waitcnt lgkmcnt(7)
s_add_u32 m0, s52, 0x12c20
TR 44,18,8544
v_exp_f32 v138, v138
Mvaa 148,20,92
buffer_load_dwordx4 v31, s[16:19], s3 offen offset:256 nt lds
TR 46,18,9056
v_exp_f32 v139, v139
Mvaa 140,24,96
s_waitcnt lgkmcnt(8)
s_add_u32 s50, s76, 0
s_add_u32 m0, s52, 0
v_exp_f32 v144, v144
Mvaa 148,24,100
buffer_load_dwordx4 v10, s[24:27], s50 offen lds
v_exp_f32 v145, v145
Mvaa 140,28,104
s_waitcnt lgkmcnt(6)
s_add_u32 m0, s52, 0x420
v_exp_f32 v146, v146
Mvaa 148,28,108
buffer_load_dwordx4 v11, s[24:27], s50 offen lds
v_exp_f32 v147, v147
Mvav 160,32,114
s_waitcnt lgkmcnt(4)
s_add_u32 s50, s76, 0x10000
s_add_u32 m0, s52, 0x2100
TR 48,18,8576
TR 50,18,9088
Mvav 168,32,122
buffer_load_dwordx4 v10, s[24:27], s50 offen lds
v_exp_f32 v140, v140
Mvav 172,36,122
s_waitcnt lgkmcnt(4)
s_add_u32 m0, s52, 0x2520
TR 52,18,8608
TR 54,18,9120
Mvav 164,36,114
buffer_load_dwordx4 v11, s[24:27], s50 offen lds
v_exp_f32 v141, v141
Mvav 176,40,114
s_waitcnt lgkmcnt(4)
s_add_u32 s51, s82, 0
TR 56,18,8640
TR 58,18,9152
Mvav 184,40,122
buffer_load_dwordx4 a[128:131], v20, s[20:23], s51 offen sc1
v_exp_f32 v142, v142
Mvav 188,44,122
s_waitcnt lgkmcnt(4)
TR 60,18,8672
TR 62,18,9184
Mvav 180,44,114
buffer_load_dwordx4 a[140:143], v20, s[20:23], s51 offen offset:1024 sc1
v_exp_f32 v143, v143
Mvav 192,48,114
v_exp_f32 v148, v148
Mvav 200,48,122
s_waitcnt lgkmcnt(4)
v_add_u32 v16, 0x8400, v15
v_add_u32 v18, 0x8400, v17
Mvav 204,52,122
v_exp_f32 v149, v149
Mvav 196,52,114
s_call_b64 s[70:71], f_pad15
s_waitcnt vmcnt(21) lgkmcnt(0)
s_barrier
Mvav 208,56,114
RD 0,16,0
Mvav 216,56,122
RD 4,16,64
Mvav 220,60,122
RD 8,16,128
v_exp_f32 v150, v150
Mvav 212,60,114
RD 12,16,192
v_exp_f32 v151, v151
Mvvv 52,24,114
Mvvv 56,24,122
s_waitcnt lgkmcnt(3)
fl_a29:
Cvaa 112,0,80,40
RD 16,16,512
v_cvt_pk_bf16_f32 v139, v138, v139
Cvaa 120,0,84,44
s_waitcnt lgkmcnt(3)
RD 20,16,576
v_cvt_pk_bf16_f32 v138, v136, v137
Mvaa 112,4,88
RD 24,16,640
v_cvt_pk_bf16_f32 v140, v140, v141
Mvaa 120,4,92
s_waitcnt lgkmcnt(4)
RD 28,16,704
v_cvt_pk_bf16_f32 v141, v142, v143
Mvaa 112,8,96
TR 32,18,8448
v_cvt_pk_bf16_f32 v147, v146, v147
Mvaa 120,8,100
s_waitcnt lgkmcnt(5)
TR 34,18,8960
v_cvt_pk_bf16_f32 v146, v144, v145
Mvaa 112,12,104
TR 36,18,8480
v_cvt_pk_bf16_f32 v148, v148, v149
Mvaa 120,12,108
s_waitcnt lgkmcnt(6)
TR 38,18,8992
v_cvt_pk_bf16_f32 v149, v150, v151
Cvaa 116,16,80,40
s_waitcnt lgkmcnt(6)
s_add_u32 s50, s76, 0x20000
s_add_u32 m0, s52, 0x4200
TR 40,18,8512
v_exp_f32 v112, v112
Cvaa 124,16,84,44
buffer_load_dwordx4 v10, s[24:27], s50 offen lds
TR 42,18,9024
v_exp_f32 v113, v113
Mvaa 116,20,88
s_waitcnt lgkmcnt(7)
s_add_u32 m0, s52, 0x4620
TR 44,18,8544
v_exp_f32 v114, v114
Mvaa 124,20,92
buffer_load_dwordx4 v11, s[24:27], s50 offen lds
TR 46,18,9056
v_exp_f32 v115, v115
Mvaa 116,24,96
s_waitcnt lgkmcnt(8)
s_add_u32 s50, s76, 0x30000
s_add_u32 m0, s52, 0x6300
v_exp_f32 v120, v120
Mvaa 124,24,100
buffer_load_dwordx4 v10, s[24:27], s50 offen lds
v_exp_f32 v121, v121
Mvaa 116,28,104
s_waitcnt lgkmcnt(6)
s_add_u32 m0, s52, 0x6720
v_exp_f32 v122, v122
Mvaa 124,28,108
buffer_load_dwordx4 v11, s[24:27], s50 offen lds
v_exp_f32 v123, v123
Mvav 160,32,138
s_waitcnt lgkmcnt(4)
TR 48,18,8576
TR 50,18,9088
Mvav 168,32,146
buffer_load_dwordx4 a[132:135], v12, s[20:23], s51 offen sc1
v_exp_f32 v116, v116
Mvav 172,36,146
s_waitcnt lgkmcnt(4)
TR 52,18,8608
TR 54,18,9120
Mvav 164,36,138
buffer_load_dwordx4 a[144:147], v12, s[20:23], s51 offen offset:1024 sc1
v_exp_f32 v117, v117
Mvav 176,40,138
TR 56,18,8640
TR 58,18,9152
Mvav 184,40,146
s_waitcnt lgkmcnt(6)
v_exp_f32 v118, v118
Mvav 188,44,146
TR 60,18,8672
TR 62,18,9184
Mvav 180,44,138
s_waitcnt lgkmcnt(6)
v_exp_f32 v119, v119
Mvav 192,48,138
v_exp_f32 v124, v124
Mvav 200,48,146
s_waitcnt lgkmcnt(4)
v_add_u32 v16, 0xc600, v15
v_add_u32 v18, 0xc600, v17
Mvav 204,52,146
v_exp_f32 v125, v125
Mvav 196,52,138
s_waitcnt vmcnt(18) lgkmcnt(0)
s_barrier
Mvav 208,56,138
RD 0,16,0
Mvav 216,56,146
RD 4,16,64
Mvav 220,60,146
RD 8,16,128
v_exp_f32 v126, v126
Mvav 212,60,138
RD 12,16,192
v_exp_f32 v127, v127
Mvvv 52,24,138
Mvvv 56,24,146
s_waitcnt lgkmcnt(3)
fl_a30:
Cvaa 136,0,80,40
RD 16,16,512
v_cvt_pk_bf16_f32 v115, v114, v115
Cvaa 144,0,84,44
s_waitcnt lgkmcnt(3)
RD 20,16,576
v_cvt_pk_bf16_f32 v114, v112, v113
Mvaa 136,4,88
RD 24,16,640
v_cvt_pk_bf16_f32 v116, v116, v117
Mvaa 144,4,92
s_waitcnt lgkmcnt(4)
RD 28,16,704
v_cvt_pk_bf16_f32 v117, v118, v119
Mvaa 136,8,96
TR 32,18,8448
v_cvt_pk_bf16_f32 v123, v122, v123
Mvaa 144,8,100
s_waitcnt lgkmcnt(5)
TR 34,18,8960
v_cvt_pk_bf16_f32 v122, v120, v121
Mvaa 136,12,104
TR 36,18,8480
v_cvt_pk_bf16_f32 v124, v124, v125
Mvaa 144,12,108
s_waitcnt lgkmcnt(6)
TR 38,18,8992
v_cvt_pk_bf16_f32 v125, v126, v127
Cvaa 140,16,80,40
s_waitcnt lgkmcnt(6)
s_add_u32 s50, s76, 0x80000
s_add_u32 m0, s52, 0x8400
TR 40,18,8512
v_exp_f32 v136, v136
Cvaa 148,16,84,44
buffer_load_dwordx4 v10, s[24:27], s50 offen lds
TR 42,18,9024
v_exp_f32 v137, v137
Mvaa 140,20,88
s_waitcnt lgkmcnt(7)
s_add_u32 m0, s52, 0x8820
TR 44,18,8544
v_exp_f32 v138, v138
Mvaa 148,20,92
buffer_load_dwordx4 v11, s[24:27], s50 offen lds
TR 46,18,9056
v_exp_f32 v139, v139
Mvaa 140,24,96
s_waitcnt lgkmcnt(8)
s_add_u32 s50, s76, 0x90000
s_add_u32 m0, s52, 0xa500
v_exp_f32 v144, v144
Mvaa 148,24,100
buffer_load_dwordx4 v10, s[24:27], s50 offen lds
v_exp_f32 v145, v145
Mvaa 140,28,104
s_waitcnt lgkmcnt(6)
s_add_u32 m0, s52, 0xa920
v_exp_f32 v146, v146
Mvaa 148,28,108
buffer_load_dwordx4 v11, s[24:27], s50 offen lds
v_exp_f32 v147, v147
Mvav 160,32,114
s_waitcnt lgkmcnt(4)
s_add_u32 s51, s82, 0x5800
TR 48,18,8576
TR 50,18,9088
Mvav 168,32,122
buffer_load_dwordx4 a[152:155], v20, s[20:23], s51 offen sc1
v_exp_f32 v140, v140
Mvav 172,36,122
s_waitcnt lgkmcnt(4)
TR 52,18,8608
TR 54,18,9120
Mvav 164,36,114
buffer_load_dwordx4 a[164:167], v20, s[20:23], s51 offen offset:1024 sc1
v_exp_f32 v141, v141
Mvav 176,40,114
s_waitcnt lgkmcnt(4)
TR 56,18,8640
TR 58,18,9152
v_add_u32 v226, ((fh_a30-f_start+5120)&0xffffff80), v227
v_min_u32 v226, f_end-f_start, v226
Mvav 184,40,122
global_load_dword v224, v226, s[98:99]
v_exp_f32 v142, v142
Mvav 188,44,122
s_waitcnt lgkmcnt(4)
TR 60,18,8672
TR 62,18,9184
v_add_u32 v226, ((fl_a30-f_start+5120)&0xffffff80), v227
v_min_u32 v226, f_end-f_start, v226
Mvav 180,44,114
global_load_dword v224, v226, s[98:99]
v_exp_f32 v143, v143
Mvav 192,48,114
v_exp_f32 v148, v148
Mvav 200,48,122
s_waitcnt lgkmcnt(4)
v_add_u32 v16, 0x10800, v15
v_add_u32 v18, 0x10800, v17
Mvav 204,52,122
v_exp_f32 v149, v149
Mvav 196,52,114
s_waitcnt vmcnt(20) lgkmcnt(0)
s_barrier
Mvav 208,56,114
RD 0,16,0
Mvav 216,56,122
RD 4,16,64
Mvav 220,60,122
RD 8,16,128
v_exp_f32 v150, v150
Mvav 212,60,114
RD 12,16,192
v_exp_f32 v151, v151
Mvvv 52,24,114
Mvvv 56,24,122
TR 32,18,8448
TR 34,18,8960
TR 36,18,8480
TR 38,18,8992
TR 40,18,8512
TR 42,18,9024
TR 44,18,8544
TR 46,18,9056
TR 48,18,8576
TR 50,18,9088
TR 52,18,8608
TR 54,18,9120
TR 56,18,8640
TR 58,18,9152
TR 60,18,8672
TR 62,18,9184
v_cvt_pk_bf16_f32 v139, v138, v139
v_cvt_pk_bf16_f32 v138, v136, v137
v_cvt_pk_bf16_f32 v140, v140, v141
v_cvt_pk_bf16_f32 v141, v142, v143
v_cvt_pk_bf16_f32 v147, v146, v147
v_cvt_pk_bf16_f32 v146, v144, v145
v_cvt_pk_bf16_f32 v148, v148, v149
v_cvt_pk_bf16_f32 v149, v150, v151
Mvvv 52,24,138
s_waitcnt lgkmcnt(8)
Mvvv 56,24,146
s_add_u32 s50, s76, 0xa0000
s_add_u32 m0, s52, 0xc600
s_nop 0
buffer_load_dwordx4 v10, s[24:27], s50 offen lds
s_add_u32 m0, s52, 0xca20
s_nop 0
buffer_load_dwordx4 v11, s[24:27], s50 offen lds
Mvav 160,32,138
s_add_u32 s50, s76, 0xb0000
s_add_u32 m0, s52, 0xe700
s_nop 0
buffer_load_dwordx4 v10, s[24:27], s50 offen lds
Mvav 168,32,146
s_add_u32 m0, s52, 0xeb20
s_nop 0
buffer_load_dwordx4 v11, s[24:27], s50 offen lds
Mvav 172,36,146
buffer_load_dwordx4 a[156:159], v12, s[20:23], s51 offen sc1
Mvav 164,36,138
buffer_load_dwordx4 a[168:171], v12, s[20:23], s51 offen offset:1024 sc1
s_add_u32 s51, s82, 0x16000
buffer_load_dwordx4 a[176:179], v20, s[20:23], s51 offen sc1
Mvav 176,40,138
buffer_load_dwordx4 a[188:191], v20, s[20:23], s51 offen offset:1024 sc1
Mvav 184,40,146
buffer_load_dwordx4 a[180:183], v12, s[20:23], s51 offen sc1
Mvav 188,44,146
buffer_load_dwordx4 a[192:195], v12, s[20:23], s51 offen offset:1024 sc1
Mvav 180,44,138
s_waitcnt lgkmcnt(6)
v_add_u32 v14, 0x14a00, v17
Mvav 192,48,138
s_waitcnt vmcnt(55) lgkmcnt(0)
s_barrier
Mvav 200,48,146
TR 0,14,0
TR 2,14,512
Mvav 204,52,146
TR 4,14,32
TR 6,14,544
Mvav 196,52,138
TR 8,14,64
TR 10,14,576
Mvav 208,56,138
TR 12,14,96
TR 14,14,608
Mvav 216,56,146
TR 16,14,128
TR 18,14,640
Mvav 220,60,146
TR 20,14,160
TR 22,14,672
Mvav 212,60,138
TR 24,14,192
TR 26,14,704
s_mov_b32 s41, 0x47800000
v_add_f32 v3, v52, v56
v_cmp_nge_f32 vcc, s41, v3
v_rcp_f32 v32, v52
v_rcp_f32 v34, v56
s_cbranch_vccnz fl_slow1
fl_norm1:
v_pk_mul_f32 v[160:161], v[160:161], v[32:33] op_sel_hi:[1,0]
v_pk_mul_f32 v[162:163], v[162:163], v[32:33] op_sel_hi:[1,0]
v_pk_mul_f32 v[164:165], v[164:165], v[32:33] op_sel_hi:[1,0]
v_pk_mul_f32 v[166:167], v[166:167], v[32:33] op_sel_hi:[1,0]
v_cvt_pk_bf16_f32 v112, v160, v161
v_cvt_pk_bf16_f32 v113, v162, v163
v_cvt_pk_bf16_f32 v114, v164, v165
v_cvt_pk_bf16_f32 v115, v166, v167
v_pk_mul_f32 v[176:177], v[176:177], v[32:33] op_sel_hi:[1,0]
v_pk_mul_f32 v[178:179], v[178:179], v[32:33] op_sel_hi:[1,0]
v_pk_mul_f32 v[180:181], v[180:181], v[32:33] op_sel_hi:[1,0]
v_pk_mul_f32 v[182:183], v[182:183], v[32:33] op_sel_hi:[1,0]
v_cvt_pk_bf16_f32 v120, v176, v177
v_cvt_pk_bf16_f32 v121, v178, v179
v_cvt_pk_bf16_f32 v122, v180, v181
v_cvt_pk_bf16_f32 v123, v182, v183
v_pk_mul_f32 v[192:193], v[192:193], v[32:33] op_sel_hi:[1,0]
v_pk_mul_f32 v[194:195], v[194:195], v[32:33] op_sel_hi:[1,0]
v_pk_mul_f32 v[196:197], v[196:197], v[32:33] op_sel_hi:[1,0]
v_pk_mul_f32 v[198:199], v[198:199], v[32:33] op_sel_hi:[1,0]
v_cvt_pk_bf16_f32 v128, v192, v193
v_cvt_pk_bf16_f32 v129, v194, v195
v_cvt_pk_bf16_f32 v130, v196, v197
v_cvt_pk_bf16_f32 v131, v198, v199
v_pk_mul_f32 v[208:209], v[208:209], v[32:33] op_sel_hi:[1,0]
v_pk_mul_f32 v[210:211], v[210:211], v[32:33] op_sel_hi:[1,0]
v_pk_mul_f32 v[212:213], v[212:213], v[32:33] op_sel_hi:[1,0]
v_pk_mul_f32 v[214:215], v[214:215], v[32:33] op_sel_hi:[1,0]
v_cvt_pk_bf16_f32 v136, v208, v209
v_cvt_pk_bf16_f32 v137, v210, v211
v_cvt_pk_bf16_f32 v138, v212, v213
v_cvt_pk_bf16_f32 v139, v214, v215
v_pk_mul_f32 v[168:169], v[168:169], v[34:35] op_sel_hi:[1,0]
v_pk_mul_f32 v[170:171], v[170:171], v[34:35] op_sel_hi:[1,0]
v_pk_mul_f32 v[172:173], v[172:173], v[34:35] op_sel_hi:[1,0]
v_pk_mul_f32 v[174:175], v[174:175], v[34:35] op_sel_hi:[1,0]
v_cvt_pk_bf16_f32 v116, v168, v169
v_cvt_pk_bf16_f32 v117, v170, v171
v_cvt_pk_bf16_f32 v118, v172, v173
v_cvt_pk_bf16_f32 v119, v174, v175
v_pk_mul_f32 v[184:185], v[184:185], v[34:35] op_sel_hi:[1,0]
v_pk_mul_f32 v[186:187], v[186:187], v[34:35] op_sel_hi:[1,0]
v_pk_mul_f32 v[188:189], v[188:189], v[34:35] op_sel_hi:[1,0]
v_pk_mul_f32 v[190:191], v[190:191], v[34:35] op_sel_hi:[1,0]
v_cvt_pk_bf16_f32 v124, v184, v185
v_cvt_pk_bf16_f32 v125, v186, v187
v_cvt_pk_bf16_f32 v126, v188, v189
v_cvt_pk_bf16_f32 v127, v190, v191
v_pk_mul_f32 v[200:201], v[200:201], v[34:35] op_sel_hi:[1,0]
v_pk_mul_f32 v[202:203], v[202:203], v[34:35] op_sel_hi:[1,0]
v_pk_mul_f32 v[204:205], v[204:205], v[34:35] op_sel_hi:[1,0]
v_pk_mul_f32 v[206:207], v[206:207], v[34:35] op_sel_hi:[1,0]
v_cvt_pk_bf16_f32 v132, v200, v201
v_cvt_pk_bf16_f32 v133, v202, v203
v_cvt_pk_bf16_f32 v134, v204, v205
v_cvt_pk_bf16_f32 v135, v206, v207
v_pk_mul_f32 v[216:217], v[216:217], v[34:35] op_sel_hi:[1,0]
v_pk_mul_f32 v[218:219], v[218:219], v[34:35] op_sel_hi:[1,0]
v_pk_mul_f32 v[220:221], v[220:221], v[34:35] op_sel_hi:[1,0]
v_pk_mul_f32 v[222:223], v[222:223], v[34:35] op_sel_hi:[1,0]
v_cvt_pk_bf16_f32 v140, v216, v217
v_cvt_pk_bf16_f32 v141, v218, v219
v_cvt_pk_bf16_f32 v142, v220, v221
v_cvt_pk_bf16_f32 v143, v222, v223
fl_u0:
s_waitcnt lgkmcnt(12)
Zvav 160,0,64
s_waitcnt lgkmcnt(10)
s_add_u32 s44, s78, 0xb000
TR 28,14,224
TR 30,14,736
Zvav 164,0,68
buffer_store_dwordx4 v[112:115], v20, s[20:23], s44 offen sc1
Zvav 172,4,68
s_waitcnt lgkmcnt(10)
TR 0,14,8448
TR 2,14,8960
Zvav 168,4,64
buffer_store_dwordx4 v[120:123], v20, s[20:23], s44 offen offset:1024 sc1
Zvav 176,8,64
s_waitcnt lgkmcnt(10)
s_add_u32 s50, s76, 0x100000
s_add_u32 m0, s52, 0x10800
TR 4,14,8480
TR 6,14,8992
Zvav 180,8,68
buffer_load_dwordx4 v10, s[24:27], s50 offen lds
Zvav 188,12,68
s_waitcnt lgkmcnt(10)
s_add_u32 m0, s52, 0x10c20
TR 8,14,8512
TR 10,14,9024
Zvav 184,12,64
buffer_load_dwordx4 v11, s[24:27], s50 offen lds
Zvav 192,16,64
s_waitcnt lgkmcnt(10)
s_add_u32 s50, s76, 0x110000
s_add_u32 m0, s52, 0x12900
TR 12,14,8544
TR 14,14,9056
Zvav 196,16,68
buffer_load_dwordx4 v10, s[24:27], s50 offen lds
Zvav 204,20,68
s_waitcnt lgkmcnt(10)
s_add_u32 m0, s52, 0x12d20
TR 16,14,8576
TR 18,14,9088
Zvav 200,20,64
buffer_load_dwordx4 v11, s[24:27], s50 offen lds
Zvav 208,24,64
s_waitcnt lgkmcnt(10)
s_add_u32 s51, s82, 0x1b800
TR 20,14,8608
TR 22,14,9120
Zvav 212,24,68
buffer_load_dwordx4 a[200:203], v20, s[20:23], s51 offen sc1
Zvav 220,28,68
s_waitcnt lgkmcnt(10)
TR 24,14,8640
TR 26,14,9152
Zvav 216,28,64
buffer_load_dwordx4 a[212:215], v20, s[20:23], s51 offen offset:1024 sc1
Mvav 160,0,72
s_waitcnt lgkmcnt(10)
TR 28,14,8672
TR 30,14,9184
Mvav 164,0,76
buffer_load_dwordx4 a[204:207], v12, s[20:23], s51 offen sc1
Mvav 172,4,76
s_waitcnt lgkmcnt(10)
Mvav 168,4,72
buffer_load_dwordx4 a[216:219], v12, s[20:23], s51 offen offset:1024 sc1
Mvav 176,8,72
Mvav 180,8,76
s_waitcnt lgkmcnt(8)
Mvav 188,12,76
v_add_u32 v14, 0x18c00, v17
Mvav 184,12,72
s_call_b64 s[70:71], f_pad16
s_waitcnt vmcnt(56) lgkmcnt(0)
s_barrier
Mvav 192,16,72
TR 0,14,0
TR 2,14,512
Mvav 196,16,76
TR 4,14,32
TR 6,14,544
Mvav 204,20,76
TR 8,14,64
TR 10,14,576
Mvav 200,20,72
TR 12,14,96
TR 14,14,608
Mvav 208,24,72
TR 16,14,128
TR 18,14,640
Mvav 212,24,76
TR 20,14,160
TR 22,14,672
Mvav 220,28,76
TR 24,14,192
TR 26,14,704
Mvav 216,28,72
s_waitcnt lgkmcnt(12)
fl_u1:
Mvav 160,0,80
s_waitcnt lgkmcnt(10)
TR 28,14,224
TR 30,14,736
Mvav 164,0,84
buffer_store_dwordx4 v[116:119], v12, s[20:23], s44 offen sc1
Mvav 172,4,84
s_waitcnt lgkmcnt(10)
TR 0,14,8448
TR 2,14,8960
Mvav 168,4,80
buffer_store_dwordx4 v[124:127], v12, s[20:23], s44 offen offset:1024 sc1
Mvav 176,8,80
s_waitcnt lgkmcnt(10)
s_add_u32 s50, s76, 0x120000
s_add_u32 m0, s52, 0x14a00
TR 4,14,8480
TR 6,14,8992
Mvav 180,8,84
buffer_load_dwordx4 v10, s[24:27], s50 offen lds
Mvav 188,12,84
s_waitcnt lgkmcnt(10)
s_add_u32 m0, s52, 0x14e20
TR 8,14,8512
TR 10,14,9024
Mvav 184,12,80
buffer_load_dwordx4 v11, s[24:27], s50 offen lds
Mvav 192,16,80
s_waitcnt lgkmcnt(10)
s_add_u32 s50, s76, 0x130000
s_add_u32 m0, s52, 0x16b00
TR 12,14,8544
TR 14,14,9056
Mvav 196,16,84
buffer_load_dwordx4 v10, s[24:27], s50 offen lds
Mvav 204,20,84
s_waitcnt lgkmcnt(10)
s_add_u32 m0, s52, 0x16f20
TR 16,14,8576
TR 18,14,9088
Mvav 200,20,80
buffer_load_dwordx4 v11, s[24:27], s50 offen lds
Mvav 208,24,80
s_waitcnt lgkmcnt(10)
s_add_u32 s51, s82, 0x2c000
TR 20,14,8608
TR 22,14,9120
Mvav 212,24,84
buffer_load_dwordx4 a[224:227], v20, s[20:23], s51 offen sc1
Mvav 220,28,84
s_waitcnt lgkmcnt(10)
TR 24,14,8640
TR 26,14,9152
Mvav 216,28,80
buffer_load_dwordx4 a[236:239], v20, s[20:23], s51 offen offset:1024 sc1
Mvav 160,0,88
s_waitcnt lgkmcnt(10)
TR 28,14,8672
TR 30,14,9184
Mvav 164,0,92
buffer_load_dwordx4 a[228:231], v12, s[20:23], s51 offen sc1
Mvav 172,4,92
s_waitcnt lgkmcnt(10)
Mvav 168,4,88
buffer_load_dwordx4 a[240:243], v12, s[20:23], s51 offen offset:1024 sc1
Mvav 176,8,88
Mvav 180,8,92
s_waitcnt lgkmcnt(8)
Mvav 188,12,92
v_add_u32 v14, 0x1ce00, v17
Mvav 184,12,88
s_waitcnt vmcnt(60) lgkmcnt(0)
s_barrier
Mvav 192,16,88
TR 0,14,0
TR 2,14,512
Mvav 196,16,92
TR 4,14,32
TR 6,14,544
Mvav 204,20,92
TR 8,14,64
TR 10,14,576
Mvav 200,20,88
TR 12,14,96
TR 14,14,608
Mvav 208,24,88
TR 16,14,128
TR 18,14,640
Mvav 212,24,92
TR 20,14,160
TR 22,14,672
Mvav 220,28,92
TR 24,14,192
TR 26,14,704
Mvav 216,28,88
s_waitcnt lgkmcnt(12)
fl_u2:
Mvav 160,0,112
s_waitcnt lgkmcnt(10)
s_add_u32 s50, s76, 0x180000
s_add_u32 m0, s52, 0x18c00
TR 28,14,224
TR 30,14,736
Mvav 164,0,116
buffer_load_dwordx4 v10, s[24:27], s50 offen lds
Mvav 172,4,116
s_waitcnt lgkmcnt(10)
s_add_u32 m0, s52, 0x19020
TR 0,14,8448
TR 2,14,8960
Mvav 168,4,112
buffer_load_dwordx4 v11, s[24:27], s50 offen lds
Mvav 176,8,112
s_waitcnt lgkmcnt(10)
s_add_u32 s50, s76, 0x190000
s_add_u32 m0, s52, 0x1ad00
TR 4,14,8480
TR 6,14,8992
Mvav 180,8,116
buffer_load_dwordx4 v10, s[24:27], s50 offen lds
Mvav 188,12,116
s_waitcnt lgkmcnt(10)
s_add_u32 m0, s52, 0x1b120
TR 8,14,8512
TR 10,14,9024
Mvav 184,12,112
buffer_load_dwordx4 v11, s[24:27], s50 offen lds
Mvav 192,16,112
s_waitcnt lgkmcnt(10)
s_add_u32 s51, s82, 0x31800
TR 12,14,8544
TR 14,14,9056
Mvav 196,16,116
buffer_load_dwordx4 a[80:83], v20, s[20:23], s51 offen sc1
Mvav 204,20,116
s_waitcnt lgkmcnt(10)
TR 16,14,8576
TR 18,14,9088
Mvav 200,20,112
buffer_load_dwordx4 a[92:95], v20, s[20:23], s51 offen offset:1024 sc1
Mvav 208,24,112
s_waitcnt lgkmcnt(10)
TR 20,14,8608
TR 22,14,9120
Mvav 212,24,116
buffer_load_dwordx4 a[84:87], v12, s[20:23], s51 offen sc1
Mvav 220,28,116
s_waitcnt lgkmcnt(10)
TR 24,14,8640
TR 26,14,9152
Mvav 216,28,112
buffer_load_dwordx4 a[96:99], v12, s[20:23], s51 offen offset:1024 sc1
Mvav 160,0,120
TR 28,14,8672
TR 30,14,9184
Mvav 164,0,124
s_waitcnt lgkmcnt(12)
Mvav 172,4,124
Mvav 168,4,120
s_waitcnt lgkmcnt(10)
Mvav 176,8,120
Mvav 180,8,124
s_waitcnt lgkmcnt(8)
Mvav 188,12,124
v_add_u32 v14, 0x21000, v17
Mvav 184,12,120
s_waitcnt vmcnt(60) lgkmcnt(0)
s_barrier
Mvav 192,16,120
TR 0,14,0
TR 2,14,512
Mvav 196,16,124
TR 4,14,32
TR 6,14,544
Mvav 204,20,124
TR 8,14,64
TR 10,14,576
Mvav 200,20,120
TR 12,14,96
TR 14,14,608
Mvav 208,24,120
TR 16,14,128
TR 18,14,640
Mvav 212,24,124
TR 20,14,160
TR 22,14,672
Mvav 220,28,124
TR 24,14,192
TR 26,14,704
Mvav 216,28,120
s_waitcnt lgkmcnt(12)
fl_u3:
Mvav 160,0,128
s_waitcnt lgkmcnt(10)
s_add_u32 s44, s78, 0x10800
TR 28,14,224
TR 30,14,736
Mvav 164,0,132
buffer_store_dwordx4 v[128:131], v20, s[20:23], s44 offen sc1
Mvav 172,4,132
s_waitcnt lgkmcnt(10)
TR 0,14,8448
TR 2,14,8960
Mvav 168,4,128
buffer_store_dwordx4 v[136:139], v20, s[20:23], s44 offen offset:1024 sc1
Mvav 176,8,128
s_waitcnt lgkmcnt(10)
s_add_u32 s50, s76, 0x1a0000
s_add_u32 m0, s52, 0x1ce00
TR 4,14,8480
TR 6,14,8992
Mvav 180,8,132
buffer_load_dwordx4 v10, s[24:27], s50 offen lds
Mvav 188,12,132
s_waitcnt lgkmcnt(10)
s_add_u32 m0, s52, 0x1d220
TR 8,14,8512
TR 10,14,9024
Mvav 184,12,128
buffer_load_dwordx4 v11, s[24:27], s50 offen lds
Mvav 192,16,128
s_waitcnt lgkmcnt(10)
s_add_u32 s50, s76, 0x1b0000
s_add_u32 m0, s52, 0x1ef00
TR 12,14,8544
TR 14,14,9056
Mvav 196,16,132
buffer_load_dwordx4 v10, s[24:27], s50 offen lds
Mvav 204,20,132
s_waitcnt lgkmcnt(10)
s_add_u32 m0, s52, 0x1f320
TR 16,14,8576
TR 18,14,9088
Mvav 200,20,128
buffer_load_dwordx4 v11, s[24:27], s50 offen lds
Mvav 208,24,128
s_waitcnt lgkmcnt(10)
s_add_u32 s51, s82, 0x42000
TR 20,14,8608
TR 22,14,9120
Mvav 212,24,132
buffer_load_dwordx4 a[104:107], v20, s[20:23], s51 offen sc1
Mvav 220,28,132
s_waitcnt lgkmcnt(10)
TR 24,14,8640
TR 26,14,9152
Mvav 216,28,128
buffer_load_dwordx4 a[116:119], v20, s[20:23], s51 offen offset:1024 sc1
Mvav 160,0,136
s_waitcnt lgkmcnt(10)
TR 28,14,8672
TR 30,14,9184
Mvav 164,0,140
buffer_load_dwordx4 a[108:111], v12, s[20:23], s51 offen sc1
Mvav 172,4,140
s_waitcnt lgkmcnt(10)
Mvav 168,4,136
buffer_load_dwordx4 a[120:123], v12, s[20:23], s51 offen offset:1024 sc1
Mvav 176,8,136
Mvav 180,8,140
s_waitcnt lgkmcnt(8)
Mvav 188,12,140
v_add_u32 v14, 0, v17
Mvav 184,12,136
s_waitcnt vmcnt(63) lgkmcnt(0)
s_barrier
Mvav 192,16,136
TR 0,14,0
TR 2,14,512
Mvav 196,16,140
TR 4,14,32
TR 6,14,544
Mvav 204,20,140
TR 8,14,64
TR 10,14,576
Mvav 200,20,136
TR 12,14,96
TR 14,14,608
Mvav 208,24,136
TR 16,14,128
TR 18,14,640
Mvav 212,24,140
TR 20,14,160
TR 22,14,672
Mvav 220,28,140
TR 24,14,192
TR 26,14,704
Mvav 216,28,136
s_waitcnt lgkmcnt(12)
fl_u4:
Mvaa 160,0,128
s_waitcnt vmcnt(57) lgkmcnt(10)
s_add_u32 s50, s73, 0
s_add_u32 m0, s52, 0x21000
TR 28,14,224
TR 30,14,736
Mvaa 164,0,132
buffer_load_dwordx4 v10, s[24:27], s50 offen lds
Mvaa 172,4,132
s_waitcnt lgkmcnt(10)
s_add_u32 m0, s52, 0x21420
TR 0,14,8448
TR 2,14,8960
Mvaa 168,4,128
buffer_load_dwordx4 v11, s[24:27], s50 offen lds
Mvaa 176,8,128
s_waitcnt lgkmcnt(10)
s_add_u32 s50, s73, 0x10000
s_add_u32 m0, s52, 0x23100
TR 4,14,8480
TR 6,14,8992
Mvaa 180,8,132
buffer_load_dwordx4 v10, s[24:27], s50 offen lds
Mvaa 188,12,132
s_waitcnt lgkmcnt(10)
s_add_u32 m0, s52, 0x23520
TR 8,14,8512
TR 10,14,9024
Mvaa 184,12,128
buffer_load_dwordx4 v11, s[24:27], s50 offen lds
Mvaa 192,16,128
s_waitcnt lgkmcnt(10)
s_add_u32 s51, s82, 0x47800
TR 12,14,8544
TR 14,14,9056
Mvaa 196,16,132
buffer_load_dwordx4 a[32:35], v20, s[20:23], s51 offen sc1
Mvaa 204,20,132
s_waitcnt lgkmcnt(10)
TR 16,14,8576
TR 18,14,9088
Mvaa 200,20,128
buffer_load_dwordx4 a[44:47], v20, s[20:23], s51 offen offset:1024 sc1
Mvaa 208,24,128
s_waitcnt lgkmcnt(10)
TR 20,14,8608
TR 22,14,9120
Mvaa 212,24,132
buffer_load_dwordx4 a[36:39], v12, s[20:23], s51 offen sc1
Mvaa 220,28,132
s_waitcnt lgkmcnt(10)
TR 24,14,8640
TR 26,14,9152
Mvaa 216,28,128
buffer_load_dwordx4 a[48:51], v12, s[20:23], s51 offen offset:1024 sc1
Mvaa 160,0,140
s_waitcnt vmcnt(63) lgkmcnt(10)
TR 28,14,8672
TR 30,14,9184
v_add_u32 v226, ((fh_u4-f_start+5120)&0xffffff80), v227
v_min_u32 v226, f_end-f_start, v226
Mvaa 164,0,144
global_load_dword v224, v226, s[98:99]
Mvaa 172,4,144
s_waitcnt lgkmcnt(10)
v_add_u32 v226, ((fl_u4-f_start+5120)&0xffffff80), v227
v_min_u32 v226, f_end-f_start, v226
Mvaa 168,4,140
global_load_dword v224, v226, s[98:99]
Mvaa 176,8,140
Mvaa 180,8,144
s_waitcnt lgkmcnt(8)
Mvaa 188,12,144
v_add_u32 v14, 0x4200, v17
Mvaa 184,12,140
s_waitcnt vmcnt(63) lgkmcnt(0)
s_barrier
Mvaa 192,16,140
TR 0,14,0
TR 2,14,512
Mvaa 196,16,144
TR 4,14,32
TR 6,14,544
Mvaa 204,20,144
TR 8,14,64
TR 10,14,576
Mvaa 200,20,140
TR 12,14,96
TR 14,14,608
Mvaa 208,24,140
TR 16,14,128
TR 18,14,640
Mvaa 212,24,144
TR 20,14,160
TR 22,14,672
Mvaa 220,28,144
TR 24,14,192
TR 26,14,704
Mvaa 216,28,140
s_waitcnt vmcnt(61) lgkmcnt(12)
fl_u5:
Mvaa 160,0,152
s_waitcnt vmcnt(53) lgkmcnt(10)
TR 28,14,224
TR 30,14,736
Mvaa 164,0,156
buffer_store_dwordx4 v[132:135], v12, s[20:23], s44 offen sc1
Mvaa 172,4,156
s_waitcnt lgkmcnt(10)
TR 0,14,8448
TR 2,14,8960
Mvaa 168,4,152
buffer_store_dwordx4 v[140:143], v12, s[20:23], s44 offen offset:1024 sc1
Mvaa 176,8,152
s_waitcnt lgkmcnt(10)
s_add_u32 s50, s73, 0x20000
s_add_u32 m0, s52, 0
TR 4,14,8480
TR 6,14,8992
Mvaa 180,8,156
buffer_load_dwordx4 v10, s[24:27], s50 offen lds
Mvaa 188,12,156
s_waitcnt lgkmcnt(10)
s_add_u32 m0, s52, 0x420
TR 8,14,8512
TR 10,14,9024
Mvaa 184,12,152
buffer_load_dwordx4 v11, s[24:27], s50 offen lds
Mvaa 192,16,152
s_waitcnt lgkmcnt(10)
s_add_u32 s50, s73, 0x30000
s_add_u32 m0, s52, 0x2100
TR 12,14,8544
TR 14,14,9056
Mvaa 196,16,156
buffer_load_dwordx4 v10, s[24:27], s50 offen lds
Mvaa 204,20,156
s_waitcnt lgkmcnt(10)
s_add_u32 m0, s52, 0x2520
TR 16,14,8576
TR 18,14,9088
Mvaa 200,20,152
buffer_load_dwordx4 v11, s[24:27], s50 offen lds
Mvaa 208,24,152
s_waitcnt lgkmcnt(10)
s_add_u32 s51, s79, 0
TR 20,14,8608
TR 22,14,9120
Mvaa 212,24,156
buffer_load_dwordx4 a[128:131], v20, s[20:23], s51 offen sc1
Mvaa 220,28,156
s_waitcnt lgkmcnt(10)
TR 24,14,8640
TR 26,14,9152
Mvaa 216,28,152
buffer_load_dwordx4 a[140:143], v20, s[20:23], s51 offen offset:1024 sc1
Mvaa 160,0,164
s_waitcnt vmcnt(60) lgkmcnt(10)
TR 28,14,8672
TR 30,14,9184
Mvaa 164,0,168
buffer_load_dwordx4 a[132:135], v12, s[20:23], s51 offen sc1
Mvaa 172,4,168
s_waitcnt lgkmcnt(10)
Mvaa 168,4,164
buffer_load_dwordx4 a[144:147], v12, s[20:23], s51 offen offset:1024 sc1
Mvaa 176,8,164
Mvaa 180,8,168
s_waitcnt lgkmcnt(8)
Mvaa 188,12,168
v_add_u32 v14, 0x8400, v17
Mvaa 184,12,164
s_call_b64 s[70:71], f_pad17
s_waitcnt vmcnt(63) lgkmcnt(0)
s_barrier
Mvaa 192,16,164
TR 0,14,0
TR 2,14,512
Mvaa 196,16,168
TR 4,14,32
TR 6,14,544
Mvaa 204,20,168
TR 8,14,64
TR 10,14,576
Mvaa 200,20,164
TR 12,14,96
TR 14,14,608
Mvaa 208,24,164
TR 16,14,128
TR 18,14,640
Mvaa 212,24,168
TR 20,14,160
TR 22,14,672
Mvaa 220,28,168
TR 24,14,192
TR 26,14,704
Mvaa 216,28,164
s_waitcnt vmcnt(61) lgkmcnt(12)
fl_u6:
Mvaa 160,0,176
s_waitcnt vmcnt(59) lgkmcnt(10)
s_add_u32 s50, s74, 0
s_add_u32 m0, s52, 0x4200
TR 28,14,224
TR 30,14,736
Mvaa 164,0,180
buffer_load_dwordx4 v10, s[24:27], s50 offen lds
Mvaa 172,4,180
s_waitcnt lgkmcnt(10)
s_add_u32 m0, s52, 0x4620
TR 0,14,8448
TR 2,14,8960
Mvaa 168,4,176
buffer_load_dwordx4 v11, s[24:27], s50 offen lds
Mvaa 176,8,176
s_waitcnt lgkmcnt(10)
s_add_u32 s50, s74, 0x10000
s_add_u32 m0, s52, 0x6300
TR 4,14,8480
TR 6,14,8992
Mvaa 180,8,180
buffer_load_dwordx4 v10, s[24:27], s50 offen lds
Mvaa 188,12,180
s_waitcnt lgkmcnt(10)
s_add_u32 m0, s52, 0x6720
TR 8,14,8512
TR 10,14,9024
Mvaa 184,12,176
buffer_load_dwordx4 v11, s[24:27], s50 offen lds
Mvaa 192,16,176
s_waitcnt lgkmcnt(10)
s_add_u32 s51, s79, 0x5800
TR 12,14,8544
TR 14,14,9056
Mvaa 196,16,180
buffer_load_dwordx4 a[152:155], v20, s[20:23], s51 offen sc1
Mvaa 204,20,180
s_waitcnt lgkmcnt(10)
TR 16,14,8576
TR 18,14,9088
Mvaa 200,20,176
buffer_load_dwordx4 a[164:167], v20, s[20:23], s51 offen offset:1024 sc1
Mvaa 208,24,176
s_waitcnt lgkmcnt(10)
TR 20,14,8608
TR 22,14,9120
Mvaa 212,24,180
buffer_load_dwordx4 a[156:159], v12, s[20:23], s51 offen sc1
Mvaa 220,28,180
s_waitcnt lgkmcnt(10)
TR 24,14,8640
TR 26,14,9152
Mvaa 216,28,176
buffer_load_dwordx4 a[168:171], v12, s[20:23], s51 offen offset:1024 sc1
Mvaa 160,0,188
s_waitcnt vmcnt(63)
TR 28,14,8672
TR 30,14,9184
Mvaa 164,0,192
s_waitcnt lgkmcnt(12)
Mvaa 172,4,192
Mvaa 168,4,188
s_waitcnt lgkmcnt(10)
Mvaa 176,8,188
Mvaa 180,8,192
s_waitcnt lgkmcnt(8)
Mvaa 188,12,192
v_add_u32 v14, 0xc600, v17
Mvaa 184,12,188
s_waitcnt vmcnt(63) lgkmcnt(0)
s_barrier
Mvaa 192,16,188
TR 0,14,0
TR 2,14,512
Mvaa 196,16,192
TR 4,14,32
TR 6,14,544
Mvaa 204,20,192
TR 8,14,64
TR 10,14,576
Mvaa 200,20,188
TR 12,14,96
TR 14,14,608
Mvaa 208,24,188
TR 16,14,128
TR 18,14,640
Mvaa 212,24,192
TR 20,14,160
TR 22,14,672
Mvaa 220,28,192
TR 24,14,192
TR 26,14,704
Mvaa 216,28,188
s_waitcnt vmcnt(59) lgkmcnt(12)
fl_u7:
Mvaa 160,0,200
s_waitcnt vmcnt(57) lgkmcnt(10)
s_add_u32 s50, s74, 0x20000
s_add_u32 m0, s52, 0x8400
TR 28,14,224
TR 30,14,736
Mvaa 164,0,204
buffer_load_dwordx4 v10, s[24:27], s50 offen lds
Mvaa 172,4,204
s_waitcnt lgkmcnt(10)
s_add_u32 m0, s52, 0x8820
TR 0,14,8448
TR 2,14,8960
Mvaa 168,4,200
buffer_load_dwordx4 v11, s[24:27], s50 offen lds
Mvaa 176,8,200
s_waitcnt lgkmcnt(10)
s_add_u32 s50, s74, 0x30000
s_add_u32 m0, s52, 0xa500
TR 4,14,8480
TR 6,14,8992
Mvaa 180,8,204
buffer_load_dwordx4 v10, s[24:27], s50 offen lds
Mvaa 188,12,204
s_waitcnt lgkmcnt(10)
s_add_u32 m0, s52, 0xa920
TR 8,14,8512
TR 10,14,9024
Mvaa 184,12,200
buffer_load_dwordx4 v11, s[24:27], s50 offen lds
Mvaa 192,16,200
s_waitcnt lgkmcnt(10)
s_add_u32 s51, s80, 0
TR 12,14,8544
TR 14,14,9056
Mvaa 196,16,204
buffer_load_dwordx4 a[176:179], v20, s[20:23], s51 offen sc1
Mvaa 204,20,204
s_waitcnt lgkmcnt(10)
TR 16,14,8576
TR 18,14,9088
Mvaa 200,20,200
buffer_load_dwordx4 a[188:191], v20, s[20:23], s51 offen offset:1024 sc1
Mvaa 208,24,200
s_waitcnt lgkmcnt(10)
TR 20,14,8608
TR 22,14,9120
Mvaa 212,24,204
buffer_load_dwordx4 a[180:183], v12, s[20:23], s51 offen sc1
Mvaa 220,28,204
s_waitcnt lgkmcnt(10)
TR 24,14,8640
TR 26,14,9152
Mvaa 216,28,200
buffer_load_dwordx4 a[192:195], v12, s[20:23], s51 offen offset:1024 sc1
Mvaa 160,0,212
s_waitcnt vmcnt(63)
TR 28,14,8672
TR 30,14,9184
Mvaa 164,0,216
s_waitcnt lgkmcnt(12)
Mvaa 172,4,216
Mvaa 168,4,212
s_waitcnt lgkmcnt(10)
Mvaa 176,8,212
Mvaa 180,8,216
s_waitcnt lgkmcnt(8)
Mvaa 188,12,216
v_add_u32 v14, 0x10800, v17
Mvaa 184,12,212
s_waitcnt vmcnt(63) lgkmcnt(0)
s_barrier
Mvaa 192,16,212
TR 0,14,0
TR 2,14,512
Mvaa 196,16,216
TR 4,14,32
TR 6,14,544
Mvaa 204,20,216
TR 8,14,64
TR 10,14,576
Mvaa 200,20,212
TR 12,14,96
TR 14,14,608
Mvaa 208,24,212
TR 16,14,128
TR 18,14,640
Mvaa 212,24,216
TR 20,14,160
TR 22,14,672
Mvaa 220,28,216
TR 24,14,192
TR 26,14,704
Mvaa 216,28,212
s_waitcnt vmcnt(57) lgkmcnt(12)
fl_u8:
Mvaa 160,0,224
s_waitcnt vmcnt(55) lgkmcnt(10)
s_add_u32 s50, s75, 0
s_add_u32 m0, s52, 0xc600
TR 28,14,224
TR 30,14,736
Mvaa 164,0,228
buffer_load_dwordx4 v10, s[24:27], s50 offen lds
Mvaa 172,4,228
s_waitcnt lgkmcnt(10)
s_add_u32 m0, s52, 0xca20
TR 0,14,8448
TR 2,14,8960
Mvaa 168,4,224
buffer_load_dwordx4 v11, s[24:27], s50 offen lds
Mvaa 176,8,224
s_waitcnt lgkmcnt(10)
s_add_u32 s50, s75, 0x10000
s_add_u32 m0, s52, 0xe700
TR 4,14,8480
TR 6,14,8992
Mvaa 180,8,228
buffer_load_dwordx4 v10, s[24:27], s50 offen lds
Mvaa 188,12,228
s_waitcnt lgkmcnt(10)
s_add_u32 m0, s52, 0xeb20
TR 8,14,8512
TR 10,14,9024
Mvaa 184,12,224
buffer_load_dwordx4 v11, s[24:27], s50 offen lds
Mvaa 192,16,224
s_waitcnt lgkmcnt(10)
s_add_u32 s51, s80, 0x5800
TR 12,14,8544
TR 14,14,9056
Mvaa 196,16,228
buffer_load_dwordx4 a[200:203], v20, s[20:23], s51 offen sc1
Mvaa 204,20,228
s_waitcnt lgkmcnt(10)
TR 16,14,8576
TR 18,14,9088
Mvaa 200,20,224
buffer_load_dwordx4 a[212:215], v20, s[20:23], s51 offen offset:1024 sc1
Mvaa 208,24,224
s_waitcnt lgkmcnt(10)
TR 20,14,8608
TR 22,14,9120
Mvaa 212,24,228
buffer_load_dwordx4 a[204:207], v12, s[20:23], s51 offen sc1
Mvaa 220,28,228
s_waitcnt lgkmcnt(10)
TR 24,14,8640
TR 26,14,9152
Mvaa 216,28,224
buffer_load_dwordx4 a[216:219], v12, s[20:23], s51 offen offset:1024 sc1
Mvaa 160,0,236
s_waitcnt vmcnt(62)
TR 28,14,8672
TR 30,14,9184
Mvaa 164,0,240
s_waitcnt lgkmcnt(12)
Mvaa 172,4,240
Mvaa 168,4,236
s_waitcnt lgkmcnt(10)
Mvaa 176,8,236
Mvaa 180,8,240
s_waitcnt lgkmcnt(8)
Mvaa 188,12,240
v_add_u32 v14, 0x14a00, v17
Mvaa 184,12,236
s_waitcnt vmcnt(32) lgkmcnt(0)
s_barrier
buffer_atomic_add v29, v28, s[20:23], s32 offen offset:128 sc1
Mvaa 192,16,236
TR 0,14,0
TR 2,14,512
Mvaa 196,16,240
TR 4,14,32
TR 6,14,544
Mvaa 204,20,240
TR 8,14,64
TR 10,14,576
Mvaa 200,20,236
TR 12,14,96
TR 14,14,608
Mvaa 208,24,236
TR 16,14,128
TR 18,14,640
Mvaa 212,24,240
TR 20,14,160
TR 22,14,672
Mvaa 220,28,240
TR 24,14,192
TR 26,14,704
Mvaa 216,28,236
s_waitcnt lgkmcnt(12)
fl_u9:
Mvaa 160,0,80
s_waitcnt lgkmcnt(10)
s_add_u32 s50, s75, 0x20000
s_add_u32 m0, s52, 0x10800
TR 28,14,224
TR 30,14,736
Mvaa 164,0,84
buffer_load_dwordx4 v10, s[24:27], s50 offen lds
Mvaa 172,4,84
s_waitcnt lgkmcnt(10)
s_add_u32 m0, s52, 0x10c20
TR 0,14,8448
TR 2,14,8960
Mvaa 168,4,80
buffer_load_dwordx4 v11, s[24:27], s50 offen lds
Mvaa 176,8,80
s_waitcnt lgkmcnt(10)
s_add_u32 s50, s75, 0x30000
s_add_u32 m0, s52, 0x12900
TR 4,14,8480
TR 6,14,8992
Mvaa 180,8,84
buffer_load_dwordx4 v10, s[24:27], s50 offen lds
Mvaa 188,12,84
s_waitcnt lgkmcnt(10)
s_add_u32 m0, s52, 0x12d20
TR 8,14,8512
TR 10,14,9024
Mvaa 184,12,80
buffer_load_dwordx4 v11, s[24:27], s50 offen lds
Mvaa 192,16,80
s_waitcnt lgkmcnt(10)
s_add_u32 s51, s81, 0
TR 12,14,8544
TR 14,14,9056
Mvaa 196,16,84
buffer_load_dwordx4 a[224:227], v20, s[20:23], s51 offen sc1
Mvaa 204,20,84
s_waitcnt lgkmcnt(10)
TR 16,14,8576
TR 18,14,9088
Mvaa 200,20,80
buffer_load_dwordx4 a[236:239], v20, s[20:23], s51 offen offset:1024 sc1
Mvaa 208,24,80
s_waitcnt lgkmcnt(10)
TR 20,14,8608
TR 22,14,9120
Mvaa 212,24,84
buffer_load_dwordx4 a[228:231], v12, s[20:23], s51 offen sc1
Mvaa 220,28,84
s_waitcnt lgkmcnt(10)
TR 24,14,8640
TR 26,14,9152
Mvaa 216,28,80
buffer_load_dwordx4 a[240:243], v12, s[20:23], s51 offen offset:1024 sc1
Mvaa 160,0,92
TR 28,14,8672
TR 30,14,9184
Mvaa 164,0,96
s_waitcnt lgkmcnt(12)
Mvaa 172,4,96
Mvaa 168,4,92
s_waitcnt lgkmcnt(10)
Mvaa 176,8,92
Mvaa 180,8,96
s_waitcnt lgkmcnt(8)
Mvaa 188,12,96
v_add_u32 v14, 0x18c00, v17
Mvaa 184,12,92
s_waitcnt vmcnt(63) lgkmcnt(0)
s_barrier
Mvaa 192,16,92
TR 0,14,0
TR 2,14,512
Mvaa 196,16,96
TR 4,14,32
TR 6,14,544
Mvaa 204,20,96
TR 8,14,64
TR 10,14,576
Mvaa 200,20,92
TR 12,14,96
TR 14,14,608
Mvaa 208,24,92
TR 16,14,128
TR 18,14,640
Mvaa 212,24,96
TR 20,14,160
TR 22,14,672
Mvaa 220,28,96
TR 24,14,192
TR 26,14,704
Mvaa 216,28,92
s_waitcnt lgkmcnt(12)
fl_u10:
Mvaa 160,0,104
s_waitcnt lgkmcnt(10)
s_add_u32 s50, s76, 0x40000
s_add_u32 m0, s52, 0x14a00
TR 28,14,224
TR 30,14,736
Mvaa 164,0,108
buffer_load_dwordx4 v10, s[24:27], s50 offen lds
Mvaa 172,4,108
s_waitcnt lgkmcnt(10)
s_add_u32 m0, s52, 0x14e20
TR 0,14,8448
TR 2,14,8960
Mvaa 168,4,104
buffer_load_dwordx4 v11, s[24:27], s50 offen lds
Mvaa 176,8,104
s_waitcnt lgkmcnt(10)
s_add_u32 s50, s76, 0x50000
s_add_u32 m0, s52, 0x16b00
TR 4,14,8480
TR 6,14,8992
Mvaa 180,8,108
buffer_load_dwordx4 v10, s[24:27], s50 offen lds
Mvaa 188,12,108
s_waitcnt lgkmcnt(10)
s_add_u32 m0, s52, 0x16f20
TR 8,14,8512
TR 10,14,9024
Mvaa 184,12,104
buffer_load_dwordx4 v11, s[24:27], s50 offen lds
Mvaa 192,16,104
s_waitcnt lgkmcnt(10)
s_add_u32 s51, s81, 0x5800
TR 12,14,8544
TR 14,14,9056
Mvaa 196,16,108
buffer_load_dwordx4 a[80:83], v20, s[20:23], s51 offen sc1
Mvaa 204,20,108
s_waitcnt lgkmcnt(10)
TR 16,14,8576
TR 18,14,9088
Mvaa 200,20,104
buffer_load_dwordx4 a[92:95], v20, s[20:23], s51 offen offset:1024 sc1
Mvaa 208,24,104
s_waitcnt lgkmcnt(10)
TR 20,14,8608
TR 22,14,9120
Mvaa 212,24,108
buffer_load_dwordx4 a[84:87], v12, s[20:23], s51 offen sc1
Mvaa 220,28,108
s_waitcnt lgkmcnt(10)
TR 24,14,8640
TR 26,14,9152
Mvaa 216,28,104
buffer_load_dwordx4 a[96:99], v12, s[20:23], s51 offen offset:1024 sc1
Mvaa 160,0,116
TR 28,14,8672
TR 30,14,9184
Mvaa 164,0,120
s_waitcnt lgkmcnt(12)
Mvaa 172,4,120
Mvaa 168,4,116
s_waitcnt lgkmcnt(10)
Mvaa 176,8,116
Mvaa 180,8,120
s_waitcnt lgkmcnt(8)
Mvaa 188,12,120
v_add_u32 v14, 0x1ce00, v17
Mvaa 184,12,116
s_call_b64 s[70:71], f_pad18
s_waitcnt vmcnt(63) lgkmcnt(0)
s_barrier
Mvaa 192,16,116
TR 0,14,0
TR 2,14,512
Mvaa 196,16,120
TR 4,14,32
TR 6,14,544
Mvaa 204,20,120
TR 8,14,64
TR 10,14,576
Mvaa 200,20,116
TR 12,14,96
TR 14,14,608
Mvaa 208,24,116
TR 16,14,128
TR 18,14,640
Mvaa 212,24,120
TR 20,14,160
TR 22,14,672
Mvaa 220,28,120
TR 24,14,192
TR 26,14,704
Mvaa 216,28,116
s_waitcnt lgkmcnt(12)
fl_u11:
Mvaa 160,0,32
s_waitcnt lgkmcnt(10)
s_add_u32 s50, s76, 0x60000
s_add_u32 m0, s52, 0x18c00
TR 28,14,224
TR 30,14,736
Mvaa 164,0,36
buffer_load_dwordx4 v10, s[24:27], s50 offen lds
Mvaa 172,4,36
s_waitcnt lgkmcnt(10)
s_add_u32 m0, s52, 0x19020
TR 0,14,8448
TR 2,14,8960
Mvaa 168,4,32
buffer_load_dwordx4 v11, s[24:27], s50 offen lds
Mvaa 176,8,32
s_waitcnt lgkmcnt(10)
s_add_u32 s50, s76, 0x70000
s_add_u32 m0, s52, 0x1ad00
TR 4,14,8480
TR 6,14,8992
Mvaa 180,8,36
buffer_load_dwordx4 v10, s[24:27], s50 offen lds
Mvaa 188,12,36
s_waitcnt lgkmcnt(10)
s_add_u32 m0, s52, 0x1b120
TR 8,14,8512
TR 10,14,9024
Mvaa 184,12,32
buffer_load_dwordx4 v11, s[24:27], s50 offen lds
Mvaa 192,16,32
TR 12,14,8544
TR 14,14,9056
Mvaa 196,16,36
s_waitcnt lgkmcnt(12)
Mvaa 204,20,36
TR 16,14,8576
TR 18,14,9088
Mvaa 200,20,32
s_waitcnt lgkmcnt(12)
Mvaa 208,24,32
TR 20,14,8608
TR 22,14,9120
Mvaa 212,24,36
s_waitcnt lgkmcnt(12)
Mvaa 220,28,36
TR 24,14,8640
TR 26,14,9152
Mvaa 216,28,32
s_waitcnt lgkmcnt(12)
Mvaa 160,0,44
TR 28,14,8672
TR 30,14,9184
Mvaa 164,0,48
s_waitcnt lgkmcnt(12)
Mvaa 172,4,48
Mvaa 168,4,44
s_waitcnt lgkmcnt(10)
Mvaa 176,8,44
Mvaa 180,8,48
s_waitcnt lgkmcnt(8)
Mvaa 188,12,48
v_add_u32 v14, 0x21000, v17
Mvaa 184,12,44
s_waitcnt vmcnt(61) lgkmcnt(0)
s_barrier
Mvaa 192,16,44
TR 0,14,0
TR 2,14,512
Mvaa 196,16,48
TR 4,14,32
TR 6,14,544
Mvaa 204,20,48
TR 8,14,64
TR 10,14,576
Mvaa 200,20,44
TR 12,14,96
TR 14,14,608
Mvaa 208,24,44
TR 16,14,128
TR 18,14,640
Mvaa 212,24,48
TR 20,14,160
TR 22,14,672
Mvaa 220,28,48
TR 24,14,192
TR 26,14,704
Mvaa 216,28,44
s_waitcnt vmcnt(48) lgkmcnt(12)
fl_u12:
Mvaa 160,0,128
s_waitcnt vmcnt(46) lgkmcnt(10)
s_add_u32 s50, s76, 0xc0000
s_add_u32 m0, s52, 0x1ce00
TR 28,14,224
TR 30,14,736
Mvaa 164,0,132
buffer_load_dwordx4 v10, s[24:27], s50 offen lds
Mvaa 172,4,132
s_waitcnt lgkmcnt(10)
s_add_u32 m0, s52, 0x1d220
TR 0,14,8448
TR 2,14,8960
Mvaa 168,4,128
buffer_load_dwordx4 v11, s[24:27], s50 offen lds
Mvaa 176,8,128
s_waitcnt lgkmcnt(10)
s_add_u32 s50, s76, 0xd0000
s_add_u32 m0, s52, 0x1ef00
TR 4,14,8480
TR 6,14,8992
Mvaa 180,8,132
buffer_load_dwordx4 v10, s[24:27], s50 offen lds
Mvaa 188,12,132
s_waitcnt lgkmcnt(10)
s_add_u32 m0, s52, 0x1f320
TR 8,14,8512
TR 10,14,9024
Mvaa 184,12,128
buffer_load_dwordx4 v11, s[24:27], s50 offen lds
Mvaa 192,16,128
s_waitcnt lgkmcnt(10)
TR 12,14,8544
TR 14,14,9056
v_add_u32 v226, ((fh_u12-f_start+5120)&0xffffff80), v227
v_min_u32 v226, f_end-f_start, v226
Mvaa 196,16,132
global_load_dword v224, v226, s[98:99]
Mvaa 204,20,132
s_waitcnt lgkmcnt(10)
TR 16,14,8576
TR 18,14,9088
v_add_u32 v226, ((fl_u12-f_start+5120)&0xffffff80), v227
v_min_u32 v226, f_end-f_start, v226
Mvaa 200,20,128
global_load_dword v224, v226, s[98:99]
Mvaa 208,24,128
TR 20,14,8608
TR 22,14,9120
Mvaa 212,24,132
s_waitcnt lgkmcnt(12)
Mvaa 220,28,132
TR 24,14,8640
TR 26,14,9152
Mvaa 216,28,128
s_waitcnt lgkmcnt(12)
Mvaa 160,0,140
s_waitcnt vmcnt(51)
TR 28,14,8672
TR 30,14,9184
Mvaa 164,0,144
s_waitcnt lgkmcnt(12)
Mvaa 172,4,144
Mvaa 168,4,140
s_waitcnt lgkmcnt(10)
Mvaa 176,8,140
Mvaa 180,8,144
s_waitcnt lgkmcnt(8)
Mvaa 188,12,144
v_add_u32 v14, 0, v17
Mvaa 184,12,140
s_waitcnt vmcnt(55) lgkmcnt(0)
s_barrier
buffer_load_dword v30, v28, s[20:23], s32 offen offset:128 sc1
Mvaa 192,16,140
TR 0,14,0
TR 2,14,512
Mvaa 196,16,144
TR 4,14,32
TR 6,14,544
Mvaa 204,20,144
TR 8,14,64
TR 10,14,576
Mvaa 200,20,140
TR 12,14,96
TR 14,14,608
Mvaa 208,24,140
TR 16,14,128
TR 18,14,640
Mvaa 212,24,144
TR 20,14,160
TR 22,14,672
Mvaa 220,28,144
TR 24,14,192
TR 26,14,704
Mvaa 216,28,140
s_waitcnt vmcnt(47) lgkmcnt(12)
fl_u13:
Mvaa 160,0,152
s_waitcnt vmcnt(45) lgkmcnt(10)
s_add_u32 s50, s76, 0xe0000
s_add_u32 m0, s52, 0x21000
TR 28,14,224
TR 30,14,736
Mvaa 164,0,156
buffer_load_dwordx4 v10, s[24:27], s50 offen lds
Mvaa 172,4,156
s_waitcnt lgkmcnt(10)
s_add_u32 m0, s52, 0x21420
TR 0,14,8448
TR 2,14,8960
Mvaa 168,4,152
buffer_load_dwordx4 v11, s[24:27], s50 offen lds
Mvaa 176,8,152
s_waitcnt lgkmcnt(10)
s_add_u32 s50, s76, 0xf0000
s_add_u32 m0, s52, 0x23100
TR 4,14,8480
TR 6,14,8992
Mvaa 180,8,156
buffer_load_dwordx4 v10, s[24:27], s50 offen lds
Mvaa 188,12,156
s_waitcnt lgkmcnt(10)
s_add_u32 m0, s52, 0x23520
TR 8,14,8512
TR 10,14,9024
Mvaa 184,12,152
buffer_load_dwordx4 v11, s[24:27], s50 offen lds
Mvaa 192,16,152
TR 12,14,8544
TR 14,14,9056
Mvaa 196,16,156
s_waitcnt lgkmcnt(12)
Mvaa 204,20,156
TR 16,14,8576
TR 18,14,9088
Mvaa 200,20,152
s_waitcnt lgkmcnt(12)
Mvaa 208,24,152
TR 20,14,8608
TR 22,14,9120
Mvaa 212,24,156
s_waitcnt lgkmcnt(12)
Mvaa 220,28,156
TR 24,14,8640
TR 26,14,9152
Mvaa 216,28,152
s_waitcnt lgkmcnt(12)
Mvaa 160,0,164
s_waitcnt vmcnt(48)
TR 28,14,8672
TR 30,14,9184
Mvaa 164,0,168
s_waitcnt lgkmcnt(12)
Mvaa 172,4,168
Mvaa 168,4,164
s_waitcnt lgkmcnt(10)
Mvaa 176,8,164
Mvaa 180,8,168
s_waitcnt lgkmcnt(8)
Mvaa 188,12,168
s_waitcnt vmcnt(4)
v_add_u32 v14, 0x4200, v17
Mvaa 184,12,164
v_readfirstlane_b32 s41, v30
s_nop 0
s_cmp_lt_u32 s41, 16
s_cbranch_scc1 fl_p1_spin
fl_p1_ok:
s_waitcnt vmcnt(52) lgkmcnt(0)
s_barrier
Mvaa 192,16,164
TR 0,14,0
TR 2,14,512
Mvaa 196,16,168
TR 4,14,32
TR 6,14,544
Mvaa 204,20,168
TR 8,14,64
TR 10,14,576
Mvaa 200,20,164
TR 12,14,96
TR 14,14,608
Mvaa 208,24,164
TR 16,14,128
TR 18,14,640
Mvaa 212,24,168
TR 20,14,160
TR 22,14,672
Mvaa 220,28,168
TR 24,14,192
TR 26,14,704
Mvaa 216,28,164
s_waitcnt lgkmcnt(12)
fl_u14:
Mvaa 160,0,176
s_waitcnt lgkmcnt(10)
s_add_u32 s50, s76, 0x140000
s_add_u32 m0, s52, 0
TR 28,14,224
TR 30,14,736
Mvaa 164,0,180
buffer_load_dwordx4 v10, s[24:27], s50 offen lds
Mvaa 172,4,180
s_waitcnt lgkmcnt(10)
s_add_u32 m0, s52, 0x420
TR 0,14,8448
TR 2,14,8960
Mvaa 168,4,176
buffer_load_dwordx4 v11, s[24:27], s50 offen lds
Mvaa 176,8,176
s_waitcnt lgkmcnt(10)
s_add_u32 s50, s76, 0x150000
s_add_u32 m0, s52, 0x2100
TR 4,14,8480
TR 6,14,8992
Mvaa 180,8,180
buffer_load_dwordx4 v10, s[24:27], s50 offen lds
Mvaa 188,12,180
s_waitcnt lgkmcnt(10)
s_add_u32 m0, s52, 0x2520
TR 8,14,8512
TR 10,14,9024
Mvaa 184,12,176
buffer_load_dwordx4 v11, s[24:27], s50 offen lds
Mvaa 192,16,176
s_waitcnt lgkmcnt(10)
s_add_u32 s51, s82, 0xb000
TR 12,14,8544
TR 14,14,9056
Mvaa 196,16,180
buffer_load_dwordx4 a[104:107], v20, s[20:23], s51 offen sc1
Mvaa 204,20,180
s_waitcnt lgkmcnt(10)
TR 16,14,8576
TR 18,14,9088
Mvaa 200,20,176
buffer_load_dwordx4 a[116:119], v20, s[20:23], s51 offen offset:1024 sc1
Mvaa 208,24,176
s_waitcnt lgkmcnt(10)
TR 20,14,8608
TR 22,14,9120
Mvaa 212,24,180
buffer_load_dwordx4 a[108:111], v12, s[20:23], s51 offen sc1
Mvaa 220,28,180
s_waitcnt lgkmcnt(10)
TR 24,14,8640
TR 26,14,9152
Mvaa 216,28,176
buffer_load_dwordx4 a[120:123], v12, s[20:23], s51 offen offset:1024 sc1
Mvaa 160,0,188
TR 28,14,8672
TR 30,14,9184
Mvaa 164,0,192
s_waitcnt lgkmcnt(12)
Mvaa 172,4,192
Mvaa 168,4,188
s_waitcnt lgkmcnt(10)
Mvaa 176,8,188
Mvaa 180,8,192
s_waitcnt lgkmcnt(8)
Mvaa 188,12,192
v_add_u32 v14, 0x8400, v17
Mvaa 184,12,188
s_waitcnt vmcnt(52) lgkmcnt(0)
s_barrier
Mvaa 192,16,188
TR 0,14,0
TR 2,14,512
Mvaa 196,16,192
TR 4,14,32
TR 6,14,544
Mvaa 204,20,192
TR 8,14,64
TR 10,14,576
Mvaa 200,20,188
TR 12,14,96
TR 14,14,608
Mvaa 208,24,188
TR 16,14,128
TR 18,14,640
Mvaa 212,24,192
TR 20,14,160
TR 22,14,672
Mvaa 220,28,192
TR 24,14,192
TR 26,14,704
Mvaa 216,28,188
s_waitcnt lgkmcnt(12)
fl_u15:
Mvaa 160,0,200
s_waitcnt lgkmcnt(10)
s_add_u32 s50, s76, 0x160000
s_add_u32 m0, s52, 0x4200
TR 28,14,224
TR 30,14,736
Mvaa 164,0,204
buffer_load_dwordx4 v10, s[24:27], s50 offen lds
Mvaa 172,4,204
s_waitcnt lgkmcnt(10)
s_add_u32 m0, s52, 0x4620
TR 0,14,8448
TR 2,14,8960
Mvaa 168,4,200
buffer_load_dwordx4 v11, s[24:27], s50 offen lds
Mvaa 176,8,200
s_waitcnt lgkmcnt(10)
s_add_u32 s50, s76, 0x170000
s_add_u32 m0, s52, 0x6300
TR 4,14,8480
TR 6,14,8992
Mvaa 180,8,204
buffer_load_dwordx4 v10, s[24:27], s50 offen lds
Mvaa 188,12,204
s_waitcnt lgkmcnt(10)
s_add_u32 m0, s52, 0x6720
TR 8,14,8512
TR 10,14,9024
Mvaa 184,12,200
buffer_load_dwordx4 v11, s[24:27], s50 offen lds
Mvaa 192,16,200
s_waitcnt lgkmcnt(10)
s_add_u32 s51, s82, 0x10800
TR 12,14,8544
TR 14,14,9056
Mvaa 196,16,204
buffer_load_dwordx4 a[32:35], v20, s[20:23], s51 offen sc1
Mvaa 204,20,204
s_waitcnt lgkmcnt(10)
TR 16,14,8576
TR 18,14,9088
Mvaa 200,20,200
buffer_load_dwordx4 a[44:47], v20, s[20:23], s51 offen offset:1024 sc1
Mvaa 208,24,200
s_waitcnt lgkmcnt(10)
TR 20,14,8608
TR 22,14,9120
Mvaa 212,24,204
buffer_load_dwordx4 a[36:39], v12, s[20:23], s51 offen sc1
Mvaa 220,28,204
s_waitcnt lgkmcnt(10)
TR 24,14,8640
TR 26,14,9152
Mvaa 216,28,200
buffer_load_dwordx4 a[48:51], v12, s[20:23], s51 offen offset:1024 sc1
Mvaa 160,0,212
TR 28,14,8672
TR 30,14,9184
Mvaa 164,0,216
s_waitcnt lgkmcnt(12)
Mvaa 172,4,216
Mvaa 168,4,212
s_waitcnt lgkmcnt(10)
Mvaa 176,8,212
Mvaa 180,8,216
s_waitcnt lgkmcnt(8)
Mvaa 188,12,216
v_add_u32 v14, 0xc600, v17
Mvaa 184,12,212
s_call_b64 s[70:71], f_pad19
s_waitcnt vmcnt(52) lgkmcnt(0)
s_barrier
Mvaa 192,16,212
TR 0,14,0
TR 2,14,512
Mvaa 196,16,216
TR 4,14,32
TR 6,14,544
Mvaa 204,20,216
TR 8,14,64
TR 10,14,576
Mvaa 200,20,212
TR 12,14,96
TR 14,14,608
Mvaa 208,24,212
TR 16,14,128
TR 18,14,640
Mvaa 212,24,216
TR 20,14,160
TR 22,14,672
Mvaa 220,28,216
TR 24,14,192
TR 26,14,704
Mvaa 216,28,212
s_waitcnt lgkmcnt(12)
fl_u16:
Mvaa 160,0,224
s_waitcnt lgkmcnt(10)
s_add_u32 s50, s76, 0x1c0000
s_add_u32 m0, s52, 0x8400
TR 28,14,224
TR 30,14,736
Mvaa 164,0,228
buffer_load_dwordx4 v10, s[24:27], s50 offen lds
Mvaa 172,4,228
s_waitcnt lgkmcnt(10)
s_add_u32 m0, s52, 0x8820
TR 0,14,8448
TR 2,14,8960
Mvaa 168,4,224
buffer_load_dwordx4 v11, s[24:27], s50 offen lds
Mvaa 176,8,224
s_waitcnt lgkmcnt(10)
s_add_u32 s50, s76, 0x1d0000
s_add_u32 m0, s52, 0xa500
TR 4,14,8480
TR 6,14,8992
Mvaa 180,8,228
buffer_load_dwordx4 v10, s[24:27], s50 offen lds
Mvaa 188,12,228
s_waitcnt lgkmcnt(10)
s_add_u32 m0, s52, 0xa920
TR 8,14,8512
TR 10,14,9024
Mvaa 184,12,224
buffer_load_dwordx4 v11, s[24:27], s50 offen lds
Mvaa 192,16,224
s_waitcnt lgkmcnt(10)
s_add_u32 s51, s82, 0x21000
TR 12,14,8544
TR 14,14,9056
Mvaa 196,16,228
buffer_load_dwordx4 a[128:131], v20, s[20:23], s51 offen sc1
Mvaa 204,20,228
s_waitcnt lgkmcnt(10)
TR 16,14,8576
TR 18,14,9088
Mvaa 200,20,224
buffer_load_dwordx4 a[140:143], v20, s[20:23], s51 offen offset:1024 sc1
Mvaa 208,24,224
s_waitcnt lgkmcnt(10)
TR 20,14,8608
TR 22,14,9120
Mvaa 212,24,228
buffer_load_dwordx4 a[132:135], v12, s[20:23], s51 offen sc1
Mvaa 220,28,228
s_waitcnt lgkmcnt(10)
TR 24,14,8640
TR 26,14,9152
Mvaa 216,28,224
buffer_load_dwordx4 a[144:147], v12, s[20:23], s51 offen offset:1024 sc1
Mvaa 160,0,236
TR 28,14,8672
TR 30,14,9184
Mvaa 164,0,240
s_waitcnt lgkmcnt(12)
Mvaa 172,4,240
Mvaa 168,4,236
s_waitcnt lgkmcnt(10)
Mvaa 176,8,236
Mvaa 180,8,240
s_waitcnt lgkmcnt(8)
Mvaa 188,12,240
v_add_u32 v14, 0x10800, v17
Mvaa 184,12,236
s_waitcnt vmcnt(51) lgkmcnt(0)
s_barrier
Mvaa 192,16,236
TR 0,14,0
TR 2,14,512
Mvaa 196,16,240
TR 4,14,32
TR 6,14,544
Mvaa 204,20,240
TR 8,14,64
TR 10,14,576
Mvaa 200,20,236
TR 12,14,96
TR 14,14,608
Mvaa 208,24,236
TR 16,14,128
TR 18,14,640
Mvaa 212,24,240
TR 20,14,160
TR 22,14,672
Mvaa 220,28,240
TR 24,14,192
TR 26,14,704
Mvaa 216,28,236
s_waitcnt lgkmcnt(12)
fl_u17:
Mvaa 160,0,80
s_waitcnt lgkmcnt(10)
s_add_u32 s50, s76, 0x1e0000
s_add_u32 m0, s52, 0xc600
TR 28,14,224
TR 30,14,736
Mvaa 164,0,84
buffer_load_dwordx4 v10, s[24:27], s50 offen lds
Mvaa 172,4,84
s_waitcnt lgkmcnt(10)
s_add_u32 m0, s52, 0xca20
TR 0,14,8448
TR 2,14,8960
Mvaa 168,4,80
buffer_load_dwordx4 v11, s[24:27], s50 offen lds
Mvaa 176,8,80
s_waitcnt lgkmcnt(10)
s_add_u32 s50, s76, 0x1f0000
s_add_u32 m0, s52, 0xe700
TR 4,14,8480
TR 6,14,8992
Mvaa 180,8,84
buffer_load_dwordx4 v10, s[24:27], s50 offen lds
Mvaa 188,12,84
s_waitcnt lgkmcnt(10)
s_add_u32 m0, s52, 0xeb20
TR 8,14,8512
TR 10,14,9024
Mvaa 184,12,80
buffer_load_dwordx4 v11, s[24:27], s50 offen lds
Mvaa 192,16,80
s_waitcnt lgkmcnt(10)
s_add_u32 s51, s82, 0x26800
TR 12,14,8544
TR 14,14,9056
Mvaa 196,16,84
buffer_load_dwordx4 a[152:155], v20, s[20:23], s51 offen sc1
Mvaa 204,20,84
s_waitcnt lgkmcnt(10)
TR 16,14,8576
TR 18,14,9088
Mvaa 200,20,80
buffer_load_dwordx4 a[164:167], v20, s[20:23], s51 offen offset:1024 sc1
Mvaa 208,24,80
s_waitcnt lgkmcnt(10)
TR 20,14,8608
TR 22,14,9120
Mvaa 212,24,84
buffer_load_dwordx4 a[156:159], v12, s[20:23], s51 offen sc1
Mvaa 220,28,84
s_waitcnt lgkmcnt(10)
TR 24,14,8640
TR 26,14,9152
Mvaa 216,28,80
buffer_load_dwordx4 a[168:171], v12, s[20:23], s51 offen offset:1024 sc1
Mvaa 160,0,92
TR 28,14,8672
TR 30,14,9184
Mvaa 164,0,96
s_waitcnt lgkmcnt(12)
Mvaa 172,4,96
Mvaa 168,4,92
s_waitcnt lgkmcnt(10)
Mvaa 176,8,92
Mvaa 180,8,96
s_waitcnt lgkmcnt(8)
Mvaa 188,12,96
v_add_u32 v14, 0x14a00, v17
Mvaa 184,12,92
s_waitcnt vmcnt(51) lgkmcnt(0)
s_barrier
Mvaa 192,16,92
TR 0,14,0
TR 2,14,512
Mvaa 196,16,96
TR 4,14,32
TR 6,14,544
Mvaa 204,20,96
TR 8,14,64
TR 10,14,576
Mvaa 200,20,92
TR 12,14,96
TR 14,14,608
Mvaa 208,24,92
TR 16,14,128
TR 18,14,640
Mvaa 212,24,96
TR 20,14,160
TR 22,14,672
Mvaa 220,28,96
TR 24,14,192
TR 26,14,704
Mvaa 216,28,92
s_waitcnt vmcnt(27) lgkmcnt(12)
fl_u18:
Mvaa 160,0,104
s_waitcnt vmcnt(25) lgkmcnt(10)
s_add_u32 s50, s73, 0x40000
s_add_u32 m0, s52, 0x10800
TR 28,14,224
TR 30,14,736
Mvaa 164,0,108
buffer_load_dwordx4 v10, s[24:27], s50 offen lds
Mvaa 172,4,108
s_waitcnt lgkmcnt(10)
s_add_u32 m0, s52, 0x10c20
TR 0,14,8448
TR 2,14,8960
Mvaa 168,4,104
buffer_load_dwordx4 v11, s[24:27], s50 offen lds
Mvaa 176,8,104
s_waitcnt lgkmcnt(10)
s_add_u32 s50, s73, 0x50000
s_add_u32 m0, s52, 0x12900
TR 4,14,8480
TR 6,14,8992
Mvaa 180,8,108
buffer_load_dwordx4 v10, s[24:27], s50 offen lds
Mvaa 188,12,108
s_waitcnt lgkmcnt(10)
s_add_u32 m0, s52, 0x12d20
TR 8,14,8512
TR 10,14,9024
Mvaa 184,12,104
buffer_load_dwordx4 v11, s[24:27], s50 offen lds
Mvaa 192,16,104
s_waitcnt lgkmcnt(10)
s_add_u32 s51, s82, 0x37000
TR 12,14,8544
TR 14,14,9056
Mvaa 196,16,108
buffer_load_dwordx4 a[176:179], v20, s[20:23], s51 offen sc1
Mvaa 204,20,108
s_waitcnt lgkmcnt(10)
TR 16,14,8576
TR 18,14,9088
Mvaa 200,20,104
buffer_load_dwordx4 a[188:191], v20, s[20:23], s51 offen offset:1024 sc1
Mvaa 208,24,104
s_waitcnt lgkmcnt(10)
TR 20,14,8608
TR 22,14,9120
Mvaa 212,24,108
buffer_load_dwordx4 a[180:183], v12, s[20:23], s51 offen sc1
Mvaa 220,28,108
s_waitcnt lgkmcnt(10)
TR 24,14,8640
TR 26,14,9152
Mvaa 216,28,104
buffer_load_dwordx4 a[192:195], v12, s[20:23], s51 offen offset:1024 sc1
Mvaa 160,0,116
s_waitcnt vmcnt(32)
TR 28,14,8672
TR 30,14,9184
Mvaa 164,0,120
s_waitcnt lgkmcnt(12)
Mvaa 172,4,120
Mvaa 168,4,116
s_waitcnt lgkmcnt(10)
Mvaa 176,8,116
Mvaa 180,8,120
s_waitcnt lgkmcnt(8)
Mvaa 188,12,120
v_add_u32 v14, 0x18c00, v17
Mvaa 184,12,116
s_waitcnt vmcnt(51) lgkmcnt(0)
s_barrier
Mvaa 192,16,116
TR 0,14,0
TR 2,14,512
Mvaa 196,16,120
TR 4,14,32
TR 6,14,544
Mvaa 204,20,120
TR 8,14,64
TR 10,14,576
Mvaa 200,20,116
TR 12,14,96
TR 14,14,608
Mvaa 208,24,116
TR 16,14,128
TR 18,14,640
Mvaa 212,24,120
TR 20,14,160
TR 22,14,672
Mvaa 220,28,120
TR 24,14,192
TR 26,14,704
Mvaa 216,28,116
s_waitcnt vmcnt(27) lgkmcnt(12)
fl_u19:
Mvaa 160,0,32
s_waitcnt vmcnt(25) lgkmcnt(10)
s_add_u32 s50, s73, 0x60000
s_add_u32 m0, s52, 0x14a00
TR 28,14,224
TR 30,14,736
Mvaa 164,0,36
buffer_load_dwordx4 v10, s[24:27], s50 offen lds
Mvaa 172,4,36
s_waitcnt lgkmcnt(10)
s_add_u32 m0, s52, 0x14e20
TR 0,14,8448
TR 2,14,8960
Mvaa 168,4,32
buffer_load_dwordx4 v11, s[24:27], s50 offen lds
Mvaa 176,8,32
s_waitcnt lgkmcnt(10)
s_add_u32 s50, s73, 0x70000
s_add_u32 m0, s52, 0x16b00
TR 4,14,8480
TR 6,14,8992
Mvaa 180,8,36
buffer_load_dwordx4 v10, s[24:27], s50 offen lds
Mvaa 188,12,36
s_waitcnt lgkmcnt(10)
s_add_u32 m0, s52, 0x16f20
TR 8,14,8512
TR 10,14,9024
Mvaa 184,12,32
buffer_load_dwordx4 v11, s[24:27], s50 offen lds
Mvaa 192,16,32
s_waitcnt lgkmcnt(10)
s_add_u32 s51, s82, 0x3c800
TR 12,14,8544
TR 14,14,9056
Mvaa 196,16,36
buffer_load_dwordx4 a[200:203], v20, s[20:23], s51 offen sc1
Mvaa 204,20,36
s_waitcnt lgkmcnt(10)
TR 16,14,8576
TR 18,14,9088
Mvaa 200,20,32
buffer_load_dwordx4 a[212:215], v20, s[20:23], s51 offen offset:1024 sc1
Mvaa 208,24,32
s_waitcnt lgkmcnt(10)
TR 20,14,8608
TR 22,14,9120
Mvaa 212,24,36
buffer_load_dwordx4 a[204:207], v12, s[20:23], s51 offen sc1
Mvaa 220,28,36
s_waitcnt lgkmcnt(10)
TR 24,14,8640
TR 26,14,9152
Mvaa 216,28,32
buffer_load_dwordx4 a[216:219], v12, s[20:23], s51 offen offset:1024 sc1
Mvaa 160,0,44
s_waitcnt vmcnt(32)
TR 28,14,8672
TR 30,14,9184
Mvaa 164,0,48
s_waitcnt lgkmcnt(12)
Mvaa 172,4,48
Mvaa 168,4,44
s_waitcnt lgkmcnt(10)
Mvaa 176,8,44
Mvaa 180,8,48
s_waitcnt lgkmcnt(8)
Mvaa 188,12,48
v_add_u32 v14, 0x1ce00, v17
Mvaa 184,12,44
s_call_b64 s[70:71], f_pad20
s_waitcnt vmcnt(55) lgkmcnt(0)
s_barrier
Mvaa 192,16,44
TR 0,14,0
TR 2,14,512
Mvaa 196,16,48
TR 4,14,32
TR 6,14,544
Mvaa 204,20,48
TR 8,14,64
TR 10,14,576
Mvaa 200,20,44
TR 12,14,96
TR 14,14,608
Mvaa 208,24,44
TR 16,14,128
TR 18,14,640
Mvaa 212,24,48
TR 20,14,160
TR 22,14,672
Mvaa 220,28,48
TR 24,14,192
TR 26,14,704
Mvaa 216,28,44
s_waitcnt vmcnt(27) lgkmcnt(12)
fl_u20:
Mvaa 160,0,128
s_waitcnt vmcnt(25) lgkmcnt(10)
s_add_u32 s50, s74, 0x40000
s_add_u32 m0, s52, 0x18c00
TR 28,14,224
TR 30,14,736
Mvaa 164,0,132
buffer_load_dwordx4 v10, s[24:27], s50 offen lds
Mvaa 172,4,132
s_waitcnt lgkmcnt(10)
s_add_u32 m0, s52, 0x19020
TR 0,14,8448
TR 2,14,8960
Mvaa 168,4,128
buffer_load_dwordx4 v11, s[24:27], s50 offen lds
Mvaa 176,8,128
s_waitcnt lgkmcnt(10)
s_add_u32 s50, s74, 0x50000
s_add_u32 m0, s52, 0x1ad00
TR 4,14,8480
TR 6,14,8992
Mvaa 180,8,132
buffer_load_dwordx4 v10, s[24:27], s50 offen lds
Mvaa 188,12,132
s_waitcnt lgkmcnt(10)
s_add_u32 m0, s52, 0x1b120
TR 8,14,8512
TR 10,14,9024
Mvaa 184,12,128
buffer_load_dwordx4 v11, s[24:27], s50 offen lds
Mvaa 192,16,128
s_waitcnt lgkmcnt(10)
s_add_u32 s51, s82, 0x4d000
TR 12,14,8544
TR 14,14,9056
Mvaa 196,16,132
buffer_load_dwordx4 a[224:227], v20, s[20:23], s51 offen sc1
Mvaa 204,20,132
s_waitcnt lgkmcnt(10)
TR 16,14,8576
TR 18,14,9088
Mvaa 200,20,128
buffer_load_dwordx4 a[236:239], v20, s[20:23], s51 offen offset:1024 sc1
Mvaa 208,24,128
s_waitcnt lgkmcnt(10)
TR 20,14,8608
TR 22,14,9120
Mvaa 212,24,132
buffer_load_dwordx4 a[228:231], v12, s[20:23], s51 offen sc1
Mvaa 220,28,132
s_waitcnt lgkmcnt(10)
TR 24,14,8640
TR 26,14,9152
Mvaa 216,28,128
buffer_load_dwordx4 a[240:243], v12, s[20:23], s51 offen offset:1024 sc1
Mvaa 160,0,140
s_waitcnt vmcnt(32) lgkmcnt(10)
TR 28,14,8672
TR 30,14,9184
v_add_u32 v226, ((fh_u20-f_start+5120)&0xffffff80), v227
v_min_u32 v226, f_end-f_start, v226
Mvaa 164,0,144
global_load_dword v224, v226, s[98:99]
Mvaa 172,4,144
s_waitcnt lgkmcnt(10)
v_add_u32 v226, ((fl_u20-f_start+5120)&0xffffff80), v227
v_min_u32 v226, f_end-f_start, v226
Mvaa 168,4,140
global_load_dword v224, v226, s[98:99]
Mvaa 176,8,140
Mvaa 180,8,144
s_waitcnt lgkmcnt(8)
Mvaa 188,12,144
v_add_u32 v14, 0x21000, v17
Mvaa 184,12,140
s_waitcnt vmcnt(58) lgkmcnt(0)
s_barrier
Mvaa 192,16,140
TR 0,14,0
TR 2,14,512
Mvaa 196,16,144
TR 4,14,32
TR 6,14,544
Mvaa 204,20,144
TR 8,14,64
TR 10,14,576
Mvaa 200,20,140
TR 12,14,96
TR 14,14,608
Mvaa 208,24,140
TR 16,14,128
TR 18,14,640
Mvaa 212,24,144
TR 20,14,160
TR 22,14,672
Mvaa 220,28,144
TR 24,14,192
TR 26,14,704
Mvaa 216,28,140
s_waitcnt vmcnt(29) lgkmcnt(12)
fl_u21:
Mvaa 160,0,152
s_waitcnt vmcnt(27) lgkmcnt(10)
s_add_u32 s50, s74, 0x60000
s_add_u32 m0, s52, 0x1ce00
TR 28,14,224
TR 30,14,736
Mvaa 164,0,156
buffer_load_dwordx4 v10, s[24:27], s50 offen lds
Mvaa 172,4,156
s_waitcnt lgkmcnt(10)
s_add_u32 m0, s52, 0x1d220
TR 0,14,8448
TR 2,14,8960
Mvaa 168,4,152
buffer_load_dwordx4 v11, s[24:27], s50 offen lds
Mvaa 176,8,152
s_waitcnt lgkmcnt(10)
s_add_u32 s50, s74, 0x70000
s_add_u32 m0, s52, 0x1ef00
TR 4,14,8480
TR 6,14,8992
Mvaa 180,8,156
buffer_load_dwordx4 v10, s[24:27], s50 offen lds
Mvaa 188,12,156
s_waitcnt lgkmcnt(10)
s_add_u32 m0, s52, 0x1f320
TR 8,14,8512
TR 10,14,9024
Mvaa 184,12,152
buffer_load_dwordx4 v11, s[24:27], s50 offen lds
Mvaa 192,16,152
s_waitcnt lgkmcnt(10)
s_add_u32 s51, s82, 0x52800
TR 12,14,8544
TR 14,14,9056
Mvaa 196,16,156
buffer_load_dwordx4 a[80:83], v20, s[20:23], s51 offen sc1
Mvaa 204,20,156
s_waitcnt lgkmcnt(10)
TR 16,14,8576
TR 18,14,9088
Mvaa 200,20,152
buffer_load_dwordx4 a[92:95], v20, s[20:23], s51 offen offset:1024 sc1
Mvaa 208,24,152
s_waitcnt lgkmcnt(10)
TR 20,14,8608
TR 22,14,9120
Mvaa 212,24,156
buffer_load_dwordx4 a[84:87], v12, s[20:23], s51 offen sc1
Mvaa 220,28,156
s_waitcnt lgkmcnt(10)
TR 24,14,8640
TR 26,14,9152
Mvaa 216,28,152
buffer_load_dwordx4 a[96:99], v12, s[20:23], s51 offen offset:1024 sc1
Mvaa 160,0,164
s_waitcnt vmcnt(34)
TR 28,14,8672
TR 30,14,9184
Mvaa 164,0,168
s_waitcnt lgkmcnt(12)
Mvaa 172,4,168
Mvaa 168,4,164
s_waitcnt lgkmcnt(10)
Mvaa 176,8,164
Mvaa 180,8,168
s_waitcnt lgkmcnt(8)
Mvaa 188,12,168
v_add_u32 v14, 0, v17
Mvaa 184,12,164
s_waitcnt vmcnt(62) lgkmcnt(0)
s_barrier
Mvaa 192,16,164
TR 0,14,0
TR 2,14,512
Mvaa 196,16,168
TR 4,14,32
TR 6,14,544
Mvaa 204,20,168
TR 8,14,64
TR 10,14,576
Mvaa 200,20,164
TR 12,14,96
TR 14,14,608
Mvaa 208,24,164
TR 16,14,128
TR 18,14,640
Mvaa 212,24,168
TR 20,14,160
TR 22,14,672
Mvaa 220,28,168
TR 24,14,192
TR 26,14,704
Mvaa 216,28,164
s_waitcnt vmcnt(29) lgkmcnt(12)
fl_u22:
Mvaa 160,0,176
s_waitcnt vmcnt(27) lgkmcnt(10)
s_add_u32 s50, s75, 0x40000
s_add_u32 m0, s52, 0x21000
TR 28,14,224
TR 30,14,736
Mvaa 164,0,180
buffer_load_dwordx4 v10, s[24:27], s50 offen lds
Mvaa 172,4,180
s_waitcnt lgkmcnt(10)
s_add_u32 m0, s52, 0x21420
TR 0,14,8448
TR 2,14,8960
Mvaa 168,4,176
buffer_load_dwordx4 v11, s[24:27], s50 offen lds
Mvaa 176,8,176
s_waitcnt lgkmcnt(10)
s_add_u32 s50, s75, 0x50000
s_add_u32 m0, s52, 0x23100
TR 4,14,8480
TR 6,14,8992
Mvaa 180,8,180
buffer_load_dwordx4 v10, s[24:27], s50 offen lds
Mvaa 188,12,180
s_waitcnt lgkmcnt(10)
s_add_u32 m0, s52, 0x23520
TR 8,14,8512
TR 10,14,9024
Mvaa 184,12,176
buffer_load_dwordx4 v11, s[24:27], s50 offen lds
Mvaa 192,16,176
s_waitcnt lgkmcnt(10)
s_add_u32 s51, s79, 0xb000
TR 12,14,8544
TR 14,14,9056
Mvaa 196,16,180
buffer_load_dwordx4 a[104:107], v20, s[20:23], s51 offen sc1
Mvaa 204,20,180
s_waitcnt lgkmcnt(10)
TR 16,14,8576
TR 18,14,9088
Mvaa 200,20,176
buffer_load_dwordx4 a[116:119], v20, s[20:23], s51 offen offset:1024 sc1
Mvaa 208,24,176
s_waitcnt lgkmcnt(10)
TR 20,14,8608
TR 22,14,9120
Mvaa 212,24,180
buffer_load_dwordx4 a[108:111], v12, s[20:23], s51 offen sc1
Mvaa 220,28,180
s_waitcnt lgkmcnt(10)
TR 24,14,8640
TR 26,14,9152
Mvaa 216,28,176
buffer_load_dwordx4 a[120:123], v12, s[20:23], s51 offen offset:1024 sc1
Mvaa 160,0,188
s_waitcnt vmcnt(34)
TR 28,14,8672
TR 30,14,9184
Mvaa 164,0,192
s_waitcnt lgkmcnt(12)
Mvaa 172,4,192
Mvaa 168,4,188
s_waitcnt lgkmcnt(10)
Mvaa 176,8,188
Mvaa 180,8,192
s_waitcnt lgkmcnt(8)
Mvaa 188,12,192
v_add_u32 v14, 0x4200, v17
Mvaa 184,12,188
s_waitcnt vmcnt(62) lgkmcnt(0)
s_barrier
Mvaa 192,16,188
TR 0,14,0
TR 2,14,512
Mvaa 196,16,192
TR 4,14,32
TR 6,14,544
Mvaa 204,20,192
TR 8,14,64
TR 10,14,576
Mvaa 200,20,188
TR 12,14,96
TR 14,14,608
Mvaa 208,24,188
TR 16,14,128
TR 18,14,640
Mvaa 212,24,192
TR 20,14,160
TR 22,14,672
Mvaa 220,28,192
TR 24,14,192
TR 26,14,704
Mvaa 216,28,188
s_waitcnt vmcnt(29) lgkmcnt(12)
fl_u23:
Mvaa 160,0,200
s_waitcnt vmcnt(27) lgkmcnt(10)
s_add_u32 s50, s75, 0x60000
s_add_u32 m0, s52, 0
TR 28,14,224
TR 30,14,736
Mvaa 164,0,204
buffer_load_dwordx4 v10, s[24:27], s50 offen lds
Mvaa 172,4,204
s_waitcnt lgkmcnt(10)
s_add_u32 m0, s52, 0x420
TR 0,14,8448
TR 2,14,8960
Mvaa 168,4,200
buffer_load_dwordx4 v11, s[24:27], s50 offen lds
Mvaa 176,8,200
s_waitcnt lgkmcnt(10)
s_add_u32 s50, s75, 0x70000
s_add_u32 m0, s52, 0x2100
TR 4,14,8480
TR 6,14,8992
Mvaa 180,8,204
buffer_load_dwordx4 v10, s[24:27], s50 offen lds
Mvaa 188,12,204
s_waitcnt lgkmcnt(10)
s_add_u32 m0, s52, 0x2520
TR 8,14,8512
TR 10,14,9024
Mvaa 184,12,200
buffer_load_dwordx4 v11, s[24:27], s50 offen lds
Mvaa 192,16,200
s_waitcnt lgkmcnt(10)
s_add_u32 s51, s79, 0x10800
TR 12,14,8544
TR 14,14,9056
Mvaa 196,16,204
buffer_load_dwordx4 a[32:35], v20, s[20:23], s51 offen sc1
Mvaa 204,20,204
s_waitcnt lgkmcnt(10)
TR 16,14,8576
TR 18,14,9088
Mvaa 200,20,200
buffer_load_dwordx4 a[44:47], v20, s[20:23], s51 offen offset:1024 sc1
Mvaa 208,24,200
s_waitcnt lgkmcnt(10)
TR 20,14,8608
TR 22,14,9120
Mvaa 212,24,204
buffer_load_dwordx4 a[36:39], v12, s[20:23], s51 offen sc1
Mvaa 220,28,204
s_waitcnt lgkmcnt(10)
TR 24,14,8640
TR 26,14,9152
Mvaa 216,28,200
buffer_load_dwordx4 a[48:51], v12, s[20:23], s51 offen offset:1024 sc1
Mvaa 160,0,212
s_waitcnt vmcnt(34)
TR 28,14,8672
TR 30,14,9184
Mvaa 164,0,216
s_waitcnt lgkmcnt(12)
Mvaa 172,4,216
Mvaa 168,4,212
s_waitcnt lgkmcnt(10)
Mvaa 176,8,212
Mvaa 180,8,216
s_waitcnt lgkmcnt(8)
Mvaa 188,12,216
v_add_u32 v14, 0x8400, v17
Mvaa 184,12,212
s_waitcnt vmcnt(62) lgkmcnt(0)
s_barrier
Mvaa 192,16,212
TR 0,14,0
TR 2,14,512
Mvaa 196,16,216
TR 4,14,32
TR 6,14,544
Mvaa 204,20,216
TR 8,14,64
TR 10,14,576
Mvaa 200,20,212
TR 12,14,96
TR 14,14,608
Mvaa 208,24,212
TR 16,14,128
TR 18,14,640
Mvaa 212,24,216
TR 20,14,160
TR 22,14,672
Mvaa 220,28,216
TR 24,14,192
TR 26,14,704
Mvaa 216,28,212
s_waitcnt vmcnt(29) lgkmcnt(12)
fl_u24:
Mvaa 160,0,224
s_waitcnt vmcnt(27) lgkmcnt(10)
s_add_u32 s51, s80, 0xb000
TR 28,14,224
TR 30,14,736
Mvaa 164,0,228
buffer_load_dwordx4 a[128:131], v20, s[20:23], s51 offen sc1
Mvaa 172,4,228
s_waitcnt lgkmcnt(10)
TR 0,14,8448
TR 2,14,8960
Mvaa 168,4,224
buffer_load_dwordx4 a[140:143], v20, s[20:23], s51 offen offset:1024 sc1
Mvaa 176,8,224
s_waitcnt lgkmcnt(10)
TR 4,14,8480
TR 6,14,8992
Mvaa 180,8,228
buffer_load_dwordx4 a[132:135], v12, s[20:23], s51 offen sc1
Mvaa 188,12,228
s_waitcnt lgkmcnt(10)
TR 8,14,8512
TR 10,14,9024
Mvaa 184,12,224
buffer_load_dwordx4 a[144:147], v12, s[20:23], s51 offen offset:1024 sc1
Mvaa 192,16,224
s_waitcnt lgkmcnt(10)
s_add_u32 s51, s80, 0x10800
TR 12,14,8544
TR 14,14,9056
Mvaa 196,16,228
buffer_load_dwordx4 a[152:155], v20, s[20:23], s51 offen sc1
Mvaa 204,20,228
s_waitcnt lgkmcnt(10)
TR 16,14,8576
TR 18,14,9088
Mvaa 200,20,224
buffer_load_dwordx4 a[164:167], v20, s[20:23], s51 offen offset:1024 sc1
Mvaa 208,24,224
s_waitcnt lgkmcnt(10)
TR 20,14,8608
TR 22,14,9120
Mvaa 212,24,228
buffer_load_dwordx4 a[156:159], v12, s[20:23], s51 offen sc1
Mvaa 220,28,228
s_waitcnt lgkmcnt(10)
TR 24,14,8640
TR 26,14,9152
Mvaa 216,28,224
buffer_load_dwordx4 a[168:171], v12, s[20:23], s51 offen offset:1024 sc1
Mvaa 160,0,236
s_waitcnt vmcnt(34)
TR 28,14,8672
TR 30,14,9184
Mvaa 164,0,240
s_waitcnt lgkmcnt(12)
Mvaa 172,4,240
Mvaa 168,4,236
s_waitcnt lgkmcnt(10)
Mvaa 176,8,236
Mvaa 180,8,240
s_waitcnt lgkmcnt(8)
Mvaa 188,12,240
v_add_u32 v14, 0xc600, v17
Mvaa 184,12,236
s_call_b64 s[70:71], f_pad21
s_waitcnt vmcnt(62) lgkmcnt(0)
s_barrier
Mvaa 192,16,236
TR 0,14,0
TR 2,14,512
Mvaa 196,16,240
TR 4,14,32
TR 6,14,544
Mvaa 204,20,240
TR 8,14,64
TR 10,14,576
Mvaa 200,20,236
TR 12,14,96
TR 14,14,608
Mvaa 208,24,236
TR 16,14,128
TR 18,14,640
Mvaa 212,24,240
TR 20,14,160
TR 22,14,672
Mvaa 220,28,240
TR 24,14,192
TR 26,14,704
Mvaa 216,28,236
s_waitcnt vmcnt(27) lgkmcnt(12)
fl_u25:
Mvaa 160,0,80
s_waitcnt vmcnt(25) lgkmcnt(10)
s_add_u32 s51, s81, 0xb000
TR 28,14,224
TR 30,14,736
Mvaa 164,0,84
buffer_load_dwordx4 a[176:179], v20, s[20:23], s51 offen sc1
Mvaa 172,4,84
s_waitcnt lgkmcnt(10)
TR 0,14,8448
TR 2,14,8960
Mvaa 168,4,80
buffer_load_dwordx4 a[188:191], v20, s[20:23], s51 offen offset:1024 sc1
Mvaa 176,8,80
s_waitcnt lgkmcnt(10)
TR 4,14,8480
TR 6,14,8992
Mvaa 180,8,84
buffer_load_dwordx4 a[180:183], v12, s[20:23], s51 offen sc1
Mvaa 188,12,84
s_waitcnt lgkmcnt(10)
TR 8,14,8512
TR 10,14,9024
Mvaa 184,12,80
buffer_load_dwordx4 a[192:195], v12, s[20:23], s51 offen offset:1024 sc1
Mvaa 192,16,80
s_waitcnt lgkmcnt(10)
s_add_u32 s51, s81, 0x10800
TR 12,14,8544
TR 14,14,9056
Mvaa 196,16,84
buffer_load_dwordx4 a[200:203], v20, s[20:23], s51 offen sc1
Mvaa 204,20,84
s_waitcnt lgkmcnt(10)
TR 16,14,8576
TR 18,14,9088
Mvaa 200,20,80
buffer_load_dwordx4 a[212:215], v20, s[20:23], s51 offen offset:1024 sc1
Mvaa 208,24,80
s_waitcnt lgkmcnt(10)
TR 20,14,8608
TR 22,14,9120
Mvaa 212,24,84
buffer_load_dwordx4 a[204:207], v12, s[20:23], s51 offen sc1
Mvaa 220,28,84
s_waitcnt lgkmcnt(10)
TR 24,14,8640
TR 26,14,9152
Mvaa 216,28,80
buffer_load_dwordx4 a[216:219], v12, s[20:23], s51 offen offset:1024 sc1
Mvaa 160,0,92
s_waitcnt vmcnt(32)
TR 28,14,8672
TR 30,14,9184
Mvaa 164,0,96
s_waitcnt lgkmcnt(12)
Mvaa 172,4,96
Mvaa 168,4,92
s_waitcnt lgkmcnt(10)
Mvaa 176,8,92
Mvaa 180,8,96
s_waitcnt lgkmcnt(8)
Mvaa 188,12,96
v_add_u32 v14, 0x10800, v17
Mvaa 184,12,92
s_waitcnt vmcnt(62) lgkmcnt(0)
s_barrier
Mvaa 192,16,92
TR 0,14,0
TR 2,14,512
Mvaa 196,16,96
TR 4,14,32
TR 6,14,544
Mvaa 204,20,96
TR 8,14,64
TR 10,14,576
Mvaa 200,20,92
TR 12,14,96
TR 14,14,608
Mvaa 208,24,92
TR 16,14,128
TR 18,14,640
Mvaa 212,24,96
TR 20,14,160
TR 22,14,672
Mvaa 220,28,96
TR 24,14,192
TR 26,14,704
Mvaa 216,28,92
s_waitcnt vmcnt(27) lgkmcnt(12)
fl_u26:
Mvaa 160,0,104
s_waitcnt vmcnt(25)
TR 28,14,224
TR 30,14,736
Mvaa 164,0,108
s_waitcnt lgkmcnt(12)
Mvaa 172,4,108
TR 0,14,8448
TR 2,14,8960
Mvaa 168,4,104
s_waitcnt lgkmcnt(12)
Mvaa 176,8,104
TR 4,14,8480
TR 6,14,8992
Mvaa 180,8,108
s_waitcnt lgkmcnt(12)
Mvaa 188,12,108
TR 8,14,8512
TR 10,14,9024
Mvaa 184,12,104
s_waitcnt lgkmcnt(12)
Mvaa 192,16,104
TR 12,14,8544
TR 14,14,9056
Mvaa 196,16,108
s_waitcnt lgkmcnt(12)
Mvaa 204,20,108
TR 16,14,8576
TR 18,14,9088
Mvaa 200,20,104
s_waitcnt lgkmcnt(12)
Mvaa 208,24,104
TR 20,14,8608
TR 22,14,9120
Mvaa 212,24,108
s_waitcnt lgkmcnt(12)
Mvaa 220,28,108
TR 24,14,8640
TR 26,14,9152
Mvaa 216,28,104
s_waitcnt lgkmcnt(12)
Mvaa 160,0,116
s_waitcnt vmcnt(24)
TR 28,14,8672
TR 30,14,9184
Mvaa 164,0,120
s_waitcnt lgkmcnt(12)
Mvaa 172,4,120
Mvaa 168,4,116
s_waitcnt lgkmcnt(10)
Mvaa 176,8,116
v_add_u32 v18, 0x1c000, v17
Mvaa 180,8,120
s_waitcnt lgkmcnt(8)
v_add_u32 v16, 0xe000, v17
Mvaa 188,12,120
v_add_u32 v14, 0x14a00, v17
Mvaa 184,12,116
s_call_b64 s[70:71], f_pad22
s_waitcnt vmcnt(20) lgkmcnt(0)
s_barrier
Mvaa 192,16,116
TR 0,16,27264
TR 2,16,27776
Mvaa 196,16,120
TR 4,16,35712
TR 6,16,36224
Mvaa 204,20,120
TR 8,16,44160
TR 10,16,44672
Mvaa 200,20,116
TR 12,16,52608
TR 14,16,53120
Mvaa 208,24,116
TR 16,18,3712
TR 18,18,4224
Mvaa 212,24,120
TR 20,18,12160
TR 22,18,12672
Mvaa 220,28,120
TR 24,18,20608
TR 26,18,21120
Mvaa 216,28,116
s_waitcnt vmcnt(19) lgkmcnt(12)
fl_fin:
Mvaa 192,0,32
s_waitcnt vmcnt(17)
s_add_u32 s44, s59, 0x1000
TR 28,18,29056
TR 30,18,29568
Mvaa 196,0,36
s_waitcnt lgkmcnt(12)
Mvaa 192,4,44
s_waitcnt vmcnt(15) lgkmcnt(10)
TR 0,17,128
TR 2,17,640
v_add_u32 v226, ((fh_fin-f_start+5120)&0xffffff80), v227
v_min_u32 v226, f_end-f_start, v226
Mvaa 196,4,48
global_load_dword v224, v226, s[98:99]
Mvaa 192,8,128
s_waitcnt vmcnt(14) lgkmcnt(10)
TR 4,17,8576
TR 6,17,9088
v_add_u32 v226, ((fl_fin-f_start+5120)&0xffffff80), v227
v_min_u32 v226, f_end-f_start, v226
Mvaa 196,8,132
global_load_dword v224, v226, s[98:99]
Mvaa 192,12,140
s_waitcnt vmcnt(14)
TR 8,16,27296
TR 10,16,27808
Mvaa 196,12,144
s_waitcnt vmcnt(13) lgkmcnt(12)
Mvaa 192,16,152
s_waitcnt vmcnt(11)
TR 12,16,35744
TR 14,16,36256
Mvaa 196,16,156
s_waitcnt lgkmcnt(12)
Mvaa 192,20,164
s_waitcnt vmcnt(10)
TR 16,16,44192
TR 18,16,44704
Mvaa 196,20,168
s_waitcnt vmcnt(9) lgkmcnt(12)
Mvaa 192,24,176
s_waitcnt vmcnt(7)
TR 20,16,52640
TR 22,16,53152
Mvaa 196,24,180
s_waitcnt lgkmcnt(12)
Mvaa 192,28,188
s_waitcnt vmcnt(6)
TR 24,18,3744
TR 26,18,4256
Mvaa 196,28,192
s_waitcnt vmcnt(5) lgkmcnt(12)
Mvaa 192,0,200
s_waitcnt vmcnt(3)
TR 28,18,12192
TR 30,18,12704
Mvaa 196,0,204
s_waitcnt lgkmcnt(12)
Mvaa 192,4,212
s_waitcnt vmcnt(2)
TR 0,18,20640
TR 2,18,21152
Mvaa 196,4,216
s_waitcnt lgkmcnt(12)
Mvaa 200,8,32
TR 4,18,29088
TR 6,18,29600
Mvaa 204,8,36
s_waitcnt lgkmcnt(12)
Mvaa 200,12,44
TR 8,17,160
TR 10,17,672
Mvaa 204,12,48
s_waitcnt lgkmcnt(12)
Mvaa 200,16,128
TR 12,17,8608
TR 14,17,9120
Mvaa 204,16,132
s_waitcnt lgkmcnt(12)
Mvaa 200,20,140
TR 16,16,27328
TR 18,16,27840
Mvaa 204,20,144
s_waitcnt lgkmcnt(12)
Mvaa 200,24,152
TR 20,16,35776
TR 22,16,36288
Mvaa 204,24,156
s_waitcnt lgkmcnt(12)
Mvaa 200,28,164
TR 24,16,44224
TR 26,16,44736
Mvaa 204,28,168
s_waitcnt lgkmcnt(12)
Mvaa 200,0,176
TR 28,16,52672
TR 30,16,53184
Mvaa 204,0,180
s_waitcnt lgkmcnt(12)
Mvaa 200,4,188
TR 0,18,3776
TR 2,18,4288
Mvaa 204,4,192
s_waitcnt lgkmcnt(12)
Mvaa 200,8,200
TR 4,18,12224
TR 6,18,12736
Mvaa 204,8,204
s_waitcnt lgkmcnt(12)
Mvaa 200,12,212
TR 8,18,20672
TR 10,18,21184
Mvaa 204,12,216
s_waitcnt lgkmcnt(12)
Mvaa 208,16,32
TR 12,18,29120
TR 14,18,29632
Mvaa 212,16,36
s_waitcnt lgkmcnt(12)
Mvaa 208,20,44
TR 16,17,192
TR 18,17,704
Mvaa 212,20,48
s_waitcnt lgkmcnt(12)
v_cvt_pk_bf16_f32 v112, v192, v193
Mvaa 208,24,128
TR 20,17,8640
TR 22,17,9152
v_cvt_pk_bf16_f32 v113, v194, v195
Mvaa 212,24,132
s_waitcnt lgkmcnt(12)
v_cvt_pk_bf16_f32 v114, v200, v201
Mvaa 208,28,140
s_waitcnt lgkmcnt(10)
TR 24,16,27360
TR 26,16,27872
v_cvt_pk_bf16_f32 v115, v202, v203
Mvaa 212,28,144
buffer_store_dwordx4 v[112:115], v20, s[20:23], s59 offen sc1
Mvaa 208,0,152
TR 28,16,35808
TR 30,16,36320
v_cvt_pk_bf16_f32 v116, v196, v197
Mvaa 212,0,156
s_waitcnt lgkmcnt(12)
v_cvt_pk_bf16_f32 v117, v198, v199
Mvaa 208,4,164
TR 0,16,44256
TR 2,16,44768
v_cvt_pk_bf16_f32 v118, v204, v205
Mvaa 212,4,168
s_waitcnt lgkmcnt(12)
v_cvt_pk_bf16_f32 v119, v206, v207
Mvaa 208,8,176
s_waitcnt lgkmcnt(10)
TR 4,16,52704
TR 6,16,53216
Mvaa 212,8,180
buffer_store_dwordx4 v[116:119], v20, s[20:23], s59 offen offset:1024 sc1
Mvaa 208,12,188
TR 8,18,3808
TR 10,18,4320
Mvaa 212,12,192
s_waitcnt lgkmcnt(12)
Mvaa 208,16,200
TR 12,18,12256
TR 14,18,12768
Mvaa 212,16,204
s_waitcnt lgkmcnt(12)
Mvaa 208,20,212
TR 16,18,20704
TR 18,18,21216
Mvaa 212,20,216
s_waitcnt lgkmcnt(12)
Mvaa 216,24,32
TR 20,18,29152
TR 22,18,29664
Mvaa 220,24,36
s_waitcnt lgkmcnt(12)
Mvaa 216,28,44
TR 24,17,224
TR 26,17,736
Mvaa 220,28,48
s_waitcnt lgkmcnt(12)
Mvaa 216,0,128
TR 28,17,8672
TR 30,17,9184
Mvaa 220,0,132
s_waitcnt lgkmcnt(12)
Mvaa 216,4,140
TR 0,16,27136
TR 2,16,27648
Mvaa 220,4,144
s_waitcnt lgkmcnt(12)
Mvaa 216,8,152
TR 4,16,35584
TR 6,16,36096
Mvaa 220,8,156
s_waitcnt lgkmcnt(12)
Mvaa 216,12,164
TR 8,16,44032
TR 10,16,44544
Mvaa 220,12,168
s_waitcnt lgkmcnt(12)
Mvaa 216,16,176
TR 12,16,52480
TR 14,16,52992
Mvaa 220,16,180
s_waitcnt lgkmcnt(12)
Mvaa 216,20,188
TR 16,18,3584
TR 18,18,4096
Mvaa 220,20,192
s_waitcnt lgkmcnt(12)
Mvaa 216,24,200
TR 20,18,12032
TR 22,18,12544
Mvaa 220,24,204
s_waitcnt lgkmcnt(12)
Mvaa 216,28,212
TR 24,18,20480
TR 26,18,20992
Mvaa 220,28,216
s_waitcnt lgkmcnt(12)
Mvaa 160,0,32
TR 28,18,28928
TR 30,18,29440
Mvaa 164,0,36
s_waitcnt lgkmcnt(12)
Mvaa 160,4,44
TR 0,17,0
TR 2,17,512
Mvaa 164,4,48
s_waitcnt lgkmcnt(12)
v_cvt_pk_bf16_f32 v120, v208, v209
Mvaa 160,8,128
TR 4,17,8448
TR 6,17,8960
v_cvt_pk_bf16_f32 v121, v210, v211
Mvaa 164,8,132
s_waitcnt lgkmcnt(12)
v_cvt_pk_bf16_f32 v122, v216, v217
Mvaa 160,12,140
s_waitcnt lgkmcnt(10)
TR 8,16,27168
TR 10,16,27680
v_cvt_pk_bf16_f32 v123, v218, v219
Mvaa 164,12,144
buffer_store_dwordx4 v[120:123], v20, s[20:23], s59 offen offset:2048 sc1
Mvaa 160,16,152
TR 12,16,35616
TR 14,16,36128
v_cvt_pk_bf16_f32 v124, v212, v213
Mvaa 164,16,156
s_waitcnt lgkmcnt(12)
v_cvt_pk_bf16_f32 v125, v214, v215
Mvaa 160,20,164
TR 16,16,44064
TR 18,16,44576
v_cvt_pk_bf16_f32 v126, v220, v221
Mvaa 164,20,168
s_waitcnt lgkmcnt(12)
v_cvt_pk_bf16_f32 v127, v222, v223
Mvaa 160,24,176
s_waitcnt lgkmcnt(10)
TR 20,16,52512
TR 22,16,53024
Mvaa 164,24,180
buffer_store_dwordx4 v[124:127], v20, s[20:23], s59 offen offset:3072 sc1
Mvaa 160,28,188
TR 24,18,3616
TR 26,18,4128
Mvaa 164,28,192
s_waitcnt lgkmcnt(12)
Mvaa 160,0,200
TR 28,18,12064
TR 30,18,12576
Mvaa 164,0,204
s_waitcnt lgkmcnt(12)
Mvaa 160,4,212
TR 0,18,20512
TR 2,18,21024
Mvaa 164,4,216
s_waitcnt lgkmcnt(12)
Mvaa 168,8,32
TR 4,18,28960
TR 6,18,29472
Mvaa 172,8,36
s_waitcnt lgkmcnt(12)
Mvaa 168,12,44
TR 8,17,32
TR 10,17,544
Mvaa 172,12,48
s_waitcnt lgkmcnt(12)
Mvaa 168,16,128
TR 12,17,8480
TR 14,17,8992
Mvaa 172,16,132
s_waitcnt lgkmcnt(12)
Mvaa 168,20,140
TR 16,16,27200
TR 18,16,27712
Mvaa 172,20,144
s_waitcnt lgkmcnt(12)
Mvaa 168,24,152
TR 20,16,35648
TR 22,16,36160
Mvaa 172,24,156
s_waitcnt lgkmcnt(12)
Mvaa 168,28,164
TR 24,16,44096
TR 26,16,44608
Mvaa 172,28,168
s_waitcnt lgkmcnt(12)
Mvaa 168,0,176
TR 28,16,52544
TR 30,16,53056
Mvaa 172,0,180
s_waitcnt vmcnt(0) lgkmcnt(12)
s_barrier
buffer_store_dword v29, v28, s[20:23], s62 offen sc1
Mvaa 168,4,188
s_add_u32 s44, s60, 0x1000
TR 0,18,3648
TR 2,18,4160
Mvaa 172,4,192
s_waitcnt lgkmcnt(12)
Mvaa 168,8,200
TR 4,18,12096
TR 6,18,12608
Mvaa 172,8,204
s_waitcnt lgkmcnt(12)
Mvaa 168,12,212
TR 8,18,20544
TR 10,18,21056
Mvaa 172,12,216
s_waitcnt lgkmcnt(12)
Mvaa 176,16,32
s_waitcnt lgkmcnt(10)
TR 12,18,28992
TR 14,18,29504
Mvaa 180,16,36
buffer_load_dword v30, v28, s[20:23], s61 offen sc1
Mvaa 176,20,44
TR 16,17,64
TR 18,17,576
Mvaa 180,20,48
s_waitcnt lgkmcnt(12)
Mvaa 176,24,128
TR 20,17,8512
TR 22,17,9024
Mvaa 180,24,132
s_waitcnt lgkmcnt(12)
Mvaa 176,28,140
TR 24,16,27232
TR 26,16,27744
Mvaa 180,28,144
s_waitcnt lgkmcnt(12)
Mvaa 176,0,152
TR 28,16,35680
TR 30,16,36192
Mvaa 180,0,156
s_waitcnt lgkmcnt(12)
Mvaa 176,4,164
TR 0,16,44128
TR 2,16,44640
Mvaa 180,4,168
s_waitcnt lgkmcnt(12)
Mvaa 176,8,176
TR 4,16,52576
TR 6,16,53088
Mvaa 180,8,180
s_waitcnt lgkmcnt(12)
Mvaa 176,12,188
TR 8,18,3680
TR 10,18,4192
Mvaa 180,12,192
s_waitcnt lgkmcnt(12)
Mvaa 176,16,200
TR 12,18,12128
TR 14,18,12640
Mvaa 180,16,204
s_waitcnt vmcnt(0)
v_readfirstlane_b32 s43, v30
s_nop 0
s_cmp_lt_u32 s43, 1
s_cbranch_scc1 fl_xskip
buffer_load_dwordx4 v[64:67], v20, s[20:23], s60 offen sc1
buffer_load_dwordx4 v[68:71], v20, s[20:23], s60 offen offset:1024 sc1
buffer_load_dwordx4 v[72:75], v20, s[20:23], s60 offen offset:2048 sc1
buffer_load_dwordx4 v[76:79], v20, s[20:23], s60 offen offset:3072 sc1
fl_xskip:
s_waitcnt lgkmcnt(12)
Mvaa 176,20,212
TR 16,18,20576
TR 18,18,21088
Mvaa 180,20,216
s_waitcnt lgkmcnt(12)
Mvaa 184,24,32
TR 20,18,29024
TR 22,18,29536
Mvaa 188,24,36
s_waitcnt lgkmcnt(12)
Mvaa 184,28,44
TR 24,17,96
TR 26,17,608
Mvaa 188,28,48
s_waitcnt lgkmcnt(12)
Mvaa 184,0,128
TR 28,17,8544
TR 30,17,9056
Mvaa 188,0,132
s_waitcnt lgkmcnt(12)
Mvaa 184,4,140
Mvaa 188,4,144
s_waitcnt lgkmcnt(10)
Mvaa 184,8,152
Mvaa 188,8,156
s_waitcnt lgkmcnt(8)
Mvaa 184,12,164
Mvaa 188,12,168
s_waitcnt lgkmcnt(6)
Mvaa 184,16,176
Mvaa 188,16,180
s_waitcnt lgkmcnt(4)
Mvaa 184,20,188
Mvaa 188,20,192
s_waitcnt lgkmcnt(2)
Mvaa 184,24,200
Mvaa 188,24,204
s_waitcnt lgkmcnt(0)
Mvaa 184,28,212
Mvaa 188,28,216
s_cmp_lt_u32 s43, 1
s_cbranch_scc1 fl_px_spin
fl_xgo:
s_waitcnt vmcnt(0)
s_mov_b32 s42, 0xffff0000
v_lshlrev_b32 v32, 16, v64
v_and_b32 v33, s42, v64
v_lshlrev_b32 v34, 16, v65
v_and_b32 v35, s42, v65
v_pk_add_f32 v[160:161], v[160:161], v[32:33]
v_pk_add_f32 v[162:163], v[162:163], v[34:35]
v_lshlrev_b32 v32, 16, v66
v_and_b32 v33, s42, v66
v_lshlrev_b32 v34, 16, v67
v_and_b32 v35, s42, v67
v_pk_add_f32 v[168:169], v[168:169], v[32:33]
v_pk_add_f32 v[170:171], v[170:171], v[34:35]
v_cvt_pk_bf16_f32 v136, v160, v161
v_cvt_pk_bf16_f32 v137, v162, v163
v_cvt_pk_bf16_f32 v138, v168, v169
v_cvt_pk_bf16_f32 v139, v170, v171
v_lshlrev_b32 v32, 16, v68
v_and_b32 v33, s42, v68
v_lshlrev_b32 v34, 16, v69
v_and_b32 v35, s42, v69
v_pk_add_f32 v[164:165], v[164:165], v[32:33]
v_pk_add_f32 v[166:167], v[166:167], v[34:35]
v_lshlrev_b32 v32, 16, v70
v_and_b32 v33, s42, v70
v_lshlrev_b32 v34, 16, v71
v_and_b32 v35, s42, v71
v_pk_add_f32 v[172:173], v[172:173], v[32:33]
v_pk_add_f32 v[174:175], v[174:175], v[34:35]
v_cvt_pk_bf16_f32 v140, v164, v165
v_cvt_pk_bf16_f32 v141, v166, v167
v_cvt_pk_bf16_f32 v142, v172, v173
v_cvt_pk_bf16_f32 v143, v174, v175
v_permlane32_swap_b32 v136, v138
v_permlane32_swap_b32 v137, v139
v_permlane32_swap_b32 v140, v142
v_permlane32_swap_b32 v141, v143
v_permlane16_swap_b32 v136, v138
v_permlane16_swap_b32 v137, v139
v_permlane16_swap_b32 v140, v142
v_permlane16_swap_b32 v141, v143
s_mov_b32 s41, 0
buffer_store_dwordx4 v[136:139], v22, s[28:31], s41 offen nt
s_mov_b32 s41, 0x10000
buffer_store_dwordx4 v[140:143], v22, s[28:31], s41 offen nt
v_lshlrev_b32 v32, 16, v72
v_and_b32 v33, s42, v72
v_lshlrev_b32 v34, 16, v73
v_and_b32 v35, s42, v73
v_pk_add_f32 v[176:177], v[176:177], v[32:33]
v_pk_add_f32 v[178:179], v[178:179], v[34:35]
v_lshlrev_b32 v32, 16, v74
v_and_b32 v33, s42, v74
v_lshlrev_b32 v34, 16, v75
v_and_b32 v35, s42, v75
v_pk_add_f32 v[184:185], v[184:185], v[32:33]
v_pk_add_f32 v[186:187], v[186:187], v[34:35]
v_cvt_pk_bf16_f32 v144, v176, v177
v_cvt_pk_bf16_f32 v145, v178, v179
v_cvt_pk_bf16_f32 v146, v184, v185
v_cvt_pk_bf16_f32 v147, v186, v187
v_lshlrev_b32 v32, 16, v76
v_and_b32 v33, s42, v76
v_lshlrev_b32 v34, 16, v77
v_and_b32 v35, s42, v77
v_pk_add_f32 v[180:181], v[180:181], v[32:33]
v_pk_add_f32 v[182:183], v[182:183], v[34:35]
v_lshlrev_b32 v32, 16, v78
v_and_b32 v33, s42, v78
v_lshlrev_b32 v34, 16, v79
v_and_b32 v35, s42, v79
v_pk_add_f32 v[188:189], v[188:189], v[32:33]
v_pk_add_f32 v[190:191], v[190:191], v[34:35]
v_cvt_pk_bf16_f32 v148, v180, v181
v_cvt_pk_bf16_f32 v149, v182, v183
v_cvt_pk_bf16_f32 v150, v188, v189
v_cvt_pk_bf16_f32 v151, v190, v191
v_permlane32_swap_b32 v144, v146
v_permlane32_swap_b32 v145, v147
v_permlane32_swap_b32 v148, v150
v_permlane32_swap_b32 v149, v151
v_permlane16_swap_b32 v144, v146
v_permlane16_swap_b32 v145, v147
v_permlane16_swap_b32 v148, v150
v_permlane16_swap_b32 v149, v151
s_mov_b32 s41, 0
buffer_store_dwordx4 v[144:147], v22, s[28:31], s41 offen offset:64 nt
s_mov_b32 s41, 0x10000
buffer_store_dwordx4 v[148:151], v22, s[28:31], s41 offen offset:64 nt
s_endpgm
fl_pr_spin:
s_mov_b32 s42, 0
fl_pr_l:
s_sleep 4
buffer_load_dword v30, v28, s[36:39], s58 offen sc1
s_waitcnt vmcnt(0)
v_readfirstlane_b32 s41, v30
s_add_u32 s42, s42, 1
s_cmp_ge_u32 s42, 0x30d40
s_cbranch_scc1 fl_pr_ok
s_cmp_lt_u32 s41, 1
s_cbranch_scc1 fl_pr_l
s_branch fl_pr_ok
fl_slow0:
s_waitcnt vmcnt(0) lgkmcnt(0)
v_and_b32 v2, 15, v1
v_lshrrev_b32 v3, 4, v1
v_lshlrev_b32 v5, 8, v2
v_lshl_add_u32 v5, v3, 4, v5
v_lshlrev_b32 v13, 10, v3
v_lshl_add_u32 v13, v2, 1, v13
v_mov_b32 v2, 0xff800000
v_mov_b32 v3, 0xff800000
s_mov_b32 s41, 0
fl_s10:
s_add_u32 s42, s41, 0
buffer_load_dwordx4 a[32:35], v5, s[12:15], s42 offen
buffer_load_dwordx4 a[36:39], v5, s[12:15], s42 offen offset:64
buffer_load_dwordx4 a[40:43], v5, s[12:15], s42 offen offset:128
buffer_load_dwordx4 a[44:47], v5, s[12:15], s42 offen offset:192
s_add_u32 s42, s41, 0x1000
buffer_load_dwordx4 a[48:51], v5, s[12:15], s42 offen
buffer_load_dwordx4 a[52:55], v5, s[12:15], s42 offen offset:64
buffer_load_dwordx4 a[56:59], v5, s[12:15], s42 offen offset:128
buffer_load_dwordx4 a[60:63], v5, s[12:15], s42 offen offset:192
s_waitcnt vmcnt(0)
Zvav 136,32,64
Zvav 144,32,68
Mvav 136,36,72
Mvav 144,36,76
Mvav 136,40,80
Mvav 144,40,84
Mvav 136,44,88
Mvav 144,44,92
Zvav 140,48,64
Zvav 148,48,68
Mvav 140,52,72
Mvav 148,52,76
Mvav 140,56,80
Mvav 148,56,84
Mvav 140,60,88
Mvav 148,60,92
s_nop 7
v_max3_f32 v2, v2, v136, v137
v_max3_f32 v2, v2, v138, v139
v_max3_f32 v2, v2, v140, v141
v_max3_f32 v2, v2, v142, v143
v_max3_f32 v3, v3, v144, v145
v_max3_f32 v3, v3, v146, v147
v_max3_f32 v3, v3, v148, v149
v_max3_f32 v3, v3, v150, v151
s_add_u32 s41, s41, 0x2000
s_cmp_lt_u32 s41, 0x20000
s_cbranch_scc1 fl_s10
v_mov_b32 v32, v2
s_nop 1
v_permlane32_swap_b32 v32, v2
v_max_f32 v2, v32, v2
v_mov_b32 v32, v2
s_nop 1
v_permlane16_swap_b32 v32, v2
v_max_f32 v2, v32, v2
v_mov_b32 v52, 0
v_mov_b32 v53, 0
v_mov_b32 v54, 0
v_mov_b32 v55, 0
v_mov_b32 v32, v3
s_nop 1
v_permlane32_swap_b32 v32, v3
v_max_f32 v3, v32, v3
v_mov_b32 v32, v3
s_nop 1
v_permlane16_swap_b32 v32, v3
v_max_f32 v3, v32, v3
v_mov_b32 v56, 0
v_mov_b32 v57, 0
v_mov_b32 v58, 0
v_mov_b32 v59, 0
v_mov_b32 v160, 0
v_mov_b32 v161, 0
v_mov_b32 v162, 0
v_mov_b32 v163, 0
v_mov_b32 v164, 0
v_mov_b32 v165, 0
v_mov_b32 v166, 0
v_mov_b32 v167, 0
v_mov_b32 v168, 0
v_mov_b32 v169, 0
v_mov_b32 v170, 0
v_mov_b32 v171, 0
v_mov_b32 v172, 0
v_mov_b32 v173, 0
v_mov_b32 v174, 0
v_mov_b32 v175, 0
v_mov_b32 v176, 0
v_mov_b32 v177, 0
v_mov_b32 v178, 0
v_mov_b32 v179, 0
v_mov_b32 v180, 0
v_mov_b32 v181, 0
v_mov_b32 v182, 0
v_mov_b32 v183, 0
v_mov_b32 v184, 0
v_mov_b32 v185, 0
v_mov_b32 v186, 0
v_mov_b32 v187, 0
v_mov_b32 v188, 0
v_mov_b32 v189, 0
v_mov_b32 v190, 0
v_mov_b32 v191, 0
v_mov_b32 v192, 0
v_mov_b32 v193, 0
v_mov_b32 v194, 0
v_mov_b32 v195, 0
v_mov_b32 v196, 0
v_mov_b32 v197, 0
v_mov_b32 v198, 0
v_mov_b32 v199, 0
v_mov_b32 v200, 0
v_mov_b32 v201, 0
v_mov_b32 v202, 0
v_mov_b32 v203, 0
v_mov_b32 v204, 0
v_mov_b32 v205, 0
v_mov_b32 v206, 0
v_mov_b32 v207, 0
v_mov_b32 v208, 0
v_mov_b32 v209, 0
v_mov_b32 v210, 0
v_mov_b32 v211, 0
v_mov_b32 v212, 0
v_mov_b32 v213, 0
v_mov_b32 v214, 0
v_mov_b32 v215, 0
v_mov_b32 v216, 0
v_mov_b32 v217, 0
v_mov_b32 v218, 0
v_mov_b32 v219, 0
v_mov_b32 v220, 0
v_mov_b32 v221, 0
v_mov_b32 v222, 0
v_mov_b32 v223, 0
s_mov_b32 s41, 0
fl_s20:
s_add_u32 s42, s41, 0
buffer_load_dwordx4 a[32:35], v5, s[12:15], s42 offen
buffer_load_dwordx4 a[36:39], v5, s[12:15], s42 offen offset:64
buffer_load_dwordx4 a[40:43], v5, s[12:15], s42 offen offset:128
buffer_load_dwordx4 a[44:47], v5, s[12:15], s42 offen offset:192
s_add_u32 s42, s41, 0x1000
buffer_load_dwordx4 a[48:51], v5, s[12:15], s42 offen
buffer_load_dwordx4 a[52:55], v5, s[12:15], s42 offen offset:64
buffer_load_dwordx4 a[56:59], v5, s[12:15], s42 offen offset:128
buffer_load_dwordx4 a[60:63], v5, s[12:15], s42 offen offset:192
s_waitcnt vmcnt(0)
Zvav 136,32,64
Zvav 144,32,68
Mvav 136,36,72
Mvav 144,36,76
Mvav 136,40,80
Mvav 144,40,84
Mvav 136,44,88
Mvav 144,44,92
Zvav 140,48,64
Zvav 148,48,68
Mvav 140,52,72
Mvav 148,52,76
Mvav 140,56,80
Mvav 148,56,84
Mvav 140,60,88
Mvav 148,60,92
s_nop 7
v_sub_f32 v136, v136, v2
v_sub_f32 v137, v137, v2
v_sub_f32 v138, v138, v2
v_sub_f32 v139, v139, v2
v_sub_f32 v140, v140, v2
v_sub_f32 v141, v141, v2
v_sub_f32 v142, v142, v2
v_sub_f32 v143, v143, v2
v_sub_f32 v144, v144, v3
v_sub_f32 v145, v145, v3
v_sub_f32 v146, v146, v3
v_sub_f32 v147, v147, v3
v_sub_f32 v148, v148, v3
v_sub_f32 v149, v149, v3
v_sub_f32 v150, v150, v3
v_sub_f32 v151, v151, v3
v_exp_f32 v136, v136
v_exp_f32 v137, v137
v_exp_f32 v138, v138
v_exp_f32 v139, v139
v_exp_f32 v144, v144
v_exp_f32 v145, v145
v_exp_f32 v146, v146
v_exp_f32 v147, v147
v_exp_f32 v140, v140
v_exp_f32 v141, v141
v_exp_f32 v142, v142
v_exp_f32 v143, v143
v_exp_f32 v148, v148
v_exp_f32 v149, v149
v_exp_f32 v150, v150
v_exp_f32 v151, v151
v_cvt_pk_bf16_f32 v139, v138, v139
v_cvt_pk_bf16_f32 v138, v136, v137
v_cvt_pk_bf16_f32 v140, v140, v141
v_cvt_pk_bf16_f32 v141, v142, v143
v_cvt_pk_bf16_f32 v147, v146, v147
v_cvt_pk_bf16_f32 v146, v144, v145
v_cvt_pk_bf16_f32 v148, v148, v149
v_cvt_pk_bf16_f32 v149, v150, v151
s_add_u32 s42, s41, 0
buffer_load_ushort v32, v13, s[16:19], s42 offen offset:0
buffer_load_ushort v33, v13, s[16:19], s42 offen offset:256
buffer_load_ushort v34, v13, s[16:19], s42 offen offset:512
buffer_load_ushort v35, v13, s[16:19], s42 offen offset:768
s_add_u32 s42, s41, 0x1000
buffer_load_ushort v36, v13, s[16:19], s42 offen offset:0
buffer_load_ushort v37, v13, s[16:19], s42 offen offset:256
buffer_load_ushort v38, v13, s[16:19], s42 offen offset:512
buffer_load_ushort v39, v13, s[16:19], s42 offen offset:768
s_waitcnt vmcnt(0)
v_lshl_or_b32 v6, v33, 16, v32
v_lshl_or_b32 v7, v35, 16, v34
v_lshl_or_b32 v8, v37, 16, v36
v_lshl_or_b32 v9, v39, 16, v38
s_nop 1
Mvvv 160,6,138
Mvvv 168,6,146
s_nop 7
s_add_u32 s42, s41, 0
buffer_load_ushort v32, v13, s[16:19], s42 offen offset:32
buffer_load_ushort v33, v13, s[16:19], s42 offen offset:288
buffer_load_ushort v34, v13, s[16:19], s42 offen offset:544
buffer_load_ushort v35, v13, s[16:19], s42 offen offset:800
s_add_u32 s42, s41, 0x1000
buffer_load_ushort v36, v13, s[16:19], s42 offen offset:32
buffer_load_ushort v37, v13, s[16:19], s42 offen offset:288
buffer_load_ushort v38, v13, s[16:19], s42 offen offset:544
buffer_load_ushort v39, v13, s[16:19], s42 offen offset:800
s_waitcnt vmcnt(0)
v_lshl_or_b32 v6, v33, 16, v32
v_lshl_or_b32 v7, v35, 16, v34
v_lshl_or_b32 v8, v37, 16, v36
v_lshl_or_b32 v9, v39, 16, v38
s_nop 1
Mvvv 164,6,138
Mvvv 172,6,146
s_nop 7
s_add_u32 s42, s41, 0
buffer_load_ushort v32, v13, s[16:19], s42 offen offset:64
buffer_load_ushort v33, v13, s[16:19], s42 offen offset:320
buffer_load_ushort v34, v13, s[16:19], s42 offen offset:576
buffer_load_ushort v35, v13, s[16:19], s42 offen offset:832
s_add_u32 s42, s41, 0x1000
buffer_load_ushort v36, v13, s[16:19], s42 offen offset:64
buffer_load_ushort v37, v13, s[16:19], s42 offen offset:320
buffer_load_ushort v38, v13, s[16:19], s42 offen offset:576
buffer_load_ushort v39, v13, s[16:19], s42 offen offset:832
s_waitcnt vmcnt(0)
v_lshl_or_b32 v6, v33, 16, v32
v_lshl_or_b32 v7, v35, 16, v34
v_lshl_or_b32 v8, v37, 16, v36
v_lshl_or_b32 v9, v39, 16, v38
s_nop 1
Mvvv 176,6,138
Mvvv 184,6,146
s_nop 7
s_add_u32 s42, s41, 0
buffer_load_ushort v32, v13, s[16:19], s42 offen offset:96
buffer_load_ushort v33, v13, s[16:19], s42 offen offset:352
buffer_load_ushort v34, v13, s[16:19], s42 offen offset:608
buffer_load_ushort v35, v13, s[16:19], s42 offen offset:864
s_add_u32 s42, s41, 0x1000
buffer_load_ushort v36, v13, s[16:19], s42 offen offset:96
buffer_load_ushort v37, v13, s[16:19], s42 offen offset:352
buffer_load_ushort v38, v13, s[16:19], s42 offen offset:608
buffer_load_ushort v39, v13, s[16:19], s42 offen offset:864
s_waitcnt vmcnt(0)
v_lshl_or_b32 v6, v33, 16, v32
v_lshl_or_b32 v7, v35, 16, v34
v_lshl_or_b32 v8, v37, 16, v36
v_lshl_or_b32 v9, v39, 16, v38
s_nop 1
Mvvv 180,6,138
Mvvv 188,6,146
s_nop 7
s_add_u32 s42, s41, 0
buffer_load_ushort v32, v13, s[16:19], s42 offen offset:128
buffer_load_ushort v33, v13, s[16:19], s42 offen offset:384
buffer_load_ushort v34, v13, s[16:19], s42 offen offset:640
buffer_load_ushort v35, v13, s[16:19], s42 offen offset:896
s_add_u32 s42, s41, 0x1000
buffer_load_ushort v36, v13, s[16:19], s42 offen offset:128
buffer_load_ushort v37, v13, s[16:19], s42 offen offset:384
buffer_load_ushort v38, v13, s[16:19], s42 offen offset:640
buffer_load_ushort v39, v13, s[16:19], s42 offen offset:896
s_waitcnt vmcnt(0)
v_lshl_or_b32 v6, v33, 16, v32
v_lshl_or_b32 v7, v35, 16, v34
v_lshl_or_b32 v8, v37, 16, v36
v_lshl_or_b32 v9, v39, 16, v38
s_nop 1
Mvvv 192,6,138
Mvvv 200,6,146
s_nop 7
s_add_u32 s42, s41, 0
buffer_load_ushort v32, v13, s[16:19], s42 offen offset:160
buffer_load_ushort v33, v13, s[16:19], s42 offen offset:416
buffer_load_ushort v34, v13, s[16:19], s42 offen offset:672
buffer_load_ushort v35, v13, s[16:19], s42 offen offset:928
s_add_u32 s42, s41, 0x1000
buffer_load_ushort v36, v13, s[16:19], s42 offen offset:160
buffer_load_ushort v37, v13, s[16:19], s42 offen offset:416
buffer_load_ushort v38, v13, s[16:19], s42 offen offset:672
buffer_load_ushort v39, v13, s[16:19], s42 offen offset:928
s_waitcnt vmcnt(0)
v_lshl_or_b32 v6, v33, 16, v32
v_lshl_or_b32 v7, v35, 16, v34
v_lshl_or_b32 v8, v37, 16, v36
v_lshl_or_b32 v9, v39, 16, v38
s_nop 1
Mvvv 196,6,138
Mvvv 204,6,146
s_nop 7
s_add_u32 s42, s41, 0
buffer_load_ushort v32, v13, s[16:19], s42 offen offset:192
buffer_load_ushort v33, v13, s[16:19], s42 offen offset:448
buffer_load_ushort v34, v13, s[16:19], s42 offen offset:704
buffer_load_ushort v35, v13, s[16:19], s42 offen offset:960
s_add_u32 s42, s41, 0x1000
buffer_load_ushort v36, v13, s[16:19], s42 offen offset:192
buffer_load_ushort v37, v13, s[16:19], s42 offen offset:448
buffer_load_ushort v38, v13, s[16:19], s42 offen offset:704
buffer_load_ushort v39, v13, s[16:19], s42 offen offset:960
s_waitcnt vmcnt(0)
v_lshl_or_b32 v6, v33, 16, v32
v_lshl_or_b32 v7, v35, 16, v34
v_lshl_or_b32 v8, v37, 16, v36
v_lshl_or_b32 v9, v39, 16, v38
s_nop 1
Mvvv 208,6,138
Mvvv 216,6,146
s_nop 7
s_add_u32 s42, s41, 0
buffer_load_ushort v32, v13, s[16:19], s42 offen offset:224
buffer_load_ushort v33, v13, s[16:19], s42 offen offset:480
buffer_load_ushort v34, v13, s[16:19], s42 offen offset:736
buffer_load_ushort v35, v13, s[16:19], s42 offen offset:992
s_add_u32 s42, s41, 0x1000
buffer_load_ushort v36, v13, s[16:19], s42 offen offset:224
buffer_load_ushort v37, v13, s[16:19], s42 offen offset:480
buffer_load_ushort v38, v13, s[16:19], s42 offen offset:736
buffer_load_ushort v39, v13, s[16:19], s42 offen offset:992
s_waitcnt vmcnt(0)
v_lshl_or_b32 v6, v33, 16, v32
v_lshl_or_b32 v7, v35, 16, v34
v_lshl_or_b32 v8, v37, 16, v36
v_lshl_or_b32 v9, v39, 16, v38
s_nop 1
Mvvv 212,6,138
Mvvv 220,6,146
s_nop 7
Mvvv 52,24,138
Mvvv 56,24,146
s_nop 7
s_add_u32 s41, s41, 0x2000
s_cmp_lt_u32 s41, 0x20000
s_cbranch_scc1 fl_s20
s_nop 7
v_rcp_f32 v32, v52
v_rcp_f32 v34, v56
s_nop 1
s_branch fl_norm0
fl_p0_spin:
s_mov_b32 s42, 0
fl_p0_l:
s_sleep 4
buffer_load_dword v30, v28, s[20:23], s32 offen sc1
s_waitcnt vmcnt(0)
v_readfirstlane_b32 s41, v30
s_add_u32 s42, s42, 1
s_cmp_ge_u32 s42, 0x30d40
s_cbranch_scc1 fl_p0_ok
s_cmp_lt_u32 s41, 16
s_cbranch_scc1 fl_p0_l
s_branch fl_p0_ok
fl_slow1:
s_waitcnt vmcnt(0) lgkmcnt(0)
v_and_b32 v2, 15, v1
v_lshrrev_b32 v3, 4, v1
v_lshlrev_b32 v5, 8, v2
v_lshl_add_u32 v5, v3, 4, v5
v_lshlrev_b32 v13, 10, v3
v_lshl_add_u32 v13, v2, 1, v13
v_mov_b32 v2, 0xff800000
v_mov_b32 v3, 0xff800000
s_mov_b32 s41, 0x20000
fl_s11:
s_add_u32 s42, s41, 0
buffer_load_dwordx4 a[32:35], v5, s[12:15], s42 offen
buffer_load_dwordx4 a[36:39], v5, s[12:15], s42 offen offset:64
buffer_load_dwordx4 a[40:43], v5, s[12:15], s42 offen offset:128
buffer_load_dwordx4 a[44:47], v5, s[12:15], s42 offen offset:192
s_add_u32 s42, s41, 0x1000
buffer_load_dwordx4 a[48:51], v5, s[12:15], s42 offen
buffer_load_dwordx4 a[52:55], v5, s[12:15], s42 offen offset:64
buffer_load_dwordx4 a[56:59], v5, s[12:15], s42 offen offset:128
buffer_load_dwordx4 a[60:63], v5, s[12:15], s42 offen offset:192
s_waitcnt vmcnt(0)
Zvaa 136,32,80
Zvaa 144,32,84
Mvaa 136,36,88
Mvaa 144,36,92
Mvaa 136,40,96
Mvaa 144,40,100
Mvaa 136,44,104
Mvaa 144,44,108
Zvaa 140,48,80
Zvaa 148,48,84
Mvaa 140,52,88
Mvaa 148,52,92
Mvaa 140,56,96
Mvaa 148,56,100
Mvaa 140,60,104
Mvaa 148,60,108
s_nop 7
v_max3_f32 v2, v2, v136, v137
v_max3_f32 v2, v2, v138, v139
v_max3_f32 v2, v2, v140, v141
v_max3_f32 v2, v2, v142, v143
v_max3_f32 v3, v3, v144, v145
v_max3_f32 v3, v3, v146, v147
v_max3_f32 v3, v3, v148, v149
v_max3_f32 v3, v3, v150, v151
s_add_u32 s41, s41, 0x2000
s_cmp_lt_u32 s41, 0x40000
s_cbranch_scc1 fl_s11
v_mov_b32 v32, v2
s_nop 1
v_permlane32_swap_b32 v32, v2
v_max_f32 v2, v32, v2
v_mov_b32 v32, v2
s_nop 1
v_permlane16_swap_b32 v32, v2
v_max_f32 v2, v32, v2
v_mov_b32 v52, 0
v_mov_b32 v53, 0
v_mov_b32 v54, 0
v_mov_b32 v55, 0
v_mov_b32 v32, v3
s_nop 1
v_permlane32_swap_b32 v32, v3
v_max_f32 v3, v32, v3
v_mov_b32 v32, v3
s_nop 1
v_permlane16_swap_b32 v32, v3
v_max_f32 v3, v32, v3
v_mov_b32 v56, 0
v_mov_b32 v57, 0
v_mov_b32 v58, 0
v_mov_b32 v59, 0
v_mov_b32 v160, 0
v_mov_b32 v161, 0
v_mov_b32 v162, 0
v_mov_b32 v163, 0
v_mov_b32 v164, 0
v_mov_b32 v165, 0
v_mov_b32 v166, 0
v_mov_b32 v167, 0
v_mov_b32 v168, 0
v_mov_b32 v169, 0
v_mov_b32 v170, 0
v_mov_b32 v171, 0
v_mov_b32 v172, 0
v_mov_b32 v173, 0
v_mov_b32 v174, 0
v_mov_b32 v175, 0
v_mov_b32 v176, 0
v_mov_b32 v177, 0
v_mov_b32 v178, 0
v_mov_b32 v179, 0
v_mov_b32 v180, 0
v_mov_b32 v181, 0
v_mov_b32 v182, 0
v_mov_b32 v183, 0
v_mov_b32 v184, 0
v_mov_b32 v185, 0
v_mov_b32 v186, 0
v_mov_b32 v187, 0
v_mov_b32 v188, 0
v_mov_b32 v189, 0
v_mov_b32 v190, 0
v_mov_b32 v191, 0
v_mov_b32 v192, 0
v_mov_b32 v193, 0
v_mov_b32 v194, 0
v_mov_b32 v195, 0
v_mov_b32 v196, 0
v_mov_b32 v197, 0
v_mov_b32 v198, 0
v_mov_b32 v199, 0
v_mov_b32 v200, 0
v_mov_b32 v201, 0
v_mov_b32 v202, 0
v_mov_b32 v203, 0
v_mov_b32 v204, 0
v_mov_b32 v205, 0
v_mov_b32 v206, 0
v_mov_b32 v207, 0
v_mov_b32 v208, 0
v_mov_b32 v209, 0
v_mov_b32 v210, 0
v_mov_b32 v211, 0
v_mov_b32 v212, 0
v_mov_b32 v213, 0
v_mov_b32 v214, 0
v_mov_b32 v215, 0
v_mov_b32 v216, 0
v_mov_b32 v217, 0
v_mov_b32 v218, 0
v_mov_b32 v219, 0
v_mov_b32 v220, 0
v_mov_b32 v221, 0
v_mov_b32 v222, 0
v_mov_b32 v223, 0
s_mov_b32 s41, 0x20000
fl_s21:
s_add_u32 s42, s41, 0
buffer_load_dwordx4 a[32:35], v5, s[12:15], s42 offen
buffer_load_dwordx4 a[36:39], v5, s[12:15], s42 offen offset:64
buffer_load_dwordx4 a[40:43], v5, s[12:15], s42 offen offset:128
buffer_load_dwordx4 a[44:47], v5, s[12:15], s42 offen offset:192
s_add_u32 s42, s41, 0x1000
buffer_load_dwordx4 a[48:51], v5, s[12:15], s42 offen
buffer_load_dwordx4 a[52:55], v5, s[12:15], s42 offen offset:64
buffer_load_dwordx4 a[56:59], v5, s[12:15], s42 offen offset:128
buffer_load_dwordx4 a[60:63], v5, s[12:15], s42 offen offset:192
s_waitcnt vmcnt(0)
Zvaa 136,32,80
Zvaa 144,32,84
Mvaa 136,36,88
Mvaa 144,36,92
Mvaa 136,40,96
Mvaa 144,40,100
Mvaa 136,44,104
Mvaa 144,44,108
Zvaa 140,48,80
Zvaa 148,48,84
Mvaa 140,52,88
Mvaa 148,52,92
Mvaa 140,56,96
Mvaa 148,56,100
Mvaa 140,60,104
Mvaa 148,60,108
s_nop 7
v_sub_f32 v136, v136, v2
v_sub_f32 v137, v137, v2
v_sub_f32 v138, v138, v2
v_sub_f32 v139, v139, v2
v_sub_f32 v140, v140, v2
v_sub_f32 v141, v141, v2
v_sub_f32 v142, v142, v2
v_sub_f32 v143, v143, v2
v_sub_f32 v144, v144, v3
v_sub_f32 v145, v145, v3
v_sub_f32 v146, v146, v3
v_sub_f32 v147, v147, v3
v_sub_f32 v148, v148, v3
v_sub_f32 v149, v149, v3
v_sub_f32 v150, v150, v3
v_sub_f32 v151, v151, v3
v_exp_f32 v136, v136
v_exp_f32 v137, v137
v_exp_f32 v138, v138
v_exp_f32 v139, v139
v_exp_f32 v144, v144
v_exp_f32 v145, v145
v_exp_f32 v146, v146
v_exp_f32 v147, v147
v_exp_f32 v140, v140
v_exp_f32 v141, v141
v_exp_f32 v142, v142
v_exp_f32 v143, v143
v_exp_f32 v148, v148
v_exp_f32 v149, v149
v_exp_f32 v150, v150
v_exp_f32 v151, v151
v_cvt_pk_bf16_f32 v139, v138, v139
v_cvt_pk_bf16_f32 v138, v136, v137
v_cvt_pk_bf16_f32 v140, v140, v141
v_cvt_pk_bf16_f32 v141, v142, v143
v_cvt_pk_bf16_f32 v147, v146, v147
v_cvt_pk_bf16_f32 v146, v144, v145
v_cvt_pk_bf16_f32 v148, v148, v149
v_cvt_pk_bf16_f32 v149, v150, v151
s_add_u32 s42, s41, 0
buffer_load_ushort v32, v13, s[16:19], s42 offen offset:0
buffer_load_ushort v33, v13, s[16:19], s42 offen offset:256
buffer_load_ushort v34, v13, s[16:19], s42 offen offset:512
buffer_load_ushort v35, v13, s[16:19], s42 offen offset:768
s_add_u32 s42, s41, 0x1000
buffer_load_ushort v36, v13, s[16:19], s42 offen offset:0
buffer_load_ushort v37, v13, s[16:19], s42 offen offset:256
buffer_load_ushort v38, v13, s[16:19], s42 offen offset:512
buffer_load_ushort v39, v13, s[16:19], s42 offen offset:768
s_waitcnt vmcnt(0)
v_lshl_or_b32 v6, v33, 16, v32
v_lshl_or_b32 v7, v35, 16, v34
v_lshl_or_b32 v8, v37, 16, v36
v_lshl_or_b32 v9, v39, 16, v38
s_nop 1
Mvvv 160,6,138
Mvvv 168,6,146
s_nop 7
s_add_u32 s42, s41, 0
buffer_load_ushort v32, v13, s[16:19], s42 offen offset:32
buffer_load_ushort v33, v13, s[16:19], s42 offen offset:288
buffer_load_ushort v34, v13, s[16:19], s42 offen offset:544
buffer_load_ushort v35, v13, s[16:19], s42 offen offset:800
s_add_u32 s42, s41, 0x1000
buffer_load_ushort v36, v13, s[16:19], s42 offen offset:32
buffer_load_ushort v37, v13, s[16:19], s42 offen offset:288
buffer_load_ushort v38, v13, s[16:19], s42 offen offset:544
buffer_load_ushort v39, v13, s[16:19], s42 offen offset:800
s_waitcnt vmcnt(0)
v_lshl_or_b32 v6, v33, 16, v32
v_lshl_or_b32 v7, v35, 16, v34
v_lshl_or_b32 v8, v37, 16, v36
v_lshl_or_b32 v9, v39, 16, v38
s_nop 1
Mvvv 164,6,138
Mvvv 172,6,146
s_nop 7
s_add_u32 s42, s41, 0
buffer_load_ushort v32, v13, s[16:19], s42 offen offset:64
buffer_load_ushort v33, v13, s[16:19], s42 offen offset:320
buffer_load_ushort v34, v13, s[16:19], s42 offen offset:576
buffer_load_ushort v35, v13, s[16:19], s42 offen offset:832
s_add_u32 s42, s41, 0x1000
buffer_load_ushort v36, v13, s[16:19], s42 offen offset:64
buffer_load_ushort v37, v13, s[16:19], s42 offen offset:320
buffer_load_ushort v38, v13, s[16:19], s42 offen offset:576
buffer_load_ushort v39, v13, s[16:19], s42 offen offset:832
s_waitcnt vmcnt(0)
v_lshl_or_b32 v6, v33, 16, v32
v_lshl_or_b32 v7, v35, 16, v34
v_lshl_or_b32 v8, v37, 16, v36
v_lshl_or_b32 v9, v39, 16, v38
s_nop 1
Mvvv 176,6,138
Mvvv 184,6,146
s_nop 7
s_add_u32 s42, s41, 0
buffer_load_ushort v32, v13, s[16:19], s42 offen offset:96
buffer_load_ushort v33, v13, s[16:19], s42 offen offset:352
buffer_load_ushort v34, v13, s[16:19], s42 offen offset:608
buffer_load_ushort v35, v13, s[16:19], s42 offen offset:864
s_add_u32 s42, s41, 0x1000
buffer_load_ushort v36, v13, s[16:19], s42 offen offset:96
buffer_load_ushort v37, v13, s[16:19], s42 offen offset:352
buffer_load_ushort v38, v13, s[16:19], s42 offen offset:608
buffer_load_ushort v39, v13, s[16:19], s42 offen offset:864
s_waitcnt vmcnt(0)
v_lshl_or_b32 v6, v33, 16, v32
v_lshl_or_b32 v7, v35, 16, v34
v_lshl_or_b32 v8, v37, 16, v36
v_lshl_or_b32 v9, v39, 16, v38
s_nop 1
Mvvv 180,6,138
Mvvv 188,6,146
s_nop 7
s_add_u32 s42, s41, 0
buffer_load_ushort v32, v13, s[16:19], s42 offen offset:128
buffer_load_ushort v33, v13, s[16:19], s42 offen offset:384
buffer_load_ushort v34, v13, s[16:19], s42 offen offset:640
buffer_load_ushort v35, v13, s[16:19], s42 offen offset:896
s_add_u32 s42, s41, 0x1000
buffer_load_ushort v36, v13, s[16:19], s42 offen offset:128
buffer_load_ushort v37, v13, s[16:19], s42 offen offset:384
buffer_load_ushort v38, v13, s[16:19], s42 offen offset:640
buffer_load_ushort v39, v13, s[16:19], s42 offen offset:896
s_waitcnt vmcnt(0)
v_lshl_or_b32 v6, v33, 16, v32
v_lshl_or_b32 v7, v35, 16, v34
v_lshl_or_b32 v8, v37, 16, v36
v_lshl_or_b32 v9, v39, 16, v38
s_nop 1
Mvvv 192,6,138
Mvvv 200,6,146
s_nop 7
s_add_u32 s42, s41, 0
buffer_load_ushort v32, v13, s[16:19], s42 offen offset:160
buffer_load_ushort v33, v13, s[16:19], s42 offen offset:416
buffer_load_ushort v34, v13, s[16:19], s42 offen offset:672
buffer_load_ushort v35, v13, s[16:19], s42 offen offset:928
s_add_u32 s42, s41, 0x1000
buffer_load_ushort v36, v13, s[16:19], s42 offen offset:160
buffer_load_ushort v37, v13, s[16:19], s42 offen offset:416
buffer_load_ushort v38, v13, s[16:19], s42 offen offset:672
buffer_load_ushort v39, v13, s[16:19], s42 offen offset:928
s_waitcnt vmcnt(0)
v_lshl_or_b32 v6, v33, 16, v32
v_lshl_or_b32 v7, v35, 16, v34
v_lshl_or_b32 v8, v37, 16, v36
v_lshl_or_b32 v9, v39, 16, v38
s_nop 1
Mvvv 196,6,138
Mvvv 204,6,146
s_nop 7
s_add_u32 s42, s41, 0
buffer_load_ushort v32, v13, s[16:19], s42 offen offset:192
buffer_load_ushort v33, v13, s[16:19], s42 offen offset:448
buffer_load_ushort v34, v13, s[16:19], s42 offen offset:704
buffer_load_ushort v35, v13, s[16:19], s42 offen offset:960
s_add_u32 s42, s41, 0x1000
buffer_load_ushort v36, v13, s[16:19], s42 offen offset:192
buffer_load_ushort v37, v13, s[16:19], s42 offen offset:448
buffer_load_ushort v38, v13, s[16:19], s42 offen offset:704
buffer_load_ushort v39, v13, s[16:19], s42 offen offset:960
s_waitcnt vmcnt(0)
v_lshl_or_b32 v6, v33, 16, v32
v_lshl_or_b32 v7, v35, 16, v34
v_lshl_or_b32 v8, v37, 16, v36
v_lshl_or_b32 v9, v39, 16, v38
s_nop 1
Mvvv 208,6,138
Mvvv 216,6,146
s_nop 7
s_add_u32 s42, s41, 0
buffer_load_ushort v32, v13, s[16:19], s42 offen offset:224
buffer_load_ushort v33, v13, s[16:19], s42 offen offset:480
buffer_load_ushort v34, v13, s[16:19], s42 offen offset:736
buffer_load_ushort v35, v13, s[16:19], s42 offen offset:992
s_add_u32 s42, s41, 0x1000
buffer_load_ushort v36, v13, s[16:19], s42 offen offset:224
buffer_load_ushort v37, v13, s[16:19], s42 offen offset:480
buffer_load_ushort v38, v13, s[16:19], s42 offen offset:736
buffer_load_ushort v39, v13, s[16:19], s42 offen offset:992
s_waitcnt vmcnt(0)
v_lshl_or_b32 v6, v33, 16, v32
v_lshl_or_b32 v7, v35, 16, v34
v_lshl_or_b32 v8, v37, 16, v36
v_lshl_or_b32 v9, v39, 16, v38
s_nop 1
Mvvv 212,6,138
Mvvv 220,6,146
s_nop 7
Mvvv 52,24,138
Mvvv 56,24,146
s_nop 7
s_add_u32 s41, s41, 0x2000
s_cmp_lt_u32 s41, 0x40000
s_cbranch_scc1 fl_s21
s_nop 7
v_rcp_f32 v32, v52
v_rcp_f32 v34, v56
s_nop 1
s_branch fl_norm1
fl_p1_spin:
s_mov_b32 s42, 0
fl_p1_l:
s_sleep 4
buffer_load_dword v30, v28, s[20:23], s32 offen offset:128 sc1
s_waitcnt vmcnt(0)
v_readfirstlane_b32 s41, v30
s_add_u32 s42, s42, 1
s_cmp_ge_u32 s42, 0x30d40
s_cbranch_scc1 fl_p1_ok
s_cmp_lt_u32 s41, 16
s_cbranch_scc1 fl_p1_l
s_branch fl_p1_ok
fl_px_spin:
s_mov_b32 s42, 0
fl_px_l:
s_sleep 4
buffer_load_dword v30, v28, s[20:23], s61 offen sc1
s_waitcnt vmcnt(0)
v_readfirstlane_b32 s41, v30
s_add_u32 s42, s42, 1
s_cmp_ge_u32 s42, 0x30d40
s_cbranch_scc1 fl_px_ok
s_cmp_lt_u32 s41, 1
s_cbranch_scc1 fl_px_l
fl_px_ok:
buffer_load_dwordx4 v[64:67], v20, s[20:23], s60 offen sc1
buffer_load_dwordx4 v[68:71], v20, s[20:23], s60 offen offset:1024 sc1
buffer_load_dwordx4 v[72:75], v20, s[20:23], s60 offen offset:2048 sc1
buffer_load_dwordx4 v[76:79], v20, s[20:23], s60 offen offset:3072 sc1
s_branch fl_xgo
.p2align 12
.globl concat_heads__mha_block_cached__gqa_block_cached__near_ridge_kernel
.p2align 8
.type concat_heads__mha_block_cached__gqa_block_cached__near_ridge_kernel,@function
concat_heads__mha_block_cached__gqa_block_cached__near_ridge_kernel:
f_hstart:
s_cmp_lt_u32 s2, 0x100
s_cbranch_scc1 f_go
s_endpgm
f_go:
s_load_dwordx16 s[72:87], s[0:1], 0
s_load_dwordx8 s[88:95], s[0:1], 64
s_load_dwordx2 s[96:97], s[0:1], 96
v_and_b32 v1, 63, v0
v_lshrrev_b32 v2, 6, v0
s_nop 0
v_readfirstlane_b32 s40, v2
s_nop 0
s_cmp_eq_u32 s40, 3
s_cbranch_scc1 f_start
s_bfe_u32 s47, s2, 0x10002
s_lshr_b32 s48, s2, 5
s_bfe_u32 s41, s2, 0x20003
s_and_b32 s49, s2, 3
s_lshl_b32 s49, s49, 2
s_add_u32 s49, s49, s41
s_bfe_u32 s50, s2, 0x10001
s_and_b32 s51, s2, 1
s_lshl_b32 s51, s51, 2
s_add_u32 s51, s51, s41
v_and_b32 v2, 15, v1
v_lshrrev_b32 v3, 4, v1
s_and_b32 s41, s40, 1
s_lshl_b32 s41, s41, 1
s_lshr_b32 s42, s40, 1
s_lshl_b32 s42, s42, 3
s_add_u32 s41, s41, s42
s_lshl_b32 s41, s41, 13
v_lshrrev_b32 v4, 5, v1
v_lshlrev_b32 v4, 15, v4
v_and_b32 v5, 31, v1
v_lshl_add_u32 v4, v5, 4, v4
v_add_u32 v6, s41, v4
v_add_u32 v7, 0x20000, v6
v_add_u32 v8, 0x2000, v6
v_add_u32 v9, 0x22000, v6
s_mul_i32 s45, s40, 0x1040
s_mul_i32 s41, s40, 0x18000
v_lshrrev_b32 v4, 3, v1
v_lshlrev_b32 v4, 11, v4
v_add_u32 v4, s41, v4
v_and_b32 v5, 7, v1
v_xor_b32 v5, v3, v5
v_lshl_add_u32 v40, v5, 4, v4
v_xor_b32 v41, 64, v40
v_add_u32 v41, 0x4000, v41
v_add_u32 v42, 0x8000, v40
v_add_u32 v43, 0x8000, v41
v_add_u32 v44, 0x10000, v40
v_add_u32 v45, 0x10000, v41
s_mul_i32 s46, s40, 0x3000
s_add_u32 s46, s46, 0x4200
s_waitcnt lgkmcnt(0)
s_cmp_eq_u32 s47, 0
s_cselect_b64 s[4:5], s[72:73], s[82:83]
s_cselect_b64 s[8:9], s[78:79], s[88:89]
s_cselect_b64 s[12:13], s[74:75], s[84:85]
s_cselect_b64 s[16:17], s[76:77], s[86:87]
s_cselect_b64 s[24:25], s[80:81], s[90:91]
s_lshl_b32 s41, s49, 9
s_add_u32 s8, s8, s41
s_addc_u32 s9, s9, 0
s_sub_u32 s10, 0x800000, s41
s_mov_b32 s11, 0x20000
s_mul_i32 s41, s48, 0x58000
s_add_u32 s4, s4, s41
s_addc_u32 s5, s5, 0
s_mov_b32 s6, 0x58000
s_mov_b32 s7, 0x20000
s_mov_b32 s44, 0
s_add_u32 m0, s45, 0x1ce00
s_nop 0
buffer_load_dwordx4 v6, s[8:11], s44 offen lds
s_add_u32 m0, s45, 0x1d200
s_nop 0
buffer_load_dwordx4 v7, s[8:11], s44 offen lds
s_add_u32 m0, s45, 0x1d608
s_nop 0
buffer_load_dwordx4 v8, s[8:11], s44 offen lds
s_add_u32 m0, s45, 0x1da08
s_nop 0
buffer_load_dwordx4 v9, s[8:11], s44 offen lds
s_add_u32 m0, s46, 0
s_nop 0
buffer_load_dwordx4 v40, s[4:7], 0 offen lds
s_add_u32 m0, s46, 0x400
s_nop 0
buffer_load_dwordx4 v41, s[4:7], 0 offen lds
s_add_u32 m0, s46, 0x800
s_nop 0
buffer_load_dwordx4 v42, s[4:7], 0 offen lds
s_add_u32 m0, s46, 0xc00
s_nop 0
buffer_load_dwordx4 v43, s[4:7], 0 offen lds
s_add_u32 m0, s46, 0x1000
s_nop 0
buffer_load_dwordx4 v44, s[4:7], 0 offen lds
s_add_u32 m0, s46, 0x1400
s_nop 0
buffer_load_dwordx4 v45, s[4:7], 0 offen lds
v_lshrrev_b32 v4, 1, v2
v_xor_b32 v4, v3, v4
v_lshlrev_b32 v5, 7, v2
v_lshl_add_u32 v5, v4, 4, v5
v_add_u32 v46, s46, v5
v_xor_b32 v5, 64, v5
v_add_u32 v47, s46, v5
v_lshrrev_b32 v4, 2, v1
v_and_b32 v4, 7, v4
v_lshlrev_b32 v13, 11, v4
v_lshrrev_b32 v5, 1, v4
v_lshl_add_u32 v13, v5, 6, v13
v_and_b32 v5, 1, v4
v_lshl_add_u32 v13, v5, 3, v13
v_lshrrev_b32 v5, 5, v1
v_lshl_add_u32 v13, v5, 10, v13
v_mul_u32_u24 v17, 0x420, v4
v_lshl_add_u32 v17, v5, 8, v17
v_and_b32 v5, 3, v1
v_lshl_add_u32 v13, v5, 4, v13
v_lshl_add_u32 v17, v5, 3, v17
v_and_b32 v4, 7, v1
v_mul_u32_u24 v15, 0x420, v4
v_lshrrev_b32 v4, 3, v2
v_lshl_add_u32 v15, v4, 8, v15
v_lshl_add_u32 v15, v3, 4, v15
v_lshlrev_b32 v31, 11, v3
v_lshl_add_u32 v31, v2, 4, v31
v_lshlrev_b32 v20, 4, v1
v_add_u32 v12, 0x800, v20
v_add_u32 v21, 0x1000, v20
s_lshl_b32 s41, s40, 9
v_add_u32 v31, s41, v31
s_mul_i32 s52, s40, 0x840
v_add_u32 v0, s52, v20
v_add_u32 v23, 0xe000, v0
v_add_u32 v19, 0x1c000, v0
s_lshl_b32 s41, s50, 7
v_lshlrev_b32 v4, 4, v2
v_xor_b32 v4, s41, v4
v_lshl_add_u32 v4, v3, 14, v4
s_lshl_b32 s41, s40, 12
v_add_u32 v10, s41, v4
v_add_u32 v11, 0x800, v10
s_mul_i32 s41, s40, 0x30000
v_lshlrev_b32 v22, 12, v2
v_lshl_add_u32 v22, v3, 4, v22
v_add_u32 v22, s41, v22
v_mov_b32 v24, 0x3f803f80
v_mov_b32 v25, 0x3f803f80
v_mov_b32 v26, 0x3f803f80
v_mov_b32 v27, 0x3f803f80
v_lshlrev_b32 v28, 25, v1
v_mov_b32 v29, 1
v_mov_b32 v30, 0
s_lshl_b32 s41, s48, 4
s_add_u32 s41, s41, s49
s_lshl_b32 s41, s41, 18
s_add_u32 s12, s12, s41
s_addc_u32 s13, s13, 0
s_mov_b32 s14, 0x40000
s_mov_b32 s15, 0x20000
s_add_u32 s16, s16, s41
s_addc_u32 s17, s17, 0
s_mov_b32 s18, 0x40000
s_mov_b32 s19, 0x20000
s_lshl_b32 s41, s47, 3
s_add_u32 s41, s41, s48
s_lshl_b32 s41, s41, 21
s_add_u32 s20, s96, s41
s_addc_u32 s21, s97, 0
s_mov_b32 s22, 0x200000
s_mov_b32 s23, 0x20000
s_mul_i32 s56, s40, 0x1800
s_mul_i32 s41, s50, 0xb0000
s_add_u32 s56, s56, s41
s_lshl_b32 s86, s40, 20
s_lshl_b32 s41, s48, 14
s_add_u32 s86, s86, s41
s_and_b32 s41, s49, 3
s_and_b32 s42, s49, 4
s_and_b32 s72, s49, 7
s_cmp_ge_u32 0, s41
s_addc_u32 s73, s42, 0
s_cmp_ge_u32 1, s41
s_addc_u32 s74, s42, 1
s_cmp_ge_u32 2, s41
s_addc_u32 s75, s42, 2
s_xor_b32 s76, s42, 4
s_mul_i32 s78, s72, 0x16000
s_add_u32 s78, s78, s56
s_lshl_b32 s72, s72, 19
s_mul_i32 s79, s73, 0x16000
s_add_u32 s79, s79, s56
s_lshl_b32 s73, s73, 19
s_mul_i32 s80, s74, 0x16000
s_add_u32 s80, s80, s56
s_lshl_b32 s74, s74, 19
s_mul_i32 s81, s75, 0x16000
s_add_u32 s81, s81, s56
s_lshl_b32 s75, s75, 19
s_mul_i32 s82, s76, 0x16000
s_add_u32 s82, s82, s56
s_lshl_b32 s76, s76, 19
s_lshl_b32 s41, s50, 22
s_lshl_b32 s42, s51, 8
s_add_u32 s41, s41, s42
s_add_u32 s24, s24, s41
s_addc_u32 s25, s25, 0
s_sub_u32 s26, 0x800000, s41
s_mov_b32 s27, 0x20000
s_mul_i32 s41, s48, 0xb0000
s_add_u32 s41, s41, s42
s_lshl_b32 s42, s47, 11
s_add_u32 s41, s41, s42
s_lshl_b32 s42, s50, 7
s_add_u32 s41, s41, s42
s_add_u32 s28, s92, s41
s_addc_u32 s29, s93, 0
s_mov_b32 s30, 0xaf080
s_mov_b32 s31, 0x20000
s_mul_i32 s41, s40, 0x1800
s_add_u32 s41, s41, 0x160000
s_mul_i32 s59, s49, 0x6000
s_add_u32 s59, s59, s41
s_xor_b32 s42, s49, 8
s_mul_i32 s60, s42, 0x6000
s_add_u32 s60, s60, s41
s_lshl_b32 s61, s49, 7
s_add_u32 s61, s61, 0x1c0000
s_lshl_b32 s62, s42, 7
s_add_u32 s62, s62, 0x1c0000
s_mov_b32 s36, s94
s_mov_b32 s37, s95
s_mov_b32 s38, 0x100
s_mov_b32 s39, 0x20000
s_lshl_b32 s58, s48, 1
s_add_u32 s58, s58, s47
s_lshl_b32 s58, s58, 3
s_mov_b32 s44, 0x40000
s_add_u32 m0, s45, 0x21000
s_nop 0
buffer_load_dwordx4 v6, s[8:11], s44 offen lds
s_add_u32 m0, s45, 0x21400
s_nop 0
buffer_load_dwordx4 v7, s[8:11], s44 offen lds
s_add_u32 m0, s45, 0x21808
s_nop 0
buffer_load_dwordx4 v8, s[8:11], s44 offen lds
s_add_u32 m0, s45, 0x21c08
s_nop 0
buffer_load_dwordx4 v9, s[8:11], s44 offen lds
s_add_u32 m0, s46, 0x1780
s_nop 0
buffer_load_dwordx4 v40, s[4:7], 0 offen offset:128 lds
s_add_u32 m0, s46, 0x1b80
s_nop 0
buffer_load_dwordx4 v41, s[4:7], 0 offen offset:128 lds
s_add_u32 m0, s46, 0x1f80
s_nop 0
buffer_load_dwordx4 v42, s[4:7], 0 offen offset:128 lds
s_add_u32 m0, s46, 0x2380
s_nop 0
buffer_load_dwordx4 v43, s[4:7], 0 offen offset:128 lds
s_add_u32 m0, s46, 0x2780
s_nop 0
buffer_load_dwordx4 v44, s[4:7], 0 offen offset:128 lds
s_add_u32 m0, s46, 0x2b80
s_nop 0
buffer_load_dwordx4 v45, s[4:7], 0 offen offset:128 lds
s_mov_b32 s44, 0x80000
s_add_u32 m0, s45, 0x10800
s_nop 0
buffer_load_dwordx4 v6, s[8:11], s44 offen lds
s_add_u32 m0, s45, 0x10c00
s_nop 0
buffer_load_dwordx4 v7, s[8:11], s44 offen lds
s_add_u32 m0, s45, 0x11008
s_nop 0
buffer_load_dwordx4 v8, s[8:11], s44 offen lds
s_add_u32 m0, s45, 0x11408
s_nop 0
buffer_load_dwordx4 v9, s[8:11], s44 offen lds
s_mov_b32 s44, 0xc0000
s_add_u32 m0, s45, 0x14a00
s_nop 0
buffer_load_dwordx4 v6, s[8:11], s44 offen lds
s_add_u32 m0, s45, 0x14e00
s_nop 0
buffer_load_dwordx4 v7, s[8:11], s44 offen lds
s_add_u32 m0, s45, 0x15208
s_nop 0
buffer_load_dwordx4 v8, s[8:11], s44 offen lds
s_add_u32 m0, s45, 0x15608
s_nop 0
buffer_load_dwordx4 v9, s[8:11], s44 offen lds
v_add_u32 v14, 0x1ce00, v13
s_waitcnt vmcnt(18)
s_barrier
TR 48,14,0
TR 50,14,512
TR 52,14,8
TR 54,14,520
RD 0,46,0
RD 4,46,2048
RD 8,46,4096
RD 12,47,0
RD 16,47,2048
RD 20,47,4096
TR 56,14,64
TR 58,14,576
TR 60,14,72
TR 62,14,584
TR 64,14,128
TR 66,14,640
TR 68,14,136
TR 70,14,648
fh_q0:
s_waitcnt lgkmcnt(13)
Zvaa 64,48,0
s_waitcnt lgkmcnt(11)
s_mov_b32 s44, 0x100000
TR 72,14,192
Zvaa 72,48,4
s_add_u32 m0, s45, 0x18c00
TR 74,14,704
Zvaa 80,48,8
buffer_load_dwordx4 v6, s[8:11], s44 offen lds
Zvaa 84,52,8
s_waitcnt lgkmcnt(8)
TR 76,14,200
Zvaa 76,52,4
s_add_u32 m0, s45, 0x19000
TR 78,14,712
Zvaa 68,52,0
buffer_load_dwordx4 v7, s[8:11], s44 offen lds
Zvaa 88,56,0
s_waitcnt lgkmcnt(8)
TR 48,14,256
Zvaa 96,56,4
s_add_u32 m0, s45, 0x19408
TR 50,14,768
Zvaa 104,56,8
buffer_load_dwordx4 v8, s[8:11], s44 offen lds
Zvaa 108,60,8
s_waitcnt lgkmcnt(8)
TR 52,14,264
Zvaa 100,60,4
s_add_u32 m0, s45, 0x19808
TR 54,14,776
Zvaa 92,60,0
buffer_load_dwordx4 v9, s[8:11], s44 offen lds
Zvaa 112,64,0
s_waitcnt lgkmcnt(8)
TR 56,14,320
Zvaa 120,64,4
s_add_u32 m0, s46, 0xffffff00
TR 58,14,832
Zvaa 128,64,8
buffer_load_dwordx4 v40, s[4:7], 0 offen offset:256 lds
Zvaa 132,68,8
s_waitcnt lgkmcnt(8)
TR 60,14,328
Zvaa 124,68,4
s_add_u32 m0, s46, 0x300
TR 62,14,840
Zvaa 116,68,0
buffer_load_dwordx4 v41, s[4:7], 0 offen offset:256 lds
Zvaa 136,72,0
s_waitcnt lgkmcnt(8)
TR 64,14,384
Zvaa 144,72,4
s_add_u32 m0, s46, 0x700
TR 66,14,896
Zvaa 152,72,8
buffer_load_dwordx4 v42, s[4:7], 0 offen offset:256 lds
Zvaa 156,76,8
s_waitcnt lgkmcnt(8)
TR 68,14,392
Zvaa 148,76,4
s_add_u32 m0, s46, 0xb00
TR 70,14,904
Zvaa 140,76,0
buffer_load_dwordx4 v43, s[4:7], 0 offen offset:256 lds
Zvaa 160,48,0
s_waitcnt lgkmcnt(8)
TR 72,14,448
Zvaa 168,48,4
s_add_u32 m0, s46, 0xf00
TR 74,14,960
Zvaa 176,48,8
buffer_load_dwordx4 v44, s[4:7], 0 offen offset:256 lds
Zvaa 180,52,8
s_waitcnt lgkmcnt(8)
TR 76,14,456
Zvaa 172,52,4
s_add_u32 m0, s46, 0x1300
TR 78,14,968
Zvaa 164,52,0
buffer_load_dwordx4 v45, s[4:7], 0 offen offset:256 lds
Zvaa 184,56,0
Zvaa 192,56,4
Zvaa 200,56,8
s_waitcnt lgkmcnt(8)
Zvaa 204,60,8
Zvaa 196,60,4
v_add_u32 v14, 0x21000, v13
Zvaa 188,60,0
s_waitcnt vmcnt(24) lgkmcnt(0)
s_barrier
Zvaa 208,64,0
TR 48,14,0
Zvaa 216,64,4
TR 50,14,512
Zvaa 224,64,8
TR 52,14,8
Zvaa 228,68,8
TR 54,14,520
Zvaa 220,68,4
TR 56,14,64
Zvaa 212,68,0
TR 58,14,576
Zvaa 232,72,0
TR 60,14,72
Zvaa 240,72,4
TR 62,14,584
Zvaa 248,72,8
TR 64,14,128
Zvaa 252,76,8
TR 66,14,640
Zvaa 244,76,4
TR 68,14,136
Zvaa 236,76,0
s_waitcnt lgkmcnt(9)
TR 70,14,648
fh_q1:
Mvaa 64,48,12
s_waitcnt lgkmcnt(8)
s_mov_b32 s44, 0x140000
TR 72,14,192
Mvaa 72,48,16
s_add_u32 m0, s45, 0x1ce00
TR 74,14,704
Mvaa 80,48,20
buffer_load_dwordx4 v6, s[8:11], s44 offen lds
Mvaa 84,52,20
s_waitcnt lgkmcnt(8)
TR 76,14,200
Mvaa 76,52,16
s_add_u32 m0, s45, 0x1d200
TR 78,14,712
Mvaa 68,52,12
buffer_load_dwordx4 v7, s[8:11], s44 offen lds
Mvaa 88,56,12
s_waitcnt lgkmcnt(8)
TR 48,14,256
Mvaa 96,56,16
s_add_u32 m0, s45, 0x1d608
TR 50,14,768
Mvaa 104,56,20
buffer_load_dwordx4 v8, s[8:11], s44 offen lds
Mvaa 108,60,20
s_waitcnt lgkmcnt(8)
TR 52,14,264
Mvaa 100,60,16
s_add_u32 m0, s45, 0x1da08
TR 54,14,776
Mvaa 92,60,12
buffer_load_dwordx4 v9, s[8:11], s44 offen lds
Mvaa 112,64,12
TR 56,14,320
Mvaa 120,64,16
TR 58,14,832
Mvaa 128,64,20
s_waitcnt vmcnt(22) lgkmcnt(10)
RD 24,46,6144
Mvaa 132,68,20
TR 60,14,328
Mvaa 124,68,16
TR 62,14,840
Mvaa 116,68,12
s_waitcnt lgkmcnt(11)
RD 28,46,8192
Mvaa 136,72,12
TR 64,14,384
Mvaa 144,72,16
TR 66,14,896
Mvaa 152,72,20
s_waitcnt lgkmcnt(12)
RD 32,46,10240
Mvaa 156,76,20
TR 68,14,392
Mvaa 148,76,16
TR 70,14,904
Mvaa 140,76,12
s_waitcnt lgkmcnt(13)
RD 36,47,6144
Mvaa 160,48,12
TR 72,14,448
Mvaa 168,48,16
TR 74,14,960
Mvaa 176,48,20
s_waitcnt lgkmcnt(14)
RD 40,47,8192
Mvaa 180,52,20
TR 76,14,456
Mvaa 172,52,16
TR 78,14,968
Mvaa 164,52,12
s_waitcnt lgkmcnt(15)
RD 44,47,10240
Mvaa 184,56,12
Mvaa 192,56,16
Mvaa 200,56,20
s_waitcnt lgkmcnt(13)
Mvaa 204,60,20
Mvaa 196,60,16
v_add_u32 v14, 0x10800, v13
Mvaa 188,60,12
s_waitcnt vmcnt(18) lgkmcnt(0)
s_barrier
Mvaa 208,64,12
TR 48,14,0
Mvaa 216,64,16
TR 50,14,512
Mvaa 224,64,20
TR 52,14,8
Mvaa 228,68,20
TR 54,14,520
Mvaa 220,68,16
TR 56,14,64
Mvaa 212,68,12
TR 58,14,576
Mvaa 232,72,12
TR 60,14,72
Mvaa 240,72,16
TR 62,14,584
Mvaa 248,72,20
TR 64,14,128
Mvaa 252,76,20
TR 66,14,640
Mvaa 244,76,16
TR 68,14,136
Mvaa 236,76,12
s_waitcnt lgkmcnt(9)
TR 70,14,648
fh_q2:
Mvaa 64,48,24
s_waitcnt lgkmcnt(8)
s_mov_b32 s44, 0x180000
TR 72,14,192
Mvaa 72,48,28
s_add_u32 m0, s45, 0x21000
TR 74,14,704
Mvaa 80,48,32
buffer_load_dwordx4 v6, s[8:11], s44 offen lds
Mvaa 84,52,32
s_waitcnt lgkmcnt(8)
TR 76,14,200
Mvaa 76,52,28
s_add_u32 m0, s45, 0x21400
TR 78,14,712
Mvaa 68,52,24
buffer_load_dwordx4 v7, s[8:11], s44 offen lds
Mvaa 88,56,24
s_waitcnt lgkmcnt(8)
TR 48,14,256
Mvaa 96,56,28
s_add_u32 m0, s45, 0x21808
TR 50,14,768
Mvaa 104,56,32
buffer_load_dwordx4 v8, s[8:11], s44 offen lds
Mvaa 108,60,32
s_waitcnt lgkmcnt(8)
TR 52,14,264
Mvaa 100,60,28
s_add_u32 m0, s45, 0x21c08
TR 54,14,776
Mvaa 92,60,24
buffer_load_dwordx4 v9, s[8:11], s44 offen lds
Mvaa 112,64,24
s_waitcnt lgkmcnt(8)
TR 56,14,320
Mvaa 120,64,28
s_add_u32 m0, s46, 0x1680
TR 58,14,832
Mvaa 128,64,32
buffer_load_dwordx4 v40, s[4:7], 0 offen offset:384 lds
Mvaa 132,68,32
s_waitcnt lgkmcnt(8)
TR 60,14,328
Mvaa 124,68,28
s_add_u32 m0, s46, 0x1a80
TR 62,14,840
Mvaa 116,68,24
buffer_load_dwordx4 v41, s[4:7], 0 offen offset:384 lds
Mvaa 136,72,24
s_waitcnt lgkmcnt(8)
TR 64,14,384
Mvaa 144,72,28
s_add_u32 m0, s46, 0x1e80
TR 66,14,896
Mvaa 152,72,32
buffer_load_dwordx4 v42, s[4:7], 0 offen offset:384 lds
Mvaa 156,76,32
s_waitcnt lgkmcnt(8)
TR 68,14,392
Mvaa 148,76,28
s_add_u32 m0, s46, 0x2280
TR 70,14,904
Mvaa 140,76,24
buffer_load_dwordx4 v43, s[4:7], 0 offen offset:384 lds
Mvaa 160,48,24
s_waitcnt lgkmcnt(8)
TR 72,14,448
Mvaa 168,48,28
s_branch f_pad1s
f_pad1:
s_setpc_b64 s[70:71]
f_pad1s:
s_add_u32 m0, s46, 0x2680
TR 74,14,960
Mvaa 176,48,32
buffer_load_dwordx4 v44, s[4:7], 0 offen offset:384 lds
Mvaa 180,52,32
s_waitcnt lgkmcnt(8)
TR 76,14,456
Mvaa 172,52,28
s_add_u32 m0, s46, 0x2a80
TR 78,14,968
Mvaa 164,52,24
buffer_load_dwordx4 v45, s[4:7], 0 offen offset:384 lds
Mvaa 184,56,24
Mvaa 192,56,28
Mvaa 200,56,32
s_waitcnt lgkmcnt(8)
Mvaa 204,60,32
Mvaa 196,60,28
v_add_u32 v14, 0x14a00, v13
Mvaa 188,60,24
s_waitcnt vmcnt(24) lgkmcnt(0)
s_barrier
Mvaa 208,64,24
TR 48,14,0
Mvaa 216,64,28
TR 50,14,512
Mvaa 224,64,32
TR 52,14,8
Mvaa 228,68,32
TR 54,14,520
Mvaa 220,68,28
TR 56,14,64
Mvaa 212,68,24
TR 58,14,576
Mvaa 232,72,24
TR 60,14,72
Mvaa 240,72,28
TR 62,14,584
Mvaa 248,72,32
TR 64,14,128
Mvaa 252,76,32
TR 66,14,640
Mvaa 244,76,28
TR 68,14,136
Mvaa 236,76,24
s_waitcnt lgkmcnt(9)
TR 70,14,648
fh_q3:
Mvaa 64,48,36
s_waitcnt lgkmcnt(8)
TR 72,14,192
Mvaa 72,48,40
s_add_u32 m0, s52, 0x25200
TR 74,14,704
Mvaa 80,48,44
buffer_load_dwordx4 v31, s[12:15], 0 offen nt lds
Mvaa 84,52,44
s_waitcnt lgkmcnt(8)
TR 76,14,200
Mvaa 76,52,40
s_add_u32 m0, s52, 0x25520
TR 78,14,712
Mvaa 68,52,36
buffer_load_dwordx4 v31, s[12:15], 0 offen offset:256 nt lds
Mvaa 88,56,36
s_waitcnt lgkmcnt(8)
s_mov_b32 s3, 0x2000
TR 48,14,256
Mvaa 96,56,40
s_add_u32 m0, s52, 0
TR 50,14,768
Mvaa 104,56,44
buffer_load_dwordx4 v31, s[12:15], s3 offen nt lds
Mvaa 108,60,44
s_waitcnt lgkmcnt(8)
TR 52,14,264
Mvaa 100,60,40
s_add_u32 m0, s52, 0x320
TR 54,14,776
Mvaa 92,60,36
buffer_load_dwordx4 v31, s[12:15], s3 offen offset:256 nt lds
Mvaa 112,64,36
s_waitcnt lgkmcnt(8)
s_mov_b32 s44, 0x1c0000
TR 56,14,320
Mvaa 120,64,40
s_add_u32 m0, s45, 0x10800
TR 58,14,832
Mvaa 128,64,44
buffer_load_dwordx4 v6, s[8:11], s44 offen lds
Mvaa 132,68,44
s_waitcnt lgkmcnt(8)
TR 60,14,328
Mvaa 124,68,40
s_add_u32 m0, s45, 0x10c00
TR 62,14,840
Mvaa 116,68,36
buffer_load_dwordx4 v7, s[8:11], s44 offen lds
Mvaa 136,72,36
s_waitcnt lgkmcnt(8)
TR 64,14,384
Mvaa 144,72,40
s_add_u32 m0, s45, 0x11008
TR 66,14,896
Mvaa 152,72,44
buffer_load_dwordx4 v8, s[8:11], s44 offen lds
Mvaa 156,76,44
s_waitcnt lgkmcnt(8)
TR 68,14,392
Mvaa 148,76,40
s_add_u32 m0, s45, 0x11408
TR 70,14,904
Mvaa 140,76,36
buffer_load_dwordx4 v9, s[8:11], s44 offen lds
Mvaa 160,48,36
TR 72,14,448
Mvaa 168,48,40
TR 74,14,960
Mvaa 176,48,44
s_waitcnt vmcnt(22) lgkmcnt(10)
RD 0,46,0
Mvaa 180,52,44
TR 76,14,456
Mvaa 172,52,40
TR 78,14,968
Mvaa 164,52,36
s_waitcnt lgkmcnt(11)
RD 4,46,2048
Mvaa 184,56,36
RD 8,46,4096
Mvaa 192,56,40
RD 12,47,0
Mvaa 200,56,44
s_waitcnt lgkmcnt(12)
RD 16,47,2048
Mvaa 204,60,44
RD 20,47,4096
Mvaa 196,60,40
v_add_u32 v14, 0x18c00, v13
Mvaa 188,60,36
s_waitcnt vmcnt(28) lgkmcnt(0)
s_barrier
Mvaa 208,64,36
TR 48,14,0
Mvaa 216,64,40
TR 50,14,512
Mvaa 224,64,44
TR 52,14,8
Mvaa 228,68,44
TR 54,14,520
Mvaa 220,68,40
TR 56,14,64
Mvaa 212,68,36
TR 58,14,576
Mvaa 232,72,36
TR 60,14,72
Mvaa 240,72,40
TR 62,14,584
Mvaa 248,72,44
TR 64,14,128
Mvaa 252,76,44
TR 66,14,640
Mvaa 244,76,40
TR 68,14,136
Mvaa 236,76,36
s_waitcnt lgkmcnt(9)
TR 70,14,648
fh_q4:
Mvaa 64,48,0
s_waitcnt lgkmcnt(8)
s_mov_b32 s44, 0x200000
TR 72,14,192
Mvaa 72,48,4
s_add_u32 m0, s45, 0x14a00
TR 74,14,704
Mvaa 80,48,8
buffer_load_dwordx4 v6, s[8:11], s44 offen lds
Mvaa 84,52,8
s_waitcnt lgkmcnt(8)
TR 76,14,200
Mvaa 76,52,4
s_add_u32 m0, s45, 0x14e00
TR 78,14,712
Mvaa 68,52,0
buffer_load_dwordx4 v7, s[8:11], s44 offen lds
Mvaa 88,56,0
s_waitcnt lgkmcnt(8)
TR 48,14,256
Mvaa 96,56,4
s_add_u32 m0, s45, 0x15208
TR 50,14,768
Mvaa 104,56,8
buffer_load_dwordx4 v8, s[8:11], s44 offen lds
Mvaa 108,60,8
s_waitcnt lgkmcnt(8)
TR 52,14,264
Mvaa 100,60,4
s_add_u32 m0, s45, 0x15608
TR 54,14,776
Mvaa 92,60,0
buffer_load_dwordx4 v9, s[8:11], s44 offen lds
Mvaa 112,64,0
s_waitcnt lgkmcnt(8)
TR 56,14,320
Mvaa 120,64,4
s_add_u32 m0, s46, 0xfffffe00
TR 58,14,832
Mvaa 128,64,8
buffer_load_dwordx4 v40, s[4:7], 0 offen offset:512 lds
Mvaa 132,68,8
s_waitcnt lgkmcnt(8)
TR 60,14,328
Mvaa 124,68,4
s_add_u32 m0, s46, 0x200
TR 62,14,840
Mvaa 116,68,0
buffer_load_dwordx4 v41, s[4:7], 0 offen offset:512 lds
Mvaa 136,72,0
s_waitcnt lgkmcnt(8)
TR 64,14,384
Mvaa 144,72,4
s_add_u32 m0, s46, 0x600
TR 66,14,896
Mvaa 152,72,8
buffer_load_dwordx4 v42, s[4:7], 0 offen offset:512 lds
Mvaa 156,76,8
s_waitcnt lgkmcnt(8)
TR 68,14,392
Mvaa 148,76,4
s_add_u32 m0, s46, 0xa00
TR 70,14,904
Mvaa 140,76,0
buffer_load_dwordx4 v43, s[4:7], 0 offen offset:512 lds
Mvaa 160,48,0
s_waitcnt lgkmcnt(8)
TR 72,14,448
Mvaa 168,48,4
s_add_u32 m0, s46, 0xe00
TR 74,14,960
Mvaa 176,48,8
buffer_load_dwordx4 v44, s[4:7], 0 offen offset:512 lds
Mvaa 180,52,8
s_waitcnt lgkmcnt(8)
TR 76,14,456
Mvaa 172,52,4
s_add_u32 m0, s46, 0x1200
TR 78,14,968
Mvaa 164,52,0
buffer_load_dwordx4 v45, s[4:7], 0 offen offset:512 lds
Mvaa 184,56,0
Mvaa 192,56,4
Mvaa 200,56,8
s_waitcnt lgkmcnt(8)
Mvaa 204,60,8
Mvaa 196,60,4
v_add_u32 v14, 0x1ce00, v13
Mvaa 188,60,0
s_waitcnt vmcnt(28) lgkmcnt(0)
s_barrier
Mvaa 208,64,0
TR 48,14,0
Mvaa 216,64,4
TR 50,14,512
Mvaa 224,64,8
TR 52,14,8
Mvaa 228,68,8
TR 54,14,520
Mvaa 220,68,4
TR 56,14,64
Mvaa 212,68,0
TR 58,14,576
Mvaa 232,72,0
TR 60,14,72
Mvaa 240,72,4
TR 62,14,584
Mvaa 248,72,8
TR 64,14,128
Mvaa 252,76,8
TR 66,14,640
Mvaa 244,76,4
TR 68,14,136
Mvaa 236,76,0
s_waitcnt lgkmcnt(9)
TR 70,14,648
fh_q5:
Mvaa 64,48,12
s_waitcnt lgkmcnt(8)
s_mov_b32 s3, 0
TR 72,14,192
Mvaa 72,48,16
s_add_u32 m0, s52, 0x2100
TR 74,14,704
Mvaa 80,48,20
buffer_load_dwordx4 v31, s[16:19], s3 offen nt lds
Mvaa 84,52,20
s_waitcnt lgkmcnt(8)
TR 76,14,200
Mvaa 76,52,16
s_add_u32 m0, s52, 0x2420
TR 78,14,712
Mvaa 68,52,12
buffer_load_dwordx4 v31, s[16:19], s3 offen offset:256 nt lds
Mvaa 88,56,12
s_waitcnt lgkmcnt(8)
TR 48,14,256
Mvaa 96,56,16
s_mov_b32 s3, 0x4000
TR 50,14,768
Mvaa 104,56,20
buffer_load_dwordx4 a[80:83], v31, s[12:15], s3 offen nt
Mvaa 108,60,20
TR 52,14,264
Mvaa 100,60,16
s_waitcnt lgkmcnt(9)
TR 54,14,776
Mvaa 92,60,12
buffer_load_dwordx4 a[84:87], v31, s[12:15], s3 offen offset:256 nt
Mvaa 112,64,12
s_waitcnt lgkmcnt(8)
s_mov_b32 s44, 0x240000
TR 56,14,320
Mvaa 120,64,16
s_add_u32 m0, s45, 0x18c00
TR 58,14,832
Mvaa 128,64,20
buffer_load_dwordx4 v6, s[8:11], s44 offen lds
Mvaa 132,68,20
s_waitcnt lgkmcnt(8)
TR 60,14,328
Mvaa 124,68,16
s_add_u32 m0, s45, 0x19000
TR 62,14,840
Mvaa 116,68,12
buffer_load_dwordx4 v7, s[8:11], s44 offen lds
Mvaa 136,72,12
s_waitcnt lgkmcnt(8)
TR 64,14,384
Mvaa 144,72,16
s_add_u32 m0, s45, 0x19408
TR 66,14,896
Mvaa 152,72,20
buffer_load_dwordx4 v8, s[8:11], s44 offen lds
Mvaa 156,76,20
s_waitcnt lgkmcnt(8)
TR 68,14,392
Mvaa 148,76,16
s_add_u32 m0, s45, 0x19808
TR 70,14,904
Mvaa 140,76,12
buffer_load_dwordx4 v9, s[8:11], s44 offen lds
Mvaa 160,48,12
TR 72,14,448
Mvaa 168,48,16
TR 74,14,960
Mvaa 176,48,20
s_waitcnt vmcnt(26) lgkmcnt(10)
RD 24,46,6144
Mvaa 180,52,20
TR 76,14,456
Mvaa 172,52,16
TR 78,14,968
Mvaa 164,52,12
s_waitcnt lgkmcnt(11)
RD 28,46,8192
Mvaa 184,56,12
RD 32,46,10240
Mvaa 192,56,16
RD 36,47,6144
Mvaa 200,56,20
s_waitcnt lgkmcnt(12)
RD 40,47,8192
Mvaa 204,60,20
RD 44,47,10240
Mvaa 196,60,16
v_add_u32 v14, 0x21000, v13
Mvaa 188,60,12
s_waitcnt vmcnt(32) lgkmcnt(0)
s_barrier
Mvaa 208,64,12
TR 48,14,0
Mvaa 216,64,16
TR 50,14,512
Mvaa 224,64,20
TR 52,14,8
Mvaa 228,68,20
TR 54,14,520
Mvaa 220,68,16
TR 56,14,64
Mvaa 212,68,12
TR 58,14,576
Mvaa 232,72,12
TR 60,14,72
Mvaa 240,72,16
TR 62,14,584
Mvaa 248,72,20
TR 64,14,128
Mvaa 252,76,20
TR 66,14,640
Mvaa 244,76,16
TR 68,14,136
Mvaa 236,76,12
s_waitcnt lgkmcnt(9)
TR 70,14,648
fh_q6:
Mvaa 64,48,24
s_waitcnt lgkmcnt(8)
s_mov_b32 s44, 0x280000
TR 72,14,192
Mvaa 72,48,28
s_add_u32 m0, s45, 0x1ce00
TR 74,14,704
Mvaa 80,48,32
buffer_load_dwordx4 v6, s[8:11], s44 offen lds
Mvaa 84,52,32
s_waitcnt lgkmcnt(8)
TR 76,14,200
Mvaa 76,52,28
s_add_u32 m0, s45, 0x1d200
TR 78,14,712
Mvaa 68,52,24
buffer_load_dwordx4 v7, s[8:11], s44 offen lds
Mvaa 88,56,24
s_waitcnt lgkmcnt(8)
TR 48,14,256
Mvaa 96,56,28
s_add_u32 m0, s45, 0x1d608
TR 50,14,768
Mvaa 104,56,32
buffer_load_dwordx4 v8, s[8:11], s44 offen lds
Mvaa 108,60,32
s_waitcnt lgkmcnt(8)
TR 52,14,264
Mvaa 100,60,28
s_add_u32 m0, s45, 0x1da08
TR 54,14,776
Mvaa 92,60,24
buffer_load_dwordx4 v9, s[8:11], s44 offen lds
Mvaa 112,64,24
s_waitcnt lgkmcnt(8)
TR 56,14,320
Mvaa 120,64,28
s_add_u32 m0, s46, 0x1580
TR 58,14,832
Mvaa 128,64,32
buffer_load_dwordx4 v40, s[4:7], 0 offen offset:640 lds
Mvaa 132,68,32
s_waitcnt lgkmcnt(8)
TR 60,14,328
Mvaa 124,68,28
s_add_u32 m0, s46, 0x1980
TR 62,14,840
Mvaa 116,68,24
buffer_load_dwordx4 v41, s[4:7], 0 offen offset:640 lds
Mvaa 136,72,24
s_waitcnt lgkmcnt(8)
TR 64,14,384
Mvaa 144,72,28
s_add_u32 m0, s46, 0x1d80
TR 66,14,896
Mvaa 152,72,32
buffer_load_dwordx4 v42, s[4:7], 0 offen offset:640 lds
Mvaa 156,76,32
s_waitcnt lgkmcnt(8)
TR 68,14,392
Mvaa 148,76,28
s_add_u32 m0, s46, 0x2180
TR 70,14,904
Mvaa 140,76,24
buffer_load_dwordx4 v43, s[4:7], 0 offen offset:640 lds
Mvaa 160,48,24
s_waitcnt lgkmcnt(8)
TR 72,14,448
Mvaa 168,48,28
s_add_u32 m0, s46, 0x2580
TR 74,14,960
Mvaa 176,48,32
buffer_load_dwordx4 v44, s[4:7], 0 offen offset:640 lds
Mvaa 180,52,32
s_waitcnt lgkmcnt(8)
TR 76,14,456
Mvaa 172,52,28
s_add_u32 m0, s46, 0x2980
TR 78,14,968
Mvaa 164,52,24
buffer_load_dwordx4 v45, s[4:7], 0 offen offset:640 lds
Mvaa 184,56,24
Mvaa 192,56,28
Mvaa 200,56,32
s_waitcnt lgkmcnt(8)
Mvaa 204,60,32
Mvaa 196,60,28
v_add_u32 v14, 0x10800, v13
Mvaa 188,60,24
s_waitcnt vmcnt(28) lgkmcnt(0)
s_barrier
Mvaa 208,64,24
TR 48,14,0
Mvaa 216,64,28
TR 50,14,512
Mvaa 224,64,32
TR 52,14,8
Mvaa 228,68,32
TR 54,14,520
Mvaa 220,68,28
TR 56,14,64
Mvaa 212,68,24
TR 58,14,576
Mvaa 232,72,24
TR 60,14,72
Mvaa 240,72,28
TR 62,14,584
Mvaa 248,72,32
TR 64,14,128
Mvaa 252,76,32
TR 66,14,640
Mvaa 244,76,28
TR 68,14,136
Mvaa 236,76,24
s_waitcnt lgkmcnt(9)
TR 70,14,648
fh_q7:
Mvaa 64,48,36
s_waitcnt lgkmcnt(8)
TR 72,14,192
Mvaa 72,48,40
s_mov_b32 s3, 0x2000
TR 74,14,704
Mvaa 80,48,44
buffer_load_dwordx4 a[88:91], v31, s[16:19], s3 offen nt
Mvaa 84,52,44
TR 76,14,200
Mvaa 76,52,40
s_waitcnt lgkmcnt(9)
TR 78,14,712
Mvaa 68,52,36
buffer_load_dwordx4 a[92:95], v31, s[16:19], s3 offen offset:256 nt
Mvaa 88,56,36
s_waitcnt lgkmcnt(8)
TR 48,14,256
Mvaa 96,56,40
s_mov_b32 s3, 0x6000
TR 50,14,768
Mvaa 104,56,44
buffer_load_dwordx4 a[96:99], v31, s[12:15], s3 offen nt
Mvaa 108,60,44
TR 52,14,264
Mvaa 100,60,40
s_branch f_pad2s
f_pad2:
s_setpc_b64 s[70:71]
f_pad2s:
s_waitcnt lgkmcnt(9)
TR 54,14,776
Mvaa 92,60,36
buffer_load_dwordx4 a[100:103], v31, s[12:15], s3 offen offset:256 nt
Mvaa 112,64,36
s_waitcnt lgkmcnt(8)
s_mov_b32 s44, 0x2c0000
TR 56,14,320
Mvaa 120,64,40
s_add_u32 m0, s45, 0x21000
TR 58,14,832
Mvaa 128,64,44
buffer_load_dwordx4 v6, s[8:11], s44 offen lds
Mvaa 132,68,44
s_waitcnt lgkmcnt(8)
TR 60,14,328
Mvaa 124,68,40
s_add_u32 m0, s45, 0x21400
TR 62,14,840
Mvaa 116,68,36
buffer_load_dwordx4 v7, s[8:11], s44 offen lds
Mvaa 136,72,36
s_waitcnt lgkmcnt(8)
TR 64,14,384
Mvaa 144,72,40
s_add_u32 m0, s45, 0x21808
TR 66,14,896
Mvaa 152,72,44
buffer_load_dwordx4 v8, s[8:11], s44 offen lds
Mvaa 156,76,44
s_waitcnt lgkmcnt(8)
TR 68,14,392
Mvaa 148,76,40
s_add_u32 m0, s45, 0x21c08
TR 70,14,904
Mvaa 140,76,36
buffer_load_dwordx4 v9, s[8:11], s44 offen lds
Mvaa 160,48,36
TR 72,14,448
Mvaa 168,48,40
TR 74,14,960
Mvaa 176,48,44
s_waitcnt vmcnt(26) lgkmcnt(10)
RD 0,46,0
Mvaa 180,52,44
TR 76,14,456
Mvaa 172,52,40
TR 78,14,968
Mvaa 164,52,36
s_waitcnt lgkmcnt(11)
RD 4,46,2048
Mvaa 184,56,36
RD 8,46,4096
Mvaa 192,56,40
RD 12,47,0
Mvaa 200,56,44
s_waitcnt lgkmcnt(12)
RD 16,47,2048
Mvaa 204,60,44
RD 20,47,4096
Mvaa 196,60,40
v_add_u32 v14, 0x14a00, v13
Mvaa 188,60,36
s_waitcnt vmcnt(32) lgkmcnt(0)
s_barrier
Mvaa 208,64,36
TR 48,14,0
Mvaa 216,64,40
TR 50,14,512
Mvaa 224,64,44
TR 52,14,8
Mvaa 228,68,44
TR 54,14,520
Mvaa 220,68,40
TR 56,14,64
Mvaa 212,68,36
TR 58,14,576
Mvaa 232,72,36
TR 60,14,72
Mvaa 240,72,40
TR 62,14,584
Mvaa 248,72,44
TR 64,14,128
Mvaa 252,76,44
TR 66,14,640
Mvaa 244,76,40
TR 68,14,136
Mvaa 236,76,36
s_waitcnt lgkmcnt(9)
TR 70,14,648
fh_q8:
Mvaa 64,48,0
s_waitcnt lgkmcnt(8)
s_mov_b32 s44, 0x300000
TR 72,14,192
Mvaa 72,48,4
s_add_u32 m0, s45, 0x10800
TR 74,14,704
Mvaa 80,48,8
buffer_load_dwordx4 v6, s[8:11], s44 offen lds
Mvaa 84,52,8
s_waitcnt lgkmcnt(8)
TR 76,14,200
Mvaa 76,52,4
s_add_u32 m0, s45, 0x10c00
TR 78,14,712
Mvaa 68,52,0
buffer_load_dwordx4 v7, s[8:11], s44 offen lds
Mvaa 88,56,0
s_waitcnt lgkmcnt(8)
TR 48,14,256
Mvaa 96,56,4
s_add_u32 m0, s45, 0x11008
TR 50,14,768
Mvaa 104,56,8
buffer_load_dwordx4 v8, s[8:11], s44 offen lds
Mvaa 108,60,8
s_waitcnt lgkmcnt(8)
TR 52,14,264
Mvaa 100,60,4
s_add_u32 m0, s45, 0x11408
TR 54,14,776
Mvaa 92,60,0
buffer_load_dwordx4 v9, s[8:11], s44 offen lds
Mvaa 112,64,0
s_waitcnt lgkmcnt(8)
TR 56,14,320
Mvaa 120,64,4
s_add_u32 m0, s46, 0xfffffd00
TR 58,14,832
Mvaa 128,64,8
buffer_load_dwordx4 v40, s[4:7], 0 offen offset:768 lds
Mvaa 132,68,8
s_waitcnt lgkmcnt(8)
TR 60,14,328
Mvaa 124,68,4
s_add_u32 m0, s46, 0x100
TR 62,14,840
Mvaa 116,68,0
buffer_load_dwordx4 v41, s[4:7], 0 offen offset:768 lds
Mvaa 136,72,0
s_waitcnt lgkmcnt(8)
TR 64,14,384
Mvaa 144,72,4
s_add_u32 m0, s46, 0x500
TR 66,14,896
Mvaa 152,72,8
buffer_load_dwordx4 v42, s[4:7], 0 offen offset:768 lds
Mvaa 156,76,8
s_waitcnt lgkmcnt(8)
TR 68,14,392
Mvaa 148,76,4
s_add_u32 m0, s46, 0x900
TR 70,14,904
Mvaa 140,76,0
buffer_load_dwordx4 v43, s[4:7], 0 offen offset:768 lds
Mvaa 160,48,0
s_waitcnt lgkmcnt(8)
TR 72,14,448
Mvaa 168,48,4
s_add_u32 m0, s46, 0xd00
TR 74,14,960
Mvaa 176,48,8
buffer_load_dwordx4 v44, s[4:7], 0 offen offset:768 lds
Mvaa 180,52,8
s_waitcnt lgkmcnt(8)
TR 76,14,456
Mvaa 172,52,4
s_add_u32 m0, s46, 0x1100
TR 78,14,968
Mvaa 164,52,0
buffer_load_dwordx4 v45, s[4:7], 0 offen offset:768 lds
Mvaa 184,56,0
Mvaa 192,56,4
Mvaa 200,56,8
s_waitcnt lgkmcnt(8)
Mvaa 204,60,8
Mvaa 196,60,4
v_add_u32 v14, 0x18c00, v13
Mvaa 188,60,0
s_waitcnt vmcnt(28) lgkmcnt(0)
s_barrier
Mvaa 208,64,0
TR 48,14,0
Mvaa 216,64,4
TR 50,14,512
Mvaa 224,64,8
TR 52,14,8
Mvaa 228,68,8
TR 54,14,520
Mvaa 220,68,4
TR 56,14,64
Mvaa 212,68,0
TR 58,14,576
Mvaa 232,72,0
TR 60,14,72
Mvaa 240,72,4
TR 62,14,584
Mvaa 248,72,8
TR 64,14,128
Mvaa 252,76,8
TR 66,14,640
Mvaa 244,76,4
TR 68,14,136
Mvaa 236,76,0
s_waitcnt lgkmcnt(9)
TR 70,14,648
fh_q9:
Mvaa 64,48,12
s_waitcnt lgkmcnt(8)
TR 72,14,192
Mvaa 72,48,16
s_mov_b32 s3, 0x4000
TR 74,14,704
Mvaa 80,48,20
buffer_load_dwordx4 a[104:107], v31, s[16:19], s3 offen nt
Mvaa 84,52,20
TR 76,14,200
Mvaa 76,52,16
s_waitcnt lgkmcnt(9)
TR 78,14,712
Mvaa 68,52,12
buffer_load_dwordx4 a[108:111], v31, s[16:19], s3 offen offset:256 nt
Mvaa 88,56,12
s_waitcnt lgkmcnt(8)
TR 48,14,256
Mvaa 96,56,16
s_mov_b32 s3, 0x8000
TR 50,14,768
Mvaa 104,56,20
buffer_load_dwordx4 a[112:115], v31, s[12:15], s3 offen nt
Mvaa 108,60,20
TR 52,14,264
Mvaa 100,60,16
s_waitcnt lgkmcnt(9)
TR 54,14,776
Mvaa 92,60,12
buffer_load_dwordx4 a[116:119], v31, s[12:15], s3 offen offset:256 nt
Mvaa 112,64,12
s_waitcnt lgkmcnt(8)
s_mov_b32 s44, 0x340000
TR 56,14,320
Mvaa 120,64,16
s_add_u32 m0, s45, 0x14a00
TR 58,14,832
Mvaa 128,64,20
buffer_load_dwordx4 v6, s[8:11], s44 offen lds
Mvaa 132,68,20
s_waitcnt lgkmcnt(8)
TR 60,14,328
Mvaa 124,68,16
s_add_u32 m0, s45, 0x14e00
TR 62,14,840
Mvaa 116,68,12
buffer_load_dwordx4 v7, s[8:11], s44 offen lds
Mvaa 136,72,12
s_waitcnt lgkmcnt(8)
TR 64,14,384
Mvaa 144,72,16
s_add_u32 m0, s45, 0x15208
TR 66,14,896
Mvaa 152,72,20
buffer_load_dwordx4 v8, s[8:11], s44 offen lds
Mvaa 156,76,20
s_waitcnt lgkmcnt(8)
TR 68,14,392
Mvaa 148,76,16
s_add_u32 m0, s45, 0x15608
TR 70,14,904
Mvaa 140,76,12
buffer_load_dwordx4 v9, s[8:11], s44 offen lds
Mvaa 160,48,12
TR 72,14,448
Mvaa 168,48,16
TR 74,14,960
Mvaa 176,48,20
s_waitcnt vmcnt(26) lgkmcnt(10)
RD 24,46,6144
Mvaa 180,52,20
TR 76,14,456
Mvaa 172,52,16
TR 78,14,968
Mvaa 164,52,12
s_waitcnt lgkmcnt(11)
RD 28,46,8192
Mvaa 184,56,12
RD 32,46,10240
Mvaa 192,56,16
RD 36,47,6144
Mvaa 200,56,20
s_waitcnt lgkmcnt(12)
RD 40,47,8192
Mvaa 204,60,20
RD 44,47,10240
Mvaa 196,60,16
v_add_u32 v14, 0x1ce00, v13
Mvaa 188,60,12
s_waitcnt vmcnt(32) lgkmcnt(0)
s_barrier
Mvaa 208,64,12
TR 48,14,0
Mvaa 216,64,16
TR 50,14,512
Mvaa 224,64,20
TR 52,14,8
Mvaa 228,68,20
TR 54,14,520
Mvaa 220,68,16
TR 56,14,64
Mvaa 212,68,12
TR 58,14,576
Mvaa 232,72,12
TR 60,14,72
Mvaa 240,72,16
TR 62,14,584
Mvaa 248,72,20
TR 64,14,128
Mvaa 252,76,20
TR 66,14,640
Mvaa 244,76,16
TR 68,14,136
Mvaa 236,76,12
s_waitcnt lgkmcnt(9)
TR 70,14,648
fh_q10:
Mvaa 64,48,24
s_waitcnt lgkmcnt(8)
s_mov_b32 s44, 0x380000
TR 72,14,192
Mvaa 72,48,28
s_add_u32 m0, s45, 0x18c00
TR 74,14,704
Mvaa 80,48,32
buffer_load_dwordx4 v6, s[8:11], s44 offen lds
Mvaa 84,52,32
s_waitcnt lgkmcnt(8)
TR 76,14,200
Mvaa 76,52,28
s_add_u32 m0, s45, 0x19000
TR 78,14,712
Mvaa 68,52,24
buffer_load_dwordx4 v7, s[8:11], s44 offen lds
Mvaa 88,56,24
s_waitcnt lgkmcnt(8)
TR 48,14,256
Mvaa 96,56,28
s_add_u32 m0, s45, 0x19408
TR 50,14,768
Mvaa 104,56,32
buffer_load_dwordx4 v8, s[8:11], s44 offen lds
Mvaa 108,60,32
s_waitcnt lgkmcnt(8)
TR 52,14,264
Mvaa 100,60,28
s_add_u32 m0, s45, 0x19808
TR 54,14,776
Mvaa 92,60,24
buffer_load_dwordx4 v9, s[8:11], s44 offen lds
Mvaa 112,64,24
s_waitcnt lgkmcnt(8)
TR 56,14,320
Mvaa 120,64,28
s_add_u32 m0, s46, 0x1480
TR 58,14,832
Mvaa 128,64,32
buffer_load_dwordx4 v40, s[4:7], 0 offen offset:896 lds
Mvaa 132,68,32
s_waitcnt lgkmcnt(8)
TR 60,14,328
Mvaa 124,68,28
s_add_u32 m0, s46, 0x1880
TR 62,14,840
Mvaa 116,68,24
buffer_load_dwordx4 v41, s[4:7], 0 offen offset:896 lds
Mvaa 136,72,24
s_waitcnt lgkmcnt(8)
TR 64,14,384
Mvaa 144,72,28
s_add_u32 m0, s46, 0x1c80
TR 66,14,896
Mvaa 152,72,32
buffer_load_dwordx4 v42, s[4:7], 0 offen offset:896 lds
Mvaa 156,76,32
s_waitcnt lgkmcnt(8)
TR 68,14,392
Mvaa 148,76,28
s_add_u32 m0, s46, 0x2080
TR 70,14,904
Mvaa 140,76,24
buffer_load_dwordx4 v43, s[4:7], 0 offen offset:896 lds
Mvaa 160,48,24
s_waitcnt lgkmcnt(8)
TR 72,14,448
Mvaa 168,48,28
s_add_u32 m0, s46, 0x2480
TR 74,14,960
Mvaa 176,48,32
buffer_load_dwordx4 v44, s[4:7], 0 offen offset:896 lds
Mvaa 180,52,32
s_waitcnt lgkmcnt(8)
TR 76,14,456
Mvaa 172,52,28
s_add_u32 m0, s46, 0x2880
TR 78,14,968
Mvaa 164,52,24
buffer_load_dwordx4 v45, s[4:7], 0 offen offset:896 lds
Mvaa 184,56,24
Mvaa 192,56,28
Mvaa 200,56,32
s_waitcnt lgkmcnt(8)
Mvaa 204,60,32
Mvaa 196,60,28
v_add_u32 v14, 0x21000, v13
Mvaa 188,60,24
s_waitcnt vmcnt(28) lgkmcnt(0)
s_barrier
Mvaa 208,64,24
TR 48,14,0
Mvaa 216,64,28
TR 50,14,512
Mvaa 224,64,32
TR 52,14,8
Mvaa 228,68,32
TR 54,14,520
Mvaa 220,68,28
TR 56,14,64
Mvaa 212,68,24
TR 58,14,576
Mvaa 232,72,24
TR 60,14,72
Mvaa 240,72,28
TR 62,14,584
Mvaa 248,72,32
TR 64,14,128
Mvaa 252,76,32
TR 66,14,640
Mvaa 244,76,28
TR 68,14,136
Mvaa 236,76,24
s_waitcnt lgkmcnt(9)
TR 70,14,648
fh_q11:
Mvaa 64,48,36
s_waitcnt lgkmcnt(8)
TR 72,14,192
Mvaa 72,48,40
s_mov_b32 s3, 0x6000
TR 74,14,704
Mvaa 80,48,44
buffer_load_dwordx4 a[120:123], v31, s[16:19], s3 offen nt
Mvaa 84,52,44
TR 76,14,200
Mvaa 76,52,40
s_waitcnt lgkmcnt(9)
TR 78,14,712
Mvaa 68,52,36
buffer_load_dwordx4 a[124:127], v31, s[16:19], s3 offen offset:256 nt
Mvaa 88,56,36
s_waitcnt lgkmcnt(8)
TR 48,14,256
Mvaa 96,56,40
s_mov_b32 s3, 0xa000
TR 50,14,768
Mvaa 104,56,44
buffer_load_dwordx4 a[128:131], v31, s[12:15], s3 offen nt
Mvaa 108,60,44
TR 52,14,264
Mvaa 100,60,40
s_waitcnt lgkmcnt(9)
TR 54,14,776
Mvaa 92,60,36
buffer_load_dwordx4 a[132:135], v31, s[12:15], s3 offen offset:256 nt
Mvaa 112,64,36
s_waitcnt lgkmcnt(8)
s_mov_b32 s44, 0x3c0000
TR 56,14,320
Mvaa 120,64,40
s_add_u32 m0, s45, 0x1ce00
TR 58,14,832
Mvaa 128,64,44
buffer_load_dwordx4 v6, s[8:11], s44 offen lds
Mvaa 132,68,44
s_waitcnt lgkmcnt(8)
TR 60,14,328
Mvaa 124,68,40
s_add_u32 m0, s45, 0x1d200
TR 62,14,840
Mvaa 116,68,36
buffer_load_dwordx4 v7, s[8:11], s44 offen lds
Mvaa 136,72,36
s_waitcnt lgkmcnt(8)
TR 64,14,384
Mvaa 144,72,40
s_add_u32 m0, s45, 0x1d608
TR 66,14,896
Mvaa 152,72,44
buffer_load_dwordx4 v8, s[8:11], s44 offen lds
Mvaa 156,76,44
s_waitcnt lgkmcnt(8)
TR 68,14,392
Mvaa 148,76,40
s_add_u32 m0, s45, 0x1da08
TR 70,14,904
Mvaa 140,76,36
buffer_load_dwordx4 v9, s[8:11], s44 offen lds
Mvaa 160,48,36
TR 72,14,448
Mvaa 168,48,40
TR 74,14,960
Mvaa 176,48,44
s_waitcnt vmcnt(26) lgkmcnt(10)
RD 0,46,0
Mvaa 180,52,44
TR 76,14,456
Mvaa 172,52,40
TR 78,14,968
Mvaa 164,52,36
s_waitcnt lgkmcnt(11)
RD 4,46,2048
Mvaa 184,56,36
RD 8,46,4096
Mvaa 192,56,40
RD 12,47,0
Mvaa 200,56,44
s_waitcnt lgkmcnt(12)
RD 16,47,2048
Mvaa 204,60,44
RD 20,47,4096
Mvaa 196,60,40
v_add_u32 v14, 0x10800, v13
Mvaa 188,60,36
s_waitcnt vmcnt(32) lgkmcnt(0)
s_barrier
Mvaa 208,64,36
TR 48,14,0
Mvaa 216,64,40
TR 50,14,512
Mvaa 224,64,44
TR 52,14,8
Mvaa 228,68,44
TR 54,14,520
Mvaa 220,68,40
TR 56,14,64
Mvaa 212,68,36
TR 58,14,576
Mvaa 232,72,36
TR 60,14,72
Mvaa 240,72,40
s_branch f_pad3s
f_pad3:
s_setpc_b64 s[70:71]
f_pad3s:
TR 62,14,584
Mvaa 248,72,44
TR 64,14,128
Mvaa 252,76,44
TR 66,14,640
Mvaa 244,76,40
TR 68,14,136
Mvaa 236,76,36
s_waitcnt lgkmcnt(9)
TR 70,14,648
fh_q12:
Mvaa 64,48,0
s_waitcnt lgkmcnt(8)
s_mov_b32 s44, 0x400000
TR 72,14,192
Mvaa 72,48,4
s_add_u32 m0, s45, 0x21000
TR 74,14,704
Mvaa 80,48,8
buffer_load_dwordx4 v6, s[8:11], s44 offen lds
Mvaa 84,52,8
s_waitcnt lgkmcnt(8)
TR 76,14,200
Mvaa 76,52,4
s_add_u32 m0, s45, 0x21400
TR 78,14,712
Mvaa 68,52,0
buffer_load_dwordx4 v7, s[8:11], s44 offen lds
Mvaa 88,56,0
s_waitcnt lgkmcnt(8)
TR 48,14,256
Mvaa 96,56,4
s_add_u32 m0, s45, 0x21808
TR 50,14,768
Mvaa 104,56,8
buffer_load_dwordx4 v8, s[8:11], s44 offen lds
Mvaa 108,60,8
s_waitcnt lgkmcnt(8)
TR 52,14,264
Mvaa 100,60,4
s_add_u32 m0, s45, 0x21c08
TR 54,14,776
Mvaa 92,60,0
buffer_load_dwordx4 v9, s[8:11], s44 offen lds
Mvaa 112,64,0
s_waitcnt lgkmcnt(8)
TR 56,14,320
Mvaa 120,64,4
s_add_u32 m0, s46, 0xfffffc00
TR 58,14,832
Mvaa 128,64,8
buffer_load_dwordx4 v40, s[4:7], 0 offen offset:1024 lds
Mvaa 132,68,8
s_waitcnt lgkmcnt(8)
TR 60,14,328
Mvaa 124,68,4
s_add_u32 m0, s46, 0
TR 62,14,840
Mvaa 116,68,0
buffer_load_dwordx4 v41, s[4:7], 0 offen offset:1024 lds
Mvaa 136,72,0
s_waitcnt lgkmcnt(8)
TR 64,14,384
Mvaa 144,72,4
s_add_u32 m0, s46, 0x400
TR 66,14,896
Mvaa 152,72,8
buffer_load_dwordx4 v42, s[4:7], 0 offen offset:1024 lds
Mvaa 156,76,8
s_waitcnt lgkmcnt(8)
TR 68,14,392
Mvaa 148,76,4
s_add_u32 m0, s46, 0x800
TR 70,14,904
Mvaa 140,76,0
buffer_load_dwordx4 v43, s[4:7], 0 offen offset:1024 lds
Mvaa 160,48,0
s_waitcnt lgkmcnt(8)
TR 72,14,448
Mvaa 168,48,4
s_add_u32 m0, s46, 0xc00
TR 74,14,960
Mvaa 176,48,8
buffer_load_dwordx4 v44, s[4:7], 0 offen offset:1024 lds
Mvaa 180,52,8
s_waitcnt lgkmcnt(8)
TR 76,14,456
Mvaa 172,52,4
s_add_u32 m0, s46, 0x1000
TR 78,14,968
Mvaa 164,52,0
buffer_load_dwordx4 v45, s[4:7], 0 offen offset:1024 lds
Mvaa 184,56,0
Mvaa 192,56,4
Mvaa 200,56,8
s_waitcnt lgkmcnt(8)
Mvaa 204,60,8
Mvaa 196,60,4
v_add_u32 v14, 0x14a00, v13
Mvaa 188,60,0
s_waitcnt vmcnt(28) lgkmcnt(0)
s_barrier
Mvaa 208,64,0
TR 48,14,0
Mvaa 216,64,4
TR 50,14,512
Mvaa 224,64,8
TR 52,14,8
Mvaa 228,68,8
TR 54,14,520
Mvaa 220,68,4
TR 56,14,64
Mvaa 212,68,0
TR 58,14,576
Mvaa 232,72,0
TR 60,14,72
Mvaa 240,72,4
TR 62,14,584
Mvaa 248,72,8
TR 64,14,128
Mvaa 252,76,8
TR 66,14,640
Mvaa 244,76,4
TR 68,14,136
Mvaa 236,76,0
s_waitcnt lgkmcnt(9)
TR 70,14,648
fh_q13:
Mvaa 64,48,12
s_waitcnt lgkmcnt(8)
TR 72,14,192
Mvaa 72,48,16
s_mov_b32 s3, 0x8000
TR 74,14,704
Mvaa 80,48,20
buffer_load_dwordx4 a[136:139], v31, s[16:19], s3 offen nt
Mvaa 84,52,20
TR 76,14,200
Mvaa 76,52,16
s_waitcnt lgkmcnt(9)
TR 78,14,712
Mvaa 68,52,12
buffer_load_dwordx4 a[140:143], v31, s[16:19], s3 offen offset:256 nt
Mvaa 88,56,12
s_waitcnt lgkmcnt(8)
TR 48,14,256
Mvaa 96,56,16
s_mov_b32 s3, 0xc000
TR 50,14,768
Mvaa 104,56,20
buffer_load_dwordx4 a[144:147], v31, s[12:15], s3 offen nt
Mvaa 108,60,20
TR 52,14,264
Mvaa 100,60,16
s_waitcnt lgkmcnt(9)
TR 54,14,776
Mvaa 92,60,12
buffer_load_dwordx4 a[148:151], v31, s[12:15], s3 offen offset:256 nt
Mvaa 112,64,12
s_waitcnt lgkmcnt(8)
s_mov_b32 s44, 0x440000
TR 56,14,320
Mvaa 120,64,16
s_add_u32 m0, s45, 0x10800
TR 58,14,832
Mvaa 128,64,20
buffer_load_dwordx4 v6, s[8:11], s44 offen lds
Mvaa 132,68,20
s_waitcnt lgkmcnt(8)
TR 60,14,328
Mvaa 124,68,16
s_add_u32 m0, s45, 0x10c00
TR 62,14,840
Mvaa 116,68,12
buffer_load_dwordx4 v7, s[8:11], s44 offen lds
Mvaa 136,72,12
s_waitcnt lgkmcnt(8)
TR 64,14,384
Mvaa 144,72,16
s_add_u32 m0, s45, 0x11008
TR 66,14,896
Mvaa 152,72,20
buffer_load_dwordx4 v8, s[8:11], s44 offen lds
Mvaa 156,76,20
s_waitcnt lgkmcnt(8)
TR 68,14,392
Mvaa 148,76,16
s_add_u32 m0, s45, 0x11408
TR 70,14,904
Mvaa 140,76,12
buffer_load_dwordx4 v9, s[8:11], s44 offen lds
Mvaa 160,48,12
TR 72,14,448
Mvaa 168,48,16
TR 74,14,960
Mvaa 176,48,20
s_waitcnt vmcnt(26) lgkmcnt(10)
RD 24,46,6144
Mvaa 180,52,20
TR 76,14,456
Mvaa 172,52,16
TR 78,14,968
Mvaa 164,52,12
s_waitcnt lgkmcnt(11)
RD 28,46,8192
Mvaa 184,56,12
RD 32,46,10240
Mvaa 192,56,16
RD 36,47,6144
Mvaa 200,56,20
s_waitcnt lgkmcnt(12)
RD 40,47,8192
Mvaa 204,60,20
RD 44,47,10240
Mvaa 196,60,16
v_add_u32 v14, 0x18c00, v13
Mvaa 188,60,12
s_waitcnt vmcnt(32) lgkmcnt(0)
s_barrier
Mvaa 208,64,12
TR 48,14,0
Mvaa 216,64,16
TR 50,14,512
Mvaa 224,64,20
TR 52,14,8
Mvaa 228,68,20
TR 54,14,520
Mvaa 220,68,16
TR 56,14,64
Mvaa 212,68,12
TR 58,14,576
Mvaa 232,72,12
TR 60,14,72
Mvaa 240,72,16
TR 62,14,584
Mvaa 248,72,20
TR 64,14,128
Mvaa 252,76,20
TR 66,14,640
Mvaa 244,76,16
TR 68,14,136
Mvaa 236,76,12
s_waitcnt lgkmcnt(9)
TR 70,14,648
fh_q14:
Mvaa 64,48,24
s_waitcnt lgkmcnt(8)
s_mov_b32 s44, 0x480000
TR 72,14,192
Mvaa 72,48,28
s_add_u32 m0, s45, 0x14a00
TR 74,14,704
Mvaa 80,48,32
buffer_load_dwordx4 v6, s[8:11], s44 offen lds
Mvaa 84,52,32
s_waitcnt lgkmcnt(8)
TR 76,14,200
Mvaa 76,52,28
s_add_u32 m0, s45, 0x14e00
TR 78,14,712
Mvaa 68,52,24
buffer_load_dwordx4 v7, s[8:11], s44 offen lds
Mvaa 88,56,24
s_waitcnt lgkmcnt(8)
TR 48,14,256
Mvaa 96,56,28
s_add_u32 m0, s45, 0x15208
TR 50,14,768
Mvaa 104,56,32
buffer_load_dwordx4 v8, s[8:11], s44 offen lds
Mvaa 108,60,32
s_waitcnt lgkmcnt(8)
TR 52,14,264
Mvaa 100,60,28
s_add_u32 m0, s45, 0x15608
TR 54,14,776
Mvaa 92,60,24
buffer_load_dwordx4 v9, s[8:11], s44 offen lds
Mvaa 112,64,24
s_waitcnt lgkmcnt(8)
TR 56,14,320
Mvaa 120,64,28
s_add_u32 m0, s46, 0x1380
TR 58,14,832
Mvaa 128,64,32
buffer_load_dwordx4 v40, s[4:7], 0 offen offset:1152 lds
Mvaa 132,68,32
s_waitcnt lgkmcnt(8)
TR 60,14,328
Mvaa 124,68,28
s_add_u32 m0, s46, 0x1780
TR 62,14,840
Mvaa 116,68,24
buffer_load_dwordx4 v41, s[4:7], 0 offen offset:1152 lds
Mvaa 136,72,24
s_waitcnt lgkmcnt(8)
TR 64,14,384
Mvaa 144,72,28
s_add_u32 m0, s46, 0x1b80
TR 66,14,896
Mvaa 152,72,32
buffer_load_dwordx4 v42, s[4:7], 0 offen offset:1152 lds
Mvaa 156,76,32
s_waitcnt lgkmcnt(8)
TR 68,14,392
Mvaa 148,76,28
s_add_u32 m0, s46, 0x1f80
TR 70,14,904
Mvaa 140,76,24
buffer_load_dwordx4 v43, s[4:7], 0 offen offset:1152 lds
Mvaa 160,48,24
s_waitcnt lgkmcnt(8)
TR 72,14,448
Mvaa 168,48,28
s_add_u32 m0, s46, 0x2380
TR 74,14,960
Mvaa 176,48,32
buffer_load_dwordx4 v44, s[4:7], 0 offen offset:1152 lds
Mvaa 180,52,32
s_waitcnt lgkmcnt(8)
TR 76,14,456
Mvaa 172,52,28
s_add_u32 m0, s46, 0x2780
TR 78,14,968
Mvaa 164,52,24
buffer_load_dwordx4 v45, s[4:7], 0 offen offset:1152 lds
Mvaa 184,56,24
Mvaa 192,56,28
Mvaa 200,56,32
s_waitcnt lgkmcnt(8)
Mvaa 204,60,32
Mvaa 196,60,28
v_add_u32 v14, 0x1ce00, v13
Mvaa 188,60,24
s_waitcnt vmcnt(28) lgkmcnt(0)
s_barrier
Mvaa 208,64,24
TR 48,14,0
Mvaa 216,64,28
TR 50,14,512
Mvaa 224,64,32
TR 52,14,8
Mvaa 228,68,32
TR 54,14,520
Mvaa 220,68,28
TR 56,14,64
Mvaa 212,68,24
TR 58,14,576
Mvaa 232,72,24
TR 60,14,72
Mvaa 240,72,28
TR 62,14,584
Mvaa 248,72,32
TR 64,14,128
Mvaa 252,76,32
TR 66,14,640
Mvaa 244,76,28
TR 68,14,136
Mvaa 236,76,24
s_waitcnt lgkmcnt(9)
TR 70,14,648
fh_q15:
Mvaa 64,48,36
s_waitcnt lgkmcnt(8)
TR 72,14,192
Mvaa 72,48,40
s_mov_b32 s3, 0xa000
TR 74,14,704
Mvaa 80,48,44
buffer_load_dwordx4 a[152:155], v31, s[16:19], s3 offen nt
Mvaa 84,52,44
TR 76,14,200
Mvaa 76,52,40
s_waitcnt lgkmcnt(9)
TR 78,14,712
Mvaa 68,52,36
buffer_load_dwordx4 a[156:159], v31, s[16:19], s3 offen offset:256 nt
Mvaa 88,56,36
s_waitcnt lgkmcnt(8)
TR 48,14,256
Mvaa 96,56,40
s_mov_b32 s3, 0xe000
TR 50,14,768
Mvaa 104,56,44
buffer_load_dwordx4 a[160:163], v31, s[12:15], s3 offen nt
Mvaa 108,60,44
s_waitcnt lgkmcnt(8)
s_mov_b32 s44, 0x4c0000
TR 52,14,264
Mvaa 100,60,40
s_add_u32 m0, s45, 0x18c00
TR 54,14,776
Mvaa 92,60,36
buffer_load_dwordx4 v6, s[8:11], s44 offen lds
Mvaa 112,64,36
s_waitcnt lgkmcnt(8)
TR 56,14,320
Mvaa 120,64,40
s_add_u32 m0, s45, 0x19000
TR 58,14,832
Mvaa 128,64,44
buffer_load_dwordx4 v7, s[8:11], s44 offen lds
Mvaa 132,68,44
s_waitcnt lgkmcnt(8)
TR 60,14,328
Mvaa 124,68,40
s_add_u32 m0, s45, 0x19408
TR 62,14,840
Mvaa 116,68,36
buffer_load_dwordx4 v8, s[8:11], s44 offen lds
Mvaa 136,72,36
s_waitcnt lgkmcnt(8)
TR 64,14,384
Mvaa 144,72,40
s_add_u32 m0, s45, 0x19808
TR 66,14,896
Mvaa 152,72,44
buffer_load_dwordx4 v9, s[8:11], s44 offen lds
Mvaa 156,76,44
TR 68,14,392
Mvaa 148,76,40
TR 70,14,904
Mvaa 140,76,36
s_waitcnt vmcnt(25) lgkmcnt(10)
RD 0,46,0
Mvaa 160,48,36
TR 72,14,448
Mvaa 168,48,40
TR 74,14,960
Mvaa 176,48,44
s_waitcnt lgkmcnt(11)
RD 4,46,2048
Mvaa 180,52,44
TR 76,14,456
Mvaa 172,52,40
TR 78,14,968
Mvaa 164,52,36
s_waitcnt lgkmcnt(12)
RD 8,46,4096
Mvaa 184,56,36
RD 12,47,0
Mvaa 192,56,40
RD 16,47,2048
Mvaa 200,56,44
s_waitcnt lgkmcnt(13)
Mvaa 204,60,44
RD 20,47,4096
Mvaa 196,60,40
v_add_u32 v14, 0x21000, v13
Mvaa 188,60,36
s_waitcnt vmcnt(31) lgkmcnt(0)
s_barrier
Mvaa 208,64,36
TR 48,14,0
Mvaa 216,64,40
TR 50,14,512
Mvaa 224,64,44
TR 52,14,8
Mvaa 228,68,44
TR 54,14,520
Mvaa 220,68,40
TR 56,14,64
Mvaa 212,68,36
TR 58,14,576
Mvaa 232,72,36
TR 60,14,72
Mvaa 240,72,40
TR 62,14,584
Mvaa 248,72,44
TR 64,14,128
Mvaa 252,76,44
TR 66,14,640
Mvaa 244,76,40
TR 68,14,136
Mvaa 236,76,36
s_waitcnt lgkmcnt(9)
TR 70,14,648
fh_q16:
Mvaa 64,48,0
s_waitcnt lgkmcnt(8)
s_mov_b32 s44, 0x500000
TR 72,14,192
Mvaa 72,48,4
s_add_u32 m0, s45, 0x1ce00
TR 74,14,704
Mvaa 80,48,8
buffer_load_dwordx4 v6, s[8:11], s44 offen lds
Mvaa 84,52,8
s_waitcnt lgkmcnt(8)
TR 76,14,200
Mvaa 76,52,4
s_add_u32 m0, s45, 0x1d200
TR 78,14,712
Mvaa 68,52,0
buffer_load_dwordx4 v7, s[8:11], s44 offen lds
Mvaa 88,56,0
s_waitcnt lgkmcnt(8)
TR 48,14,256
Mvaa 96,56,4
s_add_u32 m0, s45, 0x1d608
TR 50,14,768
Mvaa 104,56,8
buffer_load_dwordx4 v8, s[8:11], s44 offen lds
Mvaa 108,60,8
s_waitcnt lgkmcnt(8)
TR 52,14,264
Mvaa 100,60,4
s_add_u32 m0, s45, 0x1da08
TR 54,14,776
Mvaa 92,60,0
buffer_load_dwordx4 v9, s[8:11], s44 offen lds
Mvaa 112,64,0
s_waitcnt lgkmcnt(8)
TR 56,14,320
Mvaa 120,64,4
s_add_u32 m0, s46, 0xfffffb00
TR 58,14,832
Mvaa 128,64,8
buffer_load_dwordx4 v40, s[4:7], 0 offen offset:1280 lds
Mvaa 132,68,8
s_waitcnt lgkmcnt(8)
TR 60,14,328
Mvaa 124,68,4
s_add_u32 m0, s46, 0xffffff00
TR 62,14,840
Mvaa 116,68,0
buffer_load_dwordx4 v41, s[4:7], 0 offen offset:1280 lds
Mvaa 136,72,0
s_waitcnt lgkmcnt(8)
TR 64,14,384
Mvaa 144,72,4
s_add_u32 m0, s46, 0x300
TR 66,14,896
Mvaa 152,72,8
buffer_load_dwordx4 v42, s[4:7], 0 offen offset:1280 lds
Mvaa 156,76,8
s_waitcnt lgkmcnt(8)
TR 68,14,392
Mvaa 148,76,4
s_add_u32 m0, s46, 0x700
TR 70,14,904
Mvaa 140,76,0
buffer_load_dwordx4 v43, s[4:7], 0 offen offset:1280 lds
Mvaa 160,48,0
s_waitcnt lgkmcnt(8)
TR 72,14,448
Mvaa 168,48,4
s_add_u32 m0, s46, 0xb00
TR 74,14,960
Mvaa 176,48,8
s_branch f_pad4s
f_pad4:
s_setpc_b64 s[70:71]
f_pad4s:
buffer_load_dwordx4 v44, s[4:7], 0 offen offset:1280 lds
Mvaa 180,52,8
s_waitcnt lgkmcnt(8)
TR 76,14,456
Mvaa 172,52,4
s_add_u32 m0, s46, 0xf00
TR 78,14,968
Mvaa 164,52,0
buffer_load_dwordx4 v45, s[4:7], 0 offen offset:1280 lds
Mvaa 184,56,0
Mvaa 192,56,4
Mvaa 200,56,8
s_waitcnt lgkmcnt(8)
Mvaa 204,60,8
Mvaa 196,60,4
v_add_u32 v14, 0x10800, v13
Mvaa 188,60,0
s_waitcnt vmcnt(27) lgkmcnt(0)
s_barrier
Mvaa 208,64,0
TR 48,14,0
Mvaa 216,64,4
TR 50,14,512
Mvaa 224,64,8
TR 52,14,8
Mvaa 228,68,8
TR 54,14,520
Mvaa 220,68,4
TR 56,14,64
Mvaa 212,68,0
TR 58,14,576
Mvaa 232,72,0
TR 60,14,72
Mvaa 240,72,4
TR 62,14,584
Mvaa 248,72,8
TR 64,14,128
Mvaa 252,76,8
TR 66,14,640
Mvaa 244,76,4
TR 68,14,136
Mvaa 236,76,0
s_waitcnt lgkmcnt(9)
TR 70,14,648
fh_q17:
Mvaa 64,48,12
TR 72,14,192
Mvaa 72,48,16
s_waitcnt lgkmcnt(9)
TR 74,14,704
Mvaa 80,48,20
buffer_load_dwordx4 a[164:167], v31, s[12:15], s3 offen offset:256 nt
Mvaa 84,52,20
s_waitcnt lgkmcnt(8)
TR 76,14,200
Mvaa 76,52,16
s_mov_b32 s3, 0xc000
TR 78,14,712
Mvaa 68,52,12
buffer_load_dwordx4 a[168:171], v31, s[16:19], s3 offen nt
Mvaa 88,56,12
TR 48,14,256
Mvaa 96,56,16
s_waitcnt lgkmcnt(9)
TR 50,14,768
Mvaa 104,56,20
buffer_load_dwordx4 a[172:175], v31, s[16:19], s3 offen offset:256 nt
Mvaa 108,60,20
s_waitcnt lgkmcnt(8)
TR 52,14,264
Mvaa 100,60,16
s_mov_b32 s3, 0x10000
TR 54,14,776
Mvaa 92,60,12
buffer_load_dwordx4 a[176:179], v31, s[12:15], s3 offen nt
Mvaa 112,64,12
s_waitcnt lgkmcnt(8)
s_mov_b32 s44, 0x540000
TR 56,14,320
Mvaa 120,64,16
s_add_u32 m0, s45, 0x21000
TR 58,14,832
Mvaa 128,64,20
buffer_load_dwordx4 v6, s[8:11], s44 offen lds
Mvaa 132,68,20
s_waitcnt lgkmcnt(8)
TR 60,14,328
Mvaa 124,68,16
s_add_u32 m0, s45, 0x21400
TR 62,14,840
Mvaa 116,68,12
buffer_load_dwordx4 v7, s[8:11], s44 offen lds
Mvaa 136,72,12
s_waitcnt lgkmcnt(8)
TR 64,14,384
Mvaa 144,72,16
s_add_u32 m0, s45, 0x21808
TR 66,14,896
Mvaa 152,72,20
buffer_load_dwordx4 v8, s[8:11], s44 offen lds
Mvaa 156,76,20
s_waitcnt lgkmcnt(8)
TR 68,14,392
Mvaa 148,76,16
s_add_u32 m0, s45, 0x21c08
TR 70,14,904
Mvaa 140,76,12
buffer_load_dwordx4 v9, s[8:11], s44 offen lds
Mvaa 160,48,12
TR 72,14,448
Mvaa 168,48,16
TR 74,14,960
Mvaa 176,48,20
s_waitcnt vmcnt(25) lgkmcnt(10)
RD 24,46,6144
Mvaa 180,52,20
TR 76,14,456
Mvaa 172,52,16
TR 78,14,968
Mvaa 164,52,12
s_waitcnt lgkmcnt(11)
RD 28,46,8192
Mvaa 184,56,12
RD 32,46,10240
Mvaa 192,56,16
RD 36,47,6144
Mvaa 200,56,20
s_waitcnt lgkmcnt(12)
RD 40,47,8192
Mvaa 204,60,20
RD 44,47,10240
Mvaa 196,60,16
v_add_u32 v14, 0x14a00, v13
Mvaa 188,60,12
s_waitcnt vmcnt(31) lgkmcnt(0)
s_barrier
Mvaa 208,64,12
TR 48,14,0
Mvaa 216,64,16
TR 50,14,512
Mvaa 224,64,20
TR 52,14,8
Mvaa 228,68,20
TR 54,14,520
Mvaa 220,68,16
TR 56,14,64
Mvaa 212,68,12
TR 58,14,576
Mvaa 232,72,12
TR 60,14,72
Mvaa 240,72,16
TR 62,14,584
Mvaa 248,72,20
TR 64,14,128
Mvaa 252,76,20
TR 66,14,640
Mvaa 244,76,16
TR 68,14,136
Mvaa 236,76,12
s_waitcnt lgkmcnt(9)
TR 70,14,648
fh_q18:
Mvaa 64,48,24
s_waitcnt lgkmcnt(8)
s_mov_b32 s44, 0x580000
TR 72,14,192
Mvaa 72,48,28
s_add_u32 m0, s45, 0x10800
TR 74,14,704
Mvaa 80,48,32
buffer_load_dwordx4 v6, s[8:11], s44 offen lds
Mvaa 84,52,32
s_waitcnt lgkmcnt(8)
TR 76,14,200
Mvaa 76,52,28
s_add_u32 m0, s45, 0x10c00
TR 78,14,712
Mvaa 68,52,24
buffer_load_dwordx4 v7, s[8:11], s44 offen lds
Mvaa 88,56,24
s_waitcnt lgkmcnt(8)
TR 48,14,256
Mvaa 96,56,28
s_add_u32 m0, s45, 0x11008
TR 50,14,768
Mvaa 104,56,32
buffer_load_dwordx4 v8, s[8:11], s44 offen lds
Mvaa 108,60,32
s_waitcnt lgkmcnt(8)
TR 52,14,264
Mvaa 100,60,28
s_add_u32 m0, s45, 0x11408
TR 54,14,776
Mvaa 92,60,24
buffer_load_dwordx4 v9, s[8:11], s44 offen lds
Mvaa 112,64,24
s_waitcnt lgkmcnt(8)
TR 56,14,320
Mvaa 120,64,28
s_add_u32 m0, s46, 0x1280
TR 58,14,832
Mvaa 128,64,32
buffer_load_dwordx4 v40, s[4:7], 0 offen offset:1408 lds
Mvaa 132,68,32
s_waitcnt lgkmcnt(8)
TR 60,14,328
Mvaa 124,68,28
s_add_u32 m0, s46, 0x1680
TR 62,14,840
Mvaa 116,68,24
buffer_load_dwordx4 v41, s[4:7], 0 offen offset:1408 lds
Mvaa 136,72,24
s_waitcnt lgkmcnt(8)
TR 64,14,384
Mvaa 144,72,28
s_add_u32 m0, s46, 0x1a80
TR 66,14,896
Mvaa 152,72,32
buffer_load_dwordx4 v42, s[4:7], 0 offen offset:1408 lds
Mvaa 156,76,32
s_waitcnt lgkmcnt(8)
TR 68,14,392
Mvaa 148,76,28
s_add_u32 m0, s46, 0x1e80
TR 70,14,904
Mvaa 140,76,24
buffer_load_dwordx4 v43, s[4:7], 0 offen offset:1408 lds
Mvaa 160,48,24
s_waitcnt lgkmcnt(8)
TR 72,14,448
Mvaa 168,48,28
s_add_u32 m0, s46, 0x2280
TR 74,14,960
Mvaa 176,48,32
buffer_load_dwordx4 v44, s[4:7], 0 offen offset:1408 lds
Mvaa 180,52,32
s_waitcnt lgkmcnt(8)
TR 76,14,456
Mvaa 172,52,28
s_add_u32 m0, s46, 0x2680
TR 78,14,968
Mvaa 164,52,24
buffer_load_dwordx4 v45, s[4:7], 0 offen offset:1408 lds
Mvaa 184,56,24
Mvaa 192,56,28
Mvaa 200,56,32
s_waitcnt lgkmcnt(8)
Mvaa 204,60,32
Mvaa 196,60,28
v_add_u32 v14, 0x18c00, v13
Mvaa 188,60,24
s_waitcnt vmcnt(28) lgkmcnt(0)
s_barrier
Mvaa 208,64,24
TR 48,14,0
Mvaa 216,64,28
TR 50,14,512
Mvaa 224,64,32
TR 52,14,8
Mvaa 228,68,32
TR 54,14,520
Mvaa 220,68,28
TR 56,14,64
Mvaa 212,68,24
TR 58,14,576
Mvaa 232,72,24
TR 60,14,72
Mvaa 240,72,28
TR 62,14,584
Mvaa 248,72,32
TR 64,14,128
Mvaa 252,76,32
TR 66,14,640
Mvaa 244,76,28
TR 68,14,136
Mvaa 236,76,24
s_waitcnt lgkmcnt(9)
TR 70,14,648
fh_q19:
Mvaa 64,48,36
TR 72,14,192
Mvaa 72,48,40
s_waitcnt lgkmcnt(9)
TR 74,14,704
Mvaa 80,48,44
buffer_load_dwordx4 a[180:183], v31, s[12:15], s3 offen offset:256 nt
Mvaa 84,52,44
s_waitcnt lgkmcnt(8)
TR 76,14,200
Mvaa 76,52,40
s_mov_b32 s3, 0xe000
TR 78,14,712
Mvaa 68,52,36
buffer_load_dwordx4 a[184:187], v31, s[16:19], s3 offen nt
Mvaa 88,56,36
TR 48,14,256
Mvaa 96,56,40
s_waitcnt lgkmcnt(9)
TR 50,14,768
Mvaa 104,56,44
buffer_load_dwordx4 a[188:191], v31, s[16:19], s3 offen offset:256 nt
Mvaa 108,60,44
s_waitcnt lgkmcnt(8)
TR 52,14,264
Mvaa 100,60,40
s_mov_b32 s3, 0x12000
TR 54,14,776
Mvaa 92,60,36
buffer_load_dwordx4 a[192:195], v31, s[12:15], s3 offen nt
Mvaa 112,64,36
s_waitcnt lgkmcnt(8)
s_mov_b32 s44, 0x5c0000
TR 56,14,320
Mvaa 120,64,40
s_add_u32 m0, s45, 0x14a00
TR 58,14,832
Mvaa 128,64,44
buffer_load_dwordx4 v6, s[8:11], s44 offen lds
Mvaa 132,68,44
s_waitcnt lgkmcnt(8)
TR 60,14,328
Mvaa 124,68,40
s_add_u32 m0, s45, 0x14e00
TR 62,14,840
Mvaa 116,68,36
buffer_load_dwordx4 v7, s[8:11], s44 offen lds
Mvaa 136,72,36
s_waitcnt lgkmcnt(8)
TR 64,14,384
Mvaa 144,72,40
s_add_u32 m0, s45, 0x15208
TR 66,14,896
Mvaa 152,72,44
buffer_load_dwordx4 v8, s[8:11], s44 offen lds
Mvaa 156,76,44
s_waitcnt lgkmcnt(8)
TR 68,14,392
Mvaa 148,76,40
s_add_u32 m0, s45, 0x15608
TR 70,14,904
Mvaa 140,76,36
buffer_load_dwordx4 v9, s[8:11], s44 offen lds
Mvaa 160,48,36
TR 72,14,448
Mvaa 168,48,40
TR 74,14,960
Mvaa 176,48,44
s_waitcnt vmcnt(26) lgkmcnt(10)
RD 0,46,0
Mvaa 180,52,44
TR 76,14,456
Mvaa 172,52,40
TR 78,14,968
Mvaa 164,52,36
s_waitcnt lgkmcnt(11)
RD 4,46,2048
Mvaa 184,56,36
RD 8,46,4096
Mvaa 192,56,40
RD 12,47,0
Mvaa 200,56,44
s_waitcnt lgkmcnt(12)
RD 16,47,2048
Mvaa 204,60,44
RD 20,47,4096
Mvaa 196,60,40
v_add_u32 v14, 0x1ce00, v13
Mvaa 188,60,36
s_waitcnt vmcnt(32) lgkmcnt(0)
s_barrier
Mvaa 208,64,36
TR 48,14,0
Mvaa 216,64,40
TR 50,14,512
Mvaa 224,64,44
TR 52,14,8
Mvaa 228,68,44
TR 54,14,520
Mvaa 220,68,40
TR 56,14,64
Mvaa 212,68,36
TR 58,14,576
Mvaa 232,72,36
TR 60,14,72
Mvaa 240,72,40
TR 62,14,584
Mvaa 248,72,44
TR 64,14,128
Mvaa 252,76,44
TR 66,14,640
Mvaa 244,76,40
TR 68,14,136
Mvaa 236,76,36
s_waitcnt lgkmcnt(9)
TR 70,14,648
fh_q20:
Mvaa 64,48,0
s_waitcnt lgkmcnt(8)
s_mov_b32 s44, 0x600000
TR 72,14,192
Mvaa 72,48,4
s_add_u32 m0, s45, 0x18c00
TR 74,14,704
Mvaa 80,48,8
buffer_load_dwordx4 v6, s[8:11], s44 offen lds
Mvaa 84,52,8
s_waitcnt lgkmcnt(8)
TR 76,14,200
Mvaa 76,52,4
s_add_u32 m0, s45, 0x19000
TR 78,14,712
Mvaa 68,52,0
buffer_load_dwordx4 v7, s[8:11], s44 offen lds
Mvaa 88,56,0
s_waitcnt lgkmcnt(8)
TR 48,14,256
Mvaa 96,56,4
s_add_u32 m0, s45, 0x19408
TR 50,14,768
Mvaa 104,56,8
buffer_load_dwordx4 v8, s[8:11], s44 offen lds
Mvaa 108,60,8
s_waitcnt lgkmcnt(8)
TR 52,14,264
Mvaa 100,60,4
s_add_u32 m0, s45, 0x19808
TR 54,14,776
Mvaa 92,60,0
buffer_load_dwordx4 v9, s[8:11], s44 offen lds
Mvaa 112,64,0
s_waitcnt lgkmcnt(8)
TR 56,14,320
Mvaa 120,64,4
s_add_u32 m0, s46, 0xfffffa00
TR 58,14,832
Mvaa 128,64,8
buffer_load_dwordx4 v40, s[4:7], 0 offen offset:1536 lds
Mvaa 132,68,8
s_waitcnt lgkmcnt(8)
TR 60,14,328
Mvaa 124,68,4
s_add_u32 m0, s46, 0xfffffe00
TR 62,14,840
Mvaa 116,68,0
buffer_load_dwordx4 v41, s[4:7], 0 offen offset:1536 lds
Mvaa 136,72,0
s_waitcnt lgkmcnt(8)
TR 64,14,384
Mvaa 144,72,4
s_add_u32 m0, s46, 0x200
TR 66,14,896
Mvaa 152,72,8
buffer_load_dwordx4 v42, s[4:7], 0 offen offset:1536 lds
Mvaa 156,76,8
s_waitcnt lgkmcnt(8)
TR 68,14,392
Mvaa 148,76,4
s_add_u32 m0, s46, 0x600
TR 70,14,904
Mvaa 140,76,0
buffer_load_dwordx4 v43, s[4:7], 0 offen offset:1536 lds
Mvaa 160,48,0
s_waitcnt lgkmcnt(8)
TR 72,14,448
Mvaa 168,48,4
s_add_u32 m0, s46, 0xa00
TR 74,14,960
Mvaa 176,48,8
buffer_load_dwordx4 v44, s[4:7], 0 offen offset:1536 lds
Mvaa 180,52,8
s_waitcnt lgkmcnt(8)
TR 76,14,456
Mvaa 172,52,4
s_add_u32 m0, s46, 0xe00
TR 78,14,968
Mvaa 164,52,0
buffer_load_dwordx4 v45, s[4:7], 0 offen offset:1536 lds
Mvaa 184,56,0
Mvaa 192,56,4
Mvaa 200,56,8
s_waitcnt lgkmcnt(8)
Mvaa 204,60,8
Mvaa 196,60,4
v_add_u32 v14, 0x21000, v13
Mvaa 188,60,0
s_waitcnt vmcnt(28) lgkmcnt(0)
s_barrier
Mvaa 208,64,0
TR 48,14,0
Mvaa 216,64,4
TR 50,14,512
Mvaa 224,64,8
TR 52,14,8
Mvaa 228,68,8
TR 54,14,520
Mvaa 220,68,4
TR 56,14,64
Mvaa 212,68,0
TR 58,14,576
Mvaa 232,72,0
TR 60,14,72
Mvaa 240,72,4
TR 62,14,584
Mvaa 248,72,8
TR 64,14,128
Mvaa 252,76,8
TR 66,14,640
Mvaa 244,76,4
TR 68,14,136
Mvaa 236,76,0
s_waitcnt lgkmcnt(9)
TR 70,14,648
fh_q21:
Mvaa 64,48,12
TR 72,14,192
Mvaa 72,48,16
s_waitcnt lgkmcnt(9)
TR 74,14,704
Mvaa 80,48,20
buffer_load_dwordx4 a[196:199], v31, s[12:15], s3 offen offset:256 nt
Mvaa 84,52,20
s_waitcnt lgkmcnt(8)
TR 76,14,200
Mvaa 76,52,16
s_mov_b32 s3, 0x10000
TR 78,14,712
Mvaa 68,52,12
buffer_load_dwordx4 a[200:203], v31, s[16:19], s3 offen nt
Mvaa 88,56,12
TR 48,14,256
Mvaa 96,56,16
s_waitcnt lgkmcnt(9)
TR 50,14,768
Mvaa 104,56,20
buffer_load_dwordx4 a[204:207], v31, s[16:19], s3 offen offset:256 nt
Mvaa 108,60,20
s_waitcnt lgkmcnt(8)
TR 52,14,264
Mvaa 100,60,16
s_mov_b32 s3, 0x14000
TR 54,14,776
Mvaa 92,60,12
buffer_load_dwordx4 a[208:211], v31, s[12:15], s3 offen nt
Mvaa 112,64,12
s_waitcnt lgkmcnt(8)
s_mov_b32 s44, 0x640000
TR 56,14,320
Mvaa 120,64,16
s_add_u32 m0, s45, 0x1ce00
TR 58,14,832
Mvaa 128,64,20
s_branch f_pad5s
f_pad5:
s_setpc_b64 s[70:71]
f_pad5s:
buffer_load_dwordx4 v6, s[8:11], s44 offen lds
Mvaa 132,68,20
s_waitcnt lgkmcnt(8)
TR 60,14,328
Mvaa 124,68,16
s_add_u32 m0, s45, 0x1d200
TR 62,14,840
Mvaa 116,68,12
buffer_load_dwordx4 v7, s[8:11], s44 offen lds
Mvaa 136,72,12
s_waitcnt lgkmcnt(8)
TR 64,14,384
Mvaa 144,72,16
s_add_u32 m0, s45, 0x1d608
TR 66,14,896
Mvaa 152,72,20
buffer_load_dwordx4 v8, s[8:11], s44 offen lds
Mvaa 156,76,20
s_waitcnt lgkmcnt(8)
TR 68,14,392
Mvaa 148,76,16
s_add_u32 m0, s45, 0x1da08
TR 70,14,904
Mvaa 140,76,12
buffer_load_dwordx4 v9, s[8:11], s44 offen lds
Mvaa 160,48,12
TR 72,14,448
Mvaa 168,48,16
TR 74,14,960
Mvaa 176,48,20
s_waitcnt vmcnt(26) lgkmcnt(10)
RD 24,46,6144
Mvaa 180,52,20
TR 76,14,456
Mvaa 172,52,16
TR 78,14,968
Mvaa 164,52,12
s_waitcnt lgkmcnt(11)
RD 28,46,8192
Mvaa 184,56,12
RD 32,46,10240
Mvaa 192,56,16
RD 36,47,6144
Mvaa 200,56,20
s_waitcnt lgkmcnt(12)
RD 40,47,8192
Mvaa 204,60,20
RD 44,47,10240
Mvaa 196,60,16
v_add_u32 v14, 0x10800, v13
Mvaa 188,60,12
s_waitcnt vmcnt(32) lgkmcnt(0)
s_barrier
Mvaa 208,64,12
TR 48,14,0
Mvaa 216,64,16
TR 50,14,512
Mvaa 224,64,20
TR 52,14,8
Mvaa 228,68,20
TR 54,14,520
Mvaa 220,68,16
TR 56,14,64
Mvaa 212,68,12
TR 58,14,576
Mvaa 232,72,12
TR 60,14,72
Mvaa 240,72,16
TR 62,14,584
Mvaa 248,72,20
TR 64,14,128
Mvaa 252,76,20
TR 66,14,640
Mvaa 244,76,16
TR 68,14,136
Mvaa 236,76,12
s_waitcnt lgkmcnt(9)
TR 70,14,648
fh_q22:
Mvaa 64,48,24
s_waitcnt lgkmcnt(8)
s_mov_b32 s44, 0x680000
TR 72,14,192
Mvaa 72,48,28
s_add_u32 m0, s45, 0x21000
TR 74,14,704
Mvaa 80,48,32
buffer_load_dwordx4 v6, s[8:11], s44 offen lds
Mvaa 84,52,32
s_waitcnt lgkmcnt(8)
TR 76,14,200
Mvaa 76,52,28
s_add_u32 m0, s45, 0x21400
TR 78,14,712
Mvaa 68,52,24
buffer_load_dwordx4 v7, s[8:11], s44 offen lds
Mvaa 88,56,24
s_waitcnt lgkmcnt(8)
TR 48,14,256
Mvaa 96,56,28
s_add_u32 m0, s45, 0x21808
TR 50,14,768
Mvaa 104,56,32
buffer_load_dwordx4 v8, s[8:11], s44 offen lds
Mvaa 108,60,32
s_waitcnt lgkmcnt(8)
TR 52,14,264
Mvaa 100,60,28
s_add_u32 m0, s45, 0x21c08
TR 54,14,776
Mvaa 92,60,24
buffer_load_dwordx4 v9, s[8:11], s44 offen lds
Mvaa 112,64,24
s_waitcnt lgkmcnt(8)
TR 56,14,320
Mvaa 120,64,28
s_add_u32 m0, s46, 0x1180
TR 58,14,832
Mvaa 128,64,32
buffer_load_dwordx4 v40, s[4:7], 0 offen offset:1664 lds
Mvaa 132,68,32
s_waitcnt lgkmcnt(8)
TR 60,14,328
Mvaa 124,68,28
s_add_u32 m0, s46, 0x1580
TR 62,14,840
Mvaa 116,68,24
buffer_load_dwordx4 v41, s[4:7], 0 offen offset:1664 lds
Mvaa 136,72,24
s_waitcnt lgkmcnt(8)
TR 64,14,384
Mvaa 144,72,28
s_add_u32 m0, s46, 0x1980
TR 66,14,896
Mvaa 152,72,32
buffer_load_dwordx4 v42, s[4:7], 0 offen offset:1664 lds
Mvaa 156,76,32
s_waitcnt lgkmcnt(8)
TR 68,14,392
Mvaa 148,76,28
s_add_u32 m0, s46, 0x1d80
TR 70,14,904
Mvaa 140,76,24
buffer_load_dwordx4 v43, s[4:7], 0 offen offset:1664 lds
Mvaa 160,48,24
s_waitcnt lgkmcnt(8)
TR 72,14,448
Mvaa 168,48,28
s_add_u32 m0, s46, 0x2180
TR 74,14,960
Mvaa 176,48,32
buffer_load_dwordx4 v44, s[4:7], 0 offen offset:1664 lds
Mvaa 180,52,32
s_waitcnt lgkmcnt(8)
TR 76,14,456
Mvaa 172,52,28
s_add_u32 m0, s46, 0x2580
TR 78,14,968
Mvaa 164,52,24
buffer_load_dwordx4 v45, s[4:7], 0 offen offset:1664 lds
Mvaa 184,56,24
Mvaa 192,56,28
Mvaa 200,56,32
s_waitcnt lgkmcnt(8)
Mvaa 204,60,32
Mvaa 196,60,28
v_add_u32 v14, 0x14a00, v13
Mvaa 188,60,24
s_waitcnt vmcnt(28) lgkmcnt(0)
s_barrier
Mvaa 208,64,24
TR 48,14,0
Mvaa 216,64,28
TR 50,14,512
Mvaa 224,64,32
TR 52,14,8
Mvaa 228,68,32
TR 54,14,520
Mvaa 220,68,28
TR 56,14,64
Mvaa 212,68,24
TR 58,14,576
Mvaa 232,72,24
TR 60,14,72
Mvaa 240,72,28
TR 62,14,584
Mvaa 248,72,32
TR 64,14,128
Mvaa 252,76,32
TR 66,14,640
Mvaa 244,76,28
TR 68,14,136
Mvaa 236,76,24
s_waitcnt lgkmcnt(9)
TR 70,14,648
fh_q23:
Mvaa 64,48,36
TR 72,14,192
Mvaa 72,48,40
s_waitcnt lgkmcnt(9)
TR 74,14,704
Mvaa 80,48,44
buffer_load_dwordx4 a[212:215], v31, s[12:15], s3 offen offset:256 nt
Mvaa 84,52,44
s_waitcnt lgkmcnt(8)
TR 76,14,200
Mvaa 76,52,40
s_mov_b32 s3, 0x12000
TR 78,14,712
Mvaa 68,52,36
buffer_load_dwordx4 a[216:219], v31, s[16:19], s3 offen nt
Mvaa 88,56,36
TR 48,14,256
Mvaa 96,56,40
s_waitcnt lgkmcnt(9)
TR 50,14,768
Mvaa 104,56,44
buffer_load_dwordx4 a[220:223], v31, s[16:19], s3 offen offset:256 nt
Mvaa 108,60,44
s_waitcnt lgkmcnt(8)
TR 52,14,264
Mvaa 100,60,40
s_mov_b32 s3, 0x16000
TR 54,14,776
Mvaa 92,60,36
buffer_load_dwordx4 a[224:227], v31, s[12:15], s3 offen nt
Mvaa 112,64,36
s_waitcnt lgkmcnt(8)
s_mov_b32 s44, 0x6c0000
TR 56,14,320
Mvaa 120,64,40
s_add_u32 m0, s45, 0x10800
TR 58,14,832
Mvaa 128,64,44
buffer_load_dwordx4 v6, s[8:11], s44 offen lds
Mvaa 132,68,44
s_waitcnt lgkmcnt(8)
TR 60,14,328
Mvaa 124,68,40
s_add_u32 m0, s45, 0x10c00
TR 62,14,840
Mvaa 116,68,36
buffer_load_dwordx4 v7, s[8:11], s44 offen lds
Mvaa 136,72,36
s_waitcnt lgkmcnt(8)
TR 64,14,384
Mvaa 144,72,40
s_add_u32 m0, s45, 0x11008
TR 66,14,896
Mvaa 152,72,44
buffer_load_dwordx4 v8, s[8:11], s44 offen lds
Mvaa 156,76,44
s_waitcnt lgkmcnt(8)
TR 68,14,392
Mvaa 148,76,40
s_add_u32 m0, s45, 0x11408
TR 70,14,904
Mvaa 140,76,36
buffer_load_dwordx4 v9, s[8:11], s44 offen lds
Mvaa 160,48,36
TR 72,14,448
Mvaa 168,48,40
TR 74,14,960
Mvaa 176,48,44
s_waitcnt vmcnt(26) lgkmcnt(10)
RD 0,46,0
Mvaa 180,52,44
TR 76,14,456
Mvaa 172,52,40
TR 78,14,968
Mvaa 164,52,36
s_waitcnt lgkmcnt(11)
RD 4,46,2048
Mvaa 184,56,36
RD 8,46,4096
Mvaa 192,56,40
RD 12,47,0
Mvaa 200,56,44
s_waitcnt lgkmcnt(12)
RD 16,47,2048
Mvaa 204,60,44
RD 20,47,4096
Mvaa 196,60,40
v_add_u32 v14, 0x18c00, v13
Mvaa 188,60,36
s_waitcnt vmcnt(32) lgkmcnt(0)
s_barrier
Mvaa 208,64,36
TR 48,14,0
Mvaa 216,64,40
TR 50,14,512
Mvaa 224,64,44
TR 52,14,8
Mvaa 228,68,44
TR 54,14,520
Mvaa 220,68,40
TR 56,14,64
Mvaa 212,68,36
TR 58,14,576
Mvaa 232,72,36
TR 60,14,72
Mvaa 240,72,40
TR 62,14,584
Mvaa 248,72,44
TR 64,14,128
Mvaa 252,76,44
TR 66,14,640
Mvaa 244,76,40
TR 68,14,136
Mvaa 236,76,36
s_waitcnt lgkmcnt(9)
TR 70,14,648
fh_q24:
Mvaa 64,48,0
s_waitcnt lgkmcnt(8)
s_mov_b32 s44, 0x700000
TR 72,14,192
Mvaa 72,48,4
s_add_u32 m0, s45, 0x14a00
TR 74,14,704
Mvaa 80,48,8
buffer_load_dwordx4 v6, s[8:11], s44 offen lds
Mvaa 84,52,8
s_waitcnt lgkmcnt(8)
TR 76,14,200
Mvaa 76,52,4
s_add_u32 m0, s45, 0x14e00
TR 78,14,712
Mvaa 68,52,0
buffer_load_dwordx4 v7, s[8:11], s44 offen lds
Mvaa 88,56,0
s_waitcnt lgkmcnt(8)
TR 48,14,256
Mvaa 96,56,4
s_add_u32 m0, s45, 0x15208
TR 50,14,768
Mvaa 104,56,8
buffer_load_dwordx4 v8, s[8:11], s44 offen lds
Mvaa 108,60,8
s_waitcnt lgkmcnt(8)
TR 52,14,264
Mvaa 100,60,4
s_add_u32 m0, s45, 0x15608
TR 54,14,776
Mvaa 92,60,0
buffer_load_dwordx4 v9, s[8:11], s44 offen lds
Mvaa 112,64,0
s_waitcnt lgkmcnt(8)
TR 56,14,320
Mvaa 120,64,4
s_add_u32 m0, s46, 0xfffff900
TR 58,14,832
Mvaa 128,64,8
buffer_load_dwordx4 v40, s[4:7], 0 offen offset:1792 lds
Mvaa 132,68,8
s_waitcnt lgkmcnt(8)
TR 60,14,328
Mvaa 124,68,4
s_add_u32 m0, s46, 0xfffffd00
TR 62,14,840
Mvaa 116,68,0
buffer_load_dwordx4 v41, s[4:7], 0 offen offset:1792 lds
Mvaa 136,72,0
s_waitcnt lgkmcnt(8)
TR 64,14,384
Mvaa 144,72,4
s_add_u32 m0, s46, 0x100
TR 66,14,896
Mvaa 152,72,8
buffer_load_dwordx4 v42, s[4:7], 0 offen offset:1792 lds
Mvaa 156,76,8
s_waitcnt lgkmcnt(8)
TR 68,14,392
Mvaa 148,76,4
s_add_u32 m0, s46, 0x500
TR 70,14,904
Mvaa 140,76,0
buffer_load_dwordx4 v43, s[4:7], 0 offen offset:1792 lds
Mvaa 160,48,0
s_waitcnt lgkmcnt(8)
TR 72,14,448
Mvaa 168,48,4
s_add_u32 m0, s46, 0x900
TR 74,14,960
Mvaa 176,48,8
buffer_load_dwordx4 v44, s[4:7], 0 offen offset:1792 lds
Mvaa 180,52,8
s_waitcnt lgkmcnt(8)
TR 76,14,456
Mvaa 172,52,4
s_add_u32 m0, s46, 0xd00
TR 78,14,968
Mvaa 164,52,0
buffer_load_dwordx4 v45, s[4:7], 0 offen offset:1792 lds
Mvaa 184,56,0
Mvaa 192,56,4
Mvaa 200,56,8
s_waitcnt lgkmcnt(8)
Mvaa 204,60,8
Mvaa 196,60,4
v_add_u32 v14, 0x1ce00, v13
Mvaa 188,60,0
s_waitcnt vmcnt(28) lgkmcnt(0)
s_barrier
Mvaa 208,64,0
TR 48,14,0
Mvaa 216,64,4
TR 50,14,512
Mvaa 224,64,8
TR 52,14,8
Mvaa 228,68,8
TR 54,14,520
Mvaa 220,68,4
TR 56,14,64
Mvaa 212,68,0
TR 58,14,576
Mvaa 232,72,0
TR 60,14,72
Mvaa 240,72,4
TR 62,14,584
Mvaa 248,72,8
TR 64,14,128
Mvaa 252,76,8
TR 66,14,640
Mvaa 244,76,4
TR 68,14,136
Mvaa 236,76,0
s_waitcnt lgkmcnt(9)
TR 70,14,648
fh_q25:
Mvaa 64,48,12
TR 72,14,192
Mvaa 72,48,16
s_waitcnt lgkmcnt(9)
TR 74,14,704
Mvaa 80,48,20
buffer_load_dwordx4 a[228:231], v31, s[12:15], s3 offen offset:256 nt
Mvaa 84,52,20
s_waitcnt lgkmcnt(8)
TR 76,14,200
Mvaa 76,52,16
s_mov_b32 s3, 0x14000
TR 78,14,712
Mvaa 68,52,12
buffer_load_dwordx4 a[232:235], v31, s[16:19], s3 offen nt
Mvaa 88,56,12
TR 48,14,256
Mvaa 96,56,16
s_waitcnt lgkmcnt(9)
TR 50,14,768
Mvaa 104,56,20
buffer_load_dwordx4 a[236:239], v31, s[16:19], s3 offen offset:256 nt
Mvaa 108,60,20
s_waitcnt lgkmcnt(8)
TR 52,14,264
Mvaa 100,60,16
s_mov_b32 s3, 0x18000
TR 54,14,776
Mvaa 92,60,12
buffer_load_dwordx4 a[240:243], v31, s[12:15], s3 offen nt
Mvaa 112,64,12
s_waitcnt lgkmcnt(8)
s_mov_b32 s44, 0x740000
TR 56,14,320
Mvaa 120,64,16
s_add_u32 m0, s45, 0x18c00
TR 58,14,832
Mvaa 128,64,20
buffer_load_dwordx4 v6, s[8:11], s44 offen lds
Mvaa 132,68,20
s_waitcnt lgkmcnt(8)
TR 60,14,328
Mvaa 124,68,16
s_add_u32 m0, s45, 0x19000
TR 62,14,840
Mvaa 116,68,12
buffer_load_dwordx4 v7, s[8:11], s44 offen lds
Mvaa 136,72,12
s_waitcnt lgkmcnt(8)
TR 64,14,384
Mvaa 144,72,16
s_add_u32 m0, s45, 0x19408
TR 66,14,896
Mvaa 152,72,20
buffer_load_dwordx4 v8, s[8:11], s44 offen lds
Mvaa 156,76,20
s_waitcnt lgkmcnt(8)
TR 68,14,392
Mvaa 148,76,16
s_add_u32 m0, s45, 0x19808
TR 70,14,904
Mvaa 140,76,12
buffer_load_dwordx4 v9, s[8:11], s44 offen lds
Mvaa 160,48,12
TR 72,14,448
Mvaa 168,48,16
TR 74,14,960
Mvaa 176,48,20
s_waitcnt vmcnt(26) lgkmcnt(10)
RD 24,46,6144
Mvaa 180,52,20
TR 76,14,456
Mvaa 172,52,16
TR 78,14,968
Mvaa 164,52,12
s_waitcnt lgkmcnt(11)
RD 28,46,8192
Mvaa 184,56,12
RD 32,46,10240
Mvaa 192,56,16
RD 36,47,6144
Mvaa 200,56,20
s_waitcnt lgkmcnt(12)
RD 40,47,8192
Mvaa 204,60,20
RD 44,47,10240
Mvaa 196,60,16
v_add_u32 v14, 0x21000, v13
Mvaa 188,60,12
s_waitcnt vmcnt(32) lgkmcnt(0)
s_barrier
Mvaa 208,64,12
TR 48,14,0
Mvaa 216,64,16
TR 50,14,512
Mvaa 224,64,20
TR 52,14,8
Mvaa 228,68,20
TR 54,14,520
Mvaa 220,68,16
TR 56,14,64
Mvaa 212,68,12
TR 58,14,576
Mvaa 232,72,12
TR 60,14,72
Mvaa 240,72,16
TR 62,14,584
Mvaa 248,72,20
TR 64,14,128
Mvaa 252,76,20
TR 66,14,640
Mvaa 244,76,16
TR 68,14,136
Mvaa 236,76,12
s_waitcnt lgkmcnt(9)
TR 70,14,648
fh_q26:
Mvaa 64,48,24
s_branch f_pad6s
f_pad6:
s_setpc_b64 s[70:71]
f_pad6s:
s_waitcnt lgkmcnt(8)
s_mov_b32 s44, 0x780000
TR 72,14,192
Mvaa 72,48,28
s_add_u32 m0, s45, 0x1ce00
TR 74,14,704
Mvaa 80,48,32
buffer_load_dwordx4 v6, s[8:11], s44 offen lds
Mvaa 84,52,32
s_waitcnt lgkmcnt(8)
TR 76,14,200
Mvaa 76,52,28
s_add_u32 m0, s45, 0x1d200
TR 78,14,712
Mvaa 68,52,24
buffer_load_dwordx4 v7, s[8:11], s44 offen lds
Mvaa 88,56,24
s_waitcnt lgkmcnt(8)
TR 48,14,256
Mvaa 96,56,28
s_add_u32 m0, s45, 0x1d608
TR 50,14,768
Mvaa 104,56,32
buffer_load_dwordx4 v8, s[8:11], s44 offen lds
Mvaa 108,60,32
s_waitcnt lgkmcnt(8)
TR 52,14,264
Mvaa 100,60,28
s_add_u32 m0, s45, 0x1da08
TR 54,14,776
Mvaa 92,60,24
buffer_load_dwordx4 v9, s[8:11], s44 offen lds
Mvaa 112,64,24
s_waitcnt lgkmcnt(8)
TR 56,14,320
Mvaa 120,64,28
s_add_u32 m0, s46, 0x1080
TR 58,14,832
Mvaa 128,64,32
buffer_load_dwordx4 v40, s[4:7], 0 offen offset:1920 lds
Mvaa 132,68,32
s_waitcnt lgkmcnt(8)
TR 60,14,328
Mvaa 124,68,28
s_add_u32 m0, s46, 0x1480
TR 62,14,840
Mvaa 116,68,24
buffer_load_dwordx4 v41, s[4:7], 0 offen offset:1920 lds
Mvaa 136,72,24
s_waitcnt lgkmcnt(8)
TR 64,14,384
Mvaa 144,72,28
s_add_u32 m0, s46, 0x1880
TR 66,14,896
Mvaa 152,72,32
buffer_load_dwordx4 v42, s[4:7], 0 offen offset:1920 lds
Mvaa 156,76,32
s_waitcnt lgkmcnt(8)
TR 68,14,392
Mvaa 148,76,28
s_add_u32 m0, s46, 0x1c80
TR 70,14,904
Mvaa 140,76,24
buffer_load_dwordx4 v43, s[4:7], 0 offen offset:1920 lds
Mvaa 160,48,24
s_waitcnt lgkmcnt(8)
TR 72,14,448
Mvaa 168,48,28
s_add_u32 m0, s46, 0x2080
TR 74,14,960
Mvaa 176,48,32
buffer_load_dwordx4 v44, s[4:7], 0 offen offset:1920 lds
Mvaa 180,52,32
s_waitcnt lgkmcnt(8)
TR 76,14,456
Mvaa 172,52,28
s_add_u32 m0, s46, 0x2480
TR 78,14,968
Mvaa 164,52,24
buffer_load_dwordx4 v45, s[4:7], 0 offen offset:1920 lds
Mvaa 184,56,24
Mvaa 192,56,28
Mvaa 200,56,32
s_waitcnt lgkmcnt(8)
Mvaa 204,60,32
Mvaa 196,60,28
v_add_u32 v14, 0x10800, v13
Mvaa 188,60,24
s_waitcnt vmcnt(28) lgkmcnt(0)
s_barrier
Mvaa 208,64,24
TR 48,14,0
Mvaa 216,64,28
TR 50,14,512
Mvaa 224,64,32
TR 52,14,8
Mvaa 228,68,32
TR 54,14,520
Mvaa 220,68,28
TR 56,14,64
Mvaa 212,68,24
TR 58,14,576
Mvaa 232,72,24
TR 60,14,72
Mvaa 240,72,28
TR 62,14,584
Mvaa 248,72,32
TR 64,14,128
Mvaa 252,76,32
TR 66,14,640
Mvaa 244,76,28
TR 68,14,136
Mvaa 236,76,24
s_waitcnt lgkmcnt(9)
TR 70,14,648
fh_q27:
Mvaa 64,48,36
TR 72,14,192
Mvaa 72,48,40
s_waitcnt lgkmcnt(9)
TR 74,14,704
Mvaa 80,48,44
buffer_load_dwordx4 a[244:247], v31, s[12:15], s3 offen offset:256 nt
Mvaa 84,52,44
s_waitcnt lgkmcnt(8)
TR 76,14,200
Mvaa 76,52,40
s_mov_b32 s3, 0x16000
TR 78,14,712
Mvaa 68,52,36
buffer_load_dwordx4 a[248:251], v31, s[16:19], s3 offen nt
Mvaa 88,56,36
TR 48,14,256
Mvaa 96,56,40
s_waitcnt lgkmcnt(9)
TR 50,14,768
Mvaa 104,56,44
buffer_load_dwordx4 a[252:255], v31, s[16:19], s3 offen offset:256 nt
Mvaa 108,60,44
s_waitcnt lgkmcnt(8)
s_mov_b32 s44, 0x7c0000
TR 52,14,264
Mvaa 100,60,40
s_add_u32 m0, s45, 0x21000
TR 54,14,776
Mvaa 92,60,36
buffer_load_dwordx4 v6, s[8:11], s44 offen lds
Mvaa 112,64,36
s_waitcnt lgkmcnt(8)
TR 56,14,320
Mvaa 120,64,40
s_add_u32 m0, s45, 0x21400
TR 58,14,832
Mvaa 128,64,44
buffer_load_dwordx4 v7, s[8:11], s44 offen lds
Mvaa 132,68,44
s_waitcnt lgkmcnt(8)
TR 60,14,328
Mvaa 124,68,40
s_add_u32 m0, s45, 0x21808
TR 62,14,840
Mvaa 116,68,36
buffer_load_dwordx4 v8, s[8:11], s44 offen lds
Mvaa 136,72,36
s_waitcnt lgkmcnt(8)
TR 64,14,384
Mvaa 144,72,40
s_add_u32 m0, s45, 0x21c08
TR 66,14,896
Mvaa 152,72,44
buffer_load_dwordx4 v9, s[8:11], s44 offen lds
Mvaa 156,76,44
TR 68,14,392
Mvaa 148,76,40
TR 70,14,904
Mvaa 140,76,36
s_waitcnt vmcnt(25) lgkmcnt(10)
RD 0,46,0
Mvaa 160,48,36
TR 72,14,448
Mvaa 168,48,40
TR 74,14,960
Mvaa 176,48,44
s_waitcnt lgkmcnt(11)
RD 4,46,2048
Mvaa 180,52,44
TR 76,14,456
Mvaa 172,52,40
TR 78,14,968
Mvaa 164,52,36
s_waitcnt lgkmcnt(12)
RD 8,46,4096
Mvaa 184,56,36
RD 12,47,0
Mvaa 192,56,40
RD 16,47,2048
Mvaa 200,56,44
s_waitcnt lgkmcnt(13)
Mvaa 204,60,44
RD 20,47,4096
Mvaa 196,60,40
v_add_u32 v14, 0x14a00, v13
Mvaa 188,60,36
s_waitcnt vmcnt(31) lgkmcnt(0)
s_barrier
Mvaa 208,64,36
TR 48,14,0
Mvaa 216,64,40
TR 50,14,512
Mvaa 224,64,44
TR 52,14,8
Mvaa 228,68,44
TR 54,14,520
Mvaa 220,68,40
TR 56,14,64
Mvaa 212,68,36
TR 58,14,576
Mvaa 232,72,36
TR 60,14,72
Mvaa 240,72,40
TR 62,14,584
Mvaa 248,72,44
TR 64,14,128
Mvaa 252,76,44
TR 66,14,640
Mvaa 244,76,40
TR 68,14,136
Mvaa 236,76,36
s_waitcnt lgkmcnt(9)
TR 70,14,648
fh_q28:
Mvaa 64,48,0
TR 72,14,192
Mvaa 72,48,4
TR 74,14,704
Mvaa 80,48,8
s_waitcnt lgkmcnt(10)
Mvaa 84,52,8
TR 76,14,200
Mvaa 76,52,4
TR 78,14,712
Mvaa 68,52,0
s_waitcnt lgkmcnt(10)
Mvaa 88,56,0
TR 48,14,256
Mvaa 96,56,4
TR 50,14,768
Mvaa 104,56,8
s_waitcnt lgkmcnt(10)
Mvaa 108,60,8
TR 52,14,264
Mvaa 100,60,4
TR 54,14,776
Mvaa 92,60,0
s_waitcnt lgkmcnt(10)
Mvaa 112,64,0
TR 56,14,320
Mvaa 120,64,4
TR 58,14,832
Mvaa 128,64,8
s_waitcnt lgkmcnt(10)
Mvaa 132,68,8
TR 60,14,328
Mvaa 124,68,4
TR 62,14,840
Mvaa 116,68,0
s_waitcnt lgkmcnt(10)
Mvaa 136,72,0
TR 64,14,384
Mvaa 144,72,4
TR 66,14,896
Mvaa 152,72,8
s_waitcnt lgkmcnt(10)
Mvaa 156,76,8
TR 68,14,392
Mvaa 148,76,4
TR 70,14,904
Mvaa 140,76,0
s_waitcnt lgkmcnt(10)
Mvaa 160,48,0
TR 72,14,448
Mvaa 168,48,4
TR 74,14,960
Mvaa 176,48,8
s_waitcnt lgkmcnt(10)
Mvaa 180,52,8
TR 76,14,456
Mvaa 172,52,4
TR 78,14,968
Mvaa 164,52,0
s_waitcnt lgkmcnt(10)
ds_write_b128 v23, a[128:131] offset:10240
Mvaa 184,56,0
ds_write_b128 v23, a[132:135] offset:11296
Mvaa 192,56,4
ds_write_b128 v23, a[136:139] offset:18688
Mvaa 200,56,8
s_waitcnt lgkmcnt(11)
ds_write_b128 v23, a[140:143] offset:19744
Mvaa 204,60,8
Mvaa 196,60,4
v_add_u32 v14, 0x18c00, v13
Mvaa 188,60,0
s_waitcnt vmcnt(17) lgkmcnt(0)
s_barrier
Mvaa 208,64,0
TR 48,14,0
Mvaa 216,64,4
TR 50,14,512
Mvaa 224,64,8
TR 52,14,8
Mvaa 228,68,8
TR 54,14,520
Mvaa 220,68,4
TR 56,14,64
Mvaa 212,68,0
TR 58,14,576
Mvaa 232,72,0
TR 60,14,72
Mvaa 240,72,4
TR 62,14,584
Mvaa 248,72,8
TR 64,14,128
Mvaa 252,76,8
TR 66,14,640
Mvaa 244,76,4
TR 68,14,136
Mvaa 236,76,0
s_waitcnt lgkmcnt(9)
TR 70,14,648
fh_q29:
Mvaa 64,48,12
s_waitcnt lgkmcnt(8)
TR 72,14,192
Mvaa 72,48,16
s_mov_b32 s3, 0x1a000
TR 74,14,704
Mvaa 80,48,20
buffer_load_dwordx4 a[128:131], v31, s[12:15], s3 offen nt
Mvaa 84,52,20
TR 76,14,200
Mvaa 76,52,16
s_waitcnt lgkmcnt(9)
TR 78,14,712
Mvaa 68,52,12
buffer_load_dwordx4 a[132:135], v31, s[12:15], s3 offen offset:256 nt
Mvaa 88,56,12
TR 48,14,256
Mvaa 96,56,16
TR 50,14,768
Mvaa 104,56,20
s_waitcnt vmcnt(9) lgkmcnt(10)
RD 24,46,6144
Mvaa 108,60,20
TR 52,14,264
Mvaa 100,60,16
TR 54,14,776
Mvaa 92,60,12
s_waitcnt lgkmcnt(11)
RD 28,46,8192
Mvaa 112,64,12
TR 56,14,320
Mvaa 120,64,16
TR 58,14,832
Mvaa 128,64,20
s_waitcnt lgkmcnt(12)
RD 32,46,10240
Mvaa 132,68,20
TR 60,14,328
Mvaa 124,68,16
TR 62,14,840
Mvaa 116,68,12
s_waitcnt lgkmcnt(13)
RD 36,47,6144
Mvaa 136,72,12
TR 64,14,384
Mvaa 144,72,16
TR 66,14,896
Mvaa 152,72,20
s_waitcnt lgkmcnt(14)
RD 40,47,8192
Mvaa 156,76,20
TR 68,14,392
Mvaa 148,76,16
TR 70,14,904
Mvaa 140,76,12
s_waitcnt lgkmcnt(15)
RD 44,47,10240
Mvaa 160,48,12
TR 72,14,448
Mvaa 168,48,16
TR 74,14,960
Mvaa 176,48,20
s_waitcnt lgkmcnt(15)
Mvaa 180,52,20
TR 76,14,456
Mvaa 172,52,16
TR 78,14,968
Mvaa 164,52,12
s_waitcnt lgkmcnt(14)
ds_write_b128 v23, a[144:147] offset:27136
Mvaa 184,56,12
ds_write_b128 v23, a[148:151] offset:28192
Mvaa 192,56,16
ds_write_b128 v23, a[152:155] offset:35584
Mvaa 200,56,20
s_waitcnt lgkmcnt(14)
ds_write_b128 v23, a[156:159] offset:36640
Mvaa 204,60,20
Mvaa 196,60,16
v_add_u32 v14, 0x1ce00, v13
Mvaa 188,60,12
s_waitcnt vmcnt(15) lgkmcnt(0)
s_barrier
Mvaa 208,64,12
TR 48,14,0
Mvaa 216,64,16
TR 50,14,512
Mvaa 224,64,20
TR 52,14,8
Mvaa 228,68,20
TR 54,14,520
Mvaa 220,68,16
TR 56,14,64
Mvaa 212,68,12
TR 58,14,576
Mvaa 232,72,12
TR 60,14,72
Mvaa 240,72,16
TR 62,14,584
Mvaa 248,72,20
TR 64,14,128
Mvaa 252,76,20
TR 66,14,640
Mvaa 244,76,16
TR 68,14,136
Mvaa 236,76,12
s_waitcnt lgkmcnt(9)
TR 70,14,648
fh_q30:
Mvaa 64,48,24
s_waitcnt lgkmcnt(8)
TR 72,14,192
Mvaa 72,48,28
s_mov_b32 s3, 0x18000
TR 74,14,704
Mvaa 80,48,32
buffer_load_dwordx4 a[136:139], v31, s[16:19], s3 offen nt
Mvaa 84,52,32
TR 76,14,200
Mvaa 76,52,28
s_waitcnt lgkmcnt(9)
TR 78,14,712
Mvaa 68,52,24
buffer_load_dwordx4 a[140:143], v31, s[16:19], s3 offen offset:256 nt
Mvaa 88,56,24
TR 48,14,256
Mvaa 96,56,28
TR 50,14,768
Mvaa 104,56,32
s_waitcnt lgkmcnt(10)
Mvaa 108,60,32
TR 52,14,264
Mvaa 100,60,28
TR 54,14,776
Mvaa 92,60,24
s_waitcnt lgkmcnt(10)
Mvaa 112,64,24
TR 56,14,320
Mvaa 120,64,28
TR 58,14,832
Mvaa 128,64,32
s_waitcnt lgkmcnt(10)
Mvaa 132,68,32
TR 60,14,328
Mvaa 124,68,28
TR 62,14,840
Mvaa 116,68,24
s_waitcnt lgkmcnt(10)
Mvaa 136,72,24
TR 64,14,384
Mvaa 144,72,28
TR 66,14,896
Mvaa 152,72,32
s_waitcnt lgkmcnt(10)
Mvaa 156,76,32
TR 68,14,392
Mvaa 148,76,28
TR 70,14,904
Mvaa 140,76,24
s_waitcnt lgkmcnt(10)
Mvaa 160,48,24
TR 72,14,448
Mvaa 168,48,28
TR 74,14,960
Mvaa 176,48,32
s_waitcnt lgkmcnt(10)
Mvaa 180,52,32
TR 76,14,456
Mvaa 172,52,28
TR 78,14,968
Mvaa 164,52,24
s_waitcnt lgkmcnt(10)
ds_write_b128 v23, a[160:163] offset:44032
Mvaa 184,56,24
ds_write_b128 v23, a[164:167] offset:45088
Mvaa 192,56,28
ds_write_b128 v23, a[168:171] offset:52480
Mvaa 200,56,32
s_waitcnt lgkmcnt(11)
ds_write_b128 v23, a[172:175] offset:53536
Mvaa 204,60,32
Mvaa 196,60,28
v_add_u32 v14, 0x21000, v13
Mvaa 188,60,24
s_waitcnt vmcnt(4) lgkmcnt(0)
s_barrier
Mvaa 208,64,24
TR 48,14,0
Mvaa 216,64,28
TR 50,14,512
Mvaa 224,64,32
TR 52,14,8
Mvaa 228,68,32
TR 54,14,520
Mvaa 220,68,28
TR 56,14,64
Mvaa 212,68,24
TR 58,14,576
Mvaa 232,72,24
TR 60,14,72
Mvaa 240,72,28
TR 62,14,584
Mvaa 248,72,32
TR 64,14,128
Mvaa 252,76,32
TR 66,14,640
Mvaa 244,76,28
TR 68,14,136
Mvaa 236,76,24
s_waitcnt lgkmcnt(9)
TR 70,14,648
fh_q31:
Mvaa 64,48,36
s_waitcnt lgkmcnt(8)
TR 72,14,192
Mvaa 72,48,40
s_mov_b32 s3, 0x1c000
TR 74,14,704
Mvaa 80,48,44
s_branch f_pad7s
f_pad7:
s_setpc_b64 s[70:71]
f_pad7s:
buffer_load_dwordx4 a[144:147], v31, s[12:15], s3 offen nt
Mvaa 84,52,44
TR 76,14,200
Mvaa 76,52,40
s_waitcnt lgkmcnt(9)
TR 78,14,712
Mvaa 68,52,36
buffer_load_dwordx4 a[148:151], v31, s[12:15], s3 offen offset:256 nt
Mvaa 88,56,36
s_waitcnt lgkmcnt(8)
TR 48,14,256
Mvaa 96,56,40
s_mov_b32 s3, 0x1a000
TR 50,14,768
Mvaa 104,56,44
buffer_load_dwordx4 a[152:155], v31, s[16:19], s3 offen nt
Mvaa 108,60,44
TR 52,14,264
Mvaa 100,60,40
TR 54,14,776
Mvaa 92,60,36
s_waitcnt lgkmcnt(10)
Mvaa 112,64,36
TR 56,14,320
Mvaa 120,64,40
TR 58,14,832
Mvaa 128,64,44
s_waitcnt lgkmcnt(10)
Mvaa 132,68,44
TR 60,14,328
Mvaa 124,68,40
TR 62,14,840
Mvaa 116,68,36
s_waitcnt lgkmcnt(10)
Mvaa 136,72,36
TR 64,14,384
Mvaa 144,72,40
TR 66,14,896
Mvaa 152,72,44
s_waitcnt lgkmcnt(10)
Mvaa 156,76,44
TR 68,14,392
Mvaa 148,76,40
TR 70,14,904
Mvaa 140,76,36
s_waitcnt lgkmcnt(10)
Mvaa 160,48,36
TR 72,14,448
Mvaa 168,48,40
TR 74,14,960
Mvaa 176,48,44
s_waitcnt lgkmcnt(10)
Mvaa 180,52,44
TR 76,14,456
Mvaa 172,52,40
TR 78,14,968
Mvaa 164,52,36
s_waitcnt lgkmcnt(10)
ds_write_b128 v0, a[80:83] offset:16896
Mvaa 184,56,36
ds_write_b128 v0, a[84:87] offset:17952
Mvaa 192,56,40
ds_write_b128 v0, a[88:91] offset:25344
Mvaa 200,56,44
s_waitcnt lgkmcnt(11)
ds_write_b128 v0, a[92:95] offset:26400
Mvaa 204,60,44
Mvaa 196,60,40
Mvaa 188,60,36
s_waitcnt lgkmcnt(0)
s_barrier
Mvaa 208,64,36
ds_write_b128 v0, a[96:99] offset:33792
Mvaa 216,64,40
ds_write_b128 v0, a[100:103] offset:34848
Mvaa 224,64,44
ds_write_b128 v0, a[104:107] offset:42240
Mvaa 228,68,44
ds_write_b128 v0, a[108:111] offset:43296
Mvaa 220,68,40
ds_write_b128 v0, a[112:115] offset:50688
Mvaa 212,68,36
ds_write_b128 v0, a[116:119] offset:51744
Mvaa 232,72,36
ds_write_b128 v23, a[120:123] offset:1792
Mvaa 240,72,40
ds_write_b128 v23, a[124:127] offset:2848
Mvaa 248,72,44
ds_write_b128 v19, a[176:179] offset:3584
Mvaa 252,76,44
ds_write_b128 v19, a[180:183] offset:4640
Mvaa 244,76,40
ds_write_b128 v19, a[184:187] offset:12032
Mvaa 236,76,36
ds_write_b128 v19, a[188:191] offset:13088
v_add_u32 v16, 0x25200, v15
RD 0,16,0
RD 4,16,64
RD 8,16,128
RD 12,16,192
RD 16,16,512
RD 20,16,576
RD 24,16,640
RD 28,16,704
s_mov_b32 s54, 0x3e0293ee
s_mov_b32 s55, 0x3e0293ee
v_pk_mul_f32 v[64:65], v[64:65], s[54:55]
v_pk_mul_f32 v[66:67], v[66:67], s[54:55]
v_pk_mul_f32 v[68:69], v[68:69], s[54:55]
v_pk_mul_f32 v[70:71], v[70:71], s[54:55]
v_cvt_pk_bf16_f32 v64, v64, v65
v_cvt_pk_bf16_f32 v65, v66, v67
v_cvt_pk_bf16_f32 v66, v68, v69
v_cvt_pk_bf16_f32 v67, v70, v71
v_pk_mul_f32 v[72:73], v[72:73], s[54:55]
v_pk_mul_f32 v[74:75], v[74:75], s[54:55]
v_pk_mul_f32 v[76:77], v[76:77], s[54:55]
v_pk_mul_f32 v[78:79], v[78:79], s[54:55]
v_cvt_pk_bf16_f32 v68, v72, v73
v_cvt_pk_bf16_f32 v69, v74, v75
v_cvt_pk_bf16_f32 v70, v76, v77
v_cvt_pk_bf16_f32 v71, v78, v79
v_pk_mul_f32 v[80:81], v[80:81], s[54:55]
v_pk_mul_f32 v[82:83], v[82:83], s[54:55]
v_pk_mul_f32 v[84:85], v[84:85], s[54:55]
v_pk_mul_f32 v[86:87], v[86:87], s[54:55]
v_cvt_pk_bf16_f32 v72, v80, v81
v_cvt_pk_bf16_f32 v73, v82, v83
v_cvt_pk_bf16_f32 v74, v84, v85
v_cvt_pk_bf16_f32 v75, v86, v87
v_pk_mul_f32 v[88:89], v[88:89], s[54:55]
v_pk_mul_f32 v[90:91], v[90:91], s[54:55]
v_pk_mul_f32 v[92:93], v[92:93], s[54:55]
v_pk_mul_f32 v[94:95], v[94:95], s[54:55]
v_cvt_pk_bf16_f32 v76, v88, v89
v_cvt_pk_bf16_f32 v77, v90, v91
v_cvt_pk_bf16_f32 v78, v92, v93
v_cvt_pk_bf16_f32 v79, v94, v95
v_pk_mul_f32 v[96:97], v[96:97], s[54:55]
v_pk_mul_f32 v[98:99], v[98:99], s[54:55]
v_pk_mul_f32 v[100:101], v[100:101], s[54:55]
v_pk_mul_f32 v[102:103], v[102:103], s[54:55]
v_cvt_pk_bf16_f32 v80, v96, v97
v_cvt_pk_bf16_f32 v81, v98, v99
v_cvt_pk_bf16_f32 v82, v100, v101
v_cvt_pk_bf16_f32 v83, v102, v103
v_pk_mul_f32 v[104:105], v[104:105], s[54:55]
v_pk_mul_f32 v[106:107], v[106:107], s[54:55]
v_pk_mul_f32 v[108:109], v[108:109], s[54:55]
v_pk_mul_f32 v[110:111], v[110:111], s[54:55]
v_cvt_pk_bf16_f32 v84, v104, v105
v_cvt_pk_bf16_f32 v85, v106, v107
v_cvt_pk_bf16_f32 v86, v108, v109
v_cvt_pk_bf16_f32 v87, v110, v111
v_pk_mul_f32 v[112:113], v[112:113], s[54:55]
v_pk_mul_f32 v[114:115], v[114:115], s[54:55]
v_pk_mul_f32 v[116:117], v[116:117], s[54:55]
v_pk_mul_f32 v[118:119], v[118:119], s[54:55]
v_cvt_pk_bf16_f32 v88, v112, v113
v_cvt_pk_bf16_f32 v89, v114, v115
v_cvt_pk_bf16_f32 v90, v116, v117
v_cvt_pk_bf16_f32 v91, v118, v119
v_pk_mul_f32 v[120:121], v[120:121], s[54:55]
v_pk_mul_f32 v[122:123], v[122:123], s[54:55]
v_pk_mul_f32 v[124:125], v[124:125], s[54:55]
v_pk_mul_f32 v[126:127], v[126:127], s[54:55]
v_cvt_pk_bf16_f32 v92, v120, v121
v_cvt_pk_bf16_f32 v93, v122, v123
v_cvt_pk_bf16_f32 v94, v124, v125
v_cvt_pk_bf16_f32 v95, v126, v127
v_pk_mul_f32 v[128:129], v[128:129], s[54:55]
v_pk_mul_f32 v[130:131], v[130:131], s[54:55]
v_pk_mul_f32 v[132:133], v[132:133], s[54:55]
v_pk_mul_f32 v[134:135], v[134:135], s[54:55]
v_cvt_pk_bf16_f32 v96, v128, v129
v_cvt_pk_bf16_f32 v97, v130, v131
v_cvt_pk_bf16_f32 v98, v132, v133
v_cvt_pk_bf16_f32 v99, v134, v135
v_pk_mul_f32 v[136:137], v[136:137], s[54:55]
v_pk_mul_f32 v[138:139], v[138:139], s[54:55]
v_pk_mul_f32 v[140:141], v[140:141], s[54:55]
v_pk_mul_f32 v[142:143], v[142:143], s[54:55]
v_cvt_pk_bf16_f32 v100, v136, v137
v_cvt_pk_bf16_f32 v101, v138, v139
v_cvt_pk_bf16_f32 v102, v140, v141
v_cvt_pk_bf16_f32 v103, v142, v143
v_pk_mul_f32 v[144:145], v[144:145], s[54:55]
v_pk_mul_f32 v[146:147], v[146:147], s[54:55]
v_pk_mul_f32 v[148:149], v[148:149], s[54:55]
v_pk_mul_f32 v[150:151], v[150:151], s[54:55]
v_cvt_pk_bf16_f32 v104, v144, v145
v_cvt_pk_bf16_f32 v105, v146, v147
v_cvt_pk_bf16_f32 v106, v148, v149
v_cvt_pk_bf16_f32 v107, v150, v151
v_pk_mul_f32 v[152:153], v[152:153], s[54:55]
v_pk_mul_f32 v[154:155], v[154:155], s[54:55]
v_pk_mul_f32 v[156:157], v[156:157], s[54:55]
v_pk_mul_f32 v[158:159], v[158:159], s[54:55]
v_cvt_pk_bf16_f32 v108, v152, v153
v_cvt_pk_bf16_f32 v109, v154, v155
v_cvt_pk_bf16_f32 v110, v156, v157
v_cvt_pk_bf16_f32 v111, v158, v159
v_pk_mul_f32 v[160:161], v[160:161], s[54:55]
v_pk_mul_f32 v[162:163], v[162:163], s[54:55]
v_pk_mul_f32 v[164:165], v[164:165], s[54:55]
v_pk_mul_f32 v[166:167], v[166:167], s[54:55]
v_cvt_pk_bf16_f32 v160, v160, v161
v_cvt_pk_bf16_f32 v161, v162, v163
v_cvt_pk_bf16_f32 v162, v164, v165
v_cvt_pk_bf16_f32 v163, v166, v167
v_accvgpr_write_b32 a80, v160
v_accvgpr_write_b32 a81, v161
v_accvgpr_write_b32 a82, v162
v_accvgpr_write_b32 a83, v163
v_pk_mul_f32 v[168:169], v[168:169], s[54:55]
v_pk_mul_f32 v[170:171], v[170:171], s[54:55]
v_pk_mul_f32 v[172:173], v[172:173], s[54:55]
v_pk_mul_f32 v[174:175], v[174:175], s[54:55]
v_cvt_pk_bf16_f32 v168, v168, v169
v_cvt_pk_bf16_f32 v169, v170, v171
v_cvt_pk_bf16_f32 v170, v172, v173
v_cvt_pk_bf16_f32 v171, v174, v175
v_accvgpr_write_b32 a84, v168
v_accvgpr_write_b32 a85, v169
v_accvgpr_write_b32 a86, v170
v_accvgpr_write_b32 a87, v171
v_pk_mul_f32 v[176:177], v[176:177], s[54:55]
v_pk_mul_f32 v[178:179], v[178:179], s[54:55]
v_pk_mul_f32 v[180:181], v[180:181], s[54:55]
v_pk_mul_f32 v[182:183], v[182:183], s[54:55]
v_cvt_pk_bf16_f32 v176, v176, v177
v_cvt_pk_bf16_f32 v177, v178, v179
v_cvt_pk_bf16_f32 v178, v180, v181
v_cvt_pk_bf16_f32 v179, v182, v183
v_accvgpr_write_b32 a88, v176
v_accvgpr_write_b32 a89, v177
v_accvgpr_write_b32 a90, v178
v_accvgpr_write_b32 a91, v179
v_pk_mul_f32 v[184:185], v[184:185], s[54:55]
v_pk_mul_f32 v[186:187], v[186:187], s[54:55]
v_pk_mul_f32 v[188:189], v[188:189], s[54:55]
v_pk_mul_f32 v[190:191], v[190:191], s[54:55]
v_cvt_pk_bf16_f32 v184, v184, v185
v_cvt_pk_bf16_f32 v185, v186, v187
v_cvt_pk_bf16_f32 v186, v188, v189
v_cvt_pk_bf16_f32 v187, v190, v191
v_accvgpr_write_b32 a92, v184
v_accvgpr_write_b32 a93, v185
v_accvgpr_write_b32 a94, v186
v_accvgpr_write_b32 a95, v187
v_pk_mul_f32 v[192:193], v[192:193], s[54:55]
v_pk_mul_f32 v[194:195], v[194:195], s[54:55]
v_pk_mul_f32 v[196:197], v[196:197], s[54:55]
v_pk_mul_f32 v[198:199], v[198:199], s[54:55]
v_cvt_pk_bf16_f32 v192, v192, v193
v_cvt_pk_bf16_f32 v193, v194, v195
v_cvt_pk_bf16_f32 v194, v196, v197
v_cvt_pk_bf16_f32 v195, v198, v199
v_accvgpr_write_b32 a96, v192
v_accvgpr_write_b32 a97, v193
v_accvgpr_write_b32 a98, v194
v_accvgpr_write_b32 a99, v195
v_pk_mul_f32 v[200:201], v[200:201], s[54:55]
v_pk_mul_f32 v[202:203], v[202:203], s[54:55]
v_pk_mul_f32 v[204:205], v[204:205], s[54:55]
v_pk_mul_f32 v[206:207], v[206:207], s[54:55]
v_cvt_pk_bf16_f32 v200, v200, v201
v_cvt_pk_bf16_f32 v201, v202, v203
v_cvt_pk_bf16_f32 v202, v204, v205
v_cvt_pk_bf16_f32 v203, v206, v207
v_accvgpr_write_b32 a100, v200
v_accvgpr_write_b32 a101, v201
v_accvgpr_write_b32 a102, v202
v_accvgpr_write_b32 a103, v203
v_pk_mul_f32 v[208:209], v[208:209], s[54:55]
v_pk_mul_f32 v[210:211], v[210:211], s[54:55]
v_pk_mul_f32 v[212:213], v[212:213], s[54:55]
v_pk_mul_f32 v[214:215], v[214:215], s[54:55]
v_cvt_pk_bf16_f32 v208, v208, v209
v_cvt_pk_bf16_f32 v209, v210, v211
v_cvt_pk_bf16_f32 v210, v212, v213
v_cvt_pk_bf16_f32 v211, v214, v215
v_accvgpr_write_b32 a104, v208
v_accvgpr_write_b32 a105, v209
v_accvgpr_write_b32 a106, v210
v_accvgpr_write_b32 a107, v211
v_pk_mul_f32 v[216:217], v[216:217], s[54:55]
v_pk_mul_f32 v[218:219], v[218:219], s[54:55]
v_pk_mul_f32 v[220:221], v[220:221], s[54:55]
v_pk_mul_f32 v[222:223], v[222:223], s[54:55]
v_cvt_pk_bf16_f32 v216, v216, v217
v_cvt_pk_bf16_f32 v217, v218, v219
v_cvt_pk_bf16_f32 v218, v220, v221
v_cvt_pk_bf16_f32 v219, v222, v223
v_accvgpr_write_b32 a108, v216
v_accvgpr_write_b32 a109, v217
v_accvgpr_write_b32 a110, v218
v_accvgpr_write_b32 a111, v219
v_pk_mul_f32 v[224:225], v[224:225], s[54:55]
v_pk_mul_f32 v[226:227], v[226:227], s[54:55]
v_pk_mul_f32 v[228:229], v[228:229], s[54:55]
v_pk_mul_f32 v[230:231], v[230:231], s[54:55]
v_cvt_pk_bf16_f32 v224, v224, v225
v_cvt_pk_bf16_f32 v225, v226, v227
v_cvt_pk_bf16_f32 v226, v228, v229
v_cvt_pk_bf16_f32 v227, v230, v231
v_accvgpr_write_b32 a112, v224
v_accvgpr_write_b32 a113, v225
v_accvgpr_write_b32 a114, v226
v_accvgpr_write_b32 a115, v227
v_pk_mul_f32 v[232:233], v[232:233], s[54:55]
v_pk_mul_f32 v[234:235], v[234:235], s[54:55]
v_pk_mul_f32 v[236:237], v[236:237], s[54:55]
v_pk_mul_f32 v[238:239], v[238:239], s[54:55]
v_cvt_pk_bf16_f32 v232, v232, v233
v_cvt_pk_bf16_f32 v233, v234, v235
v_cvt_pk_bf16_f32 v234, v236, v237
v_cvt_pk_bf16_f32 v235, v238, v239
v_accvgpr_write_b32 a116, v232
v_accvgpr_write_b32 a117, v233
v_accvgpr_write_b32 a118, v234
v_accvgpr_write_b32 a119, v235
v_pk_mul_f32 v[240:241], v[240:241], s[54:55]
v_pk_mul_f32 v[242:243], v[242:243], s[54:55]
v_pk_mul_f32 v[244:245], v[244:245], s[54:55]
v_pk_mul_f32 v[246:247], v[246:247], s[54:55]
v_cvt_pk_bf16_f32 v240, v240, v241
v_cvt_pk_bf16_f32 v241, v242, v243
v_cvt_pk_bf16_f32 v242, v244, v245
v_cvt_pk_bf16_f32 v243, v246, v247
v_accvgpr_write_b32 a120, v240
v_accvgpr_write_b32 a121, v241
v_accvgpr_write_b32 a122, v242
v_accvgpr_write_b32 a123, v243
v_pk_mul_f32 v[248:249], v[248:249], s[54:55]
v_pk_mul_f32 v[250:251], v[250:251], s[54:55]
v_pk_mul_f32 v[252:253], v[252:253], s[54:55]
v_pk_mul_f32 v[254:255], v[254:255], s[54:55]
v_cvt_pk_bf16_f32 v248, v248, v249
v_cvt_pk_bf16_f32 v249, v250, v251
v_cvt_pk_bf16_f32 v250, v252, v253
v_cvt_pk_bf16_f32 v251, v254, v255
v_accvgpr_write_b32 a124, v248
v_accvgpr_write_b32 a125, v249
v_accvgpr_write_b32 a126, v250
v_accvgpr_write_b32 a127, v251
s_waitcnt lgkmcnt(7)
Zvav 112,0,64
Zvav 120,0,68
buffer_load_dwordx4 a[156:159], v31, s[16:19], s3 offen offset:256 nt
Zvav 128,0,72
s_waitcnt lgkmcnt(6)
s_mov_b32 s3, 0x1e000
Mvav 112,4,76
buffer_load_dwordx4 a[160:163], v31, s[12:15], s3 offen nt
Mvav 120,4,80
s_waitcnt lgkmcnt(5)
Mvav 128,4,84
buffer_load_dwordx4 a[164:167], v31, s[12:15], s3 offen offset:256 nt
Mvav 112,8,88
s_mov_b32 s3, 0x1c000
Mvav 120,8,92
buffer_load_dwordx4 a[168:171], v31, s[16:19], s3 offen nt
Mvav 128,8,96
s_waitcnt lgkmcnt(4)
Mvav 112,12,100
Mvav 120,12,104
Mvav 128,12,108
s_waitcnt lgkmcnt(3)
Zvav 116,16,64
Zvav 124,16,68
Zvav 132,16,72
s_waitcnt lgkmcnt(2)
Mvav 116,20,76
Mvav 124,20,80
ds_write_b128 v19, a[192:195] offset:20480
Mvav 132,20,84
s_waitcnt lgkmcnt(2)
Mvav 116,24,88
ds_write_b128 v19, a[196:199] offset:21536
Mvav 124,24,92
Mvav 132,24,96
s_waitcnt lgkmcnt(2)
ds_write_b128 v19, a[200:203] offset:28928
Mvav 116,28,100
Mvav 124,28,104
ds_write_b128 v19, a[204:207] offset:29984
Mvav 132,28,108
v_add_u32 v16, 0, v15
v_add_u32 v18, 0, v17
RD 0,16,0
RD 4,16,64
RD 8,16,128
RD 12,16,192
v_max3_f32 v32, v112, v113, v114
v_max3_f32 v33, v120, v121, v122
v_max3_f32 v34, v128, v129, v130
v_max_f32 v32, v115, v32
v_max_f32 v33, v123, v33
v_max_f32 v34, v131, v34
v_max3_f32 v32, v32, v116, v117
v_max3_f32 v33, v33, v124, v125
v_max3_f32 v34, v34, v132, v133
v_max3_f32 v32, v32, v118, v119
v_max3_f32 v33, v33, v126, v127
v_max3_f32 v34, v34, v134, v135
v_mov_b32 v36, v32
v_mov_b32 v37, v33
v_mov_b32 v38, v34
v_permlane32_swap_b32 v36, v32
v_permlane32_swap_b32 v37, v33
v_permlane32_swap_b32 v38, v34
v_max_f32 v32, v36, v32
v_max_f32 v33, v37, v33
v_max_f32 v34, v38, v34
v_mov_b32 v36, v32
v_mov_b32 v37, v33
v_mov_b32 v38, v34
v_permlane16_swap_b32 v36, v32
v_permlane16_swap_b32 v37, v33
v_permlane16_swap_b32 v38, v34
v_max_f32 v32, v36, v32
v_max_f32 v33, v37, v33
v_max_f32 v34, v38, v34
v_sub_f32 v40, 0, v32
v_sub_f32 v44, 0, v33
v_sub_f32 v48, 0, v34
v_sub_f32 v41, 0, v32
v_sub_f32 v45, 0, v33
v_sub_f32 v49, 0, v34
v_sub_f32 v42, 0, v32
v_sub_f32 v46, 0, v33
v_sub_f32 v50, 0, v34
v_sub_f32 v43, 0, v32
v_sub_f32 v47, 0, v33
v_sub_f32 v51, 0, v34
v_sub_f32 v112, v112, v32
v_sub_f32 v120, v120, v33
v_sub_f32 v128, v128, v34
v_sub_f32 v113, v113, v32
v_sub_f32 v121, v121, v33
v_sub_f32 v129, v129, v34
v_sub_f32 v114, v114, v32
v_sub_f32 v122, v122, v33
v_sub_f32 v130, v130, v34
v_sub_f32 v115, v115, v32
v_sub_f32 v123, v123, v33
v_sub_f32 v131, v131, v34
v_sub_f32 v116, v116, v32
v_sub_f32 v124, v124, v33
v_sub_f32 v132, v132, v34
v_sub_f32 v117, v117, v32
v_sub_f32 v125, v125, v33
v_sub_f32 v133, v133, v34
v_sub_f32 v118, v118, v32
v_sub_f32 v126, v126, v33
v_sub_f32 v134, v134, v34
v_sub_f32 v119, v119, v32
v_sub_f32 v127, v127, v33
v_sub_f32 v135, v135, v34
v_exp_f32 v112, v112
v_exp_f32 v120, v120
v_exp_f32 v128, v128
v_exp_f32 v113, v113
v_exp_f32 v121, v121
v_exp_f32 v129, v129
v_exp_f32 v114, v114
v_exp_f32 v122, v122
v_exp_f32 v130, v130
v_exp_f32 v115, v115
v_exp_f32 v123, v123
v_exp_f32 v131, v131
v_exp_f32 v116, v116
v_exp_f32 v124, v124
v_exp_f32 v132, v132
v_exp_f32 v117, v117
v_exp_f32 v125, v125
v_exp_f32 v133, v133
v_exp_f32 v118, v118
v_exp_f32 v126, v126
v_exp_f32 v134, v134
v_exp_f32 v119, v119
v_exp_f32 v127, v127
v_exp_f32 v135, v135
fh_a0:
s_waitcnt lgkmcnt(3)
Cvav 136,0,64,40
RD 16,16,512
v_cvt_pk_bf16_f32 v115, v114, v115
Cvav 144,0,68,44
RD 20,16,576
v_cvt_pk_bf16_f32 v114, v112, v113
Cvav 152,0,72,48
s_waitcnt lgkmcnt(4)
RD 24,16,640
v_cvt_pk_bf16_f32 v116, v116, v117
Mvav 136,4,76
RD 28,16,704
v_cvt_pk_bf16_f32 v117, v118, v119
Mvav 144,4,80
TR 32,18,8448
v_cvt_pk_bf16_f32 v123, v122, v123
Mvav 152,4,84
s_waitcnt lgkmcnt(6)
TR 34,18,8960
v_cvt_pk_bf16_f32 v122, v120, v121
Mvav 136,8,88
TR 36,18,8480
v_cvt_pk_bf16_f32 v124, v124, v125
Mvav 144,8,92
TR 38,18,8992
v_cvt_pk_bf16_f32 v125, v126, v127
Mvav 152,8,96
s_waitcnt lgkmcnt(8)
TR 40,18,8512
v_cvt_pk_bf16_f32 v131, v130, v131
Mvav 136,12,100
TR 42,18,9024
v_cvt_pk_bf16_f32 v130, v128, v129
Mvav 144,12,104
TR 44,18,8544
v_cvt_pk_bf16_f32 v132, v132, v133
Mvav 152,12,108
s_waitcnt lgkmcnt(10)
TR 46,18,9056
v_cvt_pk_bf16_f32 v133, v134, v135
Cvav 140,16,64,40
v_exp_f32 v136, v136
Cvav 148,16,68,44
v_exp_f32 v137, v137
Cvav 156,16,72,48
s_waitcnt lgkmcnt(10)
v_exp_f32 v138, v138
Mvav 140,20,76
v_exp_f32 v139, v139
Mvav 148,20,80
v_exp_f32 v144, v144
Mvav 156,20,84
s_waitcnt lgkmcnt(9)
v_exp_f32 v145, v145
Mvav 140,24,88
v_exp_f32 v146, v146
Mvav 148,24,92
v_exp_f32 v147, v147
Mvav 156,24,96
s_waitcnt lgkmcnt(8)
v_exp_f32 v152, v152
Mvav 140,28,100
v_exp_f32 v153, v153
Mvav 148,28,104
v_exp_f32 v154, v154
Mvav 156,28,108
s_waitcnt lgkmcnt(6)
v_exp_f32 v155, v155
Zvav 160,32,114
TR 48,18,8576
TR 50,18,9088
Zvav 168,32,122
s_waitcnt lgkmcnt(6)
v_exp_f32 v140, v140
Zvav 176,32,130
buffer_load_dwordx4 a[172:175], v31, s[16:19], s3 offen offset:256 nt
Zvav 180,36,130
v_exp_f32 v141, v141
Zvav 172,36,122
TR 52,18,8608
TR 54,18,9120
Zvav 164,36,114
s_waitcnt lgkmcnt(6)
s_mov_b32 s3, 0x20000
v_exp_f32 v142, v142
Zvav 184,40,114
buffer_load_dwordx4 a[176:179], v31, s[12:15], s3 offen nt
Zvav 192,40,122
s_waitcnt lgkmcnt(4)
v_exp_f32 v143, v143
Zvav 200,40,130
s_branch f_pad8s
f_pad8:
s_setpc_b64 s[70:71]
f_pad8s:
TR 56,18,8640
TR 58,18,9152
Zvav 204,44,130
v_exp_f32 v148, v148
Zvav 196,44,122
buffer_load_dwordx4 a[180:183], v31, s[12:15], s3 offen offset:256 nt
Zvav 188,44,114
s_waitcnt lgkmcnt(4)
v_exp_f32 v149, v149
Zvav 208,48,114
TR 60,18,8672
TR 62,18,9184
Zvav 216,48,122
v_exp_f32 v150, v150
Zvav 224,48,130
s_waitcnt lgkmcnt(4)
v_exp_f32 v151, v151
Zvav 228,52,130
v_exp_f32 v156, v156
Zvav 220,52,122
v_add_u32 v16, 0x4200, v15
v_add_u32 v18, 0x4200, v17
Zvav 212,52,114
s_waitcnt lgkmcnt(2)
v_exp_f32 v157, v157
Zvav 232,56,114
s_waitcnt lgkmcnt(0)
s_barrier
Zvav 240,56,122
RD 0,16,0
Zvav 248,56,130
v_exp_f32 v158, v158
Zvav 252,60,130
RD 4,16,64
Zvav 244,60,122
v_exp_f32 v159, v159
Zvav 236,60,114
RD 8,16,128
Zvvv 52,24,114
RD 12,16,192
Zvvv 56,24,122
Zvvv 60,24,130
s_waitcnt lgkmcnt(3)
fh_a1:
Cvav 112,0,64,40
RD 16,16,512
v_cvt_pk_bf16_f32 v139, v138, v139
Cvav 120,0,68,44
RD 20,16,576
v_cvt_pk_bf16_f32 v138, v136, v137
Cvav 128,0,72,48
s_waitcnt lgkmcnt(4)
RD 24,16,640
v_cvt_pk_bf16_f32 v140, v140, v141
Mvav 112,4,76
RD 28,16,704
v_cvt_pk_bf16_f32 v141, v142, v143
Mvav 120,4,80
TR 32,18,8448
v_cvt_pk_bf16_f32 v147, v146, v147
Mvav 128,4,84
s_waitcnt lgkmcnt(6)
TR 34,18,8960
v_cvt_pk_bf16_f32 v146, v144, v145
Mvav 112,8,88
TR 36,18,8480
v_cvt_pk_bf16_f32 v148, v148, v149
Mvav 120,8,92
TR 38,18,8992
v_cvt_pk_bf16_f32 v149, v150, v151
Mvav 128,8,96
s_waitcnt lgkmcnt(8)
TR 40,18,8512
v_cvt_pk_bf16_f32 v155, v154, v155
Mvav 112,12,100
TR 42,18,9024
v_cvt_pk_bf16_f32 v154, v152, v153
Mvav 120,12,104
TR 44,18,8544
v_cvt_pk_bf16_f32 v156, v156, v157
Mvav 128,12,108
s_waitcnt lgkmcnt(10)
TR 46,18,9056
v_cvt_pk_bf16_f32 v157, v158, v159
Cvav 116,16,64,40
v_exp_f32 v112, v112
Cvav 124,16,68,44
v_exp_f32 v113, v113
Cvav 132,16,72,48
s_waitcnt lgkmcnt(10)
ds_write_b128 v0, a[208:211]
Mvav 116,20,76
v_exp_f32 v114, v114
Mvav 124,20,80
ds_write_b128 v0, a[212:215] offset:1056
Mvav 132,20,84
s_waitcnt lgkmcnt(11)
v_exp_f32 v115, v115
Mvav 116,24,88
ds_write_b128 v0, a[216:219] offset:8448
Mvav 124,24,92
v_exp_f32 v120, v120
Mvav 132,24,96
s_waitcnt lgkmcnt(11)
ds_write_b128 v0, a[220:223] offset:9504
Mvav 116,28,100
v_exp_f32 v121, v121
Mvav 124,28,104
v_exp_f32 v122, v122
Mvav 132,28,108
s_waitcnt lgkmcnt(10)
v_exp_f32 v123, v123
Mvav 160,32,138
TR 48,18,8576
TR 50,18,9088
Mvav 168,32,146
s_waitcnt lgkmcnt(10)
s_mov_b32 s3, 0x1e000
v_exp_f32 v116, v116
Mvav 176,32,154
buffer_load_dwordx4 a[184:187], v31, s[16:19], s3 offen nt
Mvav 180,36,154
v_exp_f32 v117, v117
Mvav 172,36,146
TR 52,18,8608
TR 54,18,9120
Mvav 164,36,138
s_waitcnt lgkmcnt(10)
v_exp_f32 v118, v118
Mvav 184,40,138
buffer_load_dwordx4 a[188:191], v31, s[16:19], s3 offen offset:256 nt
Mvav 192,40,146
s_waitcnt lgkmcnt(8)
v_exp_f32 v119, v119
Mvav 200,40,154
TR 56,18,8640
TR 58,18,9152
Mvav 204,44,154
v_exp_f32 v124, v124
Mvav 196,44,146
v_exp_f32 v128, v128
Mvav 188,44,138
s_waitcnt lgkmcnt(4)
v_exp_f32 v125, v125
Mvav 208,48,138
TR 60,18,8672
TR 62,18,9184
Mvav 216,48,146
v_exp_f32 v126, v126
Mvav 224,48,154
s_waitcnt lgkmcnt(4)
v_exp_f32 v129, v129
Mvav 228,52,154
v_exp_f32 v127, v127
Mvav 220,52,146
v_add_u32 v16, 0x8400, v15
v_add_u32 v18, 0x8400, v17
Mvav 212,52,138
s_waitcnt lgkmcnt(2)
v_exp_f32 v132, v132
Mvav 232,56,138
s_waitcnt lgkmcnt(0)
s_barrier
Mvav 240,56,146
RD 0,16,0
RD 4,16,64
Mvav 248,56,154
v_exp_f32 v133, v133
Mvav 252,60,154
RD 8,16,128
RD 12,16,192
Mvav 244,60,146
v_exp_f32 v130, v130
Mvav 236,60,138
v_exp_f32 v134, v134
Mvvv 52,24,138
v_exp_f32 v131, v131
Mvvv 56,24,146
v_exp_f32 v135, v135
Mvvv 60,24,154
s_waitcnt lgkmcnt(3)
fh_a2:
Cvav 136,0,64,40
RD 16,16,512
v_cvt_pk_bf16_f32 v115, v114, v115
Cvav 144,0,68,44
RD 20,16,576
v_cvt_pk_bf16_f32 v114, v112, v113
Cvav 152,0,72,48
s_waitcnt lgkmcnt(4)
RD 24,16,640
v_cvt_pk_bf16_f32 v116, v116, v117
Mvav 136,4,76
RD 28,16,704
v_cvt_pk_bf16_f32 v117, v118, v119
Mvav 144,4,80
TR 32,18,8448
v_cvt_pk_bf16_f32 v123, v122, v123
Mvav 152,4,84
s_waitcnt lgkmcnt(6)
TR 34,18,8960
v_cvt_pk_bf16_f32 v122, v120, v121
Mvav 136,8,88
TR 36,18,8480
v_cvt_pk_bf16_f32 v124, v124, v125
Mvav 144,8,92
TR 38,18,8992
v_cvt_pk_bf16_f32 v125, v126, v127
Mvav 152,8,96
s_waitcnt lgkmcnt(8)
TR 40,18,8512
v_cvt_pk_bf16_f32 v131, v130, v131
Mvav 136,12,100
TR 42,18,9024
v_cvt_pk_bf16_f32 v130, v128, v129
Mvav 144,12,104
TR 44,18,8544
v_cvt_pk_bf16_f32 v132, v132, v133
Mvav 152,12,108
s_waitcnt lgkmcnt(10)
TR 46,18,9056
v_cvt_pk_bf16_f32 v133, v134, v135
Cvav 140,16,64,40
v_exp_f32 v136, v136
Cvav 148,16,68,44
v_exp_f32 v137, v137
Cvav 156,16,72,48
s_waitcnt lgkmcnt(10)
ds_write_b128 v0, a[224:227] offset:16896
Mvav 140,20,76
v_exp_f32 v138, v138
Mvav 148,20,80
ds_write_b128 v0, a[228:231] offset:17952
Mvav 156,20,84
s_waitcnt lgkmcnt(11)
v_exp_f32 v139, v139
Mvav 140,24,88
ds_write_b128 v0, a[232:235] offset:25344
Mvav 148,24,92
v_exp_f32 v144, v144
Mvav 156,24,96
s_waitcnt lgkmcnt(11)
ds_write_b128 v0, a[236:239] offset:26400
Mvav 140,28,100
v_exp_f32 v145, v145
Mvav 148,28,104
v_exp_f32 v146, v146
Mvav 156,28,108
s_waitcnt lgkmcnt(10)
v_exp_f32 v147, v147
Mvav 160,32,114
TR 48,18,8576
TR 50,18,9088
Mvav 168,32,122
s_waitcnt lgkmcnt(10)
s_mov_b32 s3, 0x22000
v_exp_f32 v140, v140
Mvav 176,32,130
buffer_load_dwordx4 a[192:195], v31, s[12:15], s3 offen nt
Mvav 180,36,130
v_exp_f32 v141, v141
Mvav 172,36,122
TR 52,18,8608
TR 54,18,9120
Mvav 164,36,114
s_waitcnt lgkmcnt(10)
v_exp_f32 v142, v142
Mvav 184,40,114
buffer_load_dwordx4 a[196:199], v31, s[12:15], s3 offen offset:256 nt
Mvav 192,40,122
s_waitcnt lgkmcnt(8)
v_exp_f32 v143, v143
Mvav 200,40,130
TR 56,18,8640
TR 58,18,9152
Mvav 204,44,130
s_mov_b32 s3, 0x20000
v_exp_f32 v148, v148
Mvav 196,44,122
buffer_load_dwordx4 a[200:203], v31, s[16:19], s3 offen nt
Mvav 188,44,114
s_waitcnt lgkmcnt(4)
v_exp_f32 v149, v149
Mvav 208,48,114
TR 60,18,8672
TR 62,18,9184
Mvav 216,48,122
v_exp_f32 v150, v150
Mvav 224,48,130
s_waitcnt lgkmcnt(4)
v_exp_f32 v152, v152
Mvav 228,52,130
v_exp_f32 v151, v151
Mvav 220,52,122
v_add_u32 v16, 0xc600, v15
v_add_u32 v18, 0xc600, v17
Mvav 212,52,114
s_waitcnt lgkmcnt(2)
v_exp_f32 v156, v156
Mvav 232,56,114
s_waitcnt lgkmcnt(0)
s_barrier
Mvav 240,56,122
RD 0,16,0
RD 4,16,64
Mvav 248,56,130
v_exp_f32 v157, v157
Mvav 252,60,130
RD 8,16,128
RD 12,16,192
Mvav 244,60,122
v_exp_f32 v153, v153
Mvav 236,60,114
v_exp_f32 v158, v158
Mvvv 52,24,114
v_exp_f32 v154, v154
Mvvv 56,24,122
v_exp_f32 v159, v159
Mvvv 60,24,130
s_waitcnt lgkmcnt(3)
v_exp_f32 v155, v155
fh_a3:
Cvav 112,0,64,40
RD 16,16,512
v_cvt_pk_bf16_f32 v139, v138, v139
Cvav 120,0,68,44
RD 20,16,576
v_cvt_pk_bf16_f32 v138, v136, v137
Cvav 128,0,72,48
s_waitcnt lgkmcnt(4)
RD 24,16,640
v_cvt_pk_bf16_f32 v140, v140, v141
Mvav 112,4,76
RD 28,16,704
v_cvt_pk_bf16_f32 v141, v142, v143
Mvav 120,4,80
TR 32,18,8448
v_cvt_pk_bf16_f32 v147, v146, v147
Mvav 128,4,84
s_waitcnt lgkmcnt(6)
TR 34,18,8960
v_cvt_pk_bf16_f32 v146, v144, v145
Mvav 112,8,88
TR 36,18,8480
v_cvt_pk_bf16_f32 v148, v148, v149
Mvav 120,8,92
TR 38,18,8992
v_cvt_pk_bf16_f32 v149, v150, v151
Mvav 128,8,96
s_waitcnt lgkmcnt(8)
TR 40,18,8512
v_cvt_pk_bf16_f32 v155, v154, v155
Mvav 112,12,100
TR 42,18,9024
v_cvt_pk_bf16_f32 v154, v152, v153
Mvav 120,12,104
TR 44,18,8544
v_cvt_pk_bf16_f32 v156, v156, v157
Mvav 128,12,108
s_waitcnt lgkmcnt(10)
TR 46,18,9056
v_cvt_pk_bf16_f32 v157, v158, v159
Cvav 116,16,64,40
v_exp_f32 v112, v112
Cvav 124,16,68,44
v_exp_f32 v113, v113
Cvav 132,16,72,48
s_waitcnt lgkmcnt(10)
ds_write_b128 v0, a[240:243] offset:33792
Mvav 116,20,76
v_exp_f32 v114, v114
Mvav 124,20,80
ds_write_b128 v0, a[244:247] offset:34848
Mvav 132,20,84
s_waitcnt lgkmcnt(11)
v_exp_f32 v115, v115
Mvav 116,24,88
ds_write_b128 v0, a[248:251] offset:42240
Mvav 124,24,92
v_exp_f32 v120, v120
Mvav 132,24,96
s_waitcnt lgkmcnt(11)
ds_write_b128 v0, a[252:255] offset:43296
Mvav 116,28,100
v_exp_f32 v121, v121
Mvav 124,28,104
v_exp_f32 v122, v122
Mvav 132,28,108
s_waitcnt lgkmcnt(10)
v_exp_f32 v123, v123
Mvav 160,32,138
TR 48,18,8576
TR 50,18,9088
Mvav 168,32,146
s_waitcnt lgkmcnt(10)
v_exp_f32 v116, v116
Mvav 176,32,154
buffer_load_dwordx4 a[204:207], v31, s[16:19], s3 offen offset:256 nt
Mvav 180,36,154
v_exp_f32 v117, v117
Mvav 172,36,146
TR 52,18,8608
TR 54,18,9120
Mvav 164,36,138
s_waitcnt lgkmcnt(10)
s_mov_b32 s3, 0x24000
v_exp_f32 v118, v118
Mvav 184,40,138
buffer_load_dwordx4 a[208:211], v31, s[12:15], s3 offen nt
Mvav 192,40,146
s_waitcnt lgkmcnt(8)
v_exp_f32 v119, v119
Mvav 200,40,154
TR 56,18,8640
TR 58,18,9152
Mvav 204,44,154
v_exp_f32 v124, v124
Mvav 196,44,146
v_exp_f32 v128, v128
Mvav 188,44,138
s_waitcnt lgkmcnt(4)
v_exp_f32 v125, v125
Mvav 208,48,138
TR 60,18,8672
TR 62,18,9184
Mvav 216,48,146
v_exp_f32 v126, v126
Mvav 224,48,154
s_waitcnt lgkmcnt(4)
v_exp_f32 v129, v129
Mvav 228,52,154
v_exp_f32 v127, v127
Mvav 220,52,146
v_add_u32 v16, 0x10800, v15
v_add_u32 v18, 0x10800, v17
Mvav 212,52,138
s_waitcnt lgkmcnt(2)
v_exp_f32 v132, v132
Mvav 232,56,138
s_waitcnt lgkmcnt(0)
s_barrier
Mvav 240,56,146
RD 0,16,0
RD 4,16,64
Mvav 248,56,154
v_exp_f32 v133, v133
Mvav 252,60,154
RD 8,16,128
RD 12,16,192
Mvav 244,60,146
v_exp_f32 v130, v130
Mvav 236,60,138
v_exp_f32 v134, v134
Mvvv 52,24,138
v_exp_f32 v131, v131
Mvvv 56,24,146
v_exp_f32 v135, v135
Mvvv 60,24,154
s_waitcnt lgkmcnt(3)
fh_a4:
Cvav 136,0,64,40
RD 16,16,512
v_cvt_pk_bf16_f32 v115, v114, v115
Cvav 144,0,68,44
RD 20,16,576
v_cvt_pk_bf16_f32 v114, v112, v113
Cvav 152,0,72,48
s_waitcnt lgkmcnt(4)
RD 24,16,640
v_cvt_pk_bf16_f32 v116, v116, v117
Mvav 136,4,76
RD 28,16,704
v_cvt_pk_bf16_f32 v117, v118, v119
Mvav 144,4,80
TR 32,18,8448
v_cvt_pk_bf16_f32 v123, v122, v123
Mvav 152,4,84
s_waitcnt lgkmcnt(6)
TR 34,18,8960
v_cvt_pk_bf16_f32 v122, v120, v121
Mvav 136,8,88
TR 36,18,8480
v_cvt_pk_bf16_f32 v124, v124, v125
Mvav 144,8,92
TR 38,18,8992
v_cvt_pk_bf16_f32 v125, v126, v127
Mvav 152,8,96
s_waitcnt lgkmcnt(8)
TR 40,18,8512
v_cvt_pk_bf16_f32 v131, v130, v131
Mvav 136,12,100
TR 42,18,9024
v_cvt_pk_bf16_f32 v130, v128, v129
Mvav 144,12,104
TR 44,18,8544
v_cvt_pk_bf16_f32 v132, v132, v133
Mvav 152,12,108
s_waitcnt lgkmcnt(10)
TR 46,18,9056
v_cvt_pk_bf16_f32 v133, v134, v135
Cvav 140,16,64,40
v_exp_f32 v136, v136
Cvav 148,16,68,44
v_exp_f32 v137, v137
Cvav 156,16,72,48
s_waitcnt vmcnt(20) lgkmcnt(10)
ds_write_b128 v0, a[128:131] offset:50688
Mvav 140,20,76
v_exp_f32 v138, v138
Mvav 148,20,80
s_waitcnt vmcnt(19)
ds_write_b128 v0, a[132:135] offset:51744
Mvav 156,20,84
s_waitcnt lgkmcnt(11)
v_exp_f32 v139, v139
Mvav 140,24,88
s_waitcnt vmcnt(18)
ds_write_b128 v23, a[136:139] offset:1792
Mvav 148,24,92
v_exp_f32 v144, v144
Mvav 156,24,96
s_waitcnt vmcnt(17) lgkmcnt(11)
ds_write_b128 v23, a[140:143] offset:2848
Mvav 140,28,100
v_exp_f32 v145, v145
Mvav 148,28,104
v_exp_f32 v146, v146
Mvav 156,28,108
s_waitcnt lgkmcnt(10)
v_exp_f32 v147, v147
Mvav 160,32,114
TR 48,18,8576
TR 50,18,9088
Mvav 168,32,122
s_waitcnt lgkmcnt(10)
v_exp_f32 v140, v140
Mvav 176,32,130
buffer_load_dwordx4 a[212:215], v31, s[12:15], s3 offen offset:256 nt
Mvav 180,36,130
v_exp_f32 v141, v141
Mvav 172,36,122
TR 52,18,8608
TR 54,18,9120
Mvav 164,36,114
s_waitcnt lgkmcnt(10)
s_mov_b32 s3, 0x22000
v_exp_f32 v142, v142
Mvav 184,40,114
buffer_load_dwordx4 a[216:219], v31, s[16:19], s3 offen nt
Mvav 192,40,122
s_waitcnt lgkmcnt(8)
v_exp_f32 v143, v143
Mvav 200,40,130
TR 56,18,8640
TR 58,18,9152
Mvav 204,44,130
v_exp_f32 v148, v148
Mvav 196,44,122
v_exp_f32 v152, v152
Mvav 188,44,114
s_waitcnt lgkmcnt(4)
v_exp_f32 v149, v149
Mvav 208,48,114
TR 60,18,8672
TR 62,18,9184
Mvav 216,48,122
v_exp_f32 v150, v150
Mvav 224,48,130
s_waitcnt lgkmcnt(4)
v_exp_f32 v153, v153
Mvav 228,52,130
v_exp_f32 v151, v151
Mvav 220,52,122
v_add_u32 v16, 0x14a00, v15
v_add_u32 v18, 0x14a00, v17
Mvav 212,52,114
s_waitcnt lgkmcnt(2)
v_exp_f32 v156, v156
Mvav 232,56,114
s_waitcnt lgkmcnt(0)
s_barrier
Mvav 240,56,122
RD 0,16,0
RD 4,16,64
Mvav 248,56,130
v_exp_f32 v157, v157
Mvav 252,60,130
RD 8,16,128
RD 12,16,192
Mvav 244,60,122
v_exp_f32 v154, v154
Mvav 236,60,114
v_exp_f32 v158, v158
Mvvv 52,24,114
v_exp_f32 v155, v155
Mvvv 56,24,122
v_exp_f32 v159, v159
Mvvv 60,24,130
s_waitcnt lgkmcnt(3)
fh_a5:
Cvav 112,0,64,40
RD 16,16,512
v_cvt_pk_bf16_f32 v139, v138, v139
Cvav 120,0,68,44
RD 20,16,576
v_cvt_pk_bf16_f32 v138, v136, v137
Cvav 128,0,72,48
s_branch f_pad9s
f_pad9:
s_setpc_b64 s[70:71]
f_pad9s:
s_waitcnt lgkmcnt(4)
RD 24,16,640
v_cvt_pk_bf16_f32 v140, v140, v141
Mvav 112,4,76
RD 28,16,704
v_cvt_pk_bf16_f32 v141, v142, v143
Mvav 120,4,80
TR 32,18,8448
v_cvt_pk_bf16_f32 v147, v146, v147
Mvav 128,4,84
s_waitcnt lgkmcnt(6)
TR 34,18,8960
v_cvt_pk_bf16_f32 v146, v144, v145
Mvav 112,8,88
TR 36,18,8480
v_cvt_pk_bf16_f32 v148, v148, v149
Mvav 120,8,92
TR 38,18,8992
v_cvt_pk_bf16_f32 v149, v150, v151
Mvav 128,8,96
s_waitcnt lgkmcnt(8)
TR 40,18,8512
v_cvt_pk_bf16_f32 v155, v154, v155
Mvav 112,12,100
TR 42,18,9024
v_cvt_pk_bf16_f32 v154, v152, v153
Mvav 120,12,104
TR 44,18,8544
v_cvt_pk_bf16_f32 v156, v156, v157
Mvav 128,12,108
s_waitcnt lgkmcnt(10)
TR 46,18,9056
v_cvt_pk_bf16_f32 v157, v158, v159
Cvav 116,16,64,40
v_exp_f32 v112, v112
Cvav 124,16,68,44
v_exp_f32 v113, v113
Cvav 132,16,72,48
s_waitcnt vmcnt(18) lgkmcnt(10)
ds_write_b128 v23, a[144:147] offset:10240
Mvav 116,20,76
v_exp_f32 v114, v114
Mvav 124,20,80
s_waitcnt vmcnt(17)
ds_write_b128 v23, a[148:151] offset:11296
Mvav 132,20,84
s_waitcnt lgkmcnt(11)
v_exp_f32 v115, v115
Mvav 116,24,88
s_waitcnt vmcnt(16)
ds_write_b128 v23, a[152:155] offset:18688
Mvav 124,24,92
v_exp_f32 v120, v120
Mvav 132,24,96
s_waitcnt vmcnt(15) lgkmcnt(11)
ds_write_b128 v23, a[156:159] offset:19744
Mvav 116,28,100
v_exp_f32 v121, v121
Mvav 124,28,104
v_exp_f32 v122, v122
Mvav 132,28,108
s_waitcnt lgkmcnt(10)
v_exp_f32 v123, v123
Mvav 160,32,138
TR 48,18,8576
TR 50,18,9088
Mvav 168,32,146
s_waitcnt lgkmcnt(10)
v_exp_f32 v116, v116
Mvav 176,32,154
buffer_load_dwordx4 a[220:223], v31, s[16:19], s3 offen offset:256 nt
Mvav 180,36,154
v_exp_f32 v117, v117
Mvav 172,36,146
TR 52,18,8608
TR 54,18,9120
Mvav 164,36,138
s_waitcnt lgkmcnt(10)
s_mov_b32 s3, 0x26000
v_exp_f32 v118, v118
Mvav 184,40,138
buffer_load_dwordx4 a[224:227], v31, s[12:15], s3 offen nt
Mvav 192,40,146
s_waitcnt lgkmcnt(8)
v_exp_f32 v119, v119
Mvav 200,40,154
TR 56,18,8640
TR 58,18,9152
Mvav 204,44,154
v_exp_f32 v124, v124
Mvav 196,44,146
buffer_load_dwordx4 a[228:231], v31, s[12:15], s3 offen offset:256 nt
Mvav 188,44,138
s_waitcnt lgkmcnt(4)
v_exp_f32 v125, v125
Mvav 208,48,138
TR 60,18,8672
TR 62,18,9184
Mvav 216,48,146
v_exp_f32 v126, v126
Mvav 224,48,154
s_waitcnt lgkmcnt(4)
v_exp_f32 v128, v128
Mvav 228,52,154
v_exp_f32 v127, v127
Mvav 220,52,146
v_add_u32 v16, 0x18c00, v15
v_add_u32 v18, 0x18c00, v17
Mvav 212,52,138
s_waitcnt lgkmcnt(2)
v_exp_f32 v132, v132
Mvav 232,56,138
s_waitcnt lgkmcnt(0)
s_barrier
Mvav 240,56,146
RD 0,16,0
RD 4,16,64
Mvav 248,56,154
v_exp_f32 v133, v133
Mvav 252,60,154
RD 8,16,128
RD 12,16,192
Mvav 244,60,146
v_exp_f32 v129, v129
Mvav 236,60,138
v_exp_f32 v134, v134
Mvvv 52,24,138
v_exp_f32 v130, v130
Mvvv 56,24,146
v_exp_f32 v135, v135
Mvvv 60,24,154
s_waitcnt lgkmcnt(3)
v_exp_f32 v131, v131
fh_a6:
Cvav 136,0,64,40
RD 16,16,512
v_cvt_pk_bf16_f32 v115, v114, v115
Cvav 144,0,68,44
RD 20,16,576
v_cvt_pk_bf16_f32 v114, v112, v113
Cvav 152,0,72,48
s_waitcnt lgkmcnt(4)
RD 24,16,640
v_cvt_pk_bf16_f32 v116, v116, v117
Mvav 136,4,76
RD 28,16,704
v_cvt_pk_bf16_f32 v117, v118, v119
Mvav 144,4,80
TR 32,18,8448
v_cvt_pk_bf16_f32 v123, v122, v123
Mvav 152,4,84
s_waitcnt lgkmcnt(6)
TR 34,18,8960
v_cvt_pk_bf16_f32 v122, v120, v121
Mvav 136,8,88
TR 36,18,8480
v_cvt_pk_bf16_f32 v124, v124, v125
Mvav 144,8,92
TR 38,18,8992
v_cvt_pk_bf16_f32 v125, v126, v127
Mvav 152,8,96
s_waitcnt lgkmcnt(8)
TR 40,18,8512
v_cvt_pk_bf16_f32 v131, v130, v131
Mvav 136,12,100
TR 42,18,9024
v_cvt_pk_bf16_f32 v130, v128, v129
Mvav 144,12,104
TR 44,18,8544
v_cvt_pk_bf16_f32 v132, v132, v133
Mvav 152,12,108
s_waitcnt lgkmcnt(10)
TR 46,18,9056
v_cvt_pk_bf16_f32 v133, v134, v135
Cvav 140,16,64,40
v_exp_f32 v136, v136
Cvav 148,16,68,44
v_exp_f32 v137, v137
Cvav 156,16,72,48
s_waitcnt vmcnt(17) lgkmcnt(10)
ds_write_b128 v23, a[160:163] offset:27136
Mvav 140,20,76
v_exp_f32 v138, v138
Mvav 148,20,80
s_waitcnt vmcnt(16)
ds_write_b128 v23, a[164:167] offset:28192
Mvav 156,20,84
s_waitcnt lgkmcnt(11)
v_exp_f32 v139, v139
Mvav 140,24,88
s_waitcnt vmcnt(15)
ds_write_b128 v23, a[168:171] offset:35584
Mvav 148,24,92
v_exp_f32 v144, v144
Mvav 156,24,96
s_waitcnt vmcnt(14) lgkmcnt(11)
ds_write_b128 v23, a[172:175] offset:36640
Mvav 140,28,100
v_exp_f32 v145, v145
Mvav 148,28,104
v_exp_f32 v146, v146
Mvav 156,28,108
s_waitcnt lgkmcnt(10)
v_exp_f32 v147, v147
Mvav 160,32,114
TR 48,18,8576
TR 50,18,9088
Mvav 168,32,122
s_waitcnt lgkmcnt(10)
s_mov_b32 s3, 0x24000
v_exp_f32 v140, v140
Mvav 176,32,130
buffer_load_dwordx4 a[232:235], v31, s[16:19], s3 offen nt
Mvav 180,36,130
v_exp_f32 v141, v141
Mvav 172,36,122
TR 52,18,8608
TR 54,18,9120
Mvav 164,36,114
s_waitcnt lgkmcnt(10)
v_exp_f32 v142, v142
Mvav 184,40,114
buffer_load_dwordx4 a[236:239], v31, s[16:19], s3 offen offset:256 nt
Mvav 192,40,122
s_waitcnt lgkmcnt(8)
v_exp_f32 v143, v143
Mvav 200,40,130
TR 56,18,8640
TR 58,18,9152
Mvav 204,44,130
v_exp_f32 v148, v148
Mvav 196,44,122
v_exp_f32 v152, v152
Mvav 188,44,114
s_waitcnt lgkmcnt(4)
v_exp_f32 v149, v149
Mvav 208,48,114
TR 60,18,8672
TR 62,18,9184
Mvav 216,48,122
v_exp_f32 v150, v150
Mvav 224,48,130
s_waitcnt lgkmcnt(4)
v_exp_f32 v153, v153
Mvav 228,52,130
v_exp_f32 v151, v151
Mvav 220,52,122
v_add_u32 v16, 0x1ce00, v15
v_add_u32 v18, 0x1ce00, v17
Mvav 212,52,114
s_waitcnt lgkmcnt(2)
v_exp_f32 v156, v156
Mvav 232,56,114
s_waitcnt lgkmcnt(0)
s_barrier
Mvav 240,56,122
RD 0,16,0
RD 4,16,64
Mvav 248,56,130
v_exp_f32 v157, v157
Mvav 252,60,130
RD 8,16,128
RD 12,16,192
Mvav 244,60,122
v_exp_f32 v154, v154
Mvav 236,60,114
v_exp_f32 v158, v158
Mvvv 52,24,114
v_exp_f32 v155, v155
Mvvv 56,24,122
v_exp_f32 v159, v159
Mvvv 60,24,130
s_waitcnt lgkmcnt(3)
fh_a7:
Cvav 112,0,64,40
RD 16,16,512
v_cvt_pk_bf16_f32 v139, v138, v139
Cvav 120,0,68,44
RD 20,16,576
v_cvt_pk_bf16_f32 v138, v136, v137
Cvav 128,0,72,48
s_waitcnt lgkmcnt(4)
RD 24,16,640
v_cvt_pk_bf16_f32 v140, v140, v141
Mvav 112,4,76
RD 28,16,704
v_cvt_pk_bf16_f32 v141, v142, v143
Mvav 120,4,80
TR 32,18,8448
v_cvt_pk_bf16_f32 v147, v146, v147
Mvav 128,4,84
s_waitcnt lgkmcnt(6)
TR 34,18,8960
v_cvt_pk_bf16_f32 v146, v144, v145
Mvav 112,8,88
TR 36,18,8480
v_cvt_pk_bf16_f32 v148, v148, v149
Mvav 120,8,92
TR 38,18,8992
v_cvt_pk_bf16_f32 v149, v150, v151
Mvav 128,8,96
s_waitcnt lgkmcnt(8)
TR 40,18,8512
v_cvt_pk_bf16_f32 v155, v154, v155
Mvav 112,12,100
TR 42,18,9024
v_cvt_pk_bf16_f32 v154, v152, v153
Mvav 120,12,104
TR 44,18,8544
v_cvt_pk_bf16_f32 v156, v156, v157
Mvav 128,12,108
s_waitcnt lgkmcnt(10)
TR 46,18,9056
v_cvt_pk_bf16_f32 v157, v158, v159
Cvav 116,16,64,40
v_exp_f32 v112, v112
Cvav 124,16,68,44
v_exp_f32 v113, v113
Cvav 132,16,72,48
s_waitcnt vmcnt(15) lgkmcnt(10)
ds_write_b128 v23, a[176:179] offset:44032
Mvav 116,20,76
v_exp_f32 v114, v114
Mvav 124,20,80
s_waitcnt vmcnt(14)
ds_write_b128 v23, a[180:183] offset:45088
Mvav 132,20,84
s_waitcnt lgkmcnt(11)
v_exp_f32 v115, v115
Mvav 116,24,88
s_waitcnt vmcnt(13)
ds_write_b128 v23, a[184:187] offset:52480
Mvav 124,24,92
v_exp_f32 v120, v120
Mvav 132,24,96
s_waitcnt vmcnt(12) lgkmcnt(11)
ds_write_b128 v23, a[188:191] offset:53536
Mvav 116,28,100
v_exp_f32 v121, v121
Mvav 124,28,104
v_exp_f32 v122, v122
Mvav 132,28,108
s_waitcnt lgkmcnt(10)
v_exp_f32 v123, v123
Mvav 160,32,138
TR 48,18,8576
TR 50,18,9088
Mvav 168,32,146
s_waitcnt lgkmcnt(10)
s_mov_b32 s3, 0x28000
v_exp_f32 v116, v116
Mvav 176,32,154
buffer_load_dwordx4 a[240:243], v31, s[12:15], s3 offen nt
Mvav 180,36,154
v_exp_f32 v117, v117
Mvav 172,36,146
TR 52,18,8608
TR 54,18,9120
Mvav 164,36,138
s_waitcnt lgkmcnt(10)
v_exp_f32 v118, v118
Mvav 184,40,138
buffer_load_dwordx4 a[244:247], v31, s[12:15], s3 offen offset:256 nt
Mvav 192,40,146
s_waitcnt lgkmcnt(8)
v_exp_f32 v119, v119
Mvav 200,40,154
TR 56,18,8640
TR 58,18,9152
Mvav 204,44,154
s_mov_b32 s3, 0x26000
v_exp_f32 v124, v124
Mvav 196,44,146
buffer_load_dwordx4 a[248:251], v31, s[16:19], s3 offen nt
Mvav 188,44,138
s_waitcnt lgkmcnt(4)
v_exp_f32 v125, v125
Mvav 208,48,138
TR 60,18,8672
TR 62,18,9184
Mvav 216,48,146
v_exp_f32 v126, v126
Mvav 224,48,154
s_waitcnt lgkmcnt(4)
v_exp_f32 v128, v128
Mvav 228,52,154
v_exp_f32 v127, v127
Mvav 220,52,146
v_add_u32 v16, 0x21000, v15
v_add_u32 v18, 0x21000, v17
Mvav 212,52,138
s_waitcnt lgkmcnt(2)
v_exp_f32 v132, v132
Mvav 232,56,138
s_waitcnt lgkmcnt(0)
s_barrier
Mvav 240,56,146
RD 0,16,0
RD 4,16,64
Mvav 248,56,154
v_exp_f32 v133, v133
Mvav 252,60,154
RD 8,16,128
RD 12,16,192
Mvav 244,60,146
v_exp_f32 v129, v129
Mvav 236,60,138
v_exp_f32 v134, v134
Mvvv 52,24,138
v_exp_f32 v130, v130
Mvvv 56,24,146
v_exp_f32 v135, v135
Mvvv 60,24,154
s_waitcnt lgkmcnt(3)
v_exp_f32 v131, v131
fh_a8:
Cvav 136,0,64,40
RD 16,16,512
v_cvt_pk_bf16_f32 v115, v114, v115
Cvav 144,0,68,44
RD 20,16,576
v_cvt_pk_bf16_f32 v114, v112, v113
Cvav 152,0,72,48
s_waitcnt lgkmcnt(4)
RD 24,16,640
v_cvt_pk_bf16_f32 v116, v116, v117
Mvav 136,4,76
RD 28,16,704
v_cvt_pk_bf16_f32 v117, v118, v119
Mvav 144,4,80
TR 32,18,8448
v_cvt_pk_bf16_f32 v123, v122, v123
Mvav 152,4,84
s_waitcnt lgkmcnt(6)
TR 34,18,8960
v_cvt_pk_bf16_f32 v122, v120, v121
Mvav 136,8,88
TR 36,18,8480
v_cvt_pk_bf16_f32 v124, v124, v125
Mvav 144,8,92
TR 38,18,8992
v_cvt_pk_bf16_f32 v125, v126, v127
Mvav 152,8,96
s_waitcnt lgkmcnt(8)
TR 40,18,8512
v_cvt_pk_bf16_f32 v131, v130, v131
Mvav 136,12,100
TR 42,18,9024
v_cvt_pk_bf16_f32 v130, v128, v129
Mvav 144,12,104
TR 44,18,8544
v_cvt_pk_bf16_f32 v132, v132, v133
Mvav 152,12,108
s_waitcnt lgkmcnt(10)
TR 46,18,9056
v_cvt_pk_bf16_f32 v133, v134, v135
Cvav 140,16,64,40
v_exp_f32 v136, v136
Cvav 148,16,68,44
v_exp_f32 v137, v137
Cvav 156,16,72,48
s_waitcnt vmcnt(14) lgkmcnt(10)
ds_write_b128 v19, a[192:195] offset:3584
Mvav 140,20,76
v_exp_f32 v138, v138
Mvav 148,20,80
s_waitcnt vmcnt(13)
ds_write_b128 v19, a[196:199] offset:4640
Mvav 156,20,84
s_waitcnt lgkmcnt(11)
v_exp_f32 v139, v139
Mvav 140,24,88
s_waitcnt vmcnt(12)
ds_write_b128 v19, a[200:203] offset:12032
Mvav 148,24,92
v_exp_f32 v144, v144
Mvav 156,24,96
s_waitcnt vmcnt(11) lgkmcnt(11)
ds_write_b128 v19, a[204:207] offset:13088
Mvav 140,28,100
v_exp_f32 v145, v145
Mvav 148,28,104
v_exp_f32 v146, v146
Mvav 156,28,108
s_waitcnt lgkmcnt(10)
v_exp_f32 v147, v147
Mvav 160,32,114
TR 48,18,8576
TR 50,18,9088
Mvav 168,32,122
s_waitcnt lgkmcnt(10)
v_exp_f32 v140, v140
Mvav 176,32,130
buffer_load_dwordx4 a[252:255], v31, s[16:19], s3 offen offset:256 nt
Mvav 180,36,130
v_exp_f32 v141, v141
Mvav 172,36,122
TR 52,18,8608
TR 54,18,9120
Mvav 164,36,114
s_waitcnt lgkmcnt(10)
s_mov_b32 s3, 0x2a000
v_exp_f32 v142, v142
Mvav 184,40,114
buffer_load_dwordx4 a[128:131], v31, s[12:15], s3 offen nt
Mvav 192,40,122
s_waitcnt lgkmcnt(8)
v_exp_f32 v143, v143
Mvav 200,40,130
TR 56,18,8640
TR 58,18,9152
Mvav 204,44,130
v_exp_f32 v148, v148
Mvav 196,44,122
v_exp_f32 v152, v152
Mvav 188,44,114
s_waitcnt lgkmcnt(4)
v_exp_f32 v149, v149
Mvav 208,48,114
TR 60,18,8672
TR 62,18,9184
Mvav 216,48,122
v_exp_f32 v150, v150
Mvav 224,48,130
s_waitcnt lgkmcnt(4)
v_exp_f32 v153, v153
Mvav 228,52,130
v_exp_f32 v151, v151
Mvav 220,52,122
v_add_u32 v16, 0, v15
v_add_u32 v18, 0, v17
Mvav 212,52,114
s_waitcnt lgkmcnt(2)
v_exp_f32 v156, v156
Mvav 232,56,114
s_waitcnt lgkmcnt(0)
s_barrier
Mvav 240,56,122
RD 0,16,0
RD 4,16,64
Mvav 248,56,130
v_exp_f32 v157, v157
Mvav 252,60,130
RD 8,16,128
RD 12,16,192
Mvav 244,60,122
v_exp_f32 v154, v154
Mvav 236,60,114
v_exp_f32 v158, v158
Mvvv 52,24,114
v_exp_f32 v155, v155
Mvvv 56,24,122
v_exp_f32 v159, v159
Mvvv 60,24,130
s_waitcnt lgkmcnt(3)
fh_a9:
Cvav 112,0,64,40
RD 16,16,512
v_cvt_pk_bf16_f32 v139, v138, v139
Cvav 120,0,68,44
RD 20,16,576
v_cvt_pk_bf16_f32 v138, v136, v137
Cvav 128,0,72,48
s_waitcnt lgkmcnt(4)
RD 24,16,640
v_cvt_pk_bf16_f32 v140, v140, v141
Mvav 112,4,76
RD 28,16,704
v_cvt_pk_bf16_f32 v141, v142, v143
Mvav 120,4,80
TR 32,18,8448
v_cvt_pk_bf16_f32 v147, v146, v147
Mvav 128,4,84
s_waitcnt lgkmcnt(6)
TR 34,18,8960
v_cvt_pk_bf16_f32 v146, v144, v145
Mvav 112,8,88
TR 36,18,8480
v_cvt_pk_bf16_f32 v148, v148, v149
Mvav 120,8,92
TR 38,18,8992
v_cvt_pk_bf16_f32 v149, v150, v151
Mvav 128,8,96
s_waitcnt lgkmcnt(8)
TR 40,18,8512
v_cvt_pk_bf16_f32 v155, v154, v155
Mvav 112,12,100
TR 42,18,9024
v_cvt_pk_bf16_f32 v154, v152, v153
Mvav 120,12,104
TR 44,18,8544
v_cvt_pk_bf16_f32 v156, v156, v157
Mvav 128,12,108
s_waitcnt lgkmcnt(10)
TR 46,18,9056
v_cvt_pk_bf16_f32 v157, v158, v159
Cvav 116,16,64,40
v_exp_f32 v112, v112
Cvav 124,16,68,44
v_exp_f32 v113, v113
Cvav 132,16,72,48
s_waitcnt vmcnt(12) lgkmcnt(10)
ds_write_b128 v19, a[208:211] offset:20480
Mvav 116,20,76
v_exp_f32 v114, v114
Mvav 124,20,80
s_branch f_pad10s
f_pad10:
s_setpc_b64 s[70:71]
f_pad10s:
s_waitcnt vmcnt(11)
ds_write_b128 v19, a[212:215] offset:21536
Mvav 132,20,84
s_waitcnt lgkmcnt(11)
v_exp_f32 v115, v115
Mvav 116,24,88
s_waitcnt vmcnt(10)
ds_write_b128 v19, a[216:219] offset:28928
Mvav 124,24,92
v_exp_f32 v120, v120
Mvav 132,24,96
s_waitcnt vmcnt(9) lgkmcnt(11)
ds_write_b128 v19, a[220:223] offset:29984
Mvav 116,28,100
v_exp_f32 v121, v121
Mvav 124,28,104
v_exp_f32 v122, v122
Mvav 132,28,108
s_waitcnt lgkmcnt(10)
v_exp_f32 v123, v123
Mvav 160,32,138
TR 48,18,8576
TR 50,18,9088
Mvav 168,32,146
s_waitcnt lgkmcnt(10)
v_exp_f32 v116, v116
Mvav 176,32,154
buffer_load_dwordx4 a[132:135], v31, s[12:15], s3 offen offset:256 nt
Mvav 180,36,154
v_exp_f32 v117, v117
Mvav 172,36,146
TR 52,18,8608
TR 54,18,9120
Mvav 164,36,138
s_waitcnt lgkmcnt(10)
s_mov_b32 s3, 0x28000
v_exp_f32 v118, v118
Mvav 184,40,138
buffer_load_dwordx4 a[136:139], v31, s[16:19], s3 offen nt
Mvav 192,40,146
s_waitcnt lgkmcnt(8)
v_exp_f32 v119, v119
Mvav 200,40,154
TR 56,18,8640
TR 58,18,9152
Mvav 204,44,154
v_exp_f32 v124, v124
Mvav 196,44,146
v_exp_f32 v128, v128
Mvav 188,44,138
s_waitcnt lgkmcnt(4)
v_exp_f32 v125, v125
Mvav 208,48,138
TR 60,18,8672
TR 62,18,9184
Mvav 216,48,146
v_exp_f32 v126, v126
Mvav 224,48,154
s_waitcnt lgkmcnt(4)
v_exp_f32 v129, v129
Mvav 228,52,154
v_exp_f32 v127, v127
Mvav 220,52,146
v_add_u32 v16, 0x4200, v15
v_add_u32 v18, 0x4200, v17
Mvav 212,52,138
s_waitcnt lgkmcnt(2)
v_exp_f32 v132, v132
Mvav 232,56,138
s_waitcnt lgkmcnt(0)
s_barrier
Mvav 240,56,146
RD 0,16,0
RD 4,16,64
Mvav 248,56,154
v_exp_f32 v133, v133
Mvav 252,60,154
RD 8,16,128
RD 12,16,192
Mvav 244,60,146
v_exp_f32 v130, v130
Mvav 236,60,138
v_exp_f32 v134, v134
Mvvv 52,24,138
v_exp_f32 v131, v131
Mvvv 56,24,146
v_exp_f32 v135, v135
Mvvv 60,24,154
s_waitcnt lgkmcnt(3)
fh_a10:
Cvav 136,0,64,40
RD 16,16,512
v_cvt_pk_bf16_f32 v115, v114, v115
Cvav 144,0,68,44
RD 20,16,576
v_cvt_pk_bf16_f32 v114, v112, v113
Cvav 152,0,72,48
s_waitcnt lgkmcnt(4)
RD 24,16,640
v_cvt_pk_bf16_f32 v116, v116, v117
Mvav 136,4,76
RD 28,16,704
v_cvt_pk_bf16_f32 v117, v118, v119
Mvav 144,4,80
TR 32,18,8448
v_cvt_pk_bf16_f32 v123, v122, v123
Mvav 152,4,84
s_waitcnt lgkmcnt(6)
TR 34,18,8960
v_cvt_pk_bf16_f32 v122, v120, v121
Mvav 136,8,88
TR 36,18,8480
v_cvt_pk_bf16_f32 v124, v124, v125
Mvav 144,8,92
TR 38,18,8992
v_cvt_pk_bf16_f32 v125, v126, v127
Mvav 152,8,96
s_waitcnt lgkmcnt(8)
TR 40,18,8512
v_cvt_pk_bf16_f32 v131, v130, v131
Mvav 136,12,100
TR 42,18,9024
v_cvt_pk_bf16_f32 v130, v128, v129
Mvav 144,12,104
TR 44,18,8544
v_cvt_pk_bf16_f32 v132, v132, v133
Mvav 152,12,108
s_waitcnt lgkmcnt(10)
TR 46,18,9056
v_cvt_pk_bf16_f32 v133, v134, v135
Cvav 140,16,64,40
v_exp_f32 v136, v136
Cvav 148,16,68,44
v_exp_f32 v137, v137
Cvav 156,16,72,48
s_waitcnt vmcnt(10) lgkmcnt(10)
ds_write_b128 v0, a[224:227]
Mvav 140,20,76
v_exp_f32 v138, v138
Mvav 148,20,80
s_waitcnt vmcnt(9)
ds_write_b128 v0, a[228:231] offset:1056
Mvav 156,20,84
s_waitcnt lgkmcnt(11)
v_exp_f32 v139, v139
Mvav 140,24,88
s_waitcnt vmcnt(8)
ds_write_b128 v0, a[232:235] offset:8448
Mvav 148,24,92
v_exp_f32 v144, v144
Mvav 156,24,96
s_waitcnt vmcnt(7) lgkmcnt(11)
ds_write_b128 v0, a[236:239] offset:9504
Mvav 140,28,100
v_exp_f32 v145, v145
Mvav 148,28,104
v_exp_f32 v146, v146
Mvav 156,28,108
s_waitcnt lgkmcnt(10)
v_exp_f32 v147, v147
Mvav 160,32,114
TR 48,18,8576
TR 50,18,9088
Mvav 168,32,122
s_waitcnt lgkmcnt(10)
v_exp_f32 v140, v140
Mvav 176,32,130
buffer_load_dwordx4 a[140:143], v31, s[16:19], s3 offen offset:256 nt
Mvav 180,36,130
v_exp_f32 v141, v141
Mvav 172,36,122
TR 52,18,8608
TR 54,18,9120
Mvav 164,36,114
s_waitcnt lgkmcnt(10)
s_mov_b32 s3, 0x2c000
v_exp_f32 v142, v142
Mvav 184,40,114
buffer_load_dwordx4 a[144:147], v31, s[12:15], s3 offen nt
Mvav 192,40,122
s_waitcnt lgkmcnt(8)
v_exp_f32 v143, v143
Mvav 200,40,130
TR 56,18,8640
TR 58,18,9152
Mvav 204,44,130
v_exp_f32 v148, v148
Mvav 196,44,122
buffer_load_dwordx4 a[148:151], v31, s[12:15], s3 offen offset:256 nt
Mvav 188,44,114
s_waitcnt lgkmcnt(4)
v_exp_f32 v149, v149
Mvav 208,48,114
TR 60,18,8672
TR 62,18,9184
Mvav 216,48,122
v_exp_f32 v150, v150
Mvav 224,48,130
s_waitcnt lgkmcnt(4)
v_exp_f32 v152, v152
Mvav 228,52,130
v_exp_f32 v151, v151
Mvav 220,52,122
v_add_u32 v16, 0x8400, v15
v_add_u32 v18, 0x8400, v17
Mvav 212,52,114
s_waitcnt lgkmcnt(2)
v_exp_f32 v156, v156
Mvav 232,56,114
s_waitcnt lgkmcnt(0)
s_barrier
Mvav 240,56,122
RD 0,16,0
RD 4,16,64
Mvav 248,56,130
v_exp_f32 v157, v157
Mvav 252,60,130
RD 8,16,128
RD 12,16,192
Mvav 244,60,122
v_exp_f32 v153, v153
Mvav 236,60,114
v_exp_f32 v158, v158
Mvvv 52,24,114
v_exp_f32 v154, v154
Mvvv 56,24,122
v_exp_f32 v159, v159
Mvvv 60,24,130
s_waitcnt lgkmcnt(3)
v_exp_f32 v155, v155
fh_a11:
Cvav 112,0,64,40
RD 16,16,512
v_cvt_pk_bf16_f32 v139, v138, v139
Cvav 120,0,68,44
RD 20,16,576
v_cvt_pk_bf16_f32 v138, v136, v137
Cvav 128,0,72,48
s_waitcnt lgkmcnt(4)
RD 24,16,640
v_cvt_pk_bf16_f32 v140, v140, v141
Mvav 112,4,76
RD 28,16,704
v_cvt_pk_bf16_f32 v141, v142, v143
Mvav 120,4,80
TR 32,18,8448
v_cvt_pk_bf16_f32 v147, v146, v147
Mvav 128,4,84
s_waitcnt lgkmcnt(6)
TR 34,18,8960
v_cvt_pk_bf16_f32 v146, v144, v145
Mvav 112,8,88
TR 36,18,8480
v_cvt_pk_bf16_f32 v148, v148, v149
Mvav 120,8,92
TR 38,18,8992
v_cvt_pk_bf16_f32 v149, v150, v151
Mvav 128,8,96
s_waitcnt lgkmcnt(8)
TR 40,18,8512
v_cvt_pk_bf16_f32 v155, v154, v155
Mvav 112,12,100
TR 42,18,9024
v_cvt_pk_bf16_f32 v154, v152, v153
Mvav 120,12,104
TR 44,18,8544
v_cvt_pk_bf16_f32 v156, v156, v157
Mvav 128,12,108
s_waitcnt lgkmcnt(10)
TR 46,18,9056
v_cvt_pk_bf16_f32 v157, v158, v159
Cvav 116,16,64,40
v_exp_f32 v112, v112
Cvav 124,16,68,44
v_exp_f32 v113, v113
Cvav 132,16,72,48
s_waitcnt vmcnt(9) lgkmcnt(10)
ds_write_b128 v0, a[240:243] offset:16896
Mvav 116,20,76
v_exp_f32 v114, v114
Mvav 124,20,80
s_waitcnt vmcnt(8)
ds_write_b128 v0, a[244:247] offset:17952
Mvav 132,20,84
s_waitcnt lgkmcnt(11)
v_exp_f32 v115, v115
Mvav 116,24,88
s_waitcnt vmcnt(7)
ds_write_b128 v0, a[248:251] offset:25344
Mvav 124,24,92
v_exp_f32 v120, v120
Mvav 132,24,96
s_waitcnt vmcnt(6) lgkmcnt(11)
ds_write_b128 v0, a[252:255] offset:26400
Mvav 116,28,100
v_exp_f32 v121, v121
Mvav 124,28,104
v_exp_f32 v122, v122
Mvav 132,28,108
s_waitcnt lgkmcnt(10)
v_exp_f32 v123, v123
Mvav 160,32,138
TR 48,18,8576
TR 50,18,9088
Mvav 168,32,146
s_waitcnt lgkmcnt(10)
s_mov_b32 s3, 0x2a000
v_exp_f32 v116, v116
Mvav 176,32,154
buffer_load_dwordx4 a[152:155], v31, s[16:19], s3 offen nt
Mvav 180,36,154
v_exp_f32 v117, v117
Mvav 172,36,146
TR 52,18,8608
TR 54,18,9120
Mvav 164,36,138
s_waitcnt lgkmcnt(10)
v_exp_f32 v118, v118
Mvav 184,40,138
buffer_load_dwordx4 a[156:159], v31, s[16:19], s3 offen offset:256 nt
Mvav 192,40,146
s_waitcnt lgkmcnt(8)
v_exp_f32 v119, v119
Mvav 200,40,154
TR 56,18,8640
TR 58,18,9152
Mvav 204,44,154
v_exp_f32 v124, v124
Mvav 196,44,146
v_exp_f32 v128, v128
Mvav 188,44,138
s_waitcnt lgkmcnt(4)
v_exp_f32 v125, v125
Mvav 208,48,138
TR 60,18,8672
TR 62,18,9184
Mvav 216,48,146
v_exp_f32 v126, v126
Mvav 224,48,154
s_waitcnt lgkmcnt(4)
v_exp_f32 v129, v129
Mvav 228,52,154
v_exp_f32 v127, v127
Mvav 220,52,146
v_add_u32 v16, 0xc600, v15
v_add_u32 v18, 0xc600, v17
Mvav 212,52,138
s_waitcnt lgkmcnt(2)
v_exp_f32 v132, v132
Mvav 232,56,138
s_waitcnt lgkmcnt(0)
s_barrier
Mvav 240,56,146
RD 0,16,0
RD 4,16,64
Mvav 248,56,154
v_exp_f32 v133, v133
Mvav 252,60,154
RD 8,16,128
RD 12,16,192
Mvav 244,60,146
v_exp_f32 v130, v130
Mvav 236,60,138
v_exp_f32 v134, v134
Mvvv 52,24,138
v_exp_f32 v131, v131
Mvvv 56,24,146
v_exp_f32 v135, v135
Mvvv 60,24,154
s_waitcnt lgkmcnt(3)
fh_a12:
Cvav 136,0,64,40
RD 16,16,512
v_cvt_pk_bf16_f32 v115, v114, v115
Cvav 144,0,68,44
RD 20,16,576
v_cvt_pk_bf16_f32 v114, v112, v113
Cvav 152,0,72,48
s_waitcnt lgkmcnt(4)
RD 24,16,640
v_cvt_pk_bf16_f32 v116, v116, v117
Mvav 136,4,76
RD 28,16,704
v_cvt_pk_bf16_f32 v117, v118, v119
Mvav 144,4,80
TR 32,18,8448
v_cvt_pk_bf16_f32 v123, v122, v123
Mvav 152,4,84
s_waitcnt lgkmcnt(6)
TR 34,18,8960
v_cvt_pk_bf16_f32 v122, v120, v121
Mvav 136,8,88
TR 36,18,8480
v_cvt_pk_bf16_f32 v124, v124, v125
Mvav 144,8,92
TR 38,18,8992
v_cvt_pk_bf16_f32 v125, v126, v127
Mvav 152,8,96
s_waitcnt lgkmcnt(8)
TR 40,18,8512
v_cvt_pk_bf16_f32 v131, v130, v131
Mvav 136,12,100
TR 42,18,9024
v_cvt_pk_bf16_f32 v130, v128, v129
Mvav 144,12,104
TR 44,18,8544
v_cvt_pk_bf16_f32 v132, v132, v133
Mvav 152,12,108
s_waitcnt lgkmcnt(10)
TR 46,18,9056
v_cvt_pk_bf16_f32 v133, v134, v135
Cvav 140,16,64,40
v_exp_f32 v136, v136
Cvav 148,16,68,44
v_exp_f32 v137, v137
Cvav 156,16,72,48
s_waitcnt lgkmcnt(10)
v_exp_f32 v138, v138
Mvav 140,20,76
v_exp_f32 v139, v139
Mvav 148,20,80
v_exp_f32 v144, v144
Mvav 156,20,84
s_waitcnt lgkmcnt(9)
v_exp_f32 v145, v145
Mvav 140,24,88
v_exp_f32 v146, v146
Mvav 148,24,92
v_exp_f32 v147, v147
Mvav 156,24,96
s_waitcnt lgkmcnt(8)
v_exp_f32 v152, v152
Mvav 140,28,100
v_exp_f32 v153, v153
Mvav 148,28,104
v_exp_f32 v154, v154
Mvav 156,28,108
s_waitcnt lgkmcnt(6)
v_exp_f32 v155, v155
Mvav 160,32,114
TR 48,18,8576
TR 50,18,9088
Mvav 168,32,122
s_waitcnt lgkmcnt(6)
s_mov_b32 s3, 0x2e000
v_exp_f32 v140, v140
Mvav 176,32,130
buffer_load_dwordx4 a[160:163], v31, s[12:15], s3 offen nt
Mvav 180,36,130
v_exp_f32 v141, v141
Mvav 172,36,122
TR 52,18,8608
TR 54,18,9120
Mvav 164,36,114
s_waitcnt lgkmcnt(6)
v_exp_f32 v142, v142
Mvav 184,40,114
buffer_load_dwordx4 a[164:167], v31, s[12:15], s3 offen offset:256 nt
Mvav 192,40,122
s_waitcnt lgkmcnt(4)
v_exp_f32 v143, v143
Mvav 200,40,130
TR 56,18,8640
TR 58,18,9152
Mvav 204,44,130
s_mov_b32 s3, 0x2c000
v_exp_f32 v148, v148
Mvav 196,44,122
buffer_load_dwordx4 a[168:171], v31, s[16:19], s3 offen nt
Mvav 188,44,114
s_waitcnt lgkmcnt(4)
v_exp_f32 v149, v149
Mvav 208,48,114
TR 60,18,8672
TR 62,18,9184
Mvav 216,48,122
v_exp_f32 v150, v150
Mvav 224,48,130
s_waitcnt lgkmcnt(4)
v_exp_f32 v151, v151
Mvav 228,52,130
v_exp_f32 v156, v156
Mvav 220,52,122
v_add_u32 v16, 0x10800, v15
v_add_u32 v18, 0x10800, v17
Mvav 212,52,114
s_waitcnt lgkmcnt(2)
v_exp_f32 v157, v157
Mvav 232,56,114
s_waitcnt lgkmcnt(0)
s_barrier
Mvav 240,56,122
RD 0,16,0
Mvav 248,56,130
v_exp_f32 v158, v158
Mvav 252,60,130
RD 4,16,64
Mvav 244,60,122
v_exp_f32 v159, v159
Mvav 236,60,114
RD 8,16,128
Mvvv 52,24,114
RD 12,16,192
Mvvv 56,24,122
Mvvv 60,24,130
s_waitcnt lgkmcnt(3)
fh_a13:
Cvav 112,0,64,40
RD 16,16,512
v_cvt_pk_bf16_f32 v139, v138, v139
Cvav 120,0,68,44
RD 20,16,576
v_cvt_pk_bf16_f32 v138, v136, v137
Cvav 128,0,72,48
s_waitcnt lgkmcnt(4)
RD 24,16,640
v_cvt_pk_bf16_f32 v140, v140, v141
Mvav 112,4,76
RD 28,16,704
v_cvt_pk_bf16_f32 v141, v142, v143
Mvav 120,4,80
TR 32,18,8448
v_cvt_pk_bf16_f32 v147, v146, v147
Mvav 128,4,84
s_waitcnt lgkmcnt(6)
TR 34,18,8960
v_cvt_pk_bf16_f32 v146, v144, v145
Mvav 112,8,88
TR 36,18,8480
v_cvt_pk_bf16_f32 v148, v148, v149
Mvav 120,8,92
TR 38,18,8992
v_cvt_pk_bf16_f32 v149, v150, v151
Mvav 128,8,96
s_waitcnt lgkmcnt(8)
TR 40,18,8512
v_cvt_pk_bf16_f32 v155, v154, v155
Mvav 112,12,100
TR 42,18,9024
v_cvt_pk_bf16_f32 v154, v152, v153
Mvav 120,12,104
TR 44,18,8544
v_cvt_pk_bf16_f32 v156, v156, v157
Mvav 128,12,108
s_waitcnt lgkmcnt(10)
TR 46,18,9056
v_cvt_pk_bf16_f32 v157, v158, v159
Cvav 116,16,64,40
v_exp_f32 v112, v112
Cvav 124,16,68,44
v_exp_f32 v113, v113
Cvav 132,16,72,48
s_waitcnt vmcnt(10) lgkmcnt(10)
ds_write_b128 v0, a[128:131] offset:33792
Mvav 116,20,76
v_exp_f32 v114, v114
Mvav 124,20,80
s_waitcnt vmcnt(9)
ds_write_b128 v0, a[132:135] offset:34848
Mvav 132,20,84
s_waitcnt lgkmcnt(11)
v_exp_f32 v115, v115
Mvav 116,24,88
s_waitcnt vmcnt(8)
ds_write_b128 v0, a[136:139] offset:42240
Mvav 124,24,92
v_exp_f32 v120, v120
Mvav 132,24,96
s_waitcnt vmcnt(7) lgkmcnt(11)
ds_write_b128 v0, a[140:143] offset:43296
Mvav 116,28,100
v_exp_f32 v121, v121
Mvav 124,28,104
v_exp_f32 v122, v122
Mvav 132,28,108
s_waitcnt lgkmcnt(10)
v_exp_f32 v123, v123
Mvav 160,32,138
TR 48,18,8576
TR 50,18,9088
Mvav 168,32,146
s_waitcnt lgkmcnt(10)
v_exp_f32 v116, v116
Mvav 176,32,154
buffer_load_dwordx4 a[172:175], v31, s[16:19], s3 offen offset:256 nt
Mvav 180,36,154
v_exp_f32 v117, v117
Mvav 172,36,146
TR 52,18,8608
TR 54,18,9120
Mvav 164,36,138
s_waitcnt lgkmcnt(10)
s_mov_b32 s3, 0x30000
v_exp_f32 v118, v118
Mvav 184,40,138
buffer_load_dwordx4 a[176:179], v31, s[12:15], s3 offen nt
Mvav 192,40,146
s_waitcnt lgkmcnt(8)
v_exp_f32 v119, v119
Mvav 200,40,154
TR 56,18,8640
TR 58,18,9152
Mvav 204,44,154
v_exp_f32 v124, v124
Mvav 196,44,146
v_exp_f32 v128, v128
Mvav 188,44,138
s_waitcnt lgkmcnt(4)
v_exp_f32 v125, v125
Mvav 208,48,138
s_branch f_pad11s
f_pad11:
s_setpc_b64 s[70:71]
f_pad11s:
TR 60,18,8672
TR 62,18,9184
Mvav 216,48,146
v_exp_f32 v126, v126
Mvav 224,48,154
s_waitcnt lgkmcnt(4)
v_exp_f32 v129, v129
Mvav 228,52,154
v_exp_f32 v127, v127
Mvav 220,52,146
v_add_u32 v16, 0x14a00, v15
v_add_u32 v18, 0x14a00, v17
Mvav 212,52,138
s_waitcnt lgkmcnt(2)
v_exp_f32 v132, v132
Mvav 232,56,138
s_waitcnt lgkmcnt(0)
s_barrier
Mvav 240,56,146
RD 0,16,0
RD 4,16,64
Mvav 248,56,154
v_exp_f32 v133, v133
Mvav 252,60,154
RD 8,16,128
RD 12,16,192
Mvav 244,60,146
v_exp_f32 v130, v130
Mvav 236,60,138
v_exp_f32 v134, v134
Mvvv 52,24,138
v_exp_f32 v131, v131
Mvvv 56,24,146
v_exp_f32 v135, v135
Mvvv 60,24,154
s_waitcnt lgkmcnt(3)
fh_a14:
Cvav 136,0,64,40
RD 16,16,512
v_cvt_pk_bf16_f32 v115, v114, v115
Cvav 144,0,68,44
RD 20,16,576
v_cvt_pk_bf16_f32 v114, v112, v113
Cvav 152,0,72,48
s_waitcnt lgkmcnt(4)
RD 24,16,640
v_cvt_pk_bf16_f32 v116, v116, v117
Mvav 136,4,76
RD 28,16,704
v_cvt_pk_bf16_f32 v117, v118, v119
Mvav 144,4,80
TR 32,18,8448
v_cvt_pk_bf16_f32 v123, v122, v123
Mvav 152,4,84
s_waitcnt lgkmcnt(6)
TR 34,18,8960
v_cvt_pk_bf16_f32 v122, v120, v121
Mvav 136,8,88
TR 36,18,8480
v_cvt_pk_bf16_f32 v124, v124, v125
Mvav 144,8,92
TR 38,18,8992
v_cvt_pk_bf16_f32 v125, v126, v127
Mvav 152,8,96
s_waitcnt lgkmcnt(8)
TR 40,18,8512
v_cvt_pk_bf16_f32 v131, v130, v131
Mvav 136,12,100
TR 42,18,9024
v_cvt_pk_bf16_f32 v130, v128, v129
Mvav 144,12,104
TR 44,18,8544
v_cvt_pk_bf16_f32 v132, v132, v133
Mvav 152,12,108
s_waitcnt lgkmcnt(10)
TR 46,18,9056
v_cvt_pk_bf16_f32 v133, v134, v135
Cvav 140,16,64,40
v_exp_f32 v136, v136
Cvav 148,16,68,44
v_exp_f32 v137, v137
Cvav 156,16,72,48
s_waitcnt vmcnt(8) lgkmcnt(10)
ds_write_b128 v0, a[144:147] offset:50688
Mvav 140,20,76
v_exp_f32 v138, v138
Mvav 148,20,80
s_waitcnt vmcnt(7)
ds_write_b128 v0, a[148:151] offset:51744
Mvav 156,20,84
s_waitcnt lgkmcnt(11)
v_exp_f32 v139, v139
Mvav 140,24,88
s_waitcnt vmcnt(6)
ds_write_b128 v23, a[152:155] offset:1792
Mvav 148,24,92
v_exp_f32 v144, v144
Mvav 156,24,96
s_waitcnt vmcnt(5) lgkmcnt(11)
ds_write_b128 v23, a[156:159] offset:2848
Mvav 140,28,100
v_exp_f32 v145, v145
Mvav 148,28,104
v_exp_f32 v146, v146
Mvav 156,28,108
s_waitcnt lgkmcnt(10)
v_exp_f32 v147, v147
Mvav 160,32,114
TR 48,18,8576
TR 50,18,9088
Mvav 168,32,122
s_waitcnt lgkmcnt(10)
v_exp_f32 v140, v140
Mvav 176,32,130
buffer_load_dwordx4 a[180:183], v31, s[12:15], s3 offen offset:256 nt
Mvav 180,36,130
v_exp_f32 v141, v141
Mvav 172,36,122
TR 52,18,8608
TR 54,18,9120
Mvav 164,36,114
s_waitcnt lgkmcnt(10)
s_mov_b32 s3, 0x2e000
v_exp_f32 v142, v142
Mvav 184,40,114
buffer_load_dwordx4 a[184:187], v31, s[16:19], s3 offen nt
Mvav 192,40,122
s_waitcnt lgkmcnt(8)
v_exp_f32 v143, v143
Mvav 200,40,130
TR 56,18,8640
TR 58,18,9152
Mvav 204,44,130
v_exp_f32 v148, v148
Mvav 196,44,122
buffer_load_dwordx4 a[188:191], v31, s[16:19], s3 offen offset:256 nt
Mvav 188,44,114
s_waitcnt lgkmcnt(4)
v_exp_f32 v149, v149
Mvav 208,48,114
TR 60,18,8672
TR 62,18,9184
Mvav 216,48,122
v_exp_f32 v150, v150
Mvav 224,48,130
s_waitcnt lgkmcnt(4)
v_exp_f32 v152, v152
Mvav 228,52,130
v_exp_f32 v151, v151
Mvav 220,52,122
v_add_u32 v16, 0x18c00, v15
v_add_u32 v18, 0x18c00, v17
Mvav 212,52,114
s_waitcnt lgkmcnt(2)
v_exp_f32 v156, v156
Mvav 232,56,114
s_waitcnt lgkmcnt(0)
s_barrier
Mvav 240,56,122
RD 0,16,0
RD 4,16,64
Mvav 248,56,130
v_exp_f32 v157, v157
Mvav 252,60,130
RD 8,16,128
RD 12,16,192
Mvav 244,60,122
v_exp_f32 v153, v153
Mvav 236,60,114
v_exp_f32 v158, v158
Mvvv 52,24,114
v_exp_f32 v154, v154
Mvvv 56,24,122
v_exp_f32 v159, v159
Mvvv 60,24,130
s_waitcnt lgkmcnt(3)
v_exp_f32 v155, v155
fh_a15:
Zvaa 112,0,80
RD 16,16,512
v_cvt_pk_bf16_f32 v139, v138, v139
Zvaa 120,0,84
RD 20,16,576
v_cvt_pk_bf16_f32 v138, v136, v137
Zvaa 128,0,88
s_waitcnt lgkmcnt(4)
RD 24,16,640
v_cvt_pk_bf16_f32 v140, v140, v141
Mvaa 112,4,92
RD 28,16,704
v_cvt_pk_bf16_f32 v141, v142, v143
Mvaa 120,4,96
TR 32,18,8448
v_cvt_pk_bf16_f32 v147, v146, v147
Mvaa 128,4,100
s_waitcnt lgkmcnt(6)
TR 34,18,8960
v_cvt_pk_bf16_f32 v146, v144, v145
Mvaa 112,8,104
TR 36,18,8480
v_cvt_pk_bf16_f32 v148, v148, v149
Mvaa 120,8,108
TR 38,18,8992
v_cvt_pk_bf16_f32 v149, v150, v151
Mvaa 128,8,112
s_waitcnt lgkmcnt(8)
TR 40,18,8512
v_cvt_pk_bf16_f32 v155, v154, v155
Mvaa 112,12,116
TR 42,18,9024
v_cvt_pk_bf16_f32 v154, v152, v153
Mvaa 120,12,120
TR 44,18,8544
v_cvt_pk_bf16_f32 v156, v156, v157
Mvaa 128,12,124
s_waitcnt lgkmcnt(10)
TR 46,18,9056
v_cvt_pk_bf16_f32 v157, v158, v159
Zvaa 116,16,80
v_max3_f32 v32, v112, v113, v114
Zvaa 124,16,84
v_max3_f32 v33, v120, v121, v122
Zvaa 132,16,88
s_waitcnt lgkmcnt(10)
v_max3_f32 v34, v128, v129, v130
Mvaa 116,20,92
v_max_f32 v32, v115, v32
Mvaa 124,20,96
v_max_f32 v33, v123, v33
Mvaa 132,20,100
s_waitcnt lgkmcnt(9)
v_max_f32 v34, v131, v34
Mvaa 116,24,104
Mvaa 124,24,108
Mvaa 132,24,112
s_waitcnt lgkmcnt(8)
Mvaa 116,28,116
Mvaa 124,28,120
Mvaa 132,28,124
s_waitcnt lgkmcnt(6)
Mvav 160,32,138
TR 48,18,8576
TR 50,18,9088
Mvav 168,32,146
s_waitcnt lgkmcnt(6)
s_mov_b32 s3, 0x32000
v_max3_f32 v32, v32, v116, v117
v_max3_f32 v33, v33, v124, v125
Mvav 176,32,154
buffer_load_dwordx4 a[192:195], v31, s[12:15], s3 offen nt
Mvav 180,36,154
v_max3_f32 v34, v34, v132, v133
v_max3_f32 v32, v32, v118, v119
Mvav 172,36,146
TR 52,18,8608
TR 54,18,9120
Mvav 164,36,138
s_waitcnt lgkmcnt(6)
v_max3_f32 v33, v33, v126, v127
v_max3_f32 v34, v34, v134, v135
Mvav 184,40,138
buffer_load_dwordx4 a[196:199], v31, s[12:15], s3 offen offset:256 nt
Mvav 192,40,146
s_waitcnt lgkmcnt(4)
v_mov_b32 v36, v32
v_mov_b32 v37, v33
Mvav 200,40,154
TR 56,18,8640
TR 58,18,9152
Mvav 204,44,154
s_mov_b32 s3, 0x30000
v_mov_b32 v38, v34
v_permlane32_swap_b32 v36, v32
Mvav 196,44,146
buffer_load_dwordx4 a[200:203], v31, s[16:19], s3 offen nt
Mvav 188,44,138
s_waitcnt lgkmcnt(4)
v_permlane32_swap_b32 v37, v33
v_permlane32_swap_b32 v38, v34
Mvav 208,48,138
TR 60,18,8672
TR 62,18,9184
Mvav 216,48,146
s_waitcnt lgkmcnt(4)
v_max_f32 v32, v36, v32
v_max_f32 v33, v37, v33
Mvav 224,48,154
buffer_load_dwordx4 a[204:207], v31, s[16:19], s3 offen offset:256 nt
Mvav 228,52,154
v_max_f32 v34, v38, v34
v_mov_b32 v36, v32
Mvav 220,52,146
v_add_u32 v16, 0x1ce00, v15
v_add_u32 v18, 0x1ce00, v17
Mvav 212,52,138
s_waitcnt lgkmcnt(2)
v_mov_b32 v37, v33
v_mov_b32 v38, v34
Mvav 232,56,138
s_waitcnt lgkmcnt(0)
s_barrier
Mvav 240,56,146
RD 0,16,0
RD 4,16,64
Mvav 248,56,154
v_permlane16_swap_b32 v36, v32
v_permlane16_swap_b32 v37, v33
Mvav 252,60,154
s_mov_b32 s3, 0x34000
RD 8,16,128
RD 12,16,192
Mvav 244,60,146
buffer_load_dwordx4 a[208:211], v31, s[12:15], s3 offen nt
Mvav 236,60,138
v_permlane16_swap_b32 v38, v34
v_max_f32 v32, v36, v32
Mvvv 52,24,138
Mvvv 56,24,146
v_max_f32 v33, v37, v33
v_max_f32 v34, v38, v34
Mvvv 60,24,154
v_sub_f32 v40, 0, v32
v_sub_f32 v44, 0, v33
v_sub_f32 v48, 0, v34
v_sub_f32 v41, 0, v32
v_sub_f32 v45, 0, v33
v_sub_f32 v49, 0, v34
v_sub_f32 v42, 0, v32
v_sub_f32 v46, 0, v33
v_sub_f32 v50, 0, v34
v_sub_f32 v43, 0, v32
v_sub_f32 v47, 0, v33
v_sub_f32 v51, 0, v34
v_sub_f32 v112, v112, v32
v_sub_f32 v120, v120, v33
v_sub_f32 v128, v128, v34
v_sub_f32 v113, v113, v32
v_sub_f32 v121, v121, v33
v_sub_f32 v129, v129, v34
v_sub_f32 v114, v114, v32
v_sub_f32 v122, v122, v33
v_sub_f32 v130, v130, v34
v_sub_f32 v115, v115, v32
v_sub_f32 v123, v123, v33
v_sub_f32 v131, v131, v34
v_sub_f32 v116, v116, v32
v_sub_f32 v124, v124, v33
v_sub_f32 v132, v132, v34
v_sub_f32 v117, v117, v32
v_sub_f32 v125, v125, v33
v_sub_f32 v133, v133, v34
v_sub_f32 v118, v118, v32
v_sub_f32 v126, v126, v33
v_sub_f32 v134, v134, v34
v_sub_f32 v119, v119, v32
v_sub_f32 v127, v127, v33
v_sub_f32 v135, v135, v34
v_exp_f32 v112, v112
v_exp_f32 v120, v120
v_exp_f32 v128, v128
v_exp_f32 v113, v113
v_exp_f32 v121, v121
v_exp_f32 v129, v129
v_exp_f32 v114, v114
v_exp_f32 v122, v122
v_exp_f32 v130, v130
v_exp_f32 v115, v115
v_exp_f32 v123, v123
v_exp_f32 v131, v131
v_exp_f32 v116, v116
v_exp_f32 v124, v124
v_exp_f32 v132, v132
v_exp_f32 v117, v117
v_exp_f32 v125, v125
v_exp_f32 v133, v133
v_exp_f32 v118, v118
v_exp_f32 v126, v126
v_exp_f32 v134, v134
v_exp_f32 v119, v119
v_exp_f32 v127, v127
v_exp_f32 v135, v135
s_mov_b32 s41, 0x47800000
v_add_f32 v3, v52, v56
v_add_f32 v3, v60, v3
v_cmp_nge_f32 vcc, s41, v3
v_rcp_f32 v32, v52
v_rcp_f32 v34, v56
v_rcp_f32 v36, v60
s_cbranch_vccnz fh_slow0
fh_norm0:
v_pk_mul_f32 v[160:161], v[160:161], v[32:33] op_sel_hi:[1,0]
v_pk_mul_f32 v[162:163], v[162:163], v[32:33] op_sel_hi:[1,0]
v_pk_mul_f32 v[164:165], v[164:165], v[32:33] op_sel_hi:[1,0]
v_pk_mul_f32 v[166:167], v[166:167], v[32:33] op_sel_hi:[1,0]
v_cvt_pk_bf16_f32 v64, v160, v161
v_cvt_pk_bf16_f32 v65, v162, v163
v_cvt_pk_bf16_f32 v66, v164, v165
v_cvt_pk_bf16_f32 v67, v166, v167
v_pk_mul_f32 v[184:185], v[184:185], v[32:33] op_sel_hi:[1,0]
v_pk_mul_f32 v[186:187], v[186:187], v[32:33] op_sel_hi:[1,0]
v_pk_mul_f32 v[188:189], v[188:189], v[32:33] op_sel_hi:[1,0]
v_pk_mul_f32 v[190:191], v[190:191], v[32:33] op_sel_hi:[1,0]
v_cvt_pk_bf16_f32 v76, v184, v185
v_cvt_pk_bf16_f32 v77, v186, v187
v_cvt_pk_bf16_f32 v78, v188, v189
v_cvt_pk_bf16_f32 v79, v190, v191
v_pk_mul_f32 v[208:209], v[208:209], v[32:33] op_sel_hi:[1,0]
v_pk_mul_f32 v[210:211], v[210:211], v[32:33] op_sel_hi:[1,0]
v_pk_mul_f32 v[212:213], v[212:213], v[32:33] op_sel_hi:[1,0]
v_pk_mul_f32 v[214:215], v[214:215], v[32:33] op_sel_hi:[1,0]
v_cvt_pk_bf16_f32 v88, v208, v209
v_cvt_pk_bf16_f32 v89, v210, v211
v_cvt_pk_bf16_f32 v90, v212, v213
v_cvt_pk_bf16_f32 v91, v214, v215
v_pk_mul_f32 v[232:233], v[232:233], v[32:33] op_sel_hi:[1,0]
v_pk_mul_f32 v[234:235], v[234:235], v[32:33] op_sel_hi:[1,0]
v_pk_mul_f32 v[236:237], v[236:237], v[32:33] op_sel_hi:[1,0]
v_pk_mul_f32 v[238:239], v[238:239], v[32:33] op_sel_hi:[1,0]
v_cvt_pk_bf16_f32 v100, v232, v233
v_cvt_pk_bf16_f32 v101, v234, v235
v_cvt_pk_bf16_f32 v102, v236, v237
v_cvt_pk_bf16_f32 v103, v238, v239
v_pk_mul_f32 v[168:169], v[168:169], v[34:35] op_sel_hi:[1,0]
v_pk_mul_f32 v[170:171], v[170:171], v[34:35] op_sel_hi:[1,0]
v_pk_mul_f32 v[172:173], v[172:173], v[34:35] op_sel_hi:[1,0]
v_pk_mul_f32 v[174:175], v[174:175], v[34:35] op_sel_hi:[1,0]
v_cvt_pk_bf16_f32 v68, v168, v169
v_cvt_pk_bf16_f32 v69, v170, v171
v_cvt_pk_bf16_f32 v70, v172, v173
v_cvt_pk_bf16_f32 v71, v174, v175
v_pk_mul_f32 v[192:193], v[192:193], v[34:35] op_sel_hi:[1,0]
v_pk_mul_f32 v[194:195], v[194:195], v[34:35] op_sel_hi:[1,0]
v_pk_mul_f32 v[196:197], v[196:197], v[34:35] op_sel_hi:[1,0]
v_pk_mul_f32 v[198:199], v[198:199], v[34:35] op_sel_hi:[1,0]
v_cvt_pk_bf16_f32 v80, v192, v193
v_cvt_pk_bf16_f32 v81, v194, v195
v_cvt_pk_bf16_f32 v82, v196, v197
v_cvt_pk_bf16_f32 v83, v198, v199
v_pk_mul_f32 v[216:217], v[216:217], v[34:35] op_sel_hi:[1,0]
v_pk_mul_f32 v[218:219], v[218:219], v[34:35] op_sel_hi:[1,0]
v_pk_mul_f32 v[220:221], v[220:221], v[34:35] op_sel_hi:[1,0]
v_pk_mul_f32 v[222:223], v[222:223], v[34:35] op_sel_hi:[1,0]
v_cvt_pk_bf16_f32 v92, v216, v217
v_cvt_pk_bf16_f32 v93, v218, v219
v_cvt_pk_bf16_f32 v94, v220, v221
v_cvt_pk_bf16_f32 v95, v222, v223
v_pk_mul_f32 v[240:241], v[240:241], v[34:35] op_sel_hi:[1,0]
v_pk_mul_f32 v[242:243], v[242:243], v[34:35] op_sel_hi:[1,0]
v_pk_mul_f32 v[244:245], v[244:245], v[34:35] op_sel_hi:[1,0]
v_pk_mul_f32 v[246:247], v[246:247], v[34:35] op_sel_hi:[1,0]
v_cvt_pk_bf16_f32 v104, v240, v241
v_cvt_pk_bf16_f32 v105, v242, v243
v_cvt_pk_bf16_f32 v106, v244, v245
v_cvt_pk_bf16_f32 v107, v246, v247
v_pk_mul_f32 v[176:177], v[176:177], v[36:37] op_sel_hi:[1,0]
v_pk_mul_f32 v[178:179], v[178:179], v[36:37] op_sel_hi:[1,0]
v_pk_mul_f32 v[180:181], v[180:181], v[36:37] op_sel_hi:[1,0]
v_pk_mul_f32 v[182:183], v[182:183], v[36:37] op_sel_hi:[1,0]
v_cvt_pk_bf16_f32 v72, v176, v177
v_cvt_pk_bf16_f32 v73, v178, v179
v_cvt_pk_bf16_f32 v74, v180, v181
v_cvt_pk_bf16_f32 v75, v182, v183
v_pk_mul_f32 v[200:201], v[200:201], v[36:37] op_sel_hi:[1,0]
v_pk_mul_f32 v[202:203], v[202:203], v[36:37] op_sel_hi:[1,0]
v_pk_mul_f32 v[204:205], v[204:205], v[36:37] op_sel_hi:[1,0]
v_pk_mul_f32 v[206:207], v[206:207], v[36:37] op_sel_hi:[1,0]
v_cvt_pk_bf16_f32 v84, v200, v201
v_cvt_pk_bf16_f32 v85, v202, v203
v_cvt_pk_bf16_f32 v86, v204, v205
v_cvt_pk_bf16_f32 v87, v206, v207
v_pk_mul_f32 v[224:225], v[224:225], v[36:37] op_sel_hi:[1,0]
v_pk_mul_f32 v[226:227], v[226:227], v[36:37] op_sel_hi:[1,0]
v_pk_mul_f32 v[228:229], v[228:229], v[36:37] op_sel_hi:[1,0]
v_pk_mul_f32 v[230:231], v[230:231], v[36:37] op_sel_hi:[1,0]
v_cvt_pk_bf16_f32 v96, v224, v225
v_cvt_pk_bf16_f32 v97, v226, v227
v_cvt_pk_bf16_f32 v98, v228, v229
v_cvt_pk_bf16_f32 v99, v230, v231
v_pk_mul_f32 v[248:249], v[248:249], v[36:37] op_sel_hi:[1,0]
v_pk_mul_f32 v[250:251], v[250:251], v[36:37] op_sel_hi:[1,0]
v_pk_mul_f32 v[252:253], v[252:253], v[36:37] op_sel_hi:[1,0]
v_pk_mul_f32 v[254:255], v[254:255], v[36:37] op_sel_hi:[1,0]
v_cvt_pk_bf16_f32 v108, v248, v249
v_cvt_pk_bf16_f32 v109, v250, v251
v_cvt_pk_bf16_f32 v110, v252, v253
v_cvt_pk_bf16_f32 v111, v254, v255
fh_a16:
s_waitcnt lgkmcnt(3)
Cvaa 136,0,80,40
RD 16,16,512
v_cvt_pk_bf16_f32 v115, v114, v115
Cvaa 144,0,84,44
RD 20,16,576
v_cvt_pk_bf16_f32 v114, v112, v113
Cvaa 152,0,88,48
s_waitcnt lgkmcnt(4)
RD 24,16,640
v_cvt_pk_bf16_f32 v116, v116, v117
Mvaa 136,4,92
RD 28,16,704
v_cvt_pk_bf16_f32 v117, v118, v119
Mvaa 144,4,96
TR 32,18,8448
v_cvt_pk_bf16_f32 v123, v122, v123
Mvaa 152,4,100
s_waitcnt lgkmcnt(6)
TR 34,18,8960
v_cvt_pk_bf16_f32 v122, v120, v121
Mvaa 136,8,104
TR 36,18,8480
v_cvt_pk_bf16_f32 v124, v124, v125
Mvaa 144,8,108
TR 38,18,8992
v_cvt_pk_bf16_f32 v125, v126, v127
Mvaa 152,8,112
s_waitcnt lgkmcnt(8)
TR 40,18,8512
v_cvt_pk_bf16_f32 v131, v130, v131
Mvaa 136,12,116
TR 42,18,9024
v_cvt_pk_bf16_f32 v130, v128, v129
Mvaa 144,12,120
TR 44,18,8544
v_cvt_pk_bf16_f32 v132, v132, v133
Mvaa 152,12,124
s_waitcnt lgkmcnt(10)
TR 46,18,9056
v_cvt_pk_bf16_f32 v133, v134, v135
Cvaa 140,16,80,40
v_exp_f32 v136, v136
Cvaa 148,16,84,44
v_exp_f32 v137, v137
Cvaa 156,16,88,48
s_waitcnt vmcnt(12) lgkmcnt(10)
ds_write_b128 v23, a[160:163] offset:10240
Mvaa 140,20,92
v_exp_f32 v138, v138
Mvaa 148,20,96
s_waitcnt vmcnt(11)
ds_write_b128 v23, a[164:167] offset:11296
Mvaa 156,20,100
s_waitcnt lgkmcnt(11)
v_exp_f32 v139, v139
Mvaa 140,24,104
s_waitcnt vmcnt(10)
ds_write_b128 v23, a[168:171] offset:18688
Mvaa 148,24,108
v_exp_f32 v144, v144
Mvaa 156,24,112
s_waitcnt vmcnt(9) lgkmcnt(11)
ds_write_b128 v23, a[172:175] offset:19744
Mvaa 140,28,116
v_exp_f32 v145, v145
Mvaa 148,28,120
v_exp_f32 v146, v146
Mvaa 156,28,124
s_waitcnt lgkmcnt(10)
v_exp_f32 v147, v147
Zvav 160,32,114
TR 48,18,8576
TR 50,18,9088
Zvav 168,32,122
s_waitcnt lgkmcnt(10)
s_add_u32 s44, s78, 0
v_exp_f32 v140, v140
Zvav 176,32,130
buffer_store_dwordx4 v[64:67], v20, s[20:23], s44 offen sc1
Zvav 180,36,130
v_exp_f32 v141, v141
Zvav 172,36,122
TR 52,18,8608
TR 54,18,9120
Zvav 164,36,114
s_waitcnt lgkmcnt(10)
v_exp_f32 v142, v142
Zvav 184,40,114
buffer_store_dwordx4 v[76:79], v20, s[20:23], s44 offen offset:1024 sc1
Zvav 192,40,122
s_waitcnt lgkmcnt(8)
v_exp_f32 v143, v143
Zvav 200,40,130
TR 56,18,8640
TR 58,18,9152
Zvav 204,44,130
v_exp_f32 v148, v148
Zvav 196,44,122
buffer_load_dwordx4 a[212:215], v31, s[12:15], s3 offen offset:256 nt
Zvav 188,44,114
s_waitcnt lgkmcnt(4)
v_exp_f32 v149, v149
Zvav 208,48,114
TR 60,18,8672
TR 62,18,9184
Zvav 216,48,122
v_exp_f32 v150, v150
Zvav 224,48,130
s_waitcnt lgkmcnt(4)
v_exp_f32 v152, v152
Zvav 228,52,130
v_exp_f32 v151, v151
Zvav 220,52,122
v_add_u32 v16, 0x21000, v15
v_add_u32 v18, 0x21000, v17
Zvav 212,52,114
s_waitcnt lgkmcnt(2)
v_exp_f32 v156, v156
Zvav 232,56,114
s_waitcnt lgkmcnt(0)
s_barrier
Zvav 240,56,122
RD 0,16,0
RD 4,16,64
Zvav 248,56,130
v_exp_f32 v157, v157
Zvav 252,60,130
s_branch f_pad12s
f_pad12:
s_setpc_b64 s[70:71]
f_pad12s:
RD 8,16,128
RD 12,16,192
Zvav 244,60,122
v_exp_f32 v153, v153
Zvav 236,60,114
v_exp_f32 v158, v158
Zvvv 52,24,114
v_exp_f32 v154, v154
Zvvv 56,24,122
v_exp_f32 v159, v159
Zvvv 60,24,130
s_waitcnt lgkmcnt(3)
v_exp_f32 v155, v155
fh_a17:
Cvaa 112,0,80,40
RD 16,16,512
v_cvt_pk_bf16_f32 v139, v138, v139
Cvaa 120,0,84,44
RD 20,16,576
v_cvt_pk_bf16_f32 v138, v136, v137
Cvaa 128,0,88,48
s_waitcnt lgkmcnt(4)
RD 24,16,640
v_cvt_pk_bf16_f32 v140, v140, v141
Mvaa 112,4,92
RD 28,16,704
v_cvt_pk_bf16_f32 v141, v142, v143
Mvaa 120,4,96
TR 32,18,8448
v_cvt_pk_bf16_f32 v147, v146, v147
Mvaa 128,4,100
s_waitcnt lgkmcnt(6)
TR 34,18,8960
v_cvt_pk_bf16_f32 v146, v144, v145
Mvaa 112,8,104
TR 36,18,8480
v_cvt_pk_bf16_f32 v148, v148, v149
Mvaa 120,8,108
TR 38,18,8992
v_cvt_pk_bf16_f32 v149, v150, v151
Mvaa 128,8,112
s_waitcnt lgkmcnt(8)
TR 40,18,8512
v_cvt_pk_bf16_f32 v155, v154, v155
Mvaa 112,12,116
TR 42,18,9024
v_cvt_pk_bf16_f32 v154, v152, v153
Mvaa 120,12,120
TR 44,18,8544
v_cvt_pk_bf16_f32 v156, v156, v157
Mvaa 128,12,124
s_waitcnt lgkmcnt(10)
TR 46,18,9056
v_cvt_pk_bf16_f32 v157, v158, v159
Cvaa 116,16,80,40
v_exp_f32 v112, v112
Cvaa 124,16,84,44
v_exp_f32 v113, v113
Cvaa 132,16,88,48
s_waitcnt vmcnt(11) lgkmcnt(10)
ds_write_b128 v23, a[176:179] offset:27136
Mvaa 116,20,92
v_exp_f32 v114, v114
Mvaa 124,20,96
s_waitcnt vmcnt(10)
ds_write_b128 v23, a[180:183] offset:28192
Mvaa 132,20,100
s_waitcnt lgkmcnt(11)
v_exp_f32 v115, v115
Mvaa 116,24,104
s_waitcnt vmcnt(9)
ds_write_b128 v23, a[184:187] offset:35584
Mvaa 124,24,108
v_exp_f32 v120, v120
Mvaa 132,24,112
s_waitcnt vmcnt(8) lgkmcnt(11)
ds_write_b128 v23, a[188:191] offset:36640
Mvaa 116,28,116
v_exp_f32 v121, v121
Mvaa 124,28,120
v_exp_f32 v122, v122
Mvaa 132,28,124
s_waitcnt lgkmcnt(10)
v_exp_f32 v123, v123
Mvav 160,32,138
TR 48,18,8576
TR 50,18,9088
Mvav 168,32,146
s_waitcnt lgkmcnt(10)
v_exp_f32 v116, v116
Mvav 176,32,154
buffer_store_dwordx4 v[68:71], v12, s[20:23], s44 offen sc1
Mvav 180,36,154
v_exp_f32 v117, v117
Mvav 172,36,146
TR 52,18,8608
TR 54,18,9120
Mvav 164,36,138
s_waitcnt lgkmcnt(10)
v_exp_f32 v118, v118
Mvav 184,40,138
buffer_store_dwordx4 v[80:83], v12, s[20:23], s44 offen offset:1024 sc1
Mvav 192,40,146
s_waitcnt lgkmcnt(8)
v_exp_f32 v119, v119
Mvav 200,40,154
TR 56,18,8640
TR 58,18,9152
Mvav 204,44,154
s_mov_b32 s3, 0x32000
v_exp_f32 v124, v124
Mvav 196,44,146
buffer_load_dwordx4 a[216:219], v31, s[16:19], s3 offen nt
Mvav 188,44,138
s_waitcnt lgkmcnt(4)
v_exp_f32 v125, v125
Mvav 208,48,138
TR 60,18,8672
TR 62,18,9184
Mvav 216,48,146
v_exp_f32 v126, v126
Mvav 224,48,154
s_waitcnt lgkmcnt(4)
v_exp_f32 v128, v128
Mvav 228,52,154
v_exp_f32 v127, v127
Mvav 220,52,146
v_add_u32 v16, 0, v15
v_add_u32 v18, 0, v17
Mvav 212,52,138
s_waitcnt lgkmcnt(2)
v_exp_f32 v132, v132
Mvav 232,56,138
s_waitcnt lgkmcnt(0)
s_barrier
Mvav 240,56,146
RD 0,16,0
RD 4,16,64
Mvav 248,56,154
v_exp_f32 v133, v133
Mvav 252,60,154
RD 8,16,128
RD 12,16,192
Mvav 244,60,146
v_exp_f32 v129, v129
Mvav 236,60,138
v_exp_f32 v134, v134
Mvvv 52,24,138
v_exp_f32 v130, v130
Mvvv 56,24,146
v_exp_f32 v135, v135
Mvvv 60,24,154
s_waitcnt lgkmcnt(3)
v_exp_f32 v131, v131
fh_a18:
Cvaa 136,0,80,40
RD 16,16,512
v_cvt_pk_bf16_f32 v115, v114, v115
Cvaa 144,0,84,44
RD 20,16,576
v_cvt_pk_bf16_f32 v114, v112, v113
Cvaa 152,0,88,48
s_waitcnt lgkmcnt(4)
RD 24,16,640
v_cvt_pk_bf16_f32 v116, v116, v117
Mvaa 136,4,92
RD 28,16,704
v_cvt_pk_bf16_f32 v117, v118, v119
Mvaa 144,4,96
TR 32,18,8448
v_cvt_pk_bf16_f32 v123, v122, v123
Mvaa 152,4,100
s_waitcnt lgkmcnt(6)
TR 34,18,8960
v_cvt_pk_bf16_f32 v122, v120, v121
Mvaa 136,8,104
TR 36,18,8480
v_cvt_pk_bf16_f32 v124, v124, v125
Mvaa 144,8,108
TR 38,18,8992
v_cvt_pk_bf16_f32 v125, v126, v127
Mvaa 152,8,112
s_waitcnt lgkmcnt(8)
TR 40,18,8512
v_cvt_pk_bf16_f32 v131, v130, v131
Mvaa 136,12,116
TR 42,18,9024
v_cvt_pk_bf16_f32 v130, v128, v129
Mvaa 144,12,120
TR 44,18,8544
v_cvt_pk_bf16_f32 v132, v132, v133
Mvaa 152,12,124
s_waitcnt lgkmcnt(10)
TR 46,18,9056
v_cvt_pk_bf16_f32 v133, v134, v135
Cvaa 140,16,80,40
v_exp_f32 v136, v136
Cvaa 148,16,84,44
buffer_store_dwordx4 v[72:75], v21, s[20:23], s44 offen sc1
v_exp_f32 v137, v137
Cvaa 156,16,88,48
s_waitcnt vmcnt(11) lgkmcnt(10)
ds_write_b128 v23, a[192:195] offset:44032
Mvaa 140,20,92
v_exp_f32 v138, v138
Mvaa 148,20,96
s_waitcnt vmcnt(10)
ds_write_b128 v23, a[196:199] offset:45088
Mvaa 156,20,100
s_waitcnt lgkmcnt(11)
v_exp_f32 v139, v139
Mvaa 140,24,104
s_waitcnt vmcnt(9)
ds_write_b128 v23, a[200:203] offset:52480
Mvaa 148,24,108
v_exp_f32 v144, v144
Mvaa 156,24,112
s_waitcnt vmcnt(8) lgkmcnt(11)
ds_write_b128 v23, a[204:207] offset:53536
Mvaa 140,28,116
v_exp_f32 v145, v145
Mvaa 148,28,120
v_exp_f32 v146, v146
Mvaa 156,28,124
s_waitcnt lgkmcnt(10)
v_exp_f32 v147, v147
Mvav 160,32,114
TR 48,18,8576
TR 50,18,9088
Mvav 168,32,122
s_waitcnt lgkmcnt(10)
v_exp_f32 v140, v140
Mvav 176,32,130
buffer_store_dwordx4 v[84:87], v21, s[20:23], s44 offen offset:1024 sc1
Mvav 180,36,130
v_exp_f32 v141, v141
Mvav 172,36,122
TR 52,18,8608
TR 54,18,9120
Mvav 164,36,114
s_waitcnt lgkmcnt(10)
v_exp_f32 v142, v142
Mvav 184,40,114
buffer_load_dwordx4 a[220:223], v31, s[16:19], s3 offen offset:256 nt
Mvav 192,40,122
s_waitcnt lgkmcnt(8)
v_exp_f32 v143, v143
Mvav 200,40,130
TR 56,18,8640
TR 58,18,9152
Mvav 204,44,130
s_mov_b32 s3, 0x36000
s_add_u32 m0, s52, 0x21000
v_exp_f32 v148, v148
Mvav 196,44,122
buffer_load_dwordx4 v31, s[12:15], s3 offen nt lds
Mvav 188,44,114
s_waitcnt lgkmcnt(4)
v_exp_f32 v149, v149
Mvav 208,48,114
TR 60,18,8672
TR 62,18,9184
Mvav 216,48,122
v_exp_f32 v150, v150
Mvav 224,48,130
s_waitcnt lgkmcnt(4)
v_exp_f32 v152, v152
Mvav 228,52,130
v_exp_f32 v151, v151
Mvav 220,52,122
v_add_u32 v16, 0x4200, v15
v_add_u32 v18, 0x4200, v17
Mvav 212,52,114
s_waitcnt lgkmcnt(2)
v_exp_f32 v156, v156
Mvav 232,56,114
s_waitcnt lgkmcnt(0)
s_barrier
Mvav 240,56,122
RD 0,16,0
RD 4,16,64
Mvav 248,56,130
v_exp_f32 v157, v157
Mvav 252,60,130
RD 8,16,128
RD 12,16,192
Mvav 244,60,122
v_exp_f32 v153, v153
Mvav 236,60,114
v_exp_f32 v158, v158
Mvvv 52,24,114
v_exp_f32 v154, v154
Mvvv 56,24,122
v_exp_f32 v159, v159
Mvvv 60,24,130
s_waitcnt lgkmcnt(3)
v_exp_f32 v155, v155
fh_a19:
Cvaa 112,0,80,40
RD 16,16,512
v_cvt_pk_bf16_f32 v139, v138, v139
Cvaa 120,0,84,44
RD 20,16,576
v_cvt_pk_bf16_f32 v138, v136, v137
Cvaa 128,0,88,48
s_waitcnt lgkmcnt(4)
RD 24,16,640
v_cvt_pk_bf16_f32 v140, v140, v141
Mvaa 112,4,92
RD 28,16,704
v_cvt_pk_bf16_f32 v141, v142, v143
Mvaa 120,4,96
TR 32,18,8448
v_cvt_pk_bf16_f32 v147, v146, v147
Mvaa 128,4,100
s_waitcnt lgkmcnt(6)
TR 34,18,8960
v_cvt_pk_bf16_f32 v146, v144, v145
Mvaa 112,8,104
TR 36,18,8480
v_cvt_pk_bf16_f32 v148, v148, v149
Mvaa 120,8,108
TR 38,18,8992
v_cvt_pk_bf16_f32 v149, v150, v151
Mvaa 128,8,112
s_waitcnt lgkmcnt(8)
TR 40,18,8512
v_cvt_pk_bf16_f32 v155, v154, v155
Mvaa 112,12,116
TR 42,18,9024
v_cvt_pk_bf16_f32 v154, v152, v153
Mvaa 120,12,120
TR 44,18,8544
v_cvt_pk_bf16_f32 v156, v156, v157
Mvaa 128,12,124
s_waitcnt lgkmcnt(10)
TR 46,18,9056
v_cvt_pk_bf16_f32 v157, v158, v159
Cvaa 116,16,80,40
v_exp_f32 v112, v112
Cvaa 124,16,84,44
v_exp_f32 v113, v113
Cvaa 132,16,88,48
s_waitcnt lgkmcnt(10)
v_exp_f32 v114, v114
Mvaa 116,20,92
v_exp_f32 v115, v115
Mvaa 124,20,96
v_exp_f32 v120, v120
Mvaa 132,20,100
s_waitcnt lgkmcnt(9)
v_exp_f32 v121, v121
Mvaa 116,24,104
v_exp_f32 v122, v122
Mvaa 124,24,108
v_exp_f32 v123, v123
Mvaa 132,24,112
s_waitcnt lgkmcnt(8)
v_exp_f32 v128, v128
Mvaa 116,28,116
v_exp_f32 v129, v129
Mvaa 124,28,120
v_exp_f32 v130, v130
Mvaa 132,28,124
s_waitcnt lgkmcnt(6)
v_exp_f32 v131, v131
Mvav 160,32,138
TR 48,18,8576
TR 50,18,9088
Mvav 168,32,146
s_waitcnt lgkmcnt(6)
s_add_u32 s44, s78, 0x5800
v_exp_f32 v116, v116
Mvav 176,32,154
buffer_store_dwordx4 v[88:91], v20, s[20:23], s44 offen sc1
Mvav 180,36,154
v_exp_f32 v117, v117
Mvav 172,36,146
TR 52,18,8608
TR 54,18,9120
Mvav 164,36,138
s_waitcnt lgkmcnt(6)
v_exp_f32 v118, v118
Mvav 184,40,138
buffer_store_dwordx4 v[100:103], v20, s[20:23], s44 offen offset:1024 sc1
Mvav 192,40,146
s_waitcnt lgkmcnt(4)
v_exp_f32 v119, v119
Mvav 200,40,154
TR 56,18,8640
TR 58,18,9152
Mvav 204,44,154
s_add_u32 m0, s52, 0x21320
v_exp_f32 v124, v124
Mvav 196,44,146
buffer_load_dwordx4 v31, s[12:15], s3 offen offset:256 nt lds
Mvav 188,44,138
s_waitcnt lgkmcnt(4)
v_exp_f32 v125, v125
Mvav 208,48,138
TR 60,18,8672
TR 62,18,9184
Mvav 216,48,146
v_exp_f32 v126, v126
Mvav 224,48,154
s_waitcnt lgkmcnt(4)
v_exp_f32 v127, v127
Mvav 228,52,154
v_exp_f32 v132, v132
Mvav 220,52,146
v_add_u32 v16, 0x8400, v15
v_add_u32 v18, 0x8400, v17
Mvav 212,52,138
s_waitcnt lgkmcnt(2)
v_exp_f32 v133, v133
Mvav 232,56,138
s_waitcnt lgkmcnt(0)
s_barrier
Mvav 240,56,146
RD 0,16,0
Mvav 248,56,154
v_exp_f32 v134, v134
Mvav 252,60,154
RD 4,16,64
Mvav 244,60,146
v_exp_f32 v135, v135
Mvav 236,60,138
RD 8,16,128
Mvvv 52,24,138
RD 12,16,192
Mvvv 56,24,146
Mvvv 60,24,154
s_waitcnt lgkmcnt(3)
fh_a20:
Cvaa 136,0,80,40
RD 16,16,512
v_cvt_pk_bf16_f32 v115, v114, v115
Cvaa 144,0,84,44
RD 20,16,576
v_cvt_pk_bf16_f32 v114, v112, v113
Cvaa 152,0,88,48
s_waitcnt lgkmcnt(4)
RD 24,16,640
v_cvt_pk_bf16_f32 v116, v116, v117
Mvaa 136,4,92
RD 28,16,704
v_cvt_pk_bf16_f32 v117, v118, v119
Mvaa 144,4,96
TR 32,18,8448
v_cvt_pk_bf16_f32 v123, v122, v123
Mvaa 152,4,100
s_waitcnt lgkmcnt(6)
TR 34,18,8960
v_cvt_pk_bf16_f32 v122, v120, v121
Mvaa 136,8,104
TR 36,18,8480
v_cvt_pk_bf16_f32 v124, v124, v125
Mvaa 144,8,108
TR 38,18,8992
v_cvt_pk_bf16_f32 v125, v126, v127
Mvaa 152,8,112
s_waitcnt lgkmcnt(8)
TR 40,18,8512
v_cvt_pk_bf16_f32 v131, v130, v131
Mvaa 136,12,116
TR 42,18,9024
v_cvt_pk_bf16_f32 v130, v128, v129
Mvaa 144,12,120
TR 44,18,8544
v_cvt_pk_bf16_f32 v132, v132, v133
Mvaa 152,12,124
s_waitcnt lgkmcnt(10)
TR 46,18,9056
v_cvt_pk_bf16_f32 v133, v134, v135
Cvaa 140,16,80,40
v_exp_f32 v136, v136
Cvaa 148,16,84,44
v_exp_f32 v137, v137
Cvaa 156,16,88,48
s_waitcnt lgkmcnt(10)
v_exp_f32 v138, v138
Mvaa 140,20,92
v_exp_f32 v139, v139
Mvaa 148,20,96
v_exp_f32 v144, v144
Mvaa 156,20,100
s_waitcnt lgkmcnt(9)
v_exp_f32 v145, v145
Mvaa 140,24,104
v_exp_f32 v146, v146
Mvaa 148,24,108
v_exp_f32 v147, v147
Mvaa 156,24,112
s_waitcnt lgkmcnt(8)
v_exp_f32 v152, v152
Mvaa 140,28,116
v_exp_f32 v153, v153
Mvaa 148,28,120
v_exp_f32 v154, v154
Mvaa 156,28,124
s_waitcnt lgkmcnt(6)
v_exp_f32 v155, v155
Mvav 160,32,114
TR 48,18,8576
TR 50,18,9088
Mvav 168,32,122
s_waitcnt lgkmcnt(6)
v_exp_f32 v140, v140
Mvav 176,32,130
buffer_store_dwordx4 v[92:95], v12, s[20:23], s44 offen sc1
Mvav 180,36,130
v_exp_f32 v141, v141
Mvav 172,36,122
TR 52,18,8608
TR 54,18,9120
Mvav 164,36,114
s_waitcnt lgkmcnt(6)
v_exp_f32 v142, v142
Mvav 184,40,114
buffer_store_dwordx4 v[104:107], v12, s[20:23], s44 offen offset:1024 sc1
Mvav 192,40,122
s_waitcnt lgkmcnt(4)
v_exp_f32 v143, v143
Mvav 200,40,130
TR 56,18,8640
TR 58,18,9152
Mvav 204,44,130
s_mov_b32 s3, 0x34000
s_add_u32 m0, s52, 0x23100
v_exp_f32 v148, v148
Mvav 196,44,122
buffer_load_dwordx4 v31, s[16:19], s3 offen nt lds
Mvav 188,44,114
s_waitcnt lgkmcnt(4)
v_exp_f32 v149, v149
Mvav 208,48,114
TR 60,18,8672
TR 62,18,9184
Mvav 216,48,122
s_waitcnt lgkmcnt(4)
s_add_u32 m0, s52, 0x23420
v_exp_f32 v150, v150
Mvav 224,48,130
buffer_load_dwordx4 v31, s[16:19], s3 offen offset:256 nt lds
Mvav 228,52,130
v_exp_f32 v151, v151
Mvav 220,52,122
v_add_u32 v16, 0xc600, v15
v_add_u32 v18, 0xc600, v17
Mvav 212,52,114
s_waitcnt lgkmcnt(2)
v_exp_f32 v156, v156
Mvav 232,56,114
s_waitcnt lgkmcnt(0)
s_barrier
Mvav 240,56,122
RD 0,16,0
RD 4,16,64
Mvav 248,56,130
v_exp_f32 v157, v157
Mvav 252,60,130
RD 8,16,128
RD 12,16,192
Mvav 244,60,122
Mvav 236,60,114
v_exp_f32 v158, v158
Mvvv 52,24,114
Mvvv 56,24,122
v_exp_f32 v159, v159
Mvvv 60,24,130
s_waitcnt lgkmcnt(3)
fh_a21:
Cvaa 112,0,80,40
RD 16,16,512
v_cvt_pk_bf16_f32 v139, v138, v139
Cvaa 120,0,84,44
RD 20,16,576
v_cvt_pk_bf16_f32 v138, v136, v137
Cvaa 128,0,88,48
s_waitcnt lgkmcnt(4)
RD 24,16,640
v_cvt_pk_bf16_f32 v140, v140, v141
Mvaa 112,4,92
RD 28,16,704
v_cvt_pk_bf16_f32 v141, v142, v143
Mvaa 120,4,96
TR 32,18,8448
v_cvt_pk_bf16_f32 v147, v146, v147
Mvaa 128,4,100
s_waitcnt lgkmcnt(6)
TR 34,18,8960
v_cvt_pk_bf16_f32 v146, v144, v145
Mvaa 112,8,104
TR 36,18,8480
v_cvt_pk_bf16_f32 v148, v148, v149
Mvaa 120,8,108
TR 38,18,8992
v_cvt_pk_bf16_f32 v149, v150, v151
Mvaa 128,8,112
s_waitcnt lgkmcnt(8)
TR 40,18,8512
v_cvt_pk_bf16_f32 v155, v154, v155
Mvaa 112,12,116
TR 42,18,9024
v_cvt_pk_bf16_f32 v154, v152, v153
Mvaa 120,12,120
s_branch f_pad13s
f_pad13:
s_setpc_b64 s[70:71]
f_pad13s:
TR 44,18,8544
v_cvt_pk_bf16_f32 v156, v156, v157
Mvaa 128,12,124
s_waitcnt lgkmcnt(10)
TR 46,18,9056
v_cvt_pk_bf16_f32 v157, v158, v159
Cvaa 116,16,80,40
v_exp_f32 v112, v112
Cvaa 124,16,84,44
v_exp_f32 v113, v113
Cvaa 132,16,88,48
s_waitcnt vmcnt(17) lgkmcnt(10)
ds_write_b128 v19, a[208:211] offset:3584
Mvaa 116,20,92
v_exp_f32 v114, v114
Mvaa 124,20,96
s_waitcnt vmcnt(14)
ds_write_b128 v19, a[212:215] offset:4640
Mvaa 132,20,100
s_waitcnt lgkmcnt(11)
v_exp_f32 v115, v115
Mvaa 116,24,104
s_waitcnt vmcnt(11)
ds_write_b128 v19, a[216:219] offset:12032
Mvaa 124,24,108
v_exp_f32 v120, v120
Mvaa 132,24,112
s_waitcnt vmcnt(8) lgkmcnt(11)
ds_write_b128 v19, a[220:223] offset:13088
Mvaa 116,28,116
v_exp_f32 v121, v121
Mvaa 124,28,120
v_exp_f32 v122, v122
Mvaa 132,28,124
s_waitcnt lgkmcnt(10)
v_exp_f32 v123, v123
Mvav 160,32,138
TR 48,18,8576
TR 50,18,9088
Mvav 168,32,146
s_waitcnt lgkmcnt(10)
v_exp_f32 v116, v116
Mvav 176,32,154
buffer_store_dwordx4 v[96:99], v21, s[20:23], s44 offen sc1
Mvav 180,36,154
v_exp_f32 v117, v117
Mvav 172,36,146
TR 52,18,8608
TR 54,18,9120
Mvav 164,36,138
s_waitcnt lgkmcnt(10)
v_exp_f32 v118, v118
Mvav 184,40,138
buffer_store_dwordx4 v[108:111], v21, s[20:23], s44 offen offset:1024 sc1
Mvav 192,40,146
s_waitcnt lgkmcnt(8)
v_exp_f32 v119, v119
Mvav 200,40,154
TR 56,18,8640
TR 58,18,9152
Mvav 204,44,154
s_mov_b32 s3, 0x38000
s_add_u32 m0, s52, 0
v_exp_f32 v124, v124
Mvav 196,44,146
buffer_load_dwordx4 v31, s[12:15], s3 offen nt lds
Mvav 188,44,138
s_waitcnt lgkmcnt(4)
v_exp_f32 v125, v125
Mvav 208,48,138
TR 60,18,8672
TR 62,18,9184
Mvav 216,48,146
v_exp_f32 v126, v126
Mvav 224,48,154
s_waitcnt lgkmcnt(4)
v_exp_f32 v128, v128
Mvav 228,52,154
v_exp_f32 v127, v127
Mvav 220,52,146
v_add_u32 v16, 0x10800, v15
v_add_u32 v18, 0x10800, v17
Mvav 212,52,138
s_waitcnt lgkmcnt(2)
v_exp_f32 v132, v132
Mvav 232,56,138
s_waitcnt lgkmcnt(0)
s_barrier
Mvav 240,56,146
RD 0,16,0
RD 4,16,64
Mvav 248,56,154
v_exp_f32 v133, v133
Mvav 252,60,154
RD 8,16,128
RD 12,16,192
Mvav 244,60,146
v_exp_f32 v129, v129
Mvav 236,60,138
v_exp_f32 v134, v134
Mvvv 52,24,138
v_exp_f32 v130, v130
Mvvv 56,24,146
v_exp_f32 v135, v135
Mvvv 60,24,154
s_waitcnt lgkmcnt(3)
v_exp_f32 v131, v131
fh_a22:
Cvaa 136,0,80,40
RD 16,16,512
v_cvt_pk_bf16_f32 v115, v114, v115
Cvaa 144,0,84,44
RD 20,16,576
v_cvt_pk_bf16_f32 v114, v112, v113
Cvaa 152,0,88,48
s_waitcnt lgkmcnt(4)
RD 24,16,640
v_cvt_pk_bf16_f32 v116, v116, v117
Mvaa 136,4,92
RD 28,16,704
v_cvt_pk_bf16_f32 v117, v118, v119
Mvaa 144,4,96
TR 32,18,8448
v_cvt_pk_bf16_f32 v123, v122, v123
Mvaa 152,4,100
s_waitcnt lgkmcnt(6)
TR 34,18,8960
v_cvt_pk_bf16_f32 v122, v120, v121
Mvaa 136,8,104
TR 36,18,8480
v_cvt_pk_bf16_f32 v124, v124, v125
Mvaa 144,8,108
TR 38,18,8992
v_cvt_pk_bf16_f32 v125, v126, v127
Mvaa 152,8,112
s_waitcnt lgkmcnt(8)
TR 40,18,8512
v_cvt_pk_bf16_f32 v131, v130, v131
Mvaa 136,12,116
TR 42,18,9024
v_cvt_pk_bf16_f32 v130, v128, v129
Mvaa 144,12,120
TR 44,18,8544
v_cvt_pk_bf16_f32 v132, v132, v133
Mvaa 152,12,124
s_waitcnt lgkmcnt(10)
TR 46,18,9056
v_cvt_pk_bf16_f32 v133, v134, v135
Cvaa 140,16,80,40
v_exp_f32 v136, v136
Cvaa 148,16,84,44
v_exp_f32 v137, v137
Cvaa 156,16,88,48
s_waitcnt lgkmcnt(10)
v_exp_f32 v138, v138
Mvaa 140,20,92
v_exp_f32 v139, v139
Mvaa 148,20,96
v_exp_f32 v144, v144
Mvaa 156,20,100
s_waitcnt lgkmcnt(9)
v_exp_f32 v145, v145
Mvaa 140,24,104
v_exp_f32 v146, v146
Mvaa 148,24,108
v_exp_f32 v147, v147
Mvaa 156,24,112
s_waitcnt lgkmcnt(8)
v_exp_f32 v152, v152
Mvaa 140,28,116
v_exp_f32 v153, v153
Mvaa 148,28,120
v_exp_f32 v154, v154
Mvaa 156,28,124
s_waitcnt lgkmcnt(6)
v_exp_f32 v155, v155
Mvav 160,32,114
TR 48,18,8576
TR 50,18,9088
Mvav 168,32,122
s_waitcnt lgkmcnt(6)
s_add_u32 m0, s52, 0x320
v_exp_f32 v140, v140
Mvav 176,32,130
buffer_load_dwordx4 v31, s[12:15], s3 offen offset:256 nt lds
Mvav 180,36,130
v_exp_f32 v141, v141
Mvav 172,36,122
TR 52,18,8608
TR 54,18,9120
Mvav 164,36,114
s_waitcnt lgkmcnt(6)
s_mov_b32 s3, 0x36000
s_add_u32 m0, s52, 0x2100
v_exp_f32 v142, v142
Mvav 184,40,114
buffer_load_dwordx4 v31, s[16:19], s3 offen nt lds
Mvav 192,40,122
s_waitcnt lgkmcnt(4)
v_exp_f32 v143, v143
Mvav 200,40,130
TR 56,18,8640
TR 58,18,9152
Mvav 204,44,130
s_add_u32 m0, s52, 0x2420
v_exp_f32 v148, v148
Mvav 196,44,122
buffer_load_dwordx4 v31, s[16:19], s3 offen offset:256 nt lds
Mvav 188,44,114
s_waitcnt lgkmcnt(4)
v_exp_f32 v149, v149
Mvav 208,48,114
TR 60,18,8672
TR 62,18,9184
Mvav 216,48,122
v_exp_f32 v150, v150
Mvav 224,48,130
s_waitcnt lgkmcnt(4)
v_exp_f32 v151, v151
Mvav 228,52,130
v_exp_f32 v156, v156
Mvav 220,52,122
v_add_u32 v16, 0x14a00, v15
v_add_u32 v18, 0x14a00, v17
Mvav 212,52,114
s_waitcnt lgkmcnt(2)
v_exp_f32 v157, v157
Mvav 232,56,114
s_waitcnt lgkmcnt(0)
s_barrier
Mvav 240,56,122
RD 0,16,0
Mvav 248,56,130
v_exp_f32 v158, v158
Mvav 252,60,130
RD 4,16,64
Mvav 244,60,122
v_exp_f32 v159, v159
Mvav 236,60,114
RD 8,16,128
Mvvv 52,24,114
RD 12,16,192
Mvvv 56,24,122
Mvvv 60,24,130
s_waitcnt lgkmcnt(3)
fh_a23:
Cvaa 112,0,80,40
RD 16,16,512
v_cvt_pk_bf16_f32 v139, v138, v139
Cvaa 120,0,84,44
RD 20,16,576
v_cvt_pk_bf16_f32 v138, v136, v137
Cvaa 128,0,88,48
s_waitcnt lgkmcnt(4)
RD 24,16,640
v_cvt_pk_bf16_f32 v140, v140, v141
Mvaa 112,4,92
RD 28,16,704
v_cvt_pk_bf16_f32 v141, v142, v143
Mvaa 120,4,96
TR 32,18,8448
v_cvt_pk_bf16_f32 v147, v146, v147
Mvaa 128,4,100
s_waitcnt lgkmcnt(6)
TR 34,18,8960
v_cvt_pk_bf16_f32 v146, v144, v145
Mvaa 112,8,104
TR 36,18,8480
v_cvt_pk_bf16_f32 v148, v148, v149
Mvaa 120,8,108
TR 38,18,8992
v_cvt_pk_bf16_f32 v149, v150, v151
Mvaa 128,8,112
s_waitcnt lgkmcnt(8)
TR 40,18,8512
v_cvt_pk_bf16_f32 v155, v154, v155
Mvaa 112,12,116
TR 42,18,9024
v_cvt_pk_bf16_f32 v154, v152, v153
Mvaa 120,12,120
TR 44,18,8544
v_cvt_pk_bf16_f32 v156, v156, v157
Mvaa 128,12,124
s_waitcnt lgkmcnt(10)
TR 46,18,9056
v_cvt_pk_bf16_f32 v157, v158, v159
Cvaa 116,16,80,40
v_exp_f32 v112, v112
Cvaa 124,16,84,44
v_exp_f32 v113, v113
Cvaa 132,16,88,48
s_waitcnt lgkmcnt(10)
v_exp_f32 v114, v114
Mvaa 116,20,92
v_exp_f32 v115, v115
Mvaa 124,20,96
v_exp_f32 v120, v120
Mvaa 132,20,100
s_waitcnt lgkmcnt(9)
v_exp_f32 v121, v121
Mvaa 116,24,104
v_exp_f32 v122, v122
Mvaa 124,24,108
v_exp_f32 v123, v123
Mvaa 132,24,112
s_waitcnt lgkmcnt(8)
v_exp_f32 v128, v128
Mvaa 116,28,116
v_exp_f32 v129, v129
Mvaa 124,28,120
v_exp_f32 v130, v130
Mvaa 132,28,124
s_waitcnt lgkmcnt(6)
v_exp_f32 v131, v131
Mvav 160,32,138
TR 48,18,8576
TR 50,18,9088
Mvav 168,32,146
s_waitcnt lgkmcnt(6)
s_mov_b32 s3, 0x3a000
s_add_u32 m0, s52, 0x4200
v_exp_f32 v116, v116
Mvav 176,32,154
buffer_load_dwordx4 v31, s[12:15], s3 offen nt lds
Mvav 180,36,154
v_exp_f32 v117, v117
Mvav 172,36,146
TR 52,18,8608
TR 54,18,9120
Mvav 164,36,138
s_waitcnt lgkmcnt(6)
s_add_u32 m0, s52, 0x4520
v_exp_f32 v118, v118
Mvav 184,40,138
buffer_load_dwordx4 v31, s[12:15], s3 offen offset:256 nt lds
Mvav 192,40,146
s_waitcnt lgkmcnt(4)
v_exp_f32 v119, v119
Mvav 200,40,154
TR 56,18,8640
TR 58,18,9152
Mvav 204,44,154
v_exp_f32 v124, v124
Mvav 196,44,146
Mvav 188,44,138
s_waitcnt lgkmcnt(4)
v_exp_f32 v125, v125
Mvav 208,48,138
TR 60,18,8672
TR 62,18,9184
Mvav 216,48,146
v_exp_f32 v126, v126
Mvav 224,48,154
s_waitcnt lgkmcnt(4)
v_exp_f32 v127, v127
Mvav 228,52,154
v_exp_f32 v132, v132
Mvav 220,52,146
v_add_u32 v16, 0x18c00, v15
v_add_u32 v18, 0x18c00, v17
Mvav 212,52,138
s_waitcnt lgkmcnt(2)
v_exp_f32 v133, v133
Mvav 232,56,138
s_waitcnt vmcnt(6) lgkmcnt(0)
s_barrier
Mvav 240,56,146
RD 0,16,0
Mvav 248,56,154
v_exp_f32 v134, v134
Mvav 252,60,154
RD 4,16,64
Mvav 244,60,146
v_exp_f32 v135, v135
Mvav 236,60,138
RD 8,16,128
Mvvv 52,24,138
RD 12,16,192
Mvvv 56,24,146
Mvvv 60,24,154
s_waitcnt lgkmcnt(3)
fh_a24:
Cvaa 136,0,80,40
RD 16,16,512
v_cvt_pk_bf16_f32 v115, v114, v115
Cvaa 144,0,84,44
RD 20,16,576
v_cvt_pk_bf16_f32 v114, v112, v113
Cvaa 152,0,88,48
s_waitcnt lgkmcnt(4)
RD 24,16,640
v_cvt_pk_bf16_f32 v116, v116, v117
Mvaa 136,4,92
RD 28,16,704
v_cvt_pk_bf16_f32 v117, v118, v119
Mvaa 144,4,96
TR 32,18,8448
v_cvt_pk_bf16_f32 v123, v122, v123
Mvaa 152,4,100
s_waitcnt lgkmcnt(6)
TR 34,18,8960
v_cvt_pk_bf16_f32 v122, v120, v121
Mvaa 136,8,104
TR 36,18,8480
v_cvt_pk_bf16_f32 v124, v124, v125
Mvaa 144,8,108
TR 38,18,8992
v_cvt_pk_bf16_f32 v125, v126, v127
Mvaa 152,8,112
s_waitcnt lgkmcnt(8)
TR 40,18,8512
v_cvt_pk_bf16_f32 v131, v130, v131
Mvaa 136,12,116
TR 42,18,9024
v_cvt_pk_bf16_f32 v130, v128, v129
Mvaa 144,12,120
TR 44,18,8544
v_cvt_pk_bf16_f32 v132, v132, v133
Mvaa 152,12,124
s_waitcnt lgkmcnt(10)
TR 46,18,9056
v_cvt_pk_bf16_f32 v133, v134, v135
Cvaa 140,16,80,40
v_exp_f32 v136, v136
Cvaa 148,16,84,44
v_exp_f32 v137, v137
Cvaa 156,16,88,48
s_waitcnt lgkmcnt(10)
v_exp_f32 v138, v138
Mvaa 140,20,92
v_exp_f32 v139, v139
Mvaa 148,20,96
v_exp_f32 v144, v144
Mvaa 156,20,100
s_waitcnt lgkmcnt(9)
v_exp_f32 v145, v145
Mvaa 140,24,104
v_exp_f32 v146, v146
Mvaa 148,24,108
v_exp_f32 v147, v147
Mvaa 156,24,112
s_waitcnt lgkmcnt(8)
v_exp_f32 v152, v152
Mvaa 140,28,116
v_exp_f32 v153, v153
Mvaa 148,28,120
v_exp_f32 v154, v154
Mvaa 156,28,124
s_waitcnt lgkmcnt(6)
v_exp_f32 v155, v155
Mvav 160,32,114
TR 48,18,8576
TR 50,18,9088
Mvav 168,32,122
s_waitcnt lgkmcnt(6)
s_mov_b32 s3, 0x38000
s_add_u32 m0, s52, 0x6300
v_exp_f32 v140, v140
Mvav 176,32,130
buffer_load_dwordx4 v31, s[16:19], s3 offen nt lds
Mvav 180,36,130
v_exp_f32 v141, v141
Mvav 172,36,122
TR 52,18,8608
TR 54,18,9120
Mvav 164,36,114
s_waitcnt lgkmcnt(6)
s_add_u32 m0, s52, 0x6620
v_exp_f32 v142, v142
Mvav 184,40,114
buffer_load_dwordx4 v31, s[16:19], s3 offen offset:256 nt lds
Mvav 192,40,122
s_waitcnt lgkmcnt(4)
v_exp_f32 v143, v143
Mvav 200,40,130
TR 56,18,8640
TR 58,18,9152
Mvav 204,44,130
s_add_u32 s50, s72, 0
s_add_u32 m0, s52, 0x14a00
v_exp_f32 v148, v148
Mvav 196,44,122
buffer_load_dwordx4 v10, s[24:27], s50 offen lds
Mvav 188,44,114
s_waitcnt lgkmcnt(4)
v_exp_f32 v149, v149
Mvav 208,48,114
TR 60,18,8672
TR 62,18,9184
Mvav 216,48,122
s_waitcnt lgkmcnt(4)
s_add_u32 m0, s52, 0x14e20
v_exp_f32 v150, v150
Mvav 224,48,130
buffer_load_dwordx4 v11, s[24:27], s50 offen lds
Mvav 228,52,130
v_exp_f32 v151, v151
Mvav 220,52,122
v_add_u32 v16, 0x1ce00, v15
v_add_u32 v18, 0x1ce00, v17
Mvav 212,52,114
s_waitcnt lgkmcnt(2)
v_exp_f32 v156, v156
Mvav 232,56,114
s_waitcnt lgkmcnt(0)
s_barrier
Mvav 240,56,122
RD 0,16,0
RD 4,16,64
Mvav 248,56,130
v_exp_f32 v157, v157
Mvav 252,60,130
s_add_u32 s50, s72, 0x10000
s_add_u32 m0, s52, 0x16b00
RD 8,16,128
RD 12,16,192
Mvav 244,60,122
buffer_load_dwordx4 v10, s[24:27], s50 offen lds
Mvav 236,60,114
s_add_u32 m0, s52, 0x16f20
v_exp_f32 v158, v158
Mvvv 52,24,114
buffer_load_dwordx4 v11, s[24:27], s50 offen lds
Mvvv 56,24,122
v_exp_f32 v159, v159
Mvvv 60,24,130
s_waitcnt lgkmcnt(3)
fh_a25:
Cvaa 112,0,80,40
RD 16,16,512
v_cvt_pk_bf16_f32 v139, v138, v139
Cvaa 120,0,84,44
RD 20,16,576
v_cvt_pk_bf16_f32 v138, v136, v137
Cvaa 128,0,88,48
s_waitcnt lgkmcnt(4)
RD 24,16,640
v_cvt_pk_bf16_f32 v140, v140, v141
Mvaa 112,4,92
RD 28,16,704
v_cvt_pk_bf16_f32 v141, v142, v143
Mvaa 120,4,96
TR 32,18,8448
v_cvt_pk_bf16_f32 v147, v146, v147
Mvaa 128,4,100
s_waitcnt lgkmcnt(6)
TR 34,18,8960
v_cvt_pk_bf16_f32 v146, v144, v145
Mvaa 112,8,104
TR 36,18,8480
v_cvt_pk_bf16_f32 v148, v148, v149
Mvaa 120,8,108
TR 38,18,8992
v_cvt_pk_bf16_f32 v149, v150, v151
Mvaa 128,8,112
s_waitcnt lgkmcnt(8)
TR 40,18,8512
v_cvt_pk_bf16_f32 v155, v154, v155
Mvaa 112,12,116
TR 42,18,9024
v_cvt_pk_bf16_f32 v154, v152, v153
Mvaa 120,12,120
TR 44,18,8544
v_cvt_pk_bf16_f32 v156, v156, v157
Mvaa 128,12,124
s_waitcnt lgkmcnt(10)
TR 46,18,9056
v_cvt_pk_bf16_f32 v157, v158, v159
Cvaa 116,16,80,40
v_exp_f32 v112, v112
Cvaa 124,16,84,44
v_exp_f32 v113, v113
Cvaa 132,16,88,48
s_waitcnt lgkmcnt(10)
v_exp_f32 v114, v114
Mvaa 116,20,92
v_exp_f32 v115, v115
Mvaa 124,20,96
v_exp_f32 v120, v120
Mvaa 132,20,100
s_waitcnt lgkmcnt(9)
v_exp_f32 v121, v121
Mvaa 116,24,104
v_exp_f32 v122, v122
Mvaa 124,24,108
v_exp_f32 v123, v123
Mvaa 132,24,112
s_waitcnt lgkmcnt(8)
v_exp_f32 v128, v128
Mvaa 116,28,116
v_exp_f32 v129, v129
Mvaa 124,28,120
v_exp_f32 v130, v130
Mvaa 132,28,124
s_waitcnt lgkmcnt(6)
v_exp_f32 v131, v131
Mvav 160,32,138
TR 48,18,8576
TR 50,18,9088
Mvav 168,32,146
s_waitcnt lgkmcnt(6)
s_mov_b32 s3, 0x3c000
s_add_u32 m0, s52, 0x8400
v_exp_f32 v116, v116
Mvav 176,32,154
buffer_load_dwordx4 v31, s[12:15], s3 offen nt lds
Mvav 180,36,154
v_exp_f32 v117, v117
Mvav 172,36,146
s_branch f_pad14s
f_pad14:
s_setpc_b64 s[70:71]
f_pad14s:
TR 52,18,8608
TR 54,18,9120
Mvav 164,36,138
s_waitcnt lgkmcnt(6)
s_add_u32 m0, s52, 0x8720
v_exp_f32 v118, v118
Mvav 184,40,138
buffer_load_dwordx4 v31, s[12:15], s3 offen offset:256 nt lds
Mvav 192,40,146
s_waitcnt lgkmcnt(4)
v_exp_f32 v119, v119
Mvav 200,40,154
TR 56,18,8640
TR 58,18,9152
Mvav 204,44,154
s_mov_b32 s3, 0x3a000
s_add_u32 m0, s52, 0xa500
v_exp_f32 v124, v124
Mvav 196,44,146
buffer_load_dwordx4 v31, s[16:19], s3 offen nt lds
Mvav 188,44,138
s_waitcnt lgkmcnt(4)
v_exp_f32 v125, v125
Mvav 208,48,138
TR 60,18,8672
TR 62,18,9184
Mvav 216,48,146
s_waitcnt lgkmcnt(4)
s_add_u32 s50, s72, 0x20000
s_add_u32 m0, s52, 0x18c00
v_exp_f32 v126, v126
Mvav 224,48,154
buffer_load_dwordx4 v10, s[24:27], s50 offen lds
Mvav 228,52,154
v_exp_f32 v127, v127
Mvav 220,52,146
v_add_u32 v16, 0x21000, v15
v_add_u32 v18, 0x21000, v17
Mvav 212,52,138
s_waitcnt lgkmcnt(2)
v_exp_f32 v132, v132
Mvav 232,56,138
s_waitcnt vmcnt(18) lgkmcnt(0)
s_barrier
Mvav 240,56,146
RD 0,16,0
RD 4,16,64
Mvav 248,56,154
v_exp_f32 v133, v133
Mvav 252,60,154
s_add_u32 m0, s52, 0x19020
RD 8,16,128
RD 12,16,192
Mvav 244,60,146
buffer_load_dwordx4 v11, s[24:27], s50 offen lds
Mvav 236,60,138
s_add_u32 s50, s72, 0x30000
s_add_u32 m0, s52, 0x1ad00
v_exp_f32 v134, v134
Mvvv 52,24,138
buffer_load_dwordx4 v10, s[24:27], s50 offen lds
Mvvv 56,24,146
s_waitcnt lgkmcnt(3)
s_add_u32 m0, s52, 0x1b120
v_exp_f32 v135, v135
Mvvv 60,24,154
buffer_load_dwordx4 v11, s[24:27], s50 offen lds
fh_a26:
Cvaa 136,0,80,40
RD 16,16,512
v_cvt_pk_bf16_f32 v115, v114, v115
Cvaa 144,0,84,44
RD 20,16,576
v_cvt_pk_bf16_f32 v114, v112, v113
Cvaa 152,0,88,48
s_waitcnt lgkmcnt(4)
RD 24,16,640
v_cvt_pk_bf16_f32 v116, v116, v117
Mvaa 136,4,92
RD 28,16,704
v_cvt_pk_bf16_f32 v117, v118, v119
Mvaa 144,4,96
TR 32,18,8448
v_cvt_pk_bf16_f32 v123, v122, v123
Mvaa 152,4,100
s_waitcnt lgkmcnt(6)
TR 34,18,8960
v_cvt_pk_bf16_f32 v122, v120, v121
Mvaa 136,8,104
TR 36,18,8480
v_cvt_pk_bf16_f32 v124, v124, v125
Mvaa 144,8,108
TR 38,18,8992
v_cvt_pk_bf16_f32 v125, v126, v127
Mvaa 152,8,112
s_waitcnt lgkmcnt(8)
TR 40,18,8512
v_cvt_pk_bf16_f32 v131, v130, v131
Mvaa 136,12,116
TR 42,18,9024
v_cvt_pk_bf16_f32 v130, v128, v129
Mvaa 144,12,120
TR 44,18,8544
v_cvt_pk_bf16_f32 v132, v132, v133
Mvaa 152,12,124
s_waitcnt lgkmcnt(10)
TR 46,18,9056
v_cvt_pk_bf16_f32 v133, v134, v135
Cvaa 140,16,80,40
v_exp_f32 v136, v136
Cvaa 148,16,84,44
v_exp_f32 v137, v137
Cvaa 156,16,88,48
s_waitcnt lgkmcnt(10)
v_exp_f32 v138, v138
Mvaa 140,20,92
v_exp_f32 v139, v139
Mvaa 148,20,96
v_exp_f32 v144, v144
Mvaa 156,20,100
s_waitcnt lgkmcnt(9)
v_exp_f32 v145, v145
Mvaa 140,24,104
v_exp_f32 v146, v146
Mvaa 148,24,108
v_exp_f32 v147, v147
Mvaa 156,24,112
s_waitcnt lgkmcnt(8)
v_exp_f32 v152, v152
Mvaa 140,28,116
v_exp_f32 v153, v153
Mvaa 148,28,120
v_exp_f32 v154, v154
Mvaa 156,28,124
s_waitcnt lgkmcnt(6)
v_exp_f32 v155, v155
Mvav 160,32,114
TR 48,18,8576
TR 50,18,9088
Mvav 168,32,122
s_waitcnt lgkmcnt(6)
s_add_u32 m0, s52, 0xa820
v_exp_f32 v140, v140
Mvav 176,32,130
buffer_load_dwordx4 v31, s[16:19], s3 offen offset:256 nt lds
Mvav 180,36,130
v_exp_f32 v141, v141
Mvav 172,36,122
TR 52,18,8608
TR 54,18,9120
Mvav 164,36,114
s_waitcnt lgkmcnt(6)
s_mov_b32 s3, 0x3e000
s_add_u32 m0, s52, 0xc600
v_exp_f32 v142, v142
Mvav 184,40,114
buffer_load_dwordx4 v31, s[12:15], s3 offen nt lds
Mvav 192,40,122
s_waitcnt lgkmcnt(4)
v_exp_f32 v143, v143
Mvav 200,40,130
TR 56,18,8640
TR 58,18,9152
Mvav 204,44,130
s_add_u32 s50, s72, 0x40000
s_add_u32 m0, s52, 0x1ce00
v_exp_f32 v148, v148
Mvav 196,44,122
buffer_load_dwordx4 v10, s[24:27], s50 offen lds
Mvav 188,44,114
s_waitcnt lgkmcnt(4)
v_exp_f32 v149, v149
Mvav 208,48,114
TR 60,18,8672
TR 62,18,9184
Mvav 216,48,122
s_waitcnt lgkmcnt(4)
s_add_u32 m0, s52, 0x1d220
v_exp_f32 v150, v150
Mvav 224,48,130
buffer_load_dwordx4 v11, s[24:27], s50 offen lds
Mvav 228,52,130
v_exp_f32 v151, v151
Mvav 220,52,122
v_add_u32 v16, 0, v15
v_add_u32 v18, 0, v17
Mvav 212,52,114
s_waitcnt lgkmcnt(2)
v_exp_f32 v156, v156
Mvav 232,56,114
s_waitcnt vmcnt(19) lgkmcnt(0)
s_barrier
Mvav 240,56,122
RD 0,16,0
RD 4,16,64
Mvav 248,56,130
v_exp_f32 v157, v157
Mvav 252,60,130
s_add_u32 s50, s72, 0x50000
s_add_u32 m0, s52, 0x1ef00
RD 8,16,128
RD 12,16,192
Mvav 244,60,122
buffer_load_dwordx4 v10, s[24:27], s50 offen lds
Mvav 236,60,114
s_add_u32 m0, s52, 0x1f320
v_exp_f32 v158, v158
Mvvv 52,24,114
buffer_load_dwordx4 v11, s[24:27], s50 offen lds
Mvvv 56,24,122
v_exp_f32 v159, v159
Mvvv 60,24,130
s_waitcnt lgkmcnt(3)
fh_a27:
Cvaa 112,0,80,40
RD 16,16,512
v_cvt_pk_bf16_f32 v139, v138, v139
Cvaa 120,0,84,44
RD 20,16,576
v_cvt_pk_bf16_f32 v138, v136, v137
Cvaa 128,0,88,48
s_waitcnt lgkmcnt(4)
RD 24,16,640
v_cvt_pk_bf16_f32 v140, v140, v141
Mvaa 112,4,92
RD 28,16,704
v_cvt_pk_bf16_f32 v141, v142, v143
Mvaa 120,4,96
TR 32,18,8448
v_cvt_pk_bf16_f32 v147, v146, v147
Mvaa 128,4,100
s_waitcnt lgkmcnt(6)
TR 34,18,8960
v_cvt_pk_bf16_f32 v146, v144, v145
Mvaa 112,8,104
TR 36,18,8480
v_cvt_pk_bf16_f32 v148, v148, v149
Mvaa 120,8,108
TR 38,18,8992
v_cvt_pk_bf16_f32 v149, v150, v151
Mvaa 128,8,112
s_waitcnt lgkmcnt(8)
TR 40,18,8512
v_cvt_pk_bf16_f32 v155, v154, v155
Mvaa 112,12,116
TR 42,18,9024
v_cvt_pk_bf16_f32 v154, v152, v153
Mvaa 120,12,120
TR 44,18,8544
v_cvt_pk_bf16_f32 v156, v156, v157
Mvaa 128,12,124
s_waitcnt lgkmcnt(10)
TR 46,18,9056
v_cvt_pk_bf16_f32 v157, v158, v159
Cvaa 116,16,80,40
v_exp_f32 v112, v112
Cvaa 124,16,84,44
v_exp_f32 v113, v113
Cvaa 132,16,88,48
s_waitcnt lgkmcnt(10)
v_exp_f32 v114, v114
Mvaa 116,20,92
v_exp_f32 v115, v115
Mvaa 124,20,96
v_exp_f32 v120, v120
Mvaa 132,20,100
s_waitcnt lgkmcnt(9)
v_exp_f32 v121, v121
Mvaa 116,24,104
v_exp_f32 v122, v122
Mvaa 124,24,108
v_exp_f32 v123, v123
Mvaa 132,24,112
s_waitcnt lgkmcnt(8)
v_exp_f32 v128, v128
Mvaa 116,28,116
v_exp_f32 v129, v129
Mvaa 124,28,120
v_exp_f32 v130, v130
Mvaa 132,28,124
s_waitcnt lgkmcnt(6)
v_exp_f32 v131, v131
Mvav 160,32,138
TR 48,18,8576
TR 50,18,9088
Mvav 168,32,146
s_waitcnt lgkmcnt(6)
s_add_u32 m0, s52, 0xc920
v_exp_f32 v116, v116
Mvav 176,32,154
buffer_load_dwordx4 v31, s[12:15], s3 offen offset:256 nt lds
Mvav 180,36,154
v_exp_f32 v117, v117
Mvav 172,36,146
TR 52,18,8608
TR 54,18,9120
Mvav 164,36,138
s_waitcnt lgkmcnt(6)
s_mov_b32 s3, 0x3c000
s_add_u32 m0, s52, 0xe700
v_exp_f32 v118, v118
Mvav 184,40,138
buffer_load_dwordx4 v31, s[16:19], s3 offen nt lds
Mvav 192,40,146
s_waitcnt lgkmcnt(4)
v_exp_f32 v119, v119
Mvav 200,40,154
TR 56,18,8640
TR 58,18,9152
Mvav 204,44,154
s_add_u32 m0, s52, 0xea20
v_exp_f32 v124, v124
Mvav 196,44,146
buffer_load_dwordx4 v31, s[16:19], s3 offen offset:256 nt lds
Mvav 188,44,138
s_waitcnt lgkmcnt(4)
v_exp_f32 v125, v125
Mvav 208,48,138
TR 60,18,8672
TR 62,18,9184
Mvav 216,48,146
s_waitcnt lgkmcnt(4)
s_add_u32 s50, s72, 0x60000
s_add_u32 m0, s52, 0x21000
v_exp_f32 v126, v126
Mvav 224,48,154
buffer_load_dwordx4 v10, s[24:27], s50 offen lds
Mvav 228,52,154
v_exp_f32 v127, v127
Mvav 220,52,146
v_add_u32 v16, 0x4200, v15
v_add_u32 v18, 0x4200, v17
Mvav 212,52,138
s_waitcnt lgkmcnt(2)
v_exp_f32 v132, v132
Mvav 232,56,138
s_waitcnt vmcnt(21) lgkmcnt(0)
s_barrier
Mvav 240,56,146
RD 0,16,0
RD 4,16,64
Mvav 248,56,154
v_exp_f32 v133, v133
Mvav 252,60,154
s_add_u32 m0, s52, 0x21420
RD 8,16,128
RD 12,16,192
Mvav 244,60,146
buffer_load_dwordx4 v11, s[24:27], s50 offen lds
Mvav 236,60,138
s_add_u32 s50, s72, 0x70000
s_add_u32 m0, s52, 0x23100
v_exp_f32 v134, v134
Mvvv 52,24,138
buffer_load_dwordx4 v10, s[24:27], s50 offen lds
Mvvv 56,24,146
s_waitcnt lgkmcnt(3)
s_add_u32 m0, s52, 0x23520
v_exp_f32 v135, v135
Mvvv 60,24,154
buffer_load_dwordx4 v11, s[24:27], s50 offen lds
fh_a28:
Cvaa 136,0,80,40
RD 16,16,512
v_cvt_pk_bf16_f32 v115, v114, v115
Cvaa 144,0,84,44
RD 20,16,576
v_cvt_pk_bf16_f32 v114, v112, v113
Cvaa 152,0,88,48
s_waitcnt lgkmcnt(4)
RD 24,16,640
v_cvt_pk_bf16_f32 v116, v116, v117
Mvaa 136,4,92
RD 28,16,704
v_cvt_pk_bf16_f32 v117, v118, v119
Mvaa 144,4,96
TR 32,18,8448
v_cvt_pk_bf16_f32 v123, v122, v123
Mvaa 152,4,100
s_waitcnt lgkmcnt(6)
TR 34,18,8960
v_cvt_pk_bf16_f32 v122, v120, v121
Mvaa 136,8,104
TR 36,18,8480
v_cvt_pk_bf16_f32 v124, v124, v125
Mvaa 144,8,108
TR 38,18,8992
v_cvt_pk_bf16_f32 v125, v126, v127
Mvaa 152,8,112
s_waitcnt lgkmcnt(8)
TR 40,18,8512
v_cvt_pk_bf16_f32 v131, v130, v131
Mvaa 136,12,116
TR 42,18,9024
v_cvt_pk_bf16_f32 v130, v128, v129
Mvaa 144,12,120
TR 44,18,8544
v_cvt_pk_bf16_f32 v132, v132, v133
Mvaa 152,12,124
s_waitcnt lgkmcnt(10)
TR 46,18,9056
v_cvt_pk_bf16_f32 v133, v134, v135
Cvaa 140,16,80,40
s_mov_b32 s3, 0x3e000
s_add_u32 m0, s52, 0x12900
v_exp_f32 v136, v136
Cvaa 148,16,84,44
buffer_load_dwordx4 v31, s[16:19], s3 offen nt lds
v_exp_f32 v137, v137
Cvaa 156,16,88,48
s_waitcnt lgkmcnt(10)
s_add_u32 m0, s52, 0x12c20
v_exp_f32 v138, v138
Mvaa 140,20,92
buffer_load_dwordx4 v31, s[16:19], s3 offen offset:256 nt lds
v_exp_f32 v139, v139
Mvaa 148,20,96
v_exp_f32 v144, v144
Mvaa 156,20,100
s_waitcnt lgkmcnt(9)
v_exp_f32 v145, v145
Mvaa 140,24,104
v_exp_f32 v146, v146
Mvaa 148,24,108
v_exp_f32 v147, v147
Mvaa 156,24,112
s_waitcnt lgkmcnt(8)
v_exp_f32 v152, v152
Mvaa 140,28,116
v_exp_f32 v153, v153
Mvaa 148,28,120
v_exp_f32 v154, v154
Mvaa 156,28,124
s_waitcnt lgkmcnt(6)
v_exp_f32 v155, v155
Mvav 160,32,114
TR 48,18,8576
TR 50,18,9088
Mvav 168,32,122
s_waitcnt lgkmcnt(6)
s_add_u32 s50, s76, 0
s_add_u32 m0, s52, 0
v_exp_f32 v140, v140
Mvav 176,32,130
buffer_load_dwordx4 v10, s[24:27], s50 offen lds
Mvav 180,36,130
v_exp_f32 v141, v141
Mvav 172,36,122
TR 52,18,8608
TR 54,18,9120
Mvav 164,36,114
s_waitcnt lgkmcnt(6)
s_add_u32 m0, s52, 0x420
v_exp_f32 v142, v142
Mvav 184,40,114
buffer_load_dwordx4 v11, s[24:27], s50 offen lds
Mvav 192,40,122
s_waitcnt lgkmcnt(4)
v_exp_f32 v143, v143
Mvav 200,40,130
TR 56,18,8640
TR 58,18,9152
Mvav 204,44,130
s_add_u32 s50, s76, 0x10000
s_add_u32 m0, s52, 0x2100
v_exp_f32 v148, v148
Mvav 196,44,122
buffer_load_dwordx4 v10, s[24:27], s50 offen lds
Mvav 188,44,114
s_waitcnt lgkmcnt(4)
v_exp_f32 v149, v149
Mvav 208,48,114
TR 60,18,8672
TR 62,18,9184
Mvav 216,48,122
s_waitcnt lgkmcnt(4)
s_add_u32 m0, s52, 0x2520
v_exp_f32 v150, v150
Mvav 224,48,130
buffer_load_dwordx4 v11, s[24:27], s50 offen lds
Mvav 228,52,130
v_exp_f32 v151, v151
Mvav 220,52,122
v_add_u32 v16, 0x8400, v15
v_add_u32 v18, 0x8400, v17
Mvav 212,52,114
s_waitcnt lgkmcnt(2)
v_exp_f32 v156, v156
Mvav 232,56,114
s_waitcnt vmcnt(18) lgkmcnt(0)
s_barrier
Mvav 240,56,122
RD 0,16,0
RD 4,16,64
Mvav 248,56,130
v_exp_f32 v157, v157
Mvav 252,60,130
s_add_u32 s51, s82, 0
RD 8,16,128
RD 12,16,192
Mvav 244,60,122
buffer_load_dwordx4 a[128:131], v20, s[20:23], s51 offen sc1
Mvav 236,60,114
v_exp_f32 v158, v158
Mvvv 52,24,114
buffer_load_dwordx4 a[140:143], v20, s[20:23], s51 offen offset:1024 sc1
Mvvv 56,24,122
s_waitcnt lgkmcnt(3)
v_exp_f32 v159, v159
Mvvv 60,24,130
buffer_load_dwordx4 a[132:135], v12, s[20:23], s51 offen sc1
fh_a29:
Cvaa 112,0,80,40
RD 16,16,512
v_cvt_pk_bf16_f32 v139, v138, v139
Cvaa 120,0,84,44
RD 20,16,576
v_cvt_pk_bf16_f32 v138, v136, v137
Cvaa 128,0,88,48
s_waitcnt lgkmcnt(4)
RD 24,16,640
v_cvt_pk_bf16_f32 v140, v140, v141
Mvaa 112,4,92
RD 28,16,704
v_cvt_pk_bf16_f32 v141, v142, v143
Mvaa 120,4,96
TR 32,18,8448
v_cvt_pk_bf16_f32 v147, v146, v147
Mvaa 128,4,100
s_waitcnt lgkmcnt(6)
TR 34,18,8960
v_cvt_pk_bf16_f32 v146, v144, v145
Mvaa 112,8,104
TR 36,18,8480
v_cvt_pk_bf16_f32 v148, v148, v149
Mvaa 120,8,108
TR 38,18,8992
v_cvt_pk_bf16_f32 v149, v150, v151
Mvaa 128,8,112
s_waitcnt lgkmcnt(8)
TR 40,18,8512
v_cvt_pk_bf16_f32 v155, v154, v155
Mvaa 112,12,116
TR 42,18,9024
v_cvt_pk_bf16_f32 v154, v152, v153
Mvaa 120,12,120
TR 44,18,8544
v_cvt_pk_bf16_f32 v156, v156, v157
Mvaa 128,12,124
s_waitcnt lgkmcnt(10)
TR 46,18,9056
v_cvt_pk_bf16_f32 v157, v158, v159
Cvaa 116,16,80,40
v_exp_f32 v112, v112
Cvaa 124,16,84,44
v_exp_f32 v113, v113
Cvaa 132,16,88,48
s_waitcnt lgkmcnt(10)
v_exp_f32 v114, v114
Mvaa 116,20,92
v_exp_f32 v115, v115
Mvaa 124,20,96
v_exp_f32 v120, v120
Mvaa 132,20,100
s_waitcnt lgkmcnt(9)
v_exp_f32 v121, v121
Mvaa 116,24,104
v_exp_f32 v122, v122
Mvaa 124,24,108
v_exp_f32 v123, v123
Mvaa 132,24,112
s_waitcnt lgkmcnt(8)
v_exp_f32 v128, v128
Mvaa 116,28,116
v_exp_f32 v129, v129
Mvaa 124,28,120
v_exp_f32 v130, v130
Mvaa 132,28,124
s_waitcnt lgkmcnt(6)
v_exp_f32 v131, v131
Mvav 160,32,138
TR 48,18,8576
TR 50,18,9088
Mvav 168,32,146
s_waitcnt lgkmcnt(6)
s_add_u32 s50, s76, 0x20000
s_add_u32 m0, s52, 0x4200
v_exp_f32 v116, v116
Mvav 176,32,154
buffer_load_dwordx4 v10, s[24:27], s50 offen lds
Mvav 180,36,154
v_exp_f32 v117, v117
Mvav 172,36,146
TR 52,18,8608
TR 54,18,9120
Mvav 164,36,138
s_waitcnt lgkmcnt(6)
s_add_u32 m0, s52, 0x4620
v_exp_f32 v118, v118
Mvav 184,40,138
s_branch f_pad15s
f_pad15:
s_setpc_b64 s[70:71]
f_pad15s:
buffer_load_dwordx4 v11, s[24:27], s50 offen lds
Mvav 192,40,146
s_waitcnt lgkmcnt(4)
v_exp_f32 v119, v119
Mvav 200,40,154
TR 56,18,8640
TR 58,18,9152
Mvav 204,44,154
s_add_u32 s50, s76, 0x30000
s_add_u32 m0, s52, 0x6300
v_exp_f32 v124, v124
Mvav 196,44,146
buffer_load_dwordx4 v10, s[24:27], s50 offen lds
Mvav 188,44,138
s_waitcnt lgkmcnt(4)
v_exp_f32 v125, v125
Mvav 208,48,138
TR 60,18,8672
TR 62,18,9184
Mvav 216,48,146
s_waitcnt lgkmcnt(4)
s_add_u32 m0, s52, 0x6720
v_exp_f32 v126, v126
Mvav 224,48,154
buffer_load_dwordx4 v11, s[24:27], s50 offen lds
Mvav 228,52,154
v_exp_f32 v127, v127
Mvav 220,52,146
v_add_u32 v16, 0xc600, v15
v_add_u32 v18, 0xc600, v17
Mvav 212,52,138
s_waitcnt lgkmcnt(2)
v_exp_f32 v132, v132
Mvav 232,56,138
s_waitcnt vmcnt(17) lgkmcnt(0)
s_barrier
Mvav 240,56,146
RD 0,16,0
RD 4,16,64
Mvav 248,56,154
v_exp_f32 v133, v133
Mvav 252,60,154
RD 8,16,128
RD 12,16,192
Mvav 244,60,146
buffer_load_dwordx4 a[144:147], v12, s[20:23], s51 offen offset:1024 sc1
Mvav 236,60,138
v_exp_f32 v134, v134
Mvvv 52,24,138
buffer_load_dwordx4 a[136:139], v21, s[20:23], s51 offen sc1
Mvvv 56,24,146
s_waitcnt lgkmcnt(3)
v_exp_f32 v135, v135
Mvvv 60,24,154
buffer_load_dwordx4 a[148:151], v21, s[20:23], s51 offen offset:1024 sc1
fh_a30:
Cvaa 136,0,80,40
RD 16,16,512
v_cvt_pk_bf16_f32 v115, v114, v115
Cvaa 144,0,84,44
RD 20,16,576
v_cvt_pk_bf16_f32 v114, v112, v113
Cvaa 152,0,88,48
s_waitcnt lgkmcnt(4)
RD 24,16,640
v_cvt_pk_bf16_f32 v116, v116, v117
Mvaa 136,4,92
RD 28,16,704
v_cvt_pk_bf16_f32 v117, v118, v119
Mvaa 144,4,96
TR 32,18,8448
v_cvt_pk_bf16_f32 v123, v122, v123
Mvaa 152,4,100
s_waitcnt lgkmcnt(6)
TR 34,18,8960
v_cvt_pk_bf16_f32 v122, v120, v121
Mvaa 136,8,104
TR 36,18,8480
v_cvt_pk_bf16_f32 v124, v124, v125
Mvaa 144,8,108
TR 38,18,8992
v_cvt_pk_bf16_f32 v125, v126, v127
Mvaa 152,8,112
s_waitcnt lgkmcnt(8)
TR 40,18,8512
v_cvt_pk_bf16_f32 v131, v130, v131
Mvaa 136,12,116
TR 42,18,9024
v_cvt_pk_bf16_f32 v130, v128, v129
Mvaa 144,12,120
TR 44,18,8544
v_cvt_pk_bf16_f32 v132, v132, v133
Mvaa 152,12,124
s_waitcnt lgkmcnt(10)
TR 46,18,9056
v_cvt_pk_bf16_f32 v133, v134, v135
Cvaa 140,16,80,40
v_exp_f32 v136, v136
Cvaa 148,16,84,44
v_exp_f32 v137, v137
Cvaa 156,16,88,48
s_waitcnt lgkmcnt(10)
v_exp_f32 v138, v138
Mvaa 140,20,92
v_exp_f32 v139, v139
Mvaa 148,20,96
v_exp_f32 v144, v144
Mvaa 156,20,100
s_waitcnt lgkmcnt(9)
v_exp_f32 v145, v145
Mvaa 140,24,104
v_exp_f32 v146, v146
Mvaa 148,24,108
v_exp_f32 v147, v147
Mvaa 156,24,112
s_waitcnt lgkmcnt(8)
v_exp_f32 v152, v152
Mvaa 140,28,116
v_exp_f32 v153, v153
Mvaa 148,28,120
v_exp_f32 v154, v154
Mvaa 156,28,124
s_waitcnt lgkmcnt(6)
v_exp_f32 v155, v155
Mvav 160,32,114
TR 48,18,8576
TR 50,18,9088
Mvav 168,32,122
s_waitcnt lgkmcnt(6)
s_add_u32 s50, s76, 0x80000
s_add_u32 m0, s52, 0x8400
v_exp_f32 v140, v140
Mvav 176,32,130
buffer_load_dwordx4 v10, s[24:27], s50 offen lds
Mvav 180,36,130
v_exp_f32 v141, v141
Mvav 172,36,122
TR 52,18,8608
TR 54,18,9120
Mvav 164,36,114
s_waitcnt lgkmcnt(6)
s_add_u32 m0, s52, 0x8820
v_exp_f32 v142, v142
Mvav 184,40,114
buffer_load_dwordx4 v11, s[24:27], s50 offen lds
Mvav 192,40,122
s_waitcnt lgkmcnt(4)
v_exp_f32 v143, v143
Mvav 200,40,130
TR 56,18,8640
TR 58,18,9152
Mvav 204,44,130
s_add_u32 s50, s76, 0x90000
s_add_u32 m0, s52, 0xa500
v_exp_f32 v148, v148
Mvav 196,44,122
buffer_load_dwordx4 v10, s[24:27], s50 offen lds
Mvav 188,44,114
s_waitcnt lgkmcnt(4)
v_exp_f32 v149, v149
Mvav 208,48,114
TR 60,18,8672
TR 62,18,9184
Mvav 216,48,122
s_waitcnt lgkmcnt(4)
s_add_u32 m0, s52, 0xa920
v_exp_f32 v150, v150
Mvav 224,48,130
buffer_load_dwordx4 v11, s[24:27], s50 offen lds
Mvav 228,52,130
v_exp_f32 v151, v151
Mvav 220,52,122
v_add_u32 v16, 0x10800, v15
v_add_u32 v18, 0x10800, v17
Mvav 212,52,114
s_waitcnt lgkmcnt(2)
v_exp_f32 v156, v156
Mvav 232,56,114
s_waitcnt vmcnt(18) lgkmcnt(0)
s_barrier
Mvav 240,56,122
RD 0,16,0
RD 4,16,64
Mvav 248,56,130
v_exp_f32 v157, v157
Mvav 252,60,130
s_add_u32 s51, s82, 0x5800
RD 8,16,128
RD 12,16,192
Mvav 244,60,122
buffer_load_dwordx4 a[152:155], v20, s[20:23], s51 offen sc1
Mvav 236,60,114
v_exp_f32 v158, v158
Mvvv 52,24,114
buffer_load_dwordx4 a[164:167], v20, s[20:23], s51 offen offset:1024 sc1
Mvvv 56,24,122
v_exp_f32 v159, v159
Mvvv 60,24,130
buffer_load_dwordx4 a[156:159], v12, s[20:23], s51 offen sc1
TR 32,18,8448
TR 34,18,8960
TR 36,18,8480
TR 38,18,8992
TR 40,18,8512
TR 42,18,9024
TR 44,18,8544
TR 46,18,9056
TR 48,18,8576
TR 50,18,9088
TR 52,18,8608
TR 54,18,9120
TR 56,18,8640
TR 58,18,9152
TR 60,18,8672
TR 62,18,9184
v_cvt_pk_bf16_f32 v139, v138, v139
v_cvt_pk_bf16_f32 v138, v136, v137
v_cvt_pk_bf16_f32 v140, v140, v141
v_cvt_pk_bf16_f32 v141, v142, v143
v_cvt_pk_bf16_f32 v147, v146, v147
v_cvt_pk_bf16_f32 v146, v144, v145
v_cvt_pk_bf16_f32 v148, v148, v149
v_cvt_pk_bf16_f32 v149, v150, v151
v_cvt_pk_bf16_f32 v155, v154, v155
v_cvt_pk_bf16_f32 v154, v152, v153
v_cvt_pk_bf16_f32 v156, v156, v157
v_cvt_pk_bf16_f32 v157, v158, v159
Mvvv 52,24,138
s_waitcnt lgkmcnt(8)
Mvvv 56,24,146
s_add_u32 s50, s76, 0xa0000
s_add_u32 m0, s52, 0xc600
s_nop 0
buffer_load_dwordx4 v10, s[24:27], s50 offen lds
s_add_u32 m0, s52, 0xca20
s_nop 0
buffer_load_dwordx4 v11, s[24:27], s50 offen lds
Mvvv 60,24,154
s_add_u32 s50, s76, 0xb0000
s_add_u32 m0, s52, 0xe700
s_nop 0
buffer_load_dwordx4 v10, s[24:27], s50 offen lds
Mvav 160,32,138
s_add_u32 m0, s52, 0xeb20
s_nop 0
buffer_load_dwordx4 v11, s[24:27], s50 offen lds
Mvav 168,32,146
buffer_load_dwordx4 a[168:171], v12, s[20:23], s51 offen offset:1024 sc1
Mvav 176,32,154
buffer_load_dwordx4 a[160:163], v21, s[20:23], s51 offen sc1
Mvav 180,36,154
buffer_load_dwordx4 a[172:175], v21, s[20:23], s51 offen offset:1024 sc1
Mvav 172,36,146
s_add_u32 s51, s82, 0x16000
buffer_load_dwordx4 a[176:179], v20, s[20:23], s51 offen sc1
Mvav 164,36,138
buffer_load_dwordx4 a[188:191], v20, s[20:23], s51 offen offset:1024 sc1
Mvav 184,40,138
buffer_load_dwordx4 a[180:183], v12, s[20:23], s51 offen sc1
Mvav 192,40,146
buffer_load_dwordx4 a[192:195], v12, s[20:23], s51 offen offset:1024 sc1
Mvav 200,40,154
buffer_load_dwordx4 a[184:187], v21, s[20:23], s51 offen sc1
Mvav 204,44,154
buffer_load_dwordx4 a[196:199], v21, s[20:23], s51 offen offset:1024 sc1
Mvav 196,44,146
v_add_u32 v14, 0x14a00, v17
Mvav 188,44,138
s_waitcnt vmcnt(56) lgkmcnt(0)
s_barrier
Mvav 208,48,138
TR 0,14,0
Mvav 216,48,146
TR 2,14,512
Mvav 224,48,154
TR 4,14,32
Mvav 228,52,154
TR 6,14,544
Mvav 220,52,146
TR 8,14,64
Mvav 212,52,138
TR 10,14,576
Mvav 232,56,138
TR 12,14,96
Mvav 240,56,146
TR 14,14,608
Mvav 248,56,154
TR 16,14,128
Mvav 252,60,154
TR 18,14,640
Mvav 244,60,146
TR 20,14,160
Mvav 236,60,138
TR 22,14,672
s_mov_b32 s41, 0x47800000
v_add_f32 v3, v52, v56
v_add_f32 v3, v60, v3
v_cmp_nge_f32 vcc, s41, v3
v_rcp_f32 v32, v52
v_rcp_f32 v34, v56
v_rcp_f32 v36, v60
s_cbranch_vccnz fh_slow1
fh_norm1:
v_pk_mul_f32 v[160:161], v[160:161], v[32:33] op_sel_hi:[1,0]
v_pk_mul_f32 v[162:163], v[162:163], v[32:33] op_sel_hi:[1,0]
v_pk_mul_f32 v[164:165], v[164:165], v[32:33] op_sel_hi:[1,0]
v_pk_mul_f32 v[166:167], v[166:167], v[32:33] op_sel_hi:[1,0]
v_cvt_pk_bf16_f32 v112, v160, v161
v_cvt_pk_bf16_f32 v113, v162, v163
v_cvt_pk_bf16_f32 v114, v164, v165
v_cvt_pk_bf16_f32 v115, v166, v167
v_pk_mul_f32 v[184:185], v[184:185], v[32:33] op_sel_hi:[1,0]
v_pk_mul_f32 v[186:187], v[186:187], v[32:33] op_sel_hi:[1,0]
v_pk_mul_f32 v[188:189], v[188:189], v[32:33] op_sel_hi:[1,0]
v_pk_mul_f32 v[190:191], v[190:191], v[32:33] op_sel_hi:[1,0]
v_cvt_pk_bf16_f32 v124, v184, v185
v_cvt_pk_bf16_f32 v125, v186, v187
v_cvt_pk_bf16_f32 v126, v188, v189
v_cvt_pk_bf16_f32 v127, v190, v191
v_pk_mul_f32 v[208:209], v[208:209], v[32:33] op_sel_hi:[1,0]
v_pk_mul_f32 v[210:211], v[210:211], v[32:33] op_sel_hi:[1,0]
v_pk_mul_f32 v[212:213], v[212:213], v[32:33] op_sel_hi:[1,0]
v_pk_mul_f32 v[214:215], v[214:215], v[32:33] op_sel_hi:[1,0]
v_cvt_pk_bf16_f32 v136, v208, v209
v_cvt_pk_bf16_f32 v137, v210, v211
v_cvt_pk_bf16_f32 v138, v212, v213
v_cvt_pk_bf16_f32 v139, v214, v215
v_pk_mul_f32 v[232:233], v[232:233], v[32:33] op_sel_hi:[1,0]
v_pk_mul_f32 v[234:235], v[234:235], v[32:33] op_sel_hi:[1,0]
v_pk_mul_f32 v[236:237], v[236:237], v[32:33] op_sel_hi:[1,0]
v_pk_mul_f32 v[238:239], v[238:239], v[32:33] op_sel_hi:[1,0]
v_cvt_pk_bf16_f32 v148, v232, v233
v_cvt_pk_bf16_f32 v149, v234, v235
v_cvt_pk_bf16_f32 v150, v236, v237
v_cvt_pk_bf16_f32 v151, v238, v239
v_pk_mul_f32 v[168:169], v[168:169], v[34:35] op_sel_hi:[1,0]
v_pk_mul_f32 v[170:171], v[170:171], v[34:35] op_sel_hi:[1,0]
v_pk_mul_f32 v[172:173], v[172:173], v[34:35] op_sel_hi:[1,0]
v_pk_mul_f32 v[174:175], v[174:175], v[34:35] op_sel_hi:[1,0]
v_cvt_pk_bf16_f32 v116, v168, v169
v_cvt_pk_bf16_f32 v117, v170, v171
v_cvt_pk_bf16_f32 v118, v172, v173
v_cvt_pk_bf16_f32 v119, v174, v175
v_pk_mul_f32 v[192:193], v[192:193], v[34:35] op_sel_hi:[1,0]
v_pk_mul_f32 v[194:195], v[194:195], v[34:35] op_sel_hi:[1,0]
v_pk_mul_f32 v[196:197], v[196:197], v[34:35] op_sel_hi:[1,0]
v_pk_mul_f32 v[198:199], v[198:199], v[34:35] op_sel_hi:[1,0]
v_cvt_pk_bf16_f32 v128, v192, v193
v_cvt_pk_bf16_f32 v129, v194, v195
v_cvt_pk_bf16_f32 v130, v196, v197
v_cvt_pk_bf16_f32 v131, v198, v199
v_pk_mul_f32 v[216:217], v[216:217], v[34:35] op_sel_hi:[1,0]
v_pk_mul_f32 v[218:219], v[218:219], v[34:35] op_sel_hi:[1,0]
v_pk_mul_f32 v[220:221], v[220:221], v[34:35] op_sel_hi:[1,0]
v_pk_mul_f32 v[222:223], v[222:223], v[34:35] op_sel_hi:[1,0]
v_cvt_pk_bf16_f32 v140, v216, v217
v_cvt_pk_bf16_f32 v141, v218, v219
v_cvt_pk_bf16_f32 v142, v220, v221
v_cvt_pk_bf16_f32 v143, v222, v223
v_pk_mul_f32 v[240:241], v[240:241], v[34:35] op_sel_hi:[1,0]
v_pk_mul_f32 v[242:243], v[242:243], v[34:35] op_sel_hi:[1,0]
v_pk_mul_f32 v[244:245], v[244:245], v[34:35] op_sel_hi:[1,0]
v_pk_mul_f32 v[246:247], v[246:247], v[34:35] op_sel_hi:[1,0]
v_cvt_pk_bf16_f32 v152, v240, v241
v_cvt_pk_bf16_f32 v153, v242, v243
v_cvt_pk_bf16_f32 v154, v244, v245
v_cvt_pk_bf16_f32 v155, v246, v247
v_pk_mul_f32 v[176:177], v[176:177], v[36:37] op_sel_hi:[1,0]
v_pk_mul_f32 v[178:179], v[178:179], v[36:37] op_sel_hi:[1,0]
v_pk_mul_f32 v[180:181], v[180:181], v[36:37] op_sel_hi:[1,0]
v_pk_mul_f32 v[182:183], v[182:183], v[36:37] op_sel_hi:[1,0]
v_cvt_pk_bf16_f32 v120, v176, v177
v_cvt_pk_bf16_f32 v121, v178, v179
v_cvt_pk_bf16_f32 v122, v180, v181
v_cvt_pk_bf16_f32 v123, v182, v183
v_pk_mul_f32 v[200:201], v[200:201], v[36:37] op_sel_hi:[1,0]
v_pk_mul_f32 v[202:203], v[202:203], v[36:37] op_sel_hi:[1,0]
v_pk_mul_f32 v[204:205], v[204:205], v[36:37] op_sel_hi:[1,0]
v_pk_mul_f32 v[206:207], v[206:207], v[36:37] op_sel_hi:[1,0]
v_cvt_pk_bf16_f32 v132, v200, v201
v_cvt_pk_bf16_f32 v133, v202, v203
v_cvt_pk_bf16_f32 v134, v204, v205
v_cvt_pk_bf16_f32 v135, v206, v207
v_pk_mul_f32 v[224:225], v[224:225], v[36:37] op_sel_hi:[1,0]
v_pk_mul_f32 v[226:227], v[226:227], v[36:37] op_sel_hi:[1,0]
v_pk_mul_f32 v[228:229], v[228:229], v[36:37] op_sel_hi:[1,0]
v_pk_mul_f32 v[230:231], v[230:231], v[36:37] op_sel_hi:[1,0]
v_cvt_pk_bf16_f32 v144, v224, v225
v_cvt_pk_bf16_f32 v145, v226, v227
v_cvt_pk_bf16_f32 v146, v228, v229
v_cvt_pk_bf16_f32 v147, v230, v231
v_pk_mul_f32 v[248:249], v[248:249], v[36:37] op_sel_hi:[1,0]
v_pk_mul_f32 v[250:251], v[250:251], v[36:37] op_sel_hi:[1,0]
v_pk_mul_f32 v[252:253], v[252:253], v[36:37] op_sel_hi:[1,0]
v_pk_mul_f32 v[254:255], v[254:255], v[36:37] op_sel_hi:[1,0]
v_cvt_pk_bf16_f32 v156, v248, v249
v_cvt_pk_bf16_f32 v157, v250, v251
v_cvt_pk_bf16_f32 v158, v252, v253
v_cvt_pk_bf16_f32 v159, v254, v255
fh_u0:
s_waitcnt lgkmcnt(10)
Zvav 160,0,64
s_waitcnt lgkmcnt(8)
TR 24,14,192
Zvav 164,0,68
s_add_u32 s44, s78, 0xb000
TR 26,14,704
Zvav 168,0,72
buffer_store_dwordx4 v[112:115], v20, s[20:23], s44 offen sc1
Zvav 180,4,72
TR 28,14,224
Zvav 176,4,68
s_waitcnt lgkmcnt(9)
TR 30,14,736
Zvav 172,4,64
buffer_store_dwordx4 v[124:127], v20, s[20:23], s44 offen offset:1024 sc1
Zvav 184,8,64
TR 0,14,8448
Zvav 188,8,68
s_waitcnt lgkmcnt(9)
TR 2,14,8960
Zvav 192,8,72
buffer_store_dwordx4 v[116:119], v12, s[20:23], s44 offen sc1
Zvav 204,12,72
s_waitcnt lgkmcnt(8)
s_add_u32 s50, s76, 0x100000
TR 4,14,8480
Zvav 200,12,68
s_add_u32 m0, s52, 0x10800
TR 6,14,8992
Zvav 196,12,64
buffer_load_dwordx4 v10, s[24:27], s50 offen lds
Zvav 208,16,64
s_waitcnt lgkmcnt(8)
TR 8,14,8512
Zvav 212,16,68
s_add_u32 m0, s52, 0x10c20
TR 10,14,9024
Zvav 216,16,72
buffer_load_dwordx4 v11, s[24:27], s50 offen lds
Zvav 228,20,72
s_waitcnt lgkmcnt(8)
s_add_u32 s50, s76, 0x110000
TR 12,14,8544
Zvav 224,20,68
s_add_u32 m0, s52, 0x12900
TR 14,14,9056
Zvav 220,20,64
buffer_load_dwordx4 v10, s[24:27], s50 offen lds
Zvav 232,24,64
s_waitcnt lgkmcnt(8)
TR 16,14,8576
Zvav 236,24,68
s_add_u32 m0, s52, 0x12d20
TR 18,14,9088
Zvav 240,24,72
buffer_load_dwordx4 v11, s[24:27], s50 offen lds
Zvav 252,28,72
s_waitcnt lgkmcnt(8)
TR 20,14,8608
Zvav 248,28,68
s_add_u32 s51, s82, 0x1b800
TR 22,14,9120
Zvav 244,28,64
buffer_load_dwordx4 a[200:203], v20, s[20:23], s51 offen sc1
Mvav 160,0,76
TR 24,14,8640
Mvav 164,0,80
s_waitcnt lgkmcnt(9)
TR 26,14,9152
Mvav 168,0,84
buffer_load_dwordx4 a[212:215], v20, s[20:23], s51 offen offset:1024 sc1
Mvav 180,4,84
TR 28,14,8672
Mvav 176,4,80
s_waitcnt lgkmcnt(9)
TR 30,14,9184
Mvav 172,4,76
buffer_load_dwordx4 a[204:207], v12, s[20:23], s51 offen sc1
Mvav 184,8,76
buffer_load_dwordx4 a[216:219], v12, s[20:23], s51 offen offset:1024 sc1
Mvav 188,8,80
buffer_load_dwordx4 a[208:211], v21, s[20:23], s51 offen sc1
Mvav 192,8,84
s_waitcnt lgkmcnt(8)
Mvav 204,12,84
buffer_load_dwordx4 a[220:223], v21, s[20:23], s51 offen offset:1024 sc1
Mvav 200,12,80
v_add_u32 v14, 0x18c00, v17
Mvav 196,12,76
s_waitcnt vmcnt(62) lgkmcnt(0)
s_barrier
Mvav 208,16,76
TR 0,14,0
Mvav 212,16,80
TR 2,14,512
Mvav 216,16,84
TR 4,14,32
Mvav 228,20,84
TR 6,14,544
Mvav 224,20,80
TR 8,14,64
Mvav 220,20,76
TR 10,14,576
Mvav 232,24,76
TR 12,14,96
Mvav 236,24,80
TR 14,14,608
Mvav 240,24,84
TR 16,14,128
Mvav 252,28,84
TR 18,14,640
Mvav 248,28,80
TR 20,14,160
Mvav 244,28,76
s_waitcnt lgkmcnt(9)
TR 22,14,672
fh_u1:
Mvav 160,0,88
TR 24,14,192
Mvav 164,0,92
s_waitcnt lgkmcnt(9)
TR 26,14,704
Mvav 168,0,96
buffer_store_dwordx4 v[128:131], v12, s[20:23], s44 offen offset:1024 sc1
Mvav 180,4,96
TR 28,14,224
Mvav 176,4,92
s_waitcnt lgkmcnt(9)
TR 30,14,736
Mvav 172,4,88
buffer_store_dwordx4 v[120:123], v21, s[20:23], s44 offen sc1
Mvav 184,8,88
TR 0,14,8448
Mvav 188,8,92
s_waitcnt lgkmcnt(9)
TR 2,14,8960
Mvav 192,8,96
buffer_store_dwordx4 v[132:135], v21, s[20:23], s44 offen offset:1024 sc1
Mvav 204,12,96
s_waitcnt lgkmcnt(8)
s_add_u32 s50, s76, 0x120000
TR 4,14,8480
Mvav 200,12,92
s_add_u32 m0, s52, 0x14a00
TR 6,14,8992
Mvav 196,12,88
buffer_load_dwordx4 v10, s[24:27], s50 offen lds
Mvav 208,16,88
s_waitcnt lgkmcnt(8)
TR 8,14,8512
Mvav 212,16,92
s_add_u32 m0, s52, 0x14e20
TR 10,14,9024
Mvav 216,16,96
buffer_load_dwordx4 v11, s[24:27], s50 offen lds
Mvav 228,20,96
s_waitcnt lgkmcnt(8)
s_add_u32 s50, s76, 0x130000
TR 12,14,8544
Mvav 224,20,92
s_branch f_pad16s
f_pad16:
s_setpc_b64 s[70:71]
f_pad16s:
s_add_u32 m0, s52, 0x16b00
TR 14,14,9056
Mvav 220,20,88
buffer_load_dwordx4 v10, s[24:27], s50 offen lds
Mvav 232,24,88
s_waitcnt lgkmcnt(8)
TR 16,14,8576
Mvav 236,24,92
s_add_u32 m0, s52, 0x16f20
TR 18,14,9088
Mvav 240,24,96
buffer_load_dwordx4 v11, s[24:27], s50 offen lds
Mvav 252,28,96
s_waitcnt lgkmcnt(8)
TR 20,14,8608
Mvav 248,28,92
s_add_u32 s51, s82, 0x2c000
TR 22,14,9120
Mvav 244,28,88
buffer_load_dwordx4 a[224:227], v20, s[20:23], s51 offen sc1
Mvav 160,0,100
TR 24,14,8640
Mvav 164,0,104
s_waitcnt lgkmcnt(9)
TR 26,14,9152
Mvav 168,0,108
buffer_load_dwordx4 a[236:239], v20, s[20:23], s51 offen offset:1024 sc1
Mvav 180,4,108
TR 28,14,8672
Mvav 176,4,104
s_waitcnt lgkmcnt(9)
TR 30,14,9184
Mvav 172,4,100
buffer_load_dwordx4 a[228:231], v12, s[20:23], s51 offen sc1
Mvav 184,8,100
buffer_load_dwordx4 a[240:243], v12, s[20:23], s51 offen offset:1024 sc1
Mvav 188,8,104
buffer_load_dwordx4 a[232:235], v21, s[20:23], s51 offen sc1
Mvav 192,8,108
s_waitcnt lgkmcnt(8)
Mvav 204,12,108
buffer_load_dwordx4 a[244:247], v21, s[20:23], s51 offen offset:1024 sc1
Mvav 200,12,104
v_add_u32 v14, 0x1ce00, v17
Mvav 196,12,100
s_waitcnt vmcnt(63) lgkmcnt(0)
s_barrier
Mvav 208,16,100
TR 0,14,0
Mvav 212,16,104
TR 2,14,512
Mvav 216,16,108
TR 4,14,32
Mvav 228,20,108
TR 6,14,544
Mvav 224,20,104
TR 8,14,64
Mvav 220,20,100
TR 10,14,576
Mvav 232,24,100
TR 12,14,96
Mvav 236,24,104
TR 14,14,608
Mvav 240,24,108
TR 16,14,128
Mvav 252,28,108
TR 18,14,640
Mvav 248,28,104
TR 20,14,160
Mvav 244,28,100
s_waitcnt lgkmcnt(9)
TR 22,14,672
fh_u2:
Mvav 160,0,112
s_waitcnt lgkmcnt(8)
s_add_u32 s50, s76, 0x180000
TR 24,14,192
Mvav 164,0,116
s_add_u32 m0, s52, 0x18c00
TR 26,14,704
Mvav 168,0,120
buffer_load_dwordx4 v10, s[24:27], s50 offen lds
Mvav 180,4,120
s_waitcnt lgkmcnt(8)
TR 28,14,224
Mvav 176,4,116
s_add_u32 m0, s52, 0x19020
TR 30,14,736
Mvav 172,4,112
buffer_load_dwordx4 v11, s[24:27], s50 offen lds
Mvav 184,8,112
s_waitcnt lgkmcnt(8)
s_add_u32 s50, s76, 0x190000
TR 0,14,8448
Mvav 188,8,116
s_add_u32 m0, s52, 0x1ad00
TR 2,14,8960
Mvav 192,8,120
buffer_load_dwordx4 v10, s[24:27], s50 offen lds
Mvav 204,12,120
s_waitcnt lgkmcnt(8)
TR 4,14,8480
Mvav 200,12,116
s_add_u32 m0, s52, 0x1b120
TR 6,14,8992
Mvav 196,12,112
buffer_load_dwordx4 v11, s[24:27], s50 offen lds
Mvav 208,16,112
s_waitcnt lgkmcnt(8)
TR 8,14,8512
Mvav 212,16,116
s_add_u32 s51, s82, 0x31800
TR 10,14,9024
Mvav 216,16,120
buffer_load_dwordx4 a[80:83], v20, s[20:23], s51 offen sc1
Mvav 228,20,120
TR 12,14,8544
Mvav 224,20,116
s_waitcnt lgkmcnt(9)
TR 14,14,9056
Mvav 220,20,112
buffer_load_dwordx4 a[92:95], v20, s[20:23], s51 offen offset:1024 sc1
Mvav 232,24,112
TR 16,14,8576
Mvav 236,24,116
s_waitcnt lgkmcnt(9)
TR 18,14,9088
Mvav 240,24,120
buffer_load_dwordx4 a[84:87], v12, s[20:23], s51 offen sc1
Mvav 252,28,120
TR 20,14,8608
Mvav 248,28,116
s_waitcnt lgkmcnt(9)
TR 22,14,9120
Mvav 244,28,112
buffer_load_dwordx4 a[96:99], v12, s[20:23], s51 offen offset:1024 sc1
Mvav 160,0,124
TR 24,14,8640
Mvav 164,0,128
s_waitcnt lgkmcnt(9)
TR 26,14,9152
Mvav 168,0,132
buffer_load_dwordx4 a[88:91], v21, s[20:23], s51 offen sc1
Mvav 180,4,132
TR 28,14,8672
Mvav 176,4,128
s_waitcnt lgkmcnt(9)
TR 30,14,9184
Mvav 172,4,124
buffer_load_dwordx4 a[100:103], v21, s[20:23], s51 offen offset:1024 sc1
Mvav 184,8,124
Mvav 188,8,128
Mvav 192,8,132
s_waitcnt lgkmcnt(8)
Mvav 204,12,132
Mvav 200,12,128
v_add_u32 v14, 0x21000, v17
Mvav 196,12,124
s_waitcnt vmcnt(63) lgkmcnt(0)
s_barrier
Mvav 208,16,124
TR 0,14,0
Mvav 212,16,128
TR 2,14,512
Mvav 216,16,132
TR 4,14,32
Mvav 228,20,132
TR 6,14,544
Mvav 224,20,128
TR 8,14,64
Mvav 220,20,124
TR 10,14,576
Mvav 232,24,124
TR 12,14,96
Mvav 236,24,128
TR 14,14,608
Mvav 240,24,132
TR 16,14,128
Mvav 252,28,132
TR 18,14,640
Mvav 248,28,128
TR 20,14,160
Mvav 244,28,124
s_waitcnt lgkmcnt(9)
TR 22,14,672
fh_u3:
Mvav 160,0,136
s_waitcnt lgkmcnt(8)
TR 24,14,192
Mvav 164,0,140
s_add_u32 s44, s78, 0x10800
TR 26,14,704
Mvav 168,0,144
buffer_store_dwordx4 v[136:139], v20, s[20:23], s44 offen sc1
Mvav 180,4,144
TR 28,14,224
Mvav 176,4,140
s_waitcnt lgkmcnt(9)
TR 30,14,736
Mvav 172,4,136
buffer_store_dwordx4 v[148:151], v20, s[20:23], s44 offen offset:1024 sc1
Mvav 184,8,136
TR 0,14,8448
Mvav 188,8,140
s_waitcnt lgkmcnt(9)
TR 2,14,8960
Mvav 192,8,144
buffer_store_dwordx4 v[140:143], v12, s[20:23], s44 offen sc1
Mvav 204,12,144
s_waitcnt lgkmcnt(8)
s_add_u32 s50, s76, 0x1a0000
TR 4,14,8480
Mvav 200,12,140
s_add_u32 m0, s52, 0x1ce00
TR 6,14,8992
Mvav 196,12,136
buffer_load_dwordx4 v10, s[24:27], s50 offen lds
Mvav 208,16,136
s_waitcnt lgkmcnt(8)
TR 8,14,8512
Mvav 212,16,140
s_add_u32 m0, s52, 0x1d220
TR 10,14,9024
Mvav 216,16,144
buffer_load_dwordx4 v11, s[24:27], s50 offen lds
Mvav 228,20,144
s_waitcnt lgkmcnt(8)
s_add_u32 s50, s76, 0x1b0000
TR 12,14,8544
Mvav 224,20,140
s_add_u32 m0, s52, 0x1ef00
TR 14,14,9056
Mvav 220,20,136
buffer_load_dwordx4 v10, s[24:27], s50 offen lds
Mvav 232,24,136
s_waitcnt lgkmcnt(8)
TR 16,14,8576
Mvav 236,24,140
s_add_u32 m0, s52, 0x1f320
TR 18,14,9088
Mvav 240,24,144
buffer_load_dwordx4 v11, s[24:27], s50 offen lds
Mvav 252,28,144
s_waitcnt lgkmcnt(8)
TR 20,14,8608
Mvav 248,28,140
s_add_u32 s51, s82, 0x42000
TR 22,14,9120
Mvav 244,28,136
buffer_load_dwordx4 a[104:107], v20, s[20:23], s51 offen sc1
Mvav 160,0,148
TR 24,14,8640
Mvav 164,0,152
s_waitcnt lgkmcnt(9)
TR 26,14,9152
Mvav 168,0,156
buffer_load_dwordx4 a[116:119], v20, s[20:23], s51 offen offset:1024 sc1
Mvav 180,4,156
TR 28,14,8672
Mvav 176,4,152
s_waitcnt lgkmcnt(9)
TR 30,14,9184
Mvav 172,4,148
buffer_load_dwordx4 a[108:111], v12, s[20:23], s51 offen sc1
Mvav 184,8,148
buffer_load_dwordx4 a[120:123], v12, s[20:23], s51 offen offset:1024 sc1
Mvav 188,8,152
buffer_load_dwordx4 a[112:115], v21, s[20:23], s51 offen sc1
Mvav 192,8,156
s_waitcnt lgkmcnt(8)
Mvav 204,12,156
buffer_load_dwordx4 a[124:127], v21, s[20:23], s51 offen offset:1024 sc1
Mvav 200,12,152
v_add_u32 v14, 0, v17
Mvav 196,12,148
s_waitcnt vmcnt(63) lgkmcnt(0)
s_barrier
Mvav 208,16,148
TR 0,14,0
Mvav 212,16,152
TR 2,14,512
Mvav 216,16,156
TR 4,14,32
Mvav 228,20,156
TR 6,14,544
Mvav 224,20,152
TR 8,14,64
Mvav 220,20,148
TR 10,14,576
Mvav 232,24,148
TR 12,14,96
Mvav 236,24,152
TR 14,14,608
Mvav 240,24,156
TR 16,14,128
Mvav 252,28,156
TR 18,14,640
Mvav 248,28,152
TR 20,14,160
Mvav 244,28,148
s_waitcnt lgkmcnt(9)
TR 22,14,672
fh_u4:
Mvaa 160,0,128
s_waitcnt lgkmcnt(8)
s_add_u32 s50, s73, 0
TR 24,14,192
Mvaa 164,0,132
s_add_u32 m0, s52, 0x21000
TR 26,14,704
Mvaa 168,0,136
buffer_load_dwordx4 v10, s[24:27], s50 offen lds
Mvaa 180,4,136
s_waitcnt lgkmcnt(8)
TR 28,14,224
Mvaa 176,4,132
s_add_u32 m0, s52, 0x21420
TR 30,14,736
Mvaa 172,4,128
buffer_load_dwordx4 v11, s[24:27], s50 offen lds
Mvaa 184,8,128
s_waitcnt lgkmcnt(8)
s_add_u32 s50, s73, 0x10000
TR 0,14,8448
Mvaa 188,8,132
s_add_u32 m0, s52, 0x23100
TR 2,14,8960
Mvaa 192,8,136
buffer_load_dwordx4 v10, s[24:27], s50 offen lds
Mvaa 204,12,136
s_waitcnt lgkmcnt(8)
TR 4,14,8480
Mvaa 200,12,132
s_add_u32 m0, s52, 0x23520
TR 6,14,8992
Mvaa 196,12,128
buffer_load_dwordx4 v11, s[24:27], s50 offen lds
Mvaa 208,16,128
s_waitcnt lgkmcnt(8)
TR 8,14,8512
Mvaa 212,16,132
s_add_u32 s51, s82, 0x47800
TR 10,14,9024
Mvaa 216,16,136
buffer_load_dwordx4 a[32:35], v20, s[20:23], s51 offen sc1
Mvaa 228,20,136
TR 12,14,8544
Mvaa 224,20,132
s_waitcnt lgkmcnt(9)
TR 14,14,9056
Mvaa 220,20,128
buffer_load_dwordx4 a[44:47], v20, s[20:23], s51 offen offset:1024 sc1
Mvaa 232,24,128
TR 16,14,8576
Mvaa 236,24,132
s_waitcnt lgkmcnt(9)
TR 18,14,9088
Mvaa 240,24,136
buffer_load_dwordx4 a[36:39], v12, s[20:23], s51 offen sc1
Mvaa 252,28,136
TR 20,14,8608
Mvaa 248,28,132
s_waitcnt lgkmcnt(9)
TR 22,14,9120
Mvaa 244,28,128
buffer_load_dwordx4 a[48:51], v12, s[20:23], s51 offen offset:1024 sc1
Mvaa 160,0,140
TR 24,14,8640
Mvaa 164,0,144
s_waitcnt lgkmcnt(9)
TR 26,14,9152
Mvaa 168,0,148
buffer_load_dwordx4 a[40:43], v21, s[20:23], s51 offen sc1
Mvaa 180,4,148
TR 28,14,8672
Mvaa 176,4,144
s_waitcnt lgkmcnt(9)
TR 30,14,9184
Mvaa 172,4,140
buffer_load_dwordx4 a[52:55], v21, s[20:23], s51 offen offset:1024 sc1
Mvaa 184,8,140
Mvaa 188,8,144
Mvaa 192,8,148
s_waitcnt lgkmcnt(8)
Mvaa 204,12,148
Mvaa 200,12,144
v_add_u32 v14, 0x4200, v17
Mvaa 196,12,140
s_waitcnt vmcnt(63) lgkmcnt(0)
s_barrier
Mvaa 208,16,140
TR 0,14,0
Mvaa 212,16,144
TR 2,14,512
Mvaa 216,16,148
TR 4,14,32
Mvaa 228,20,148
TR 6,14,544
Mvaa 224,20,144
TR 8,14,64
Mvaa 220,20,140
TR 10,14,576
Mvaa 232,24,140
TR 12,14,96
Mvaa 236,24,144
TR 14,14,608
Mvaa 240,24,148
TR 16,14,128
Mvaa 252,28,148
TR 18,14,640
Mvaa 248,28,144
TR 20,14,160
Mvaa 244,28,140
s_waitcnt lgkmcnt(9)
TR 22,14,672
fh_u5:
Mvaa 160,0,152
TR 24,14,192
Mvaa 164,0,156
s_waitcnt lgkmcnt(9)
TR 26,14,704
Mvaa 168,0,160
buffer_store_dwordx4 v[152:155], v12, s[20:23], s44 offen offset:1024 sc1
Mvaa 180,4,160
TR 28,14,224
Mvaa 176,4,156
s_waitcnt lgkmcnt(9)
TR 30,14,736
Mvaa 172,4,152
buffer_store_dwordx4 v[144:147], v21, s[20:23], s44 offen sc1
Mvaa 184,8,152
TR 0,14,8448
Mvaa 188,8,156
s_waitcnt lgkmcnt(9)
TR 2,14,8960
Mvaa 192,8,160
buffer_store_dwordx4 v[156:159], v21, s[20:23], s44 offen offset:1024 sc1
Mvaa 204,12,160
s_waitcnt lgkmcnt(8)
s_add_u32 s50, s73, 0x20000
TR 4,14,8480
Mvaa 200,12,156
s_add_u32 m0, s52, 0
TR 6,14,8992
Mvaa 196,12,152
buffer_load_dwordx4 v10, s[24:27], s50 offen lds
Mvaa 208,16,152
s_waitcnt lgkmcnt(8)
TR 8,14,8512
Mvaa 212,16,156
s_add_u32 m0, s52, 0x420
TR 10,14,9024
Mvaa 216,16,160
buffer_load_dwordx4 v11, s[24:27], s50 offen lds
Mvaa 228,20,160
s_waitcnt lgkmcnt(8)
s_add_u32 s50, s73, 0x30000
TR 12,14,8544
Mvaa 224,20,156
s_add_u32 m0, s52, 0x2100
TR 14,14,9056
Mvaa 220,20,152
buffer_load_dwordx4 v10, s[24:27], s50 offen lds
Mvaa 232,24,152
s_waitcnt lgkmcnt(8)
TR 16,14,8576
Mvaa 236,24,156
s_add_u32 m0, s52, 0x2520
TR 18,14,9088
Mvaa 240,24,160
buffer_load_dwordx4 v11, s[24:27], s50 offen lds
Mvaa 252,28,160
s_waitcnt lgkmcnt(8)
TR 20,14,8608
Mvaa 248,28,156
s_add_u32 s51, s79, 0
TR 22,14,9120
Mvaa 244,28,152
buffer_load_dwordx4 a[128:131], v20, s[20:23], s51 offen sc1
Mvaa 160,0,164
TR 24,14,8640
Mvaa 164,0,168
s_waitcnt lgkmcnt(9)
TR 26,14,9152
Mvaa 168,0,172
buffer_load_dwordx4 a[140:143], v20, s[20:23], s51 offen offset:1024 sc1
Mvaa 180,4,172
TR 28,14,8672
Mvaa 176,4,168
s_waitcnt lgkmcnt(9)
TR 30,14,9184
Mvaa 172,4,164
buffer_load_dwordx4 a[132:135], v12, s[20:23], s51 offen sc1
Mvaa 184,8,164
buffer_load_dwordx4 a[144:147], v12, s[20:23], s51 offen offset:1024 sc1
Mvaa 188,8,168
buffer_load_dwordx4 a[136:139], v21, s[20:23], s51 offen sc1
Mvaa 192,8,172
s_waitcnt lgkmcnt(8)
Mvaa 204,12,172
buffer_load_dwordx4 a[148:151], v21, s[20:23], s51 offen offset:1024 sc1
Mvaa 200,12,168
v_add_u32 v14, 0x8400, v17
Mvaa 196,12,164
s_waitcnt vmcnt(63) lgkmcnt(0)
s_barrier
Mvaa 208,16,164
TR 0,14,0
Mvaa 212,16,168
TR 2,14,512
Mvaa 216,16,172
TR 4,14,32
Mvaa 228,20,172
TR 6,14,544
Mvaa 224,20,168
TR 8,14,64
Mvaa 220,20,164
TR 10,14,576
Mvaa 232,24,164
TR 12,14,96
Mvaa 236,24,168
TR 14,14,608
Mvaa 240,24,172
TR 16,14,128
Mvaa 252,28,172
TR 18,14,640
Mvaa 248,28,168
TR 20,14,160
Mvaa 244,28,164
s_waitcnt lgkmcnt(9)
TR 22,14,672
fh_u6:
Mvaa 160,0,176
s_waitcnt lgkmcnt(8)
s_add_u32 s50, s74, 0
TR 24,14,192
Mvaa 164,0,180
s_add_u32 m0, s52, 0x4200
TR 26,14,704
Mvaa 168,0,184
buffer_load_dwordx4 v10, s[24:27], s50 offen lds
Mvaa 180,4,184
s_waitcnt lgkmcnt(8)
TR 28,14,224
Mvaa 176,4,180
s_add_u32 m0, s52, 0x4620
TR 30,14,736
Mvaa 172,4,176
buffer_load_dwordx4 v11, s[24:27], s50 offen lds
Mvaa 184,8,176
s_waitcnt lgkmcnt(8)
s_add_u32 s50, s74, 0x10000
TR 0,14,8448
Mvaa 188,8,180
s_branch f_pad17s
f_pad17:
s_setpc_b64 s[70:71]
f_pad17s:
s_add_u32 m0, s52, 0x6300
TR 2,14,8960
Mvaa 192,8,184
buffer_load_dwordx4 v10, s[24:27], s50 offen lds
Mvaa 204,12,184
s_waitcnt lgkmcnt(8)
TR 4,14,8480
Mvaa 200,12,180
s_add_u32 m0, s52, 0x6720
TR 6,14,8992
Mvaa 196,12,176
buffer_load_dwordx4 v11, s[24:27], s50 offen lds
Mvaa 208,16,176
s_waitcnt lgkmcnt(8)
TR 8,14,8512
Mvaa 212,16,180
s_add_u32 s51, s79, 0x5800
TR 10,14,9024
Mvaa 216,16,184
buffer_load_dwordx4 a[152:155], v20, s[20:23], s51 offen sc1
Mvaa 228,20,184
TR 12,14,8544
Mvaa 224,20,180
s_waitcnt lgkmcnt(9)
TR 14,14,9056
Mvaa 220,20,176
buffer_load_dwordx4 a[164:167], v20, s[20:23], s51 offen offset:1024 sc1
Mvaa 232,24,176
TR 16,14,8576
Mvaa 236,24,180
s_waitcnt lgkmcnt(9)
TR 18,14,9088
Mvaa 240,24,184
buffer_load_dwordx4 a[156:159], v12, s[20:23], s51 offen sc1
Mvaa 252,28,184
TR 20,14,8608
Mvaa 248,28,180
s_waitcnt lgkmcnt(9)
TR 22,14,9120
Mvaa 244,28,176
buffer_load_dwordx4 a[168:171], v12, s[20:23], s51 offen offset:1024 sc1
Mvaa 160,0,188
TR 24,14,8640
Mvaa 164,0,192
s_waitcnt lgkmcnt(9)
TR 26,14,9152
Mvaa 168,0,196
buffer_load_dwordx4 a[160:163], v21, s[20:23], s51 offen sc1
Mvaa 180,4,196
TR 28,14,8672
Mvaa 176,4,192
s_waitcnt lgkmcnt(9)
TR 30,14,9184
Mvaa 172,4,188
buffer_load_dwordx4 a[172:175], v21, s[20:23], s51 offen offset:1024 sc1
Mvaa 184,8,188
Mvaa 188,8,192
Mvaa 192,8,196
s_waitcnt lgkmcnt(8)
Mvaa 204,12,196
Mvaa 200,12,192
v_add_u32 v14, 0xc600, v17
Mvaa 196,12,188
s_waitcnt vmcnt(63) lgkmcnt(0)
s_barrier
Mvaa 208,16,188
TR 0,14,0
Mvaa 212,16,192
TR 2,14,512
Mvaa 216,16,196
TR 4,14,32
Mvaa 228,20,196
TR 6,14,544
Mvaa 224,20,192
TR 8,14,64
Mvaa 220,20,188
TR 10,14,576
Mvaa 232,24,188
TR 12,14,96
Mvaa 236,24,192
TR 14,14,608
Mvaa 240,24,196
TR 16,14,128
Mvaa 252,28,196
TR 18,14,640
Mvaa 248,28,192
TR 20,14,160
Mvaa 244,28,188
s_waitcnt lgkmcnt(9)
TR 22,14,672
fh_u7:
Mvaa 160,0,200
s_waitcnt lgkmcnt(8)
s_add_u32 s50, s74, 0x20000
TR 24,14,192
Mvaa 164,0,204
s_add_u32 m0, s52, 0x8400
TR 26,14,704
Mvaa 168,0,208
buffer_load_dwordx4 v10, s[24:27], s50 offen lds
Mvaa 180,4,208
s_waitcnt lgkmcnt(8)
TR 28,14,224
Mvaa 176,4,204
s_add_u32 m0, s52, 0x8820
TR 30,14,736
Mvaa 172,4,200
buffer_load_dwordx4 v11, s[24:27], s50 offen lds
Mvaa 184,8,200
s_waitcnt lgkmcnt(8)
s_add_u32 s50, s74, 0x30000
TR 0,14,8448
Mvaa 188,8,204
s_add_u32 m0, s52, 0xa500
TR 2,14,8960
Mvaa 192,8,208
buffer_load_dwordx4 v10, s[24:27], s50 offen lds
Mvaa 204,12,208
s_waitcnt lgkmcnt(8)
TR 4,14,8480
Mvaa 200,12,204
s_add_u32 m0, s52, 0xa920
TR 6,14,8992
Mvaa 196,12,200
buffer_load_dwordx4 v11, s[24:27], s50 offen lds
Mvaa 208,16,200
s_waitcnt lgkmcnt(8)
TR 8,14,8512
Mvaa 212,16,204
s_add_u32 s51, s80, 0
TR 10,14,9024
Mvaa 216,16,208
buffer_load_dwordx4 a[176:179], v20, s[20:23], s51 offen sc1
Mvaa 228,20,208
TR 12,14,8544
Mvaa 224,20,204
s_waitcnt lgkmcnt(9)
TR 14,14,9056
Mvaa 220,20,200
buffer_load_dwordx4 a[188:191], v20, s[20:23], s51 offen offset:1024 sc1
Mvaa 232,24,200
TR 16,14,8576
Mvaa 236,24,204
s_waitcnt lgkmcnt(9)
TR 18,14,9088
Mvaa 240,24,208
buffer_load_dwordx4 a[180:183], v12, s[20:23], s51 offen sc1
Mvaa 252,28,208
TR 20,14,8608
Mvaa 248,28,204
s_waitcnt lgkmcnt(9)
TR 22,14,9120
Mvaa 244,28,200
buffer_load_dwordx4 a[192:195], v12, s[20:23], s51 offen offset:1024 sc1
Mvaa 160,0,212
TR 24,14,8640
Mvaa 164,0,216
s_waitcnt lgkmcnt(9)
TR 26,14,9152
Mvaa 168,0,220
buffer_load_dwordx4 a[184:187], v21, s[20:23], s51 offen sc1
Mvaa 180,4,220
TR 28,14,8672
Mvaa 176,4,216
s_waitcnt lgkmcnt(9)
TR 30,14,9184
Mvaa 172,4,212
buffer_load_dwordx4 a[196:199], v21, s[20:23], s51 offen offset:1024 sc1
Mvaa 184,8,212
Mvaa 188,8,216
Mvaa 192,8,220
s_waitcnt lgkmcnt(8)
Mvaa 204,12,220
Mvaa 200,12,216
v_add_u32 v14, 0x10800, v17
Mvaa 196,12,212
s_waitcnt vmcnt(63) lgkmcnt(0)
s_barrier
Mvaa 208,16,212
TR 0,14,0
Mvaa 212,16,216
TR 2,14,512
Mvaa 216,16,220
TR 4,14,32
Mvaa 228,20,220
TR 6,14,544
Mvaa 224,20,216
TR 8,14,64
Mvaa 220,20,212
TR 10,14,576
Mvaa 232,24,212
TR 12,14,96
Mvaa 236,24,216
TR 14,14,608
Mvaa 240,24,220
TR 16,14,128
Mvaa 252,28,220
TR 18,14,640
Mvaa 248,28,216
TR 20,14,160
Mvaa 244,28,212
s_waitcnt lgkmcnt(9)
TR 22,14,672
fh_u8:
Mvaa 160,0,224
s_waitcnt lgkmcnt(8)
s_add_u32 s50, s75, 0
TR 24,14,192
Mvaa 164,0,228
s_add_u32 m0, s52, 0xc600
TR 26,14,704
Mvaa 168,0,232
buffer_load_dwordx4 v10, s[24:27], s50 offen lds
Mvaa 180,4,232
s_waitcnt lgkmcnt(8)
TR 28,14,224
Mvaa 176,4,228
s_add_u32 m0, s52, 0xca20
TR 30,14,736
Mvaa 172,4,224
buffer_load_dwordx4 v11, s[24:27], s50 offen lds
Mvaa 184,8,224
s_waitcnt lgkmcnt(8)
s_add_u32 s50, s75, 0x10000
TR 0,14,8448
Mvaa 188,8,228
s_add_u32 m0, s52, 0xe700
TR 2,14,8960
Mvaa 192,8,232
buffer_load_dwordx4 v10, s[24:27], s50 offen lds
Mvaa 204,12,232
s_waitcnt lgkmcnt(8)
TR 4,14,8480
Mvaa 200,12,228
s_add_u32 m0, s52, 0xeb20
TR 6,14,8992
Mvaa 196,12,224
buffer_load_dwordx4 v11, s[24:27], s50 offen lds
Mvaa 208,16,224
s_waitcnt lgkmcnt(8)
TR 8,14,8512
Mvaa 212,16,228
s_add_u32 s51, s80, 0x5800
TR 10,14,9024
Mvaa 216,16,232
buffer_load_dwordx4 a[200:203], v20, s[20:23], s51 offen sc1
Mvaa 228,20,232
TR 12,14,8544
Mvaa 224,20,228
s_waitcnt lgkmcnt(9)
TR 14,14,9056
Mvaa 220,20,224
buffer_load_dwordx4 a[212:215], v20, s[20:23], s51 offen offset:1024 sc1
Mvaa 232,24,224
TR 16,14,8576
Mvaa 236,24,228
s_waitcnt lgkmcnt(9)
TR 18,14,9088
Mvaa 240,24,232
buffer_load_dwordx4 a[204:207], v12, s[20:23], s51 offen sc1
Mvaa 252,28,232
TR 20,14,8608
Mvaa 248,28,228
s_waitcnt lgkmcnt(9)
TR 22,14,9120
Mvaa 244,28,224
buffer_load_dwordx4 a[216:219], v12, s[20:23], s51 offen offset:1024 sc1
Mvaa 160,0,236
TR 24,14,8640
Mvaa 164,0,240
s_waitcnt lgkmcnt(9)
TR 26,14,9152
Mvaa 168,0,244
buffer_load_dwordx4 a[208:211], v21, s[20:23], s51 offen sc1
Mvaa 180,4,244
TR 28,14,8672
Mvaa 176,4,240
s_waitcnt lgkmcnt(9)
TR 30,14,9184
Mvaa 172,4,236
buffer_load_dwordx4 a[220:223], v21, s[20:23], s51 offen offset:1024 sc1
Mvaa 184,8,236
Mvaa 188,8,240
Mvaa 192,8,244
s_waitcnt lgkmcnt(8)
Mvaa 204,12,244
Mvaa 200,12,240
v_add_u32 v14, 0x14a00, v17
Mvaa 196,12,236
s_waitcnt vmcnt(40) lgkmcnt(0)
s_barrier
Mvaa 208,16,236
TR 0,14,0
Mvaa 212,16,240
TR 2,14,512
Mvaa 216,16,244
TR 4,14,32
Mvaa 228,20,244
TR 6,14,544
Mvaa 224,20,240
TR 8,14,64
Mvaa 220,20,236
TR 10,14,576
Mvaa 232,24,236
TR 12,14,96
Mvaa 236,24,240
TR 14,14,608
Mvaa 240,24,244
TR 16,14,128
Mvaa 252,28,244
TR 18,14,640
Mvaa 248,28,240
TR 20,14,160
Mvaa 244,28,236
s_waitcnt lgkmcnt(9)
TR 22,14,672
fh_u9:
Mvaa 160,0,80
s_waitcnt lgkmcnt(8)
s_add_u32 s50, s75, 0x20000
TR 24,14,192
Mvaa 164,0,84
s_add_u32 m0, s52, 0x10800
TR 26,14,704
Mvaa 168,0,88
buffer_load_dwordx4 v10, s[24:27], s50 offen lds
Mvaa 180,4,88
s_waitcnt lgkmcnt(8)
TR 28,14,224
Mvaa 176,4,84
s_add_u32 m0, s52, 0x10c20
TR 30,14,736
Mvaa 172,4,80
buffer_load_dwordx4 v11, s[24:27], s50 offen lds
Mvaa 184,8,80
s_waitcnt lgkmcnt(8)
s_add_u32 s50, s75, 0x30000
TR 0,14,8448
Mvaa 188,8,84
s_add_u32 m0, s52, 0x12900
TR 2,14,8960
Mvaa 192,8,88
buffer_load_dwordx4 v10, s[24:27], s50 offen lds
Mvaa 204,12,88
s_waitcnt lgkmcnt(8)
TR 4,14,8480
Mvaa 200,12,84
s_add_u32 m0, s52, 0x12d20
TR 6,14,8992
Mvaa 196,12,80
buffer_load_dwordx4 v11, s[24:27], s50 offen lds
Mvaa 208,16,80
s_waitcnt lgkmcnt(8)
TR 8,14,8512
Mvaa 212,16,84
s_add_u32 s51, s81, 0
TR 10,14,9024
Mvaa 216,16,88
buffer_load_dwordx4 a[224:227], v20, s[20:23], s51 offen sc1
Mvaa 228,20,88
TR 12,14,8544
Mvaa 224,20,84
s_waitcnt lgkmcnt(9)
TR 14,14,9056
Mvaa 220,20,80
buffer_load_dwordx4 a[236:239], v20, s[20:23], s51 offen offset:1024 sc1
Mvaa 232,24,80
TR 16,14,8576
Mvaa 236,24,84
s_waitcnt lgkmcnt(9)
TR 18,14,9088
Mvaa 240,24,88
buffer_load_dwordx4 a[228:231], v12, s[20:23], s51 offen sc1
Mvaa 252,28,88
TR 20,14,8608
Mvaa 248,28,84
s_waitcnt lgkmcnt(9)
TR 22,14,9120
Mvaa 244,28,80
buffer_load_dwordx4 a[240:243], v12, s[20:23], s51 offen offset:1024 sc1
Mvaa 160,0,92
TR 24,14,8640
Mvaa 164,0,96
s_waitcnt lgkmcnt(9)
TR 26,14,9152
Mvaa 168,0,100
buffer_load_dwordx4 a[232:235], v21, s[20:23], s51 offen sc1
Mvaa 180,4,100
TR 28,14,8672
Mvaa 176,4,96
s_waitcnt lgkmcnt(9)
TR 30,14,9184
Mvaa 172,4,92
buffer_load_dwordx4 a[244:247], v21, s[20:23], s51 offen offset:1024 sc1
Mvaa 184,8,92
Mvaa 188,8,96
Mvaa 192,8,100
s_waitcnt lgkmcnt(8)
Mvaa 204,12,100
Mvaa 200,12,96
v_add_u32 v14, 0x18c00, v17
Mvaa 196,12,92
s_waitcnt vmcnt(63) lgkmcnt(0)
s_barrier
Mvaa 208,16,92
TR 0,14,0
Mvaa 212,16,96
TR 2,14,512
Mvaa 216,16,100
TR 4,14,32
Mvaa 228,20,100
TR 6,14,544
Mvaa 224,20,96
TR 8,14,64
Mvaa 220,20,92
TR 10,14,576
Mvaa 232,24,92
TR 12,14,96
Mvaa 236,24,96
TR 14,14,608
Mvaa 240,24,100
TR 16,14,128
Mvaa 252,28,100
TR 18,14,640
Mvaa 248,28,96
TR 20,14,160
Mvaa 244,28,92
s_waitcnt lgkmcnt(9)
TR 22,14,672
fh_u10:
Mvaa 160,0,104
s_waitcnt lgkmcnt(8)
s_add_u32 s50, s76, 0x40000
TR 24,14,192
Mvaa 164,0,108
s_add_u32 m0, s52, 0x14a00
TR 26,14,704
Mvaa 168,0,112
buffer_load_dwordx4 v10, s[24:27], s50 offen lds
Mvaa 180,4,112
s_waitcnt lgkmcnt(8)
TR 28,14,224
Mvaa 176,4,108
s_add_u32 m0, s52, 0x14e20
TR 30,14,736
Mvaa 172,4,104
buffer_load_dwordx4 v11, s[24:27], s50 offen lds
Mvaa 184,8,104
s_waitcnt lgkmcnt(8)
s_add_u32 s50, s76, 0x50000
TR 0,14,8448
Mvaa 188,8,108
s_add_u32 m0, s52, 0x16b00
TR 2,14,8960
Mvaa 192,8,112
buffer_load_dwordx4 v10, s[24:27], s50 offen lds
Mvaa 204,12,112
s_waitcnt lgkmcnt(8)
TR 4,14,8480
Mvaa 200,12,108
s_add_u32 m0, s52, 0x16f20
TR 6,14,8992
Mvaa 196,12,104
buffer_load_dwordx4 v11, s[24:27], s50 offen lds
Mvaa 208,16,104
s_waitcnt lgkmcnt(8)
TR 8,14,8512
Mvaa 212,16,108
s_add_u32 s51, s81, 0x5800
TR 10,14,9024
Mvaa 216,16,112
buffer_load_dwordx4 a[80:83], v20, s[20:23], s51 offen sc1
Mvaa 228,20,112
TR 12,14,8544
Mvaa 224,20,108
s_waitcnt lgkmcnt(9)
TR 14,14,9056
Mvaa 220,20,104
buffer_load_dwordx4 a[92:95], v20, s[20:23], s51 offen offset:1024 sc1
Mvaa 232,24,104
TR 16,14,8576
Mvaa 236,24,108
s_waitcnt lgkmcnt(9)
TR 18,14,9088
Mvaa 240,24,112
buffer_load_dwordx4 a[84:87], v12, s[20:23], s51 offen sc1
Mvaa 252,28,112
TR 20,14,8608
Mvaa 248,28,108
s_waitcnt lgkmcnt(9)
TR 22,14,9120
Mvaa 244,28,104
buffer_load_dwordx4 a[96:99], v12, s[20:23], s51 offen offset:1024 sc1
Mvaa 160,0,116
TR 24,14,8640
Mvaa 164,0,120
s_waitcnt lgkmcnt(9)
TR 26,14,9152
Mvaa 168,0,124
buffer_load_dwordx4 a[88:91], v21, s[20:23], s51 offen sc1
Mvaa 180,4,124
TR 28,14,8672
Mvaa 176,4,120
s_waitcnt lgkmcnt(9)
TR 30,14,9184
Mvaa 172,4,116
buffer_load_dwordx4 a[100:103], v21, s[20:23], s51 offen offset:1024 sc1
Mvaa 184,8,116
Mvaa 188,8,120
Mvaa 192,8,124
s_waitcnt lgkmcnt(8)
Mvaa 204,12,124
Mvaa 200,12,120
v_add_u32 v14, 0x1ce00, v17
Mvaa 196,12,116
s_waitcnt vmcnt(63) lgkmcnt(0)
s_barrier
Mvaa 208,16,116
TR 0,14,0
Mvaa 212,16,120
TR 2,14,512
Mvaa 216,16,124
TR 4,14,32
Mvaa 228,20,124
TR 6,14,544
Mvaa 224,20,120
TR 8,14,64
Mvaa 220,20,116
TR 10,14,576
Mvaa 232,24,116
TR 12,14,96
Mvaa 236,24,120
TR 14,14,608
Mvaa 240,24,124
TR 16,14,128
Mvaa 252,28,124
TR 18,14,640
Mvaa 248,28,120
TR 20,14,160
Mvaa 244,28,116
s_waitcnt lgkmcnt(9)
TR 22,14,672
fh_u11:
Mvaa 160,0,32
s_waitcnt lgkmcnt(8)
s_add_u32 s50, s76, 0x60000
TR 24,14,192
Mvaa 164,0,36
s_add_u32 m0, s52, 0x18c00
TR 26,14,704
Mvaa 168,0,40
s_branch f_pad18s
f_pad18:
s_setpc_b64 s[70:71]
f_pad18s:
buffer_load_dwordx4 v10, s[24:27], s50 offen lds
Mvaa 180,4,40
s_waitcnt lgkmcnt(8)
TR 28,14,224
Mvaa 176,4,36
s_add_u32 m0, s52, 0x19020
TR 30,14,736
Mvaa 172,4,32
buffer_load_dwordx4 v11, s[24:27], s50 offen lds
Mvaa 184,8,32
s_waitcnt lgkmcnt(8)
s_add_u32 s50, s76, 0x70000
TR 0,14,8448
Mvaa 188,8,36
s_add_u32 m0, s52, 0x1ad00
TR 2,14,8960
Mvaa 192,8,40
buffer_load_dwordx4 v10, s[24:27], s50 offen lds
Mvaa 204,12,40
s_waitcnt lgkmcnt(8)
TR 4,14,8480
Mvaa 200,12,36
s_add_u32 m0, s52, 0x1b120
TR 6,14,8992
Mvaa 196,12,32
buffer_load_dwordx4 v11, s[24:27], s50 offen lds
Mvaa 208,16,32
TR 8,14,8512
Mvaa 212,16,36
TR 10,14,9024
Mvaa 216,16,40
s_waitcnt lgkmcnt(10)
Mvaa 228,20,40
TR 12,14,8544
Mvaa 224,20,36
TR 14,14,9056
Mvaa 220,20,32
s_waitcnt lgkmcnt(10)
Mvaa 232,24,32
TR 16,14,8576
Mvaa 236,24,36
TR 18,14,9088
Mvaa 240,24,40
s_waitcnt lgkmcnt(10)
Mvaa 252,28,40
TR 20,14,8608
Mvaa 248,28,36
TR 22,14,9120
Mvaa 244,28,32
s_waitcnt lgkmcnt(10)
Mvaa 160,0,44
TR 24,14,8640
Mvaa 164,0,48
TR 26,14,9152
Mvaa 168,0,52
s_waitcnt lgkmcnt(10)
Mvaa 180,4,52
TR 28,14,8672
Mvaa 176,4,48
TR 30,14,9184
Mvaa 172,4,44
s_waitcnt lgkmcnt(10)
Mvaa 184,8,44
Mvaa 188,8,48
Mvaa 192,8,52
s_waitcnt lgkmcnt(8)
Mvaa 204,12,52
Mvaa 200,12,48
v_add_u32 v14, 0x21000, v17
Mvaa 196,12,44
s_waitcnt vmcnt(63) lgkmcnt(0)
s_barrier
Mvaa 208,16,44
TR 0,14,0
Mvaa 212,16,48
TR 2,14,512
Mvaa 216,16,52
TR 4,14,32
Mvaa 228,20,52
TR 6,14,544
Mvaa 224,20,48
TR 8,14,64
Mvaa 220,20,44
TR 10,14,576
Mvaa 232,24,44
TR 12,14,96
Mvaa 236,24,48
TR 14,14,608
Mvaa 240,24,52
TR 16,14,128
Mvaa 252,28,52
TR 18,14,640
Mvaa 248,28,48
TR 20,14,160
Mvaa 244,28,44
s_waitcnt vmcnt(59) lgkmcnt(9)
TR 22,14,672
fh_u12:
Mvaa 160,0,128
s_waitcnt vmcnt(55) lgkmcnt(8)
s_add_u32 s50, s76, 0xc0000
TR 24,14,192
Mvaa 164,0,132
s_add_u32 m0, s52, 0x1ce00
TR 26,14,704
Mvaa 168,0,136
buffer_load_dwordx4 v10, s[24:27], s50 offen lds
Mvaa 180,4,136
s_waitcnt lgkmcnt(8)
TR 28,14,224
Mvaa 176,4,132
s_add_u32 m0, s52, 0x1d220
TR 30,14,736
Mvaa 172,4,128
buffer_load_dwordx4 v11, s[24:27], s50 offen lds
Mvaa 184,8,128
s_waitcnt lgkmcnt(8)
s_add_u32 s50, s76, 0xd0000
TR 0,14,8448
Mvaa 188,8,132
s_add_u32 m0, s52, 0x1ef00
TR 2,14,8960
Mvaa 192,8,136
buffer_load_dwordx4 v10, s[24:27], s50 offen lds
Mvaa 204,12,136
s_waitcnt lgkmcnt(8)
TR 4,14,8480
Mvaa 200,12,132
s_add_u32 m0, s52, 0x1f320
TR 6,14,8992
Mvaa 196,12,128
buffer_load_dwordx4 v11, s[24:27], s50 offen lds
Mvaa 208,16,128
TR 8,14,8512
Mvaa 212,16,132
TR 10,14,9024
Mvaa 216,16,136
s_waitcnt lgkmcnt(10)
Mvaa 228,20,136
TR 12,14,8544
Mvaa 224,20,132
TR 14,14,9056
Mvaa 220,20,128
s_waitcnt lgkmcnt(10)
Mvaa 232,24,128
TR 16,14,8576
Mvaa 236,24,132
TR 18,14,9088
Mvaa 240,24,136
s_waitcnt lgkmcnt(10)
Mvaa 252,28,136
TR 20,14,8608
Mvaa 248,28,132
TR 22,14,9120
Mvaa 244,28,128
s_waitcnt lgkmcnt(10)
Mvaa 160,0,140
TR 24,14,8640
Mvaa 164,0,144
s_waitcnt vmcnt(58)
TR 26,14,9152
Mvaa 168,0,148
s_waitcnt lgkmcnt(10)
Mvaa 180,4,148
TR 28,14,8672
Mvaa 176,4,144
TR 30,14,9184
Mvaa 172,4,140
s_waitcnt lgkmcnt(10)
Mvaa 184,8,140
Mvaa 188,8,144
Mvaa 192,8,148
s_waitcnt lgkmcnt(8)
Mvaa 204,12,148
Mvaa 200,12,144
v_add_u32 v14, 0, v17
Mvaa 196,12,140
s_waitcnt vmcnt(63) lgkmcnt(0)
s_barrier
Mvaa 208,16,140
TR 0,14,0
Mvaa 212,16,144
TR 2,14,512
Mvaa 216,16,148
TR 4,14,32
Mvaa 228,20,148
TR 6,14,544
Mvaa 224,20,144
TR 8,14,64
Mvaa 220,20,140
TR 10,14,576
Mvaa 232,24,140
TR 12,14,96
Mvaa 236,24,144
TR 14,14,608
Mvaa 240,24,148
TR 16,14,128
Mvaa 252,28,148
TR 18,14,640
Mvaa 248,28,144
TR 20,14,160
Mvaa 244,28,140
s_waitcnt vmcnt(53) lgkmcnt(9)
TR 22,14,672
fh_u13:
Mvaa 160,0,152
s_waitcnt vmcnt(49) lgkmcnt(8)
s_add_u32 s50, s76, 0xe0000
TR 24,14,192
Mvaa 164,0,156
s_add_u32 m0, s52, 0x21000
TR 26,14,704
Mvaa 168,0,160
buffer_load_dwordx4 v10, s[24:27], s50 offen lds
Mvaa 180,4,160
s_waitcnt lgkmcnt(8)
TR 28,14,224
Mvaa 176,4,156
s_add_u32 m0, s52, 0x21420
TR 30,14,736
Mvaa 172,4,152
buffer_load_dwordx4 v11, s[24:27], s50 offen lds
Mvaa 184,8,152
s_waitcnt lgkmcnt(8)
s_add_u32 s50, s76, 0xf0000
TR 0,14,8448
Mvaa 188,8,156
s_add_u32 m0, s52, 0x23100
TR 2,14,8960
Mvaa 192,8,160
buffer_load_dwordx4 v10, s[24:27], s50 offen lds
Mvaa 204,12,160
s_waitcnt lgkmcnt(8)
TR 4,14,8480
Mvaa 200,12,156
s_add_u32 m0, s52, 0x23520
TR 6,14,8992
Mvaa 196,12,152
buffer_load_dwordx4 v11, s[24:27], s50 offen lds
Mvaa 208,16,152
TR 8,14,8512
Mvaa 212,16,156
TR 10,14,9024
Mvaa 216,16,160
s_waitcnt lgkmcnt(10)
Mvaa 228,20,160
TR 12,14,8544
Mvaa 224,20,156
TR 14,14,9056
Mvaa 220,20,152
s_waitcnt lgkmcnt(10)
Mvaa 232,24,152
TR 16,14,8576
Mvaa 236,24,156
TR 18,14,9088
Mvaa 240,24,160
s_waitcnt lgkmcnt(10)
Mvaa 252,28,160
TR 20,14,8608
Mvaa 248,28,156
TR 22,14,9120
Mvaa 244,28,152
s_waitcnt lgkmcnt(10)
Mvaa 160,0,164
TR 24,14,8640
Mvaa 164,0,168
s_waitcnt vmcnt(52)
TR 26,14,9152
Mvaa 168,0,172
s_waitcnt lgkmcnt(10)
Mvaa 180,4,172
TR 28,14,8672
Mvaa 176,4,168
TR 30,14,9184
Mvaa 172,4,164
s_waitcnt lgkmcnt(10)
Mvaa 184,8,164
Mvaa 188,8,168
Mvaa 192,8,172
s_waitcnt lgkmcnt(8)
Mvaa 204,12,172
Mvaa 200,12,168
v_add_u32 v14, 0x4200, v17
Mvaa 196,12,164
s_waitcnt vmcnt(58) lgkmcnt(0)
s_barrier
Mvaa 208,16,164
TR 0,14,0
Mvaa 212,16,168
TR 2,14,512
Mvaa 216,16,172
TR 4,14,32
Mvaa 228,20,172
TR 6,14,544
Mvaa 224,20,168
TR 8,14,64
Mvaa 220,20,164
TR 10,14,576
Mvaa 232,24,164
TR 12,14,96
Mvaa 236,24,168
TR 14,14,608
Mvaa 240,24,172
TR 16,14,128
Mvaa 252,28,172
TR 18,14,640
Mvaa 248,28,168
TR 20,14,160
Mvaa 244,28,164
s_waitcnt vmcnt(47) lgkmcnt(9)
TR 22,14,672
fh_u14:
Mvaa 160,0,176
s_waitcnt vmcnt(43) lgkmcnt(8)
s_add_u32 s50, s76, 0x140000
TR 24,14,192
Mvaa 164,0,180
s_add_u32 m0, s52, 0
TR 26,14,704
Mvaa 168,0,184
buffer_load_dwordx4 v10, s[24:27], s50 offen lds
Mvaa 180,4,184
s_waitcnt lgkmcnt(8)
TR 28,14,224
Mvaa 176,4,180
s_add_u32 m0, s52, 0x420
TR 30,14,736
Mvaa 172,4,176
buffer_load_dwordx4 v11, s[24:27], s50 offen lds
Mvaa 184,8,176
s_waitcnt lgkmcnt(8)
s_add_u32 s50, s76, 0x150000
TR 0,14,8448
Mvaa 188,8,180
s_add_u32 m0, s52, 0x2100
TR 2,14,8960
Mvaa 192,8,184
buffer_load_dwordx4 v10, s[24:27], s50 offen lds
Mvaa 204,12,184
s_waitcnt lgkmcnt(8)
TR 4,14,8480
Mvaa 200,12,180
s_add_u32 m0, s52, 0x2520
TR 6,14,8992
Mvaa 196,12,176
buffer_load_dwordx4 v11, s[24:27], s50 offen lds
Mvaa 208,16,176
s_waitcnt lgkmcnt(8)
TR 8,14,8512
Mvaa 212,16,180
s_add_u32 s51, s82, 0xb000
TR 10,14,9024
Mvaa 216,16,184
buffer_load_dwordx4 a[104:107], v20, s[20:23], s51 offen sc1
Mvaa 228,20,184
TR 12,14,8544
Mvaa 224,20,180
s_waitcnt lgkmcnt(9)
TR 14,14,9056
Mvaa 220,20,176
buffer_load_dwordx4 a[116:119], v20, s[20:23], s51 offen offset:1024 sc1
Mvaa 232,24,176
TR 16,14,8576
Mvaa 236,24,180
s_waitcnt lgkmcnt(9)
TR 18,14,9088
Mvaa 240,24,184
buffer_load_dwordx4 a[108:111], v12, s[20:23], s51 offen sc1
Mvaa 252,28,184
TR 20,14,8608
Mvaa 248,28,180
s_waitcnt lgkmcnt(9)
TR 22,14,9120
Mvaa 244,28,176
buffer_load_dwordx4 a[120:123], v12, s[20:23], s51 offen offset:1024 sc1
Mvaa 160,0,188
TR 24,14,8640
Mvaa 164,0,192
s_waitcnt vmcnt(50) lgkmcnt(9)
TR 26,14,9152
Mvaa 168,0,196
buffer_load_dwordx4 a[112:115], v21, s[20:23], s51 offen sc1
Mvaa 180,4,196
TR 28,14,8672
Mvaa 176,4,192
s_waitcnt lgkmcnt(9)
TR 30,14,9184
Mvaa 172,4,188
buffer_load_dwordx4 a[124:127], v21, s[20:23], s51 offen offset:1024 sc1
Mvaa 184,8,188
Mvaa 188,8,192
Mvaa 192,8,196
s_waitcnt lgkmcnt(8)
Mvaa 204,12,196
Mvaa 200,12,192
v_add_u32 v14, 0x8400, v17
Mvaa 196,12,188
s_waitcnt vmcnt(58) lgkmcnt(0)
s_barrier
Mvaa 208,16,188
TR 0,14,0
Mvaa 212,16,192
TR 2,14,512
Mvaa 216,16,196
TR 4,14,32
Mvaa 228,20,196
TR 6,14,544
Mvaa 224,20,192
TR 8,14,64
Mvaa 220,20,188
TR 10,14,576
Mvaa 232,24,188
TR 12,14,96
Mvaa 236,24,192
TR 14,14,608
Mvaa 240,24,196
TR 16,14,128
Mvaa 252,28,196
TR 18,14,640
Mvaa 248,28,192
TR 20,14,160
Mvaa 244,28,188
s_waitcnt vmcnt(47) lgkmcnt(9)
TR 22,14,672
fh_u15:
Mvaa 160,0,200
s_waitcnt vmcnt(43) lgkmcnt(8)
s_add_u32 s50, s76, 0x160000
TR 24,14,192
Mvaa 164,0,204
s_add_u32 m0, s52, 0x4200
TR 26,14,704
Mvaa 168,0,208
buffer_load_dwordx4 v10, s[24:27], s50 offen lds
Mvaa 180,4,208
s_waitcnt lgkmcnt(8)
TR 28,14,224
Mvaa 176,4,204
s_add_u32 m0, s52, 0x4620
TR 30,14,736
Mvaa 172,4,200
buffer_load_dwordx4 v11, s[24:27], s50 offen lds
Mvaa 184,8,200
s_waitcnt lgkmcnt(8)
s_add_u32 s50, s76, 0x170000
TR 0,14,8448
Mvaa 188,8,204
s_add_u32 m0, s52, 0x6300
TR 2,14,8960
Mvaa 192,8,208
buffer_load_dwordx4 v10, s[24:27], s50 offen lds
Mvaa 204,12,208
s_waitcnt lgkmcnt(8)
TR 4,14,8480
Mvaa 200,12,204
s_add_u32 m0, s52, 0x6720
TR 6,14,8992
Mvaa 196,12,200
buffer_load_dwordx4 v11, s[24:27], s50 offen lds
Mvaa 208,16,200
s_waitcnt lgkmcnt(8)
TR 8,14,8512
Mvaa 212,16,204
s_add_u32 s51, s82, 0x10800
TR 10,14,9024
Mvaa 216,16,208
buffer_load_dwordx4 a[32:35], v20, s[20:23], s51 offen sc1
Mvaa 228,20,208
TR 12,14,8544
Mvaa 224,20,204
s_waitcnt lgkmcnt(9)
TR 14,14,9056
Mvaa 220,20,200
buffer_load_dwordx4 a[44:47], v20, s[20:23], s51 offen offset:1024 sc1
Mvaa 232,24,200
TR 16,14,8576
Mvaa 236,24,204
s_waitcnt lgkmcnt(9)
TR 18,14,9088
Mvaa 240,24,208
buffer_load_dwordx4 a[36:39], v12, s[20:23], s51 offen sc1
Mvaa 252,28,208
TR 20,14,8608
Mvaa 248,28,204
s_waitcnt lgkmcnt(9)
TR 22,14,9120
Mvaa 244,28,200
buffer_load_dwordx4 a[48:51], v12, s[20:23], s51 offen offset:1024 sc1
Mvaa 160,0,212
TR 24,14,8640
Mvaa 164,0,216
s_waitcnt vmcnt(50) lgkmcnt(9)
TR 26,14,9152
Mvaa 168,0,220
buffer_load_dwordx4 a[40:43], v21, s[20:23], s51 offen sc1
Mvaa 180,4,220
TR 28,14,8672
Mvaa 176,4,216
s_waitcnt lgkmcnt(9)
TR 30,14,9184
Mvaa 172,4,212
buffer_load_dwordx4 a[52:55], v21, s[20:23], s51 offen offset:1024 sc1
Mvaa 184,8,212
Mvaa 188,8,216
Mvaa 192,8,220
s_waitcnt lgkmcnt(8)
Mvaa 204,12,220
Mvaa 200,12,216
v_add_u32 v14, 0xc600, v17
Mvaa 196,12,212
s_waitcnt vmcnt(58) lgkmcnt(0)
s_barrier
Mvaa 208,16,212
TR 0,14,0
Mvaa 212,16,216
TR 2,14,512
Mvaa 216,16,220
TR 4,14,32
Mvaa 228,20,220
TR 6,14,544
Mvaa 224,20,216
TR 8,14,64
Mvaa 220,20,212
TR 10,14,576
Mvaa 232,24,212
TR 12,14,96
Mvaa 236,24,216
TR 14,14,608
Mvaa 240,24,220
TR 16,14,128
Mvaa 252,28,220
TR 18,14,640
Mvaa 248,28,216
TR 20,14,160
Mvaa 244,28,212
s_waitcnt vmcnt(47) lgkmcnt(9)
TR 22,14,672
fh_u16:
Mvaa 160,0,224
s_waitcnt vmcnt(43) lgkmcnt(8)
s_add_u32 s50, s76, 0x1c0000
TR 24,14,192
Mvaa 164,0,228
s_add_u32 m0, s52, 0x8400
TR 26,14,704
Mvaa 168,0,232
buffer_load_dwordx4 v10, s[24:27], s50 offen lds
Mvaa 180,4,232
s_waitcnt lgkmcnt(8)
TR 28,14,224
Mvaa 176,4,228
s_branch f_pad19s
f_pad19:
s_setpc_b64 s[70:71]
f_pad19s:
s_add_u32 m0, s52, 0x8820
TR 30,14,736
Mvaa 172,4,224
buffer_load_dwordx4 v11, s[24:27], s50 offen lds
Mvaa 184,8,224
s_waitcnt lgkmcnt(8)
s_add_u32 s50, s76, 0x1d0000
TR 0,14,8448
Mvaa 188,8,228
s_add_u32 m0, s52, 0xa500
TR 2,14,8960
Mvaa 192,8,232
buffer_load_dwordx4 v10, s[24:27], s50 offen lds
Mvaa 204,12,232
s_waitcnt lgkmcnt(8)
TR 4,14,8480
Mvaa 200,12,228
s_add_u32 m0, s52, 0xa920
TR 6,14,8992
Mvaa 196,12,224
buffer_load_dwordx4 v11, s[24:27], s50 offen lds
Mvaa 208,16,224
s_waitcnt lgkmcnt(8)
TR 8,14,8512
Mvaa 212,16,228
s_add_u32 s51, s82, 0x21000
TR 10,14,9024
Mvaa 216,16,232
buffer_load_dwordx4 a[128:131], v20, s[20:23], s51 offen sc1
Mvaa 228,20,232
TR 12,14,8544
Mvaa 224,20,228
s_waitcnt lgkmcnt(9)
TR 14,14,9056
Mvaa 220,20,224
buffer_load_dwordx4 a[140:143], v20, s[20:23], s51 offen offset:1024 sc1
Mvaa 232,24,224
TR 16,14,8576
Mvaa 236,24,228
s_waitcnt lgkmcnt(9)
TR 18,14,9088
Mvaa 240,24,232
buffer_load_dwordx4 a[132:135], v12, s[20:23], s51 offen sc1
Mvaa 252,28,232
TR 20,14,8608
Mvaa 248,28,228
s_waitcnt lgkmcnt(9)
TR 22,14,9120
Mvaa 244,28,224
buffer_load_dwordx4 a[144:147], v12, s[20:23], s51 offen offset:1024 sc1
Mvaa 160,0,236
TR 24,14,8640
Mvaa 164,0,240
s_waitcnt vmcnt(50) lgkmcnt(9)
TR 26,14,9152
Mvaa 168,0,244
buffer_load_dwordx4 a[136:139], v21, s[20:23], s51 offen sc1
Mvaa 180,4,244
TR 28,14,8672
Mvaa 176,4,240
s_waitcnt lgkmcnt(9)
TR 30,14,9184
Mvaa 172,4,236
buffer_load_dwordx4 a[148:151], v21, s[20:23], s51 offen offset:1024 sc1
Mvaa 184,8,236
Mvaa 188,8,240
Mvaa 192,8,244
s_waitcnt lgkmcnt(8)
Mvaa 204,12,244
Mvaa 200,12,240
v_add_u32 v14, 0x10800, v17
Mvaa 196,12,236
s_waitcnt vmcnt(58) lgkmcnt(0)
s_barrier
Mvaa 208,16,236
TR 0,14,0
Mvaa 212,16,240
TR 2,14,512
Mvaa 216,16,244
TR 4,14,32
Mvaa 228,20,244
TR 6,14,544
Mvaa 224,20,240
TR 8,14,64
Mvaa 220,20,236
TR 10,14,576
Mvaa 232,24,236
TR 12,14,96
Mvaa 236,24,240
TR 14,14,608
Mvaa 240,24,244
TR 16,14,128
Mvaa 252,28,244
TR 18,14,640
Mvaa 248,28,240
TR 20,14,160
Mvaa 244,28,236
s_waitcnt vmcnt(47) lgkmcnt(9)
TR 22,14,672
fh_u17:
Mvaa 160,0,80
s_waitcnt vmcnt(43) lgkmcnt(8)
s_add_u32 s50, s76, 0x1e0000
TR 24,14,192
Mvaa 164,0,84
s_add_u32 m0, s52, 0xc600
TR 26,14,704
Mvaa 168,0,88
buffer_load_dwordx4 v10, s[24:27], s50 offen lds
Mvaa 180,4,88
s_waitcnt lgkmcnt(8)
TR 28,14,224
Mvaa 176,4,84
s_add_u32 m0, s52, 0xca20
TR 30,14,736
Mvaa 172,4,80
buffer_load_dwordx4 v11, s[24:27], s50 offen lds
Mvaa 184,8,80
s_waitcnt lgkmcnt(8)
s_add_u32 s50, s76, 0x1f0000
TR 0,14,8448
Mvaa 188,8,84
s_add_u32 m0, s52, 0xe700
TR 2,14,8960
Mvaa 192,8,88
buffer_load_dwordx4 v10, s[24:27], s50 offen lds
Mvaa 204,12,88
s_waitcnt lgkmcnt(8)
TR 4,14,8480
Mvaa 200,12,84
s_add_u32 m0, s52, 0xeb20
TR 6,14,8992
Mvaa 196,12,80
buffer_load_dwordx4 v11, s[24:27], s50 offen lds
Mvaa 208,16,80
s_waitcnt lgkmcnt(8)
TR 8,14,8512
Mvaa 212,16,84
s_add_u32 s51, s82, 0x26800
TR 10,14,9024
Mvaa 216,16,88
buffer_load_dwordx4 a[152:155], v20, s[20:23], s51 offen sc1
Mvaa 228,20,88
TR 12,14,8544
Mvaa 224,20,84
s_waitcnt lgkmcnt(9)
TR 14,14,9056
Mvaa 220,20,80
buffer_load_dwordx4 a[164:167], v20, s[20:23], s51 offen offset:1024 sc1
Mvaa 232,24,80
TR 16,14,8576
Mvaa 236,24,84
s_waitcnt lgkmcnt(9)
TR 18,14,9088
Mvaa 240,24,88
buffer_load_dwordx4 a[156:159], v12, s[20:23], s51 offen sc1
Mvaa 252,28,88
TR 20,14,8608
Mvaa 248,28,84
s_waitcnt lgkmcnt(9)
TR 22,14,9120
Mvaa 244,28,80
buffer_load_dwordx4 a[168:171], v12, s[20:23], s51 offen offset:1024 sc1
Mvaa 160,0,92
TR 24,14,8640
Mvaa 164,0,96
s_waitcnt vmcnt(50) lgkmcnt(9)
TR 26,14,9152
Mvaa 168,0,100
buffer_load_dwordx4 a[160:163], v21, s[20:23], s51 offen sc1
Mvaa 180,4,100
TR 28,14,8672
Mvaa 176,4,96
s_waitcnt lgkmcnt(9)
TR 30,14,9184
Mvaa 172,4,92
buffer_load_dwordx4 a[172:175], v21, s[20:23], s51 offen offset:1024 sc1
Mvaa 184,8,92
Mvaa 188,8,96
Mvaa 192,8,100
s_waitcnt lgkmcnt(8)
Mvaa 204,12,100
Mvaa 200,12,96
v_add_u32 v14, 0x14a00, v17
Mvaa 196,12,92
s_waitcnt vmcnt(58) lgkmcnt(0)
s_barrier
Mvaa 208,16,92
TR 0,14,0
Mvaa 212,16,96
TR 2,14,512
Mvaa 216,16,100
TR 4,14,32
Mvaa 228,20,100
TR 6,14,544
Mvaa 224,20,96
TR 8,14,64
Mvaa 220,20,92
TR 10,14,576
Mvaa 232,24,92
TR 12,14,96
Mvaa 236,24,96
TR 14,14,608
Mvaa 240,24,100
TR 16,14,128
Mvaa 252,28,100
TR 18,14,640
Mvaa 248,28,96
TR 20,14,160
Mvaa 244,28,92
s_waitcnt vmcnt(35) lgkmcnt(9)
TR 22,14,672
fh_u18:
Mvaa 160,0,104
s_waitcnt vmcnt(31) lgkmcnt(8)
s_add_u32 s50, s73, 0x40000
TR 24,14,192
Mvaa 164,0,108
s_add_u32 m0, s52, 0x10800
TR 26,14,704
Mvaa 168,0,112
buffer_load_dwordx4 v10, s[24:27], s50 offen lds
Mvaa 180,4,112
s_waitcnt lgkmcnt(8)
TR 28,14,224
Mvaa 176,4,108
s_add_u32 m0, s52, 0x10c20
TR 30,14,736
Mvaa 172,4,104
buffer_load_dwordx4 v11, s[24:27], s50 offen lds
Mvaa 184,8,104
s_waitcnt lgkmcnt(8)
s_add_u32 s50, s73, 0x50000
TR 0,14,8448
Mvaa 188,8,108
s_add_u32 m0, s52, 0x12900
TR 2,14,8960
Mvaa 192,8,112
buffer_load_dwordx4 v10, s[24:27], s50 offen lds
Mvaa 204,12,112
s_waitcnt lgkmcnt(8)
TR 4,14,8480
Mvaa 200,12,108
s_add_u32 m0, s52, 0x12d20
TR 6,14,8992
Mvaa 196,12,104
buffer_load_dwordx4 v11, s[24:27], s50 offen lds
Mvaa 208,16,104
s_waitcnt lgkmcnt(8)
TR 8,14,8512
Mvaa 212,16,108
s_add_u32 s51, s82, 0x37000
TR 10,14,9024
Mvaa 216,16,112
buffer_load_dwordx4 a[176:179], v20, s[20:23], s51 offen sc1
Mvaa 228,20,112
TR 12,14,8544
Mvaa 224,20,108
s_waitcnt lgkmcnt(9)
TR 14,14,9056
Mvaa 220,20,104
buffer_load_dwordx4 a[188:191], v20, s[20:23], s51 offen offset:1024 sc1
Mvaa 232,24,104
TR 16,14,8576
Mvaa 236,24,108
s_waitcnt lgkmcnt(9)
TR 18,14,9088
Mvaa 240,24,112
buffer_load_dwordx4 a[180:183], v12, s[20:23], s51 offen sc1
Mvaa 252,28,112
TR 20,14,8608
Mvaa 248,28,108
s_waitcnt lgkmcnt(9)
TR 22,14,9120
Mvaa 244,28,104
buffer_load_dwordx4 a[192:195], v12, s[20:23], s51 offen offset:1024 sc1
Mvaa 160,0,116
TR 24,14,8640
Mvaa 164,0,120
s_waitcnt vmcnt(38) lgkmcnt(9)
TR 26,14,9152
Mvaa 168,0,124
buffer_load_dwordx4 a[184:187], v21, s[20:23], s51 offen sc1
Mvaa 180,4,124
TR 28,14,8672
Mvaa 176,4,120
s_waitcnt lgkmcnt(9)
TR 30,14,9184
Mvaa 172,4,116
buffer_load_dwordx4 a[196:199], v21, s[20:23], s51 offen offset:1024 sc1
Mvaa 184,8,116
Mvaa 188,8,120
Mvaa 192,8,124
s_waitcnt lgkmcnt(8)
Mvaa 204,12,124
Mvaa 200,12,120
v_add_u32 v14, 0x18c00, v17
Mvaa 196,12,116
s_waitcnt vmcnt(58) lgkmcnt(0)
s_barrier
Mvaa 208,16,116
TR 0,14,0
Mvaa 212,16,120
TR 2,14,512
Mvaa 216,16,124
TR 4,14,32
Mvaa 228,20,124
TR 6,14,544
Mvaa 224,20,120
TR 8,14,64
Mvaa 220,20,116
TR 10,14,576
Mvaa 232,24,116
TR 12,14,96
Mvaa 236,24,120
TR 14,14,608
Mvaa 240,24,124
TR 16,14,128
Mvaa 252,28,124
TR 18,14,640
Mvaa 248,28,120
TR 20,14,160
Mvaa 244,28,116
s_waitcnt vmcnt(35) lgkmcnt(9)
TR 22,14,672
fh_u19:
Mvaa 160,0,32
s_waitcnt vmcnt(31) lgkmcnt(8)
s_add_u32 s50, s73, 0x60000
TR 24,14,192
Mvaa 164,0,36
s_add_u32 m0, s52, 0x14a00
TR 26,14,704
Mvaa 168,0,40
buffer_load_dwordx4 v10, s[24:27], s50 offen lds
Mvaa 180,4,40
s_waitcnt lgkmcnt(8)
TR 28,14,224
Mvaa 176,4,36
s_add_u32 m0, s52, 0x14e20
TR 30,14,736
Mvaa 172,4,32
buffer_load_dwordx4 v11, s[24:27], s50 offen lds
Mvaa 184,8,32
s_waitcnt lgkmcnt(8)
s_add_u32 s50, s73, 0x70000
TR 0,14,8448
Mvaa 188,8,36
s_add_u32 m0, s52, 0x16b00
TR 2,14,8960
Mvaa 192,8,40
buffer_load_dwordx4 v10, s[24:27], s50 offen lds
Mvaa 204,12,40
s_waitcnt lgkmcnt(8)
TR 4,14,8480
Mvaa 200,12,36
s_add_u32 m0, s52, 0x16f20
TR 6,14,8992
Mvaa 196,12,32
buffer_load_dwordx4 v11, s[24:27], s50 offen lds
Mvaa 208,16,32
s_waitcnt lgkmcnt(8)
TR 8,14,8512
Mvaa 212,16,36
s_add_u32 s51, s82, 0x3c800
TR 10,14,9024
Mvaa 216,16,40
buffer_load_dwordx4 a[200:203], v20, s[20:23], s51 offen sc1
Mvaa 228,20,40
TR 12,14,8544
Mvaa 224,20,36
s_waitcnt lgkmcnt(9)
TR 14,14,9056
Mvaa 220,20,32
buffer_load_dwordx4 a[212:215], v20, s[20:23], s51 offen offset:1024 sc1
Mvaa 232,24,32
TR 16,14,8576
Mvaa 236,24,36
s_waitcnt lgkmcnt(9)
TR 18,14,9088
Mvaa 240,24,40
buffer_load_dwordx4 a[204:207], v12, s[20:23], s51 offen sc1
Mvaa 252,28,40
TR 20,14,8608
Mvaa 248,28,36
s_waitcnt lgkmcnt(9)
TR 22,14,9120
Mvaa 244,28,32
buffer_load_dwordx4 a[216:219], v12, s[20:23], s51 offen offset:1024 sc1
Mvaa 160,0,44
TR 24,14,8640
Mvaa 164,0,48
s_waitcnt vmcnt(38) lgkmcnt(9)
TR 26,14,9152
Mvaa 168,0,52
buffer_load_dwordx4 a[208:211], v21, s[20:23], s51 offen sc1
Mvaa 180,4,52
TR 28,14,8672
Mvaa 176,4,48
s_waitcnt lgkmcnt(9)
TR 30,14,9184
Mvaa 172,4,44
buffer_load_dwordx4 a[220:223], v21, s[20:23], s51 offen offset:1024 sc1
Mvaa 184,8,44
Mvaa 188,8,48
Mvaa 192,8,52
s_waitcnt lgkmcnt(8)
Mvaa 204,12,52
Mvaa 200,12,48
v_add_u32 v14, 0x1ce00, v17
Mvaa 196,12,44
s_waitcnt vmcnt(63) lgkmcnt(0)
s_barrier
Mvaa 208,16,44
TR 0,14,0
Mvaa 212,16,48
TR 2,14,512
Mvaa 216,16,52
TR 4,14,32
Mvaa 228,20,52
TR 6,14,544
Mvaa 224,20,48
TR 8,14,64
Mvaa 220,20,44
TR 10,14,576
Mvaa 232,24,44
TR 12,14,96
Mvaa 236,24,48
TR 14,14,608
Mvaa 240,24,52
TR 16,14,128
Mvaa 252,28,52
TR 18,14,640
Mvaa 248,28,48
TR 20,14,160
Mvaa 244,28,44
s_waitcnt vmcnt(35) lgkmcnt(9)
TR 22,14,672
fh_u20:
Mvaa 160,0,128
s_waitcnt vmcnt(31) lgkmcnt(8)
s_add_u32 s50, s74, 0x40000
TR 24,14,192
Mvaa 164,0,132
s_add_u32 m0, s52, 0x18c00
TR 26,14,704
Mvaa 168,0,136
buffer_load_dwordx4 v10, s[24:27], s50 offen lds
Mvaa 180,4,136
s_waitcnt lgkmcnt(8)
TR 28,14,224
Mvaa 176,4,132
s_add_u32 m0, s52, 0x19020
TR 30,14,736
Mvaa 172,4,128
buffer_load_dwordx4 v11, s[24:27], s50 offen lds
Mvaa 184,8,128
s_waitcnt lgkmcnt(8)
s_add_u32 s50, s74, 0x50000
TR 0,14,8448
Mvaa 188,8,132
s_add_u32 m0, s52, 0x1ad00
TR 2,14,8960
Mvaa 192,8,136
buffer_load_dwordx4 v10, s[24:27], s50 offen lds
Mvaa 204,12,136
s_waitcnt lgkmcnt(8)
TR 4,14,8480
Mvaa 200,12,132
s_add_u32 m0, s52, 0x1b120
TR 6,14,8992
Mvaa 196,12,128
buffer_load_dwordx4 v11, s[24:27], s50 offen lds
Mvaa 208,16,128
s_waitcnt lgkmcnt(8)
TR 8,14,8512
Mvaa 212,16,132
s_add_u32 s51, s82, 0x4d000
TR 10,14,9024
Mvaa 216,16,136
buffer_load_dwordx4 a[224:227], v20, s[20:23], s51 offen sc1
Mvaa 228,20,136
TR 12,14,8544
Mvaa 224,20,132
s_waitcnt lgkmcnt(9)
TR 14,14,9056
Mvaa 220,20,128
buffer_load_dwordx4 a[236:239], v20, s[20:23], s51 offen offset:1024 sc1
Mvaa 232,24,128
TR 16,14,8576
Mvaa 236,24,132
s_waitcnt lgkmcnt(9)
TR 18,14,9088
Mvaa 240,24,136
buffer_load_dwordx4 a[228:231], v12, s[20:23], s51 offen sc1
Mvaa 252,28,136
TR 20,14,8608
Mvaa 248,28,132
s_waitcnt lgkmcnt(9)
TR 22,14,9120
Mvaa 244,28,128
buffer_load_dwordx4 a[240:243], v12, s[20:23], s51 offen offset:1024 sc1
Mvaa 160,0,140
TR 24,14,8640
Mvaa 164,0,144
s_waitcnt vmcnt(38) lgkmcnt(9)
TR 26,14,9152
Mvaa 168,0,148
buffer_load_dwordx4 a[232:235], v21, s[20:23], s51 offen sc1
Mvaa 180,4,148
TR 28,14,8672
Mvaa 176,4,144
s_waitcnt lgkmcnt(9)
TR 30,14,9184
Mvaa 172,4,140
buffer_load_dwordx4 a[244:247], v21, s[20:23], s51 offen offset:1024 sc1
Mvaa 184,8,140
Mvaa 188,8,144
Mvaa 192,8,148
s_waitcnt lgkmcnt(8)
Mvaa 204,12,148
Mvaa 200,12,144
v_add_u32 v14, 0x21000, v17
Mvaa 196,12,140
s_waitcnt vmcnt(63) lgkmcnt(0)
s_barrier
Mvaa 208,16,140
TR 0,14,0
Mvaa 212,16,144
TR 2,14,512
Mvaa 216,16,148
TR 4,14,32
Mvaa 228,20,148
TR 6,14,544
Mvaa 224,20,144
TR 8,14,64
Mvaa 220,20,140
TR 10,14,576
Mvaa 232,24,140
TR 12,14,96
Mvaa 236,24,144
TR 14,14,608
Mvaa 240,24,148
TR 16,14,128
Mvaa 252,28,148
TR 18,14,640
Mvaa 248,28,144
TR 20,14,160
Mvaa 244,28,140
s_branch f_pad20s
f_pad20:
s_setpc_b64 s[70:71]
f_pad20s:
s_waitcnt vmcnt(35) lgkmcnt(9)
TR 22,14,672
fh_u21:
Mvaa 160,0,152
s_waitcnt vmcnt(31) lgkmcnt(8)
s_add_u32 s50, s74, 0x60000
TR 24,14,192
Mvaa 164,0,156
s_add_u32 m0, s52, 0x1ce00
TR 26,14,704
Mvaa 168,0,160
buffer_load_dwordx4 v10, s[24:27], s50 offen lds
Mvaa 180,4,160
s_waitcnt lgkmcnt(8)
TR 28,14,224
Mvaa 176,4,156
s_add_u32 m0, s52, 0x1d220
TR 30,14,736
Mvaa 172,4,152
buffer_load_dwordx4 v11, s[24:27], s50 offen lds
Mvaa 184,8,152
s_waitcnt lgkmcnt(8)
s_add_u32 s50, s74, 0x70000
TR 0,14,8448
Mvaa 188,8,156
s_add_u32 m0, s52, 0x1ef00
TR 2,14,8960
Mvaa 192,8,160
buffer_load_dwordx4 v10, s[24:27], s50 offen lds
Mvaa 204,12,160
s_waitcnt lgkmcnt(8)
TR 4,14,8480
Mvaa 200,12,156
s_add_u32 m0, s52, 0x1f320
TR 6,14,8992
Mvaa 196,12,152
buffer_load_dwordx4 v11, s[24:27], s50 offen lds
Mvaa 208,16,152
s_waitcnt lgkmcnt(8)
TR 8,14,8512
Mvaa 212,16,156
s_add_u32 s51, s82, 0x52800
TR 10,14,9024
Mvaa 216,16,160
buffer_load_dwordx4 a[80:83], v20, s[20:23], s51 offen sc1
Mvaa 228,20,160
TR 12,14,8544
Mvaa 224,20,156
s_waitcnt lgkmcnt(9)
TR 14,14,9056
Mvaa 220,20,152
buffer_load_dwordx4 a[92:95], v20, s[20:23], s51 offen offset:1024 sc1
Mvaa 232,24,152
TR 16,14,8576
Mvaa 236,24,156
s_waitcnt lgkmcnt(9)
TR 18,14,9088
Mvaa 240,24,160
buffer_load_dwordx4 a[84:87], v12, s[20:23], s51 offen sc1
Mvaa 252,28,160
TR 20,14,8608
Mvaa 248,28,156
s_waitcnt lgkmcnt(9)
TR 22,14,9120
Mvaa 244,28,152
buffer_load_dwordx4 a[96:99], v12, s[20:23], s51 offen offset:1024 sc1
Mvaa 160,0,164
TR 24,14,8640
Mvaa 164,0,168
s_waitcnt vmcnt(38) lgkmcnt(9)
TR 26,14,9152
Mvaa 168,0,172
buffer_load_dwordx4 a[88:91], v21, s[20:23], s51 offen sc1
Mvaa 180,4,172
TR 28,14,8672
Mvaa 176,4,168
s_waitcnt lgkmcnt(9)
TR 30,14,9184
Mvaa 172,4,164
buffer_load_dwordx4 a[100:103], v21, s[20:23], s51 offen offset:1024 sc1
Mvaa 184,8,164
Mvaa 188,8,168
Mvaa 192,8,172
s_waitcnt lgkmcnt(8)
Mvaa 204,12,172
Mvaa 200,12,168
v_add_u32 v14, 0, v17
Mvaa 196,12,164
s_waitcnt vmcnt(63) lgkmcnt(0)
s_barrier
Mvaa 208,16,164
TR 0,14,0
Mvaa 212,16,168
TR 2,14,512
Mvaa 216,16,172
TR 4,14,32
Mvaa 228,20,172
TR 6,14,544
Mvaa 224,20,168
TR 8,14,64
Mvaa 220,20,164
TR 10,14,576
Mvaa 232,24,164
TR 12,14,96
Mvaa 236,24,168
TR 14,14,608
Mvaa 240,24,172
TR 16,14,128
Mvaa 252,28,172
TR 18,14,640
Mvaa 248,28,168
TR 20,14,160
Mvaa 244,28,164
s_waitcnt vmcnt(35) lgkmcnt(9)
TR 22,14,672
fh_u22:
Mvaa 160,0,176
s_waitcnt vmcnt(31) lgkmcnt(8)
s_add_u32 s50, s75, 0x40000
TR 24,14,192
Mvaa 164,0,180
s_add_u32 m0, s52, 0x21000
TR 26,14,704
Mvaa 168,0,184
buffer_load_dwordx4 v10, s[24:27], s50 offen lds
Mvaa 180,4,184
s_waitcnt lgkmcnt(8)
TR 28,14,224
Mvaa 176,4,180
s_add_u32 m0, s52, 0x21420
TR 30,14,736
Mvaa 172,4,176
buffer_load_dwordx4 v11, s[24:27], s50 offen lds
Mvaa 184,8,176
s_waitcnt lgkmcnt(8)
s_add_u32 s50, s75, 0x50000
TR 0,14,8448
Mvaa 188,8,180
s_add_u32 m0, s52, 0x23100
TR 2,14,8960
Mvaa 192,8,184
buffer_load_dwordx4 v10, s[24:27], s50 offen lds
Mvaa 204,12,184
s_waitcnt lgkmcnt(8)
TR 4,14,8480
Mvaa 200,12,180
s_add_u32 m0, s52, 0x23520
TR 6,14,8992
Mvaa 196,12,176
buffer_load_dwordx4 v11, s[24:27], s50 offen lds
Mvaa 208,16,176
s_waitcnt lgkmcnt(8)
TR 8,14,8512
Mvaa 212,16,180
s_add_u32 s51, s79, 0xb000
TR 10,14,9024
Mvaa 216,16,184
buffer_load_dwordx4 a[104:107], v20, s[20:23], s51 offen sc1
Mvaa 228,20,184
TR 12,14,8544
Mvaa 224,20,180
s_waitcnt lgkmcnt(9)
TR 14,14,9056
Mvaa 220,20,176
buffer_load_dwordx4 a[116:119], v20, s[20:23], s51 offen offset:1024 sc1
Mvaa 232,24,176
TR 16,14,8576
Mvaa 236,24,180
s_waitcnt lgkmcnt(9)
TR 18,14,9088
Mvaa 240,24,184
buffer_load_dwordx4 a[108:111], v12, s[20:23], s51 offen sc1
Mvaa 252,28,184
TR 20,14,8608
Mvaa 248,28,180
s_waitcnt lgkmcnt(9)
TR 22,14,9120
Mvaa 244,28,176
buffer_load_dwordx4 a[120:123], v12, s[20:23], s51 offen offset:1024 sc1
Mvaa 160,0,188
TR 24,14,8640
Mvaa 164,0,192
s_waitcnt vmcnt(38) lgkmcnt(9)
TR 26,14,9152
Mvaa 168,0,196
buffer_load_dwordx4 a[112:115], v21, s[20:23], s51 offen sc1
Mvaa 180,4,196
TR 28,14,8672
Mvaa 176,4,192
s_waitcnt lgkmcnt(9)
TR 30,14,9184
Mvaa 172,4,188
buffer_load_dwordx4 a[124:127], v21, s[20:23], s51 offen offset:1024 sc1
Mvaa 184,8,188
Mvaa 188,8,192
Mvaa 192,8,196
s_waitcnt lgkmcnt(8)
Mvaa 204,12,196
Mvaa 200,12,192
v_add_u32 v14, 0x4200, v17
Mvaa 196,12,188
s_waitcnt vmcnt(63) lgkmcnt(0)
s_barrier
Mvaa 208,16,188
TR 0,14,0
Mvaa 212,16,192
TR 2,14,512
Mvaa 216,16,196
TR 4,14,32
Mvaa 228,20,196
TR 6,14,544
Mvaa 224,20,192
TR 8,14,64
Mvaa 220,20,188
TR 10,14,576
Mvaa 232,24,188
TR 12,14,96
Mvaa 236,24,192
TR 14,14,608
Mvaa 240,24,196
TR 16,14,128
Mvaa 252,28,196
TR 18,14,640
Mvaa 248,28,192
TR 20,14,160
Mvaa 244,28,188
s_waitcnt vmcnt(35) lgkmcnt(9)
TR 22,14,672
fh_u23:
Mvaa 160,0,200
s_waitcnt vmcnt(31) lgkmcnt(8)
s_add_u32 s50, s75, 0x60000
TR 24,14,192
Mvaa 164,0,204
s_add_u32 m0, s52, 0
TR 26,14,704
Mvaa 168,0,208
buffer_load_dwordx4 v10, s[24:27], s50 offen lds
Mvaa 180,4,208
s_waitcnt lgkmcnt(8)
TR 28,14,224
Mvaa 176,4,204
s_add_u32 m0, s52, 0x420
TR 30,14,736
Mvaa 172,4,200
buffer_load_dwordx4 v11, s[24:27], s50 offen lds
Mvaa 184,8,200
s_waitcnt lgkmcnt(8)
s_add_u32 s50, s75, 0x70000
TR 0,14,8448
Mvaa 188,8,204
s_add_u32 m0, s52, 0x2100
TR 2,14,8960
Mvaa 192,8,208
buffer_load_dwordx4 v10, s[24:27], s50 offen lds
Mvaa 204,12,208
s_waitcnt lgkmcnt(8)
TR 4,14,8480
Mvaa 200,12,204
s_add_u32 m0, s52, 0x2520
TR 6,14,8992
Mvaa 196,12,200
buffer_load_dwordx4 v11, s[24:27], s50 offen lds
Mvaa 208,16,200
s_waitcnt lgkmcnt(8)
TR 8,14,8512
Mvaa 212,16,204
s_add_u32 s51, s79, 0x10800
TR 10,14,9024
Mvaa 216,16,208
buffer_load_dwordx4 a[32:35], v20, s[20:23], s51 offen sc1
Mvaa 228,20,208
TR 12,14,8544
Mvaa 224,20,204
s_waitcnt lgkmcnt(9)
TR 14,14,9056
Mvaa 220,20,200
buffer_load_dwordx4 a[44:47], v20, s[20:23], s51 offen offset:1024 sc1
Mvaa 232,24,200
TR 16,14,8576
Mvaa 236,24,204
s_waitcnt lgkmcnt(9)
TR 18,14,9088
Mvaa 240,24,208
buffer_load_dwordx4 a[36:39], v12, s[20:23], s51 offen sc1
Mvaa 252,28,208
TR 20,14,8608
Mvaa 248,28,204
s_waitcnt lgkmcnt(9)
TR 22,14,9120
Mvaa 244,28,200
buffer_load_dwordx4 a[48:51], v12, s[20:23], s51 offen offset:1024 sc1
Mvaa 160,0,212
TR 24,14,8640
Mvaa 164,0,216
s_waitcnt vmcnt(38) lgkmcnt(9)
TR 26,14,9152
Mvaa 168,0,220
buffer_load_dwordx4 a[40:43], v21, s[20:23], s51 offen sc1
Mvaa 180,4,220
TR 28,14,8672
Mvaa 176,4,216
s_waitcnt lgkmcnt(9)
TR 30,14,9184
Mvaa 172,4,212
buffer_load_dwordx4 a[52:55], v21, s[20:23], s51 offen offset:1024 sc1
Mvaa 184,8,212
Mvaa 188,8,216
Mvaa 192,8,220
s_waitcnt lgkmcnt(8)
Mvaa 204,12,220
Mvaa 200,12,216
v_add_u32 v14, 0x8400, v17
Mvaa 196,12,212
s_waitcnt vmcnt(63) lgkmcnt(0)
s_barrier
Mvaa 208,16,212
TR 0,14,0
Mvaa 212,16,216
TR 2,14,512
Mvaa 216,16,220
TR 4,14,32
Mvaa 228,20,220
TR 6,14,544
Mvaa 224,20,216
TR 8,14,64
Mvaa 220,20,212
TR 10,14,576
Mvaa 232,24,212
TR 12,14,96
Mvaa 236,24,216
TR 14,14,608
Mvaa 240,24,220
TR 16,14,128
Mvaa 252,28,220
TR 18,14,640
Mvaa 248,28,216
TR 20,14,160
Mvaa 244,28,212
s_waitcnt vmcnt(35) lgkmcnt(9)
TR 22,14,672
fh_u24:
Mvaa 160,0,224
s_waitcnt vmcnt(31) lgkmcnt(8)
TR 24,14,192
Mvaa 164,0,228
s_add_u32 s51, s80, 0xb000
TR 26,14,704
Mvaa 168,0,232
buffer_load_dwordx4 a[128:131], v20, s[20:23], s51 offen sc1
Mvaa 180,4,232
TR 28,14,224
Mvaa 176,4,228
s_waitcnt lgkmcnt(9)
TR 30,14,736
Mvaa 172,4,224
buffer_load_dwordx4 a[140:143], v20, s[20:23], s51 offen offset:1024 sc1
Mvaa 184,8,224
TR 0,14,8448
Mvaa 188,8,228
s_waitcnt lgkmcnt(9)
TR 2,14,8960
Mvaa 192,8,232
buffer_load_dwordx4 a[132:135], v12, s[20:23], s51 offen sc1
Mvaa 204,12,232
TR 4,14,8480
Mvaa 200,12,228
s_waitcnt lgkmcnt(9)
TR 6,14,8992
Mvaa 196,12,224
buffer_load_dwordx4 a[144:147], v12, s[20:23], s51 offen offset:1024 sc1
Mvaa 208,16,224
TR 8,14,8512
Mvaa 212,16,228
s_waitcnt lgkmcnt(9)
TR 10,14,9024
Mvaa 216,16,232
buffer_load_dwordx4 a[136:139], v21, s[20:23], s51 offen sc1
Mvaa 228,20,232
TR 12,14,8544
Mvaa 224,20,228
s_waitcnt lgkmcnt(9)
TR 14,14,9056
Mvaa 220,20,224
buffer_load_dwordx4 a[148:151], v21, s[20:23], s51 offen offset:1024 sc1
Mvaa 232,24,224
s_waitcnt lgkmcnt(8)
TR 16,14,8576
Mvaa 236,24,228
s_add_u32 s51, s80, 0x10800
TR 18,14,9088
Mvaa 240,24,232
buffer_load_dwordx4 a[152:155], v20, s[20:23], s51 offen sc1
Mvaa 252,28,232
TR 20,14,8608
Mvaa 248,28,228
s_waitcnt lgkmcnt(9)
TR 22,14,9120
Mvaa 244,28,224
buffer_load_dwordx4 a[164:167], v20, s[20:23], s51 offen offset:1024 sc1
Mvaa 160,0,236
TR 24,14,8640
Mvaa 164,0,240
s_waitcnt vmcnt(38) lgkmcnt(9)
TR 26,14,9152
Mvaa 168,0,244
buffer_load_dwordx4 a[156:159], v12, s[20:23], s51 offen sc1
Mvaa 180,4,244
TR 28,14,8672
Mvaa 176,4,240
s_waitcnt lgkmcnt(9)
TR 30,14,9184
Mvaa 172,4,236
buffer_load_dwordx4 a[168:171], v12, s[20:23], s51 offen offset:1024 sc1
Mvaa 184,8,236
Mvaa 188,8,240
buffer_load_dwordx4 a[160:163], v21, s[20:23], s51 offen sc1
Mvaa 192,8,244
s_waitcnt lgkmcnt(8)
Mvaa 204,12,244
buffer_load_dwordx4 a[172:175], v21, s[20:23], s51 offen offset:1024 sc1
Mvaa 200,12,240
v_add_u32 v14, 0xc600, v17
Mvaa 196,12,236
s_waitcnt vmcnt(63) lgkmcnt(0)
s_barrier
Mvaa 208,16,236
TR 0,14,0
Mvaa 212,16,240
TR 2,14,512
Mvaa 216,16,244
TR 4,14,32
Mvaa 228,20,244
TR 6,14,544
Mvaa 224,20,240
TR 8,14,64
Mvaa 220,20,236
TR 10,14,576
Mvaa 232,24,236
TR 12,14,96
Mvaa 236,24,240
TR 14,14,608
Mvaa 240,24,244
TR 16,14,128
Mvaa 252,28,244
TR 18,14,640
Mvaa 248,28,240
TR 20,14,160
Mvaa 244,28,236
s_waitcnt vmcnt(37) lgkmcnt(9)
TR 22,14,672
fh_u25:
Mvaa 160,0,80
s_waitcnt vmcnt(33) lgkmcnt(8)
TR 24,14,192
Mvaa 164,0,84
s_add_u32 s51, s81, 0xb000
TR 26,14,704
Mvaa 168,0,88
buffer_load_dwordx4 a[176:179], v20, s[20:23], s51 offen sc1
Mvaa 180,4,88
TR 28,14,224
Mvaa 176,4,84
s_waitcnt lgkmcnt(9)
TR 30,14,736
Mvaa 172,4,80
buffer_load_dwordx4 a[188:191], v20, s[20:23], s51 offen offset:1024 sc1
Mvaa 184,8,80
TR 0,14,8448
Mvaa 188,8,84
s_waitcnt lgkmcnt(9)
TR 2,14,8960
Mvaa 192,8,88
buffer_load_dwordx4 a[180:183], v12, s[20:23], s51 offen sc1
Mvaa 204,12,88
TR 4,14,8480
Mvaa 200,12,84
s_waitcnt lgkmcnt(9)
TR 6,14,8992
Mvaa 196,12,80
buffer_load_dwordx4 a[192:195], v12, s[20:23], s51 offen offset:1024 sc1
Mvaa 208,16,80
TR 8,14,8512
Mvaa 212,16,84
s_waitcnt lgkmcnt(9)
TR 10,14,9024
Mvaa 216,16,88
buffer_load_dwordx4 a[184:187], v21, s[20:23], s51 offen sc1
Mvaa 228,20,88
TR 12,14,8544
Mvaa 224,20,84
s_waitcnt lgkmcnt(9)
TR 14,14,9056
Mvaa 220,20,80
buffer_load_dwordx4 a[196:199], v21, s[20:23], s51 offen offset:1024 sc1
Mvaa 232,24,80
s_waitcnt lgkmcnt(8)
TR 16,14,8576
Mvaa 236,24,84
s_add_u32 s51, s81, 0x10800
TR 18,14,9088
Mvaa 240,24,88
buffer_load_dwordx4 a[200:203], v20, s[20:23], s51 offen sc1
Mvaa 252,28,88
TR 20,14,8608
Mvaa 248,28,84
s_waitcnt lgkmcnt(9)
TR 22,14,9120
Mvaa 244,28,80
buffer_load_dwordx4 a[212:215], v20, s[20:23], s51 offen offset:1024 sc1
Mvaa 160,0,92
TR 24,14,8640
Mvaa 164,0,96
s_waitcnt vmcnt(40) lgkmcnt(9)
TR 26,14,9152
Mvaa 168,0,100
buffer_load_dwordx4 a[204:207], v12, s[20:23], s51 offen sc1
Mvaa 180,4,100
TR 28,14,8672
Mvaa 176,4,96
s_waitcnt lgkmcnt(9)
TR 30,14,9184
Mvaa 172,4,92
buffer_load_dwordx4 a[216:219], v12, s[20:23], s51 offen offset:1024 sc1
Mvaa 184,8,92
Mvaa 188,8,96
buffer_load_dwordx4 a[208:211], v21, s[20:23], s51 offen sc1
Mvaa 192,8,100
s_waitcnt lgkmcnt(8)
Mvaa 204,12,100
buffer_load_dwordx4 a[220:223], v21, s[20:23], s51 offen offset:1024 sc1
Mvaa 200,12,96
v_add_u32 v14, 0x10800, v17
Mvaa 196,12,92
s_waitcnt vmcnt(63) lgkmcnt(0)
s_barrier
Mvaa 208,16,92
TR 0,14,0
Mvaa 212,16,96
TR 2,14,512
Mvaa 216,16,100
TR 4,14,32
Mvaa 228,20,100
TR 6,14,544
Mvaa 224,20,96
TR 8,14,64
Mvaa 220,20,92
TR 10,14,576
Mvaa 232,24,92
TR 12,14,96
Mvaa 236,24,96
TR 14,14,608
Mvaa 240,24,100
s_branch f_pad21s
f_pad21:
s_setpc_b64 s[70:71]
f_pad21s:
TR 16,14,128
Mvaa 252,28,100
TR 18,14,640
Mvaa 248,28,96
TR 20,14,160
Mvaa 244,28,92
s_waitcnt vmcnt(39) lgkmcnt(9)
TR 22,14,672
fh_u26:
Mvaa 160,0,104
s_waitcnt vmcnt(37)
TR 24,14,192
Mvaa 164,0,108
s_waitcnt vmcnt(35)
TR 26,14,704
Mvaa 168,0,112
s_waitcnt lgkmcnt(10)
Mvaa 180,4,112
TR 28,14,224
Mvaa 176,4,108
TR 30,14,736
Mvaa 172,4,104
s_waitcnt lgkmcnt(10)
Mvaa 184,8,104
TR 0,14,8448
Mvaa 188,8,108
TR 2,14,8960
Mvaa 192,8,112
s_waitcnt lgkmcnt(10)
Mvaa 204,12,112
TR 4,14,8480
Mvaa 200,12,108
TR 6,14,8992
Mvaa 196,12,104
s_waitcnt lgkmcnt(10)
Mvaa 208,16,104
TR 8,14,8512
Mvaa 212,16,108
TR 10,14,9024
Mvaa 216,16,112
s_waitcnt lgkmcnt(10)
Mvaa 228,20,112
TR 12,14,8544
Mvaa 224,20,108
TR 14,14,9056
Mvaa 220,20,104
s_waitcnt lgkmcnt(10)
Mvaa 232,24,104
TR 16,14,8576
Mvaa 236,24,108
TR 18,14,9088
Mvaa 240,24,112
s_waitcnt lgkmcnt(10)
Mvaa 252,28,112
TR 20,14,8608
Mvaa 248,28,108
TR 22,14,9120
Mvaa 244,28,104
s_waitcnt lgkmcnt(10)
Mvaa 160,0,116
TR 24,14,8640
Mvaa 164,0,120
s_waitcnt vmcnt(34)
TR 26,14,9152
Mvaa 168,0,124
s_waitcnt lgkmcnt(10)
Mvaa 180,4,124
TR 28,14,8672
Mvaa 176,4,120
TR 30,14,9184
Mvaa 172,4,116
s_waitcnt lgkmcnt(10)
Mvaa 184,8,116
Mvaa 188,8,120
Mvaa 192,8,124
s_waitcnt lgkmcnt(8)
v_add_u32 v18, 0x1c000, v17
Mvaa 204,12,124
v_add_u32 v16, 0xe000, v17
Mvaa 200,12,120
v_add_u32 v14, 0x14a00, v17
Mvaa 196,12,116
s_waitcnt vmcnt(30) lgkmcnt(0)
s_barrier
Mvaa 208,16,116
TR 0,16,27264
Mvaa 212,16,120
TR 2,16,27776
Mvaa 216,16,124
TR 4,16,35712
Mvaa 228,20,124
TR 6,16,36224
Mvaa 224,20,120
TR 8,16,44160
Mvaa 220,20,116
TR 10,16,44672
Mvaa 232,24,116
TR 12,16,52608
Mvaa 236,24,120
TR 14,16,53120
Mvaa 240,24,124
TR 16,18,3712
Mvaa 252,28,124
TR 18,18,4224
Mvaa 248,28,120
TR 20,18,12160
Mvaa 244,28,116
s_waitcnt vmcnt(29) lgkmcnt(9)
TR 22,18,12672
fh_fin:
Mvaa 208,0,32
s_waitcnt vmcnt(27)
s_add_u32 s44, s59, 0x1000
TR 24,18,20608
Mvaa 212,0,36
s_waitcnt vmcnt(25)
TR 26,18,21120
Mvaa 216,0,40
s_waitcnt lgkmcnt(10)
Mvaa 208,4,44
TR 28,18,29056
Mvaa 212,4,48
s_waitcnt vmcnt(24)
TR 30,18,29568
Mvaa 216,4,52
s_waitcnt vmcnt(23) lgkmcnt(10)
Mvaa 208,8,128
s_waitcnt vmcnt(21)
TR 0,17,128
Mvaa 212,8,132
s_waitcnt vmcnt(19)
TR 2,17,640
Mvaa 216,8,136
s_waitcnt lgkmcnt(10)
Mvaa 208,12,140
TR 4,17,8576
Mvaa 212,12,144
s_waitcnt vmcnt(18)
TR 6,17,9088
Mvaa 216,12,148
s_waitcnt vmcnt(17) lgkmcnt(10)
Mvaa 208,16,152
s_waitcnt vmcnt(15)
TR 8,16,27296
Mvaa 212,16,156
s_waitcnt vmcnt(13)
TR 10,16,27808
Mvaa 216,16,160
s_waitcnt lgkmcnt(10)
Mvaa 208,20,164
TR 12,16,35744
Mvaa 212,20,168
s_waitcnt vmcnt(12)
TR 14,16,36256
Mvaa 216,20,172
s_waitcnt vmcnt(11) lgkmcnt(10)
Mvaa 208,24,176
s_waitcnt vmcnt(9)
TR 16,16,44192
Mvaa 212,24,180
s_waitcnt vmcnt(7)
TR 18,16,44704
Mvaa 216,24,184
s_waitcnt lgkmcnt(10)
Mvaa 208,28,188
TR 20,16,52640
Mvaa 212,28,192
s_waitcnt vmcnt(6)
TR 22,16,53152
Mvaa 216,28,196
s_waitcnt vmcnt(5) lgkmcnt(10)
Mvaa 208,0,200
s_waitcnt vmcnt(3)
TR 24,18,3744
Mvaa 212,0,204
s_waitcnt vmcnt(1)
TR 26,18,4256
Mvaa 216,0,208
s_waitcnt lgkmcnt(10)
Mvaa 208,4,212
TR 28,18,12192
Mvaa 212,4,216
s_waitcnt vmcnt(0)
TR 30,18,12704
Mvaa 216,4,220
s_waitcnt lgkmcnt(10)
Mvaa 220,8,32
TR 0,18,20640
Mvaa 224,8,36
TR 2,18,21152
Mvaa 228,8,40
s_waitcnt lgkmcnt(10)
Mvaa 220,12,44
TR 4,18,29088
Mvaa 224,12,48
TR 6,18,29600
Mvaa 228,12,52
s_waitcnt lgkmcnt(10)
Mvaa 220,16,128
TR 8,17,160
Mvaa 224,16,132
TR 10,17,672
Mvaa 228,16,136
s_waitcnt lgkmcnt(10)
Mvaa 220,20,140
TR 12,17,8608
Mvaa 224,20,144
TR 14,17,9120
Mvaa 228,20,148
s_waitcnt lgkmcnt(10)
Mvaa 220,24,152
TR 16,16,27328
Mvaa 224,24,156
TR 18,16,27840
Mvaa 228,24,160
s_waitcnt lgkmcnt(10)
Mvaa 220,28,164
TR 20,16,35776
Mvaa 224,28,168
TR 22,16,36288
Mvaa 228,28,172
s_waitcnt lgkmcnt(10)
Mvaa 220,0,176
TR 24,16,44224
Mvaa 224,0,180
TR 26,16,44736
Mvaa 228,0,184
s_waitcnt lgkmcnt(10)
Mvaa 220,4,188
TR 28,16,52672
Mvaa 224,4,192
TR 30,16,53184
Mvaa 228,4,196
s_waitcnt lgkmcnt(10)
Mvaa 220,8,200
TR 0,18,3776
Mvaa 224,8,204
TR 2,18,4288
Mvaa 228,8,208
s_waitcnt lgkmcnt(10)
Mvaa 220,12,212
TR 4,18,12224
Mvaa 224,12,216
TR 6,18,12736
Mvaa 228,12,220
s_waitcnt lgkmcnt(10)
Mvaa 232,16,32
TR 8,18,20672
Mvaa 236,16,36
TR 10,18,21184
Mvaa 240,16,40
s_waitcnt lgkmcnt(10)
Mvaa 232,20,44
TR 12,18,29120
v_cvt_pk_bf16_f32 v112, v208, v209
Mvaa 236,20,48
TR 14,18,29632
v_cvt_pk_bf16_f32 v113, v210, v211
Mvaa 240,20,52
s_waitcnt lgkmcnt(10)
Mvaa 232,24,128
TR 16,17,192
v_cvt_pk_bf16_f32 v114, v220, v221
Mvaa 236,24,132
s_waitcnt lgkmcnt(9)
TR 18,17,704
v_cvt_pk_bf16_f32 v115, v222, v223
Mvaa 240,24,136
buffer_store_dwordx4 v[112:115], v20, s[20:23], s59 offen sc1
Mvaa 232,28,140
TR 20,17,8640
v_cvt_pk_bf16_f32 v116, v212, v213
Mvaa 236,28,144
TR 22,17,9152
v_cvt_pk_bf16_f32 v117, v214, v215
Mvaa 240,28,148
s_waitcnt lgkmcnt(10)
Mvaa 232,0,152
TR 24,16,27360
v_cvt_pk_bf16_f32 v118, v224, v225
Mvaa 236,0,156
s_waitcnt lgkmcnt(9)
TR 26,16,27872
v_cvt_pk_bf16_f32 v119, v226, v227
Mvaa 240,0,160
buffer_store_dwordx4 v[116:119], v20, s[20:23], s59 offen offset:1024 sc1
Mvaa 232,4,164
TR 28,16,35808
v_cvt_pk_bf16_f32 v120, v216, v217
Mvaa 236,4,168
TR 30,16,36320
v_cvt_pk_bf16_f32 v121, v218, v219
Mvaa 240,4,172
s_waitcnt lgkmcnt(10)
Mvaa 232,8,176
TR 0,16,44256
v_cvt_pk_bf16_f32 v122, v228, v229
Mvaa 236,8,180
s_waitcnt lgkmcnt(9)
TR 2,16,44768
v_cvt_pk_bf16_f32 v123, v230, v231
Mvaa 240,8,184
buffer_store_dwordx4 v[120:123], v20, s[20:23], s59 offen offset:2048 sc1
Mvaa 232,12,188
TR 4,16,52704
Mvaa 236,12,192
TR 6,16,53216
Mvaa 240,12,196
s_waitcnt lgkmcnt(10)
Mvaa 232,16,200
TR 8,18,3808
Mvaa 236,16,204
TR 10,18,4320
Mvaa 240,16,208
s_waitcnt lgkmcnt(10)
Mvaa 232,20,212
TR 12,18,12256
Mvaa 236,20,216
TR 14,18,12768
Mvaa 240,20,220
s_waitcnt lgkmcnt(10)
Mvaa 244,24,32
TR 16,18,20704
Mvaa 248,24,36
TR 18,18,21216
Mvaa 252,24,40
s_waitcnt lgkmcnt(10)
Mvaa 244,28,44
TR 20,18,29152
Mvaa 248,28,48
TR 22,18,29664
Mvaa 252,28,52
s_waitcnt lgkmcnt(10)
Mvaa 244,0,128
TR 24,17,224
Mvaa 248,0,132
TR 26,17,736
Mvaa 252,0,136
s_waitcnt lgkmcnt(10)
Mvaa 244,4,140
TR 28,17,8672
Mvaa 248,4,144
TR 30,17,9184
Mvaa 252,4,148
s_waitcnt lgkmcnt(10)
Mvaa 244,8,152
TR 0,16,27136
Mvaa 248,8,156
TR 2,16,27648
Mvaa 252,8,160
s_waitcnt lgkmcnt(10)
Mvaa 244,12,164
TR 4,16,35584
Mvaa 248,12,168
TR 6,16,36096
Mvaa 252,12,172
s_waitcnt lgkmcnt(10)
Mvaa 244,16,176
TR 8,16,44032
Mvaa 248,16,180
TR 10,16,44544
Mvaa 252,16,184
s_waitcnt lgkmcnt(10)
Mvaa 244,20,188
TR 12,16,52480
Mvaa 248,20,192
TR 14,16,52992
Mvaa 252,20,196
s_waitcnt lgkmcnt(10)
Mvaa 244,24,200
TR 16,18,3584
Mvaa 248,24,204
TR 18,18,4096
Mvaa 252,24,208
s_waitcnt lgkmcnt(10)
Mvaa 244,28,212
TR 20,18,12032
Mvaa 248,28,216
TR 22,18,12544
Mvaa 252,28,220
s_waitcnt lgkmcnt(10)
Mvaa 160,0,32
TR 24,18,20480
Mvaa 164,0,36
TR 26,18,20992
Mvaa 168,0,40
s_waitcnt lgkmcnt(10)
Mvaa 160,4,44
TR 28,18,28928
v_cvt_pk_bf16_f32 v124, v232, v233
Mvaa 164,4,48
TR 30,18,29440
v_cvt_pk_bf16_f32 v125, v234, v235
Mvaa 168,4,52
s_waitcnt lgkmcnt(10)
Mvaa 160,8,128
TR 0,17,0
v_cvt_pk_bf16_f32 v126, v244, v245
Mvaa 164,8,132
s_waitcnt lgkmcnt(9)
TR 2,17,512
v_cvt_pk_bf16_f32 v127, v246, v247
Mvaa 168,8,136
buffer_store_dwordx4 v[124:127], v20, s[20:23], s59 offen offset:3072 sc1
Mvaa 160,12,140
TR 4,17,8448
v_cvt_pk_bf16_f32 v128, v236, v237
Mvaa 164,12,144
TR 6,17,8960
v_cvt_pk_bf16_f32 v129, v238, v239
Mvaa 168,12,148
s_waitcnt lgkmcnt(10)
Mvaa 160,16,152
TR 8,16,27168
v_cvt_pk_bf16_f32 v130, v248, v249
Mvaa 164,16,156
s_waitcnt lgkmcnt(9)
TR 10,16,27680
v_cvt_pk_bf16_f32 v131, v250, v251
Mvaa 168,16,160
buffer_store_dwordx4 v[128:131], v20, s[20:23], s44 offen sc1
Mvaa 160,20,164
TR 12,16,35616
v_cvt_pk_bf16_f32 v132, v240, v241
Mvaa 164,20,168
TR 14,16,36128
v_cvt_pk_bf16_f32 v133, v242, v243
Mvaa 168,20,172
s_waitcnt lgkmcnt(10)
Mvaa 160,24,176
TR 16,16,44064
v_cvt_pk_bf16_f32 v134, v252, v253
Mvaa 164,24,180
s_waitcnt lgkmcnt(9)
TR 18,16,44576
v_cvt_pk_bf16_f32 v135, v254, v255
Mvaa 168,24,184
buffer_store_dwordx4 v[132:135], v20, s[20:23], s44 offen offset:1024 sc1
Mvaa 160,28,188
TR 20,16,52512
Mvaa 164,28,192
TR 22,16,53024
Mvaa 168,28,196
s_waitcnt lgkmcnt(10)
Mvaa 160,0,200
TR 24,18,3616
Mvaa 164,0,204
TR 26,18,4128
Mvaa 168,0,208
s_waitcnt lgkmcnt(10)
Mvaa 160,4,212
TR 28,18,12064
Mvaa 164,4,216
TR 30,18,12576
Mvaa 168,4,220
s_waitcnt lgkmcnt(10)
Mvaa 172,8,32
TR 0,18,20512
Mvaa 176,8,36
TR 2,18,21024
Mvaa 180,8,40
s_waitcnt lgkmcnt(10)
Mvaa 172,12,44
TR 4,18,28960
Mvaa 176,12,48
TR 6,18,29472
Mvaa 180,12,52
s_waitcnt lgkmcnt(10)
Mvaa 172,16,128
TR 8,17,32
Mvaa 176,16,132
TR 10,17,544
Mvaa 180,16,136
s_waitcnt lgkmcnt(10)
Mvaa 172,20,140
TR 12,17,8480
Mvaa 176,20,144
TR 14,17,8992
Mvaa 180,20,148
s_waitcnt lgkmcnt(10)
Mvaa 172,24,152
TR 16,16,27200
Mvaa 176,24,156
TR 18,16,27712
Mvaa 180,24,160
s_waitcnt lgkmcnt(10)
Mvaa 172,28,164
TR 20,16,35648
Mvaa 176,28,168
TR 22,16,36160
Mvaa 180,28,172
s_waitcnt lgkmcnt(10)
Mvaa 172,0,176
TR 24,16,44096
Mvaa 176,0,180
TR 26,16,44608
Mvaa 180,0,184
s_waitcnt vmcnt(0) lgkmcnt(10)
s_barrier
Mvaa 172,4,188
s_add_u32 s44, s60, 0x1000
TR 28,16,52544
Mvaa 176,4,192
TR 30,16,53056
Mvaa 180,4,196
s_waitcnt lgkmcnt(10)
Mvaa 172,8,200
TR 0,18,3648
Mvaa 176,8,204
TR 2,18,4160
Mvaa 180,8,208
s_waitcnt lgkmcnt(10)
Mvaa 172,12,212
TR 4,18,12096
Mvaa 176,12,216
TR 6,18,12608
Mvaa 180,12,220
s_waitcnt lgkmcnt(10)
Mvaa 184,16,32
TR 8,18,20544
Mvaa 188,16,36
s_waitcnt lgkmcnt(9)
TR 10,18,21056
Mvaa 192,16,40
buffer_load_dword v30, v28, s[20:23], s61 offen sc1
Mvaa 184,20,44
TR 12,18,28992
Mvaa 188,20,48
TR 14,18,29504
Mvaa 192,20,52
s_waitcnt lgkmcnt(10)
Mvaa 184,24,128
TR 16,17,64
Mvaa 188,24,132
TR 18,17,576
Mvaa 192,24,136
s_waitcnt lgkmcnt(10)
Mvaa 184,28,140
TR 20,17,8512
Mvaa 188,28,144
TR 22,17,9024
Mvaa 192,28,148
s_waitcnt lgkmcnt(10)
Mvaa 184,0,152
TR 24,16,27232
Mvaa 188,0,156
TR 26,16,27744
Mvaa 192,0,160
s_waitcnt lgkmcnt(10)
Mvaa 184,4,164
TR 28,16,35680
Mvaa 188,4,168
TR 30,16,36192
Mvaa 192,4,172
s_waitcnt lgkmcnt(10)
Mvaa 184,8,176
TR 0,16,44128
Mvaa 188,8,180
TR 2,16,44640
Mvaa 192,8,184
s_waitcnt lgkmcnt(10)
Mvaa 184,12,188
s_branch f_pad22s
f_pad22:
s_setpc_b64 s[70:71]
f_pad22s:
TR 4,16,52576
Mvaa 188,12,192
TR 6,16,53088
Mvaa 192,12,196
s_waitcnt lgkmcnt(10)
Mvaa 184,16,200
TR 8,18,3680
Mvaa 188,16,204
TR 10,18,4192
Mvaa 192,16,208
s_waitcnt vmcnt(0)
v_readfirstlane_b32 s43, v30
s_nop 0
s_cmp_lt_u32 s43, 1
s_cbranch_scc1 fh_xskip
buffer_load_dwordx4 v[64:67], v20, s[20:23], s60 offen sc1
buffer_load_dwordx4 v[68:71], v20, s[20:23], s60 offen offset:1024 sc1
buffer_load_dwordx4 v[72:75], v20, s[20:23], s60 offen offset:2048 sc1
buffer_load_dwordx4 v[76:79], v20, s[20:23], s60 offen offset:3072 sc1
buffer_load_dwordx4 v[80:83], v20, s[20:23], s44 offen sc1
buffer_load_dwordx4 v[84:87], v20, s[20:23], s44 offen offset:1024 sc1
fh_xskip:
s_waitcnt lgkmcnt(10)
Mvaa 184,20,212
TR 12,18,12128
Mvaa 188,20,216
TR 14,18,12640
Mvaa 192,20,220
s_waitcnt lgkmcnt(10)
Mvaa 196,24,32
TR 16,18,20576
Mvaa 200,24,36
TR 18,18,21088
Mvaa 204,24,40
s_waitcnt lgkmcnt(10)
Mvaa 196,28,44
TR 20,18,29024
Mvaa 200,28,48
TR 22,18,29536
Mvaa 204,28,52
s_waitcnt lgkmcnt(10)
Mvaa 196,0,128
TR 24,17,96
Mvaa 200,0,132
TR 26,17,608
Mvaa 204,0,136
s_waitcnt lgkmcnt(10)
Mvaa 196,4,140
TR 28,17,8544
Mvaa 200,4,144
TR 30,17,9056
Mvaa 204,4,148
s_waitcnt lgkmcnt(10)
Mvaa 196,8,152
Mvaa 200,8,156
Mvaa 204,8,160
s_waitcnt lgkmcnt(8)
Mvaa 196,12,164
Mvaa 200,12,168
Mvaa 204,12,172
s_waitcnt lgkmcnt(6)
Mvaa 196,16,176
Mvaa 200,16,180
Mvaa 204,16,184
s_waitcnt lgkmcnt(4)
Mvaa 196,20,188
Mvaa 200,20,192
Mvaa 204,20,196
s_waitcnt lgkmcnt(2)
Mvaa 196,24,200
Mvaa 200,24,204
Mvaa 204,24,208
s_waitcnt lgkmcnt(0)
Mvaa 196,28,212
Mvaa 200,28,216
Mvaa 204,28,220
s_cmp_lt_u32 s43, 1
s_cbranch_scc1 fh_px_spin
fh_xgo:
s_waitcnt vmcnt(0)
s_mov_b32 s42, 0xffff0000
v_lshlrev_b32 v32, 16, v64
v_and_b32 v33, s42, v64
v_lshlrev_b32 v34, 16, v65
v_and_b32 v35, s42, v65
v_pk_add_f32 v[160:161], v[160:161], v[32:33]
v_pk_add_f32 v[162:163], v[162:163], v[34:35]
v_lshlrev_b32 v32, 16, v66
v_and_b32 v33, s42, v66
v_lshlrev_b32 v34, 16, v67
v_and_b32 v35, s42, v67
v_pk_add_f32 v[172:173], v[172:173], v[32:33]
v_pk_add_f32 v[174:175], v[174:175], v[34:35]
v_cvt_pk_bf16_f32 v136, v160, v161
v_cvt_pk_bf16_f32 v137, v162, v163
v_cvt_pk_bf16_f32 v138, v172, v173
v_cvt_pk_bf16_f32 v139, v174, v175
v_lshlrev_b32 v32, 16, v68
v_and_b32 v33, s42, v68
v_lshlrev_b32 v34, 16, v69
v_and_b32 v35, s42, v69
v_pk_add_f32 v[164:165], v[164:165], v[32:33]
v_pk_add_f32 v[166:167], v[166:167], v[34:35]
v_lshlrev_b32 v32, 16, v70
v_and_b32 v33, s42, v70
v_lshlrev_b32 v34, 16, v71
v_and_b32 v35, s42, v71
v_pk_add_f32 v[176:177], v[176:177], v[32:33]
v_pk_add_f32 v[178:179], v[178:179], v[34:35]
v_cvt_pk_bf16_f32 v140, v164, v165
v_cvt_pk_bf16_f32 v141, v166, v167
v_cvt_pk_bf16_f32 v142, v176, v177
v_cvt_pk_bf16_f32 v143, v178, v179
v_lshlrev_b32 v32, 16, v72
v_and_b32 v33, s42, v72
v_lshlrev_b32 v34, 16, v73
v_and_b32 v35, s42, v73
v_pk_add_f32 v[168:169], v[168:169], v[32:33]
v_pk_add_f32 v[170:171], v[170:171], v[34:35]
v_lshlrev_b32 v32, 16, v74
v_and_b32 v33, s42, v74
v_lshlrev_b32 v34, 16, v75
v_and_b32 v35, s42, v75
v_pk_add_f32 v[180:181], v[180:181], v[32:33]
v_pk_add_f32 v[182:183], v[182:183], v[34:35]
v_cvt_pk_bf16_f32 v144, v168, v169
v_cvt_pk_bf16_f32 v145, v170, v171
v_cvt_pk_bf16_f32 v146, v180, v181
v_cvt_pk_bf16_f32 v147, v182, v183
v_permlane32_swap_b32 v136, v138
v_permlane32_swap_b32 v137, v139
v_permlane32_swap_b32 v140, v142
v_permlane32_swap_b32 v141, v143
v_permlane32_swap_b32 v144, v146
v_permlane32_swap_b32 v145, v147
v_permlane16_swap_b32 v136, v138
v_permlane16_swap_b32 v137, v139
v_permlane16_swap_b32 v140, v142
v_permlane16_swap_b32 v141, v143
v_permlane16_swap_b32 v144, v146
v_permlane16_swap_b32 v145, v147
s_mov_b32 s41, 0
buffer_store_dwordx4 v[136:139], v22, s[28:31], s41 offen nt
s_mov_b32 s41, 0x10000
buffer_store_dwordx4 v[140:143], v22, s[28:31], s41 offen nt
s_mov_b32 s41, 0x20000
buffer_store_dwordx4 v[144:147], v22, s[28:31], s41 offen nt
v_lshlrev_b32 v32, 16, v76
v_and_b32 v33, s42, v76
v_lshlrev_b32 v34, 16, v77
v_and_b32 v35, s42, v77
v_pk_add_f32 v[184:185], v[184:185], v[32:33]
v_pk_add_f32 v[186:187], v[186:187], v[34:35]
v_lshlrev_b32 v32, 16, v78
v_and_b32 v33, s42, v78
v_lshlrev_b32 v34, 16, v79
v_and_b32 v35, s42, v79
v_pk_add_f32 v[196:197], v[196:197], v[32:33]
v_pk_add_f32 v[198:199], v[198:199], v[34:35]
v_cvt_pk_bf16_f32 v148, v184, v185
v_cvt_pk_bf16_f32 v149, v186, v187
v_cvt_pk_bf16_f32 v150, v196, v197
v_cvt_pk_bf16_f32 v151, v198, v199
v_lshlrev_b32 v32, 16, v80
v_and_b32 v33, s42, v80
v_lshlrev_b32 v34, 16, v81
v_and_b32 v35, s42, v81
v_pk_add_f32 v[188:189], v[188:189], v[32:33]
v_pk_add_f32 v[190:191], v[190:191], v[34:35]
v_lshlrev_b32 v32, 16, v82
v_and_b32 v33, s42, v82
v_lshlrev_b32 v34, 16, v83
v_and_b32 v35, s42, v83
v_pk_add_f32 v[200:201], v[200:201], v[32:33]
v_pk_add_f32 v[202:203], v[202:203], v[34:35]
v_cvt_pk_bf16_f32 v152, v188, v189
v_cvt_pk_bf16_f32 v153, v190, v191
v_cvt_pk_bf16_f32 v154, v200, v201
v_cvt_pk_bf16_f32 v155, v202, v203
v_lshlrev_b32 v32, 16, v84
v_and_b32 v33, s42, v84
v_lshlrev_b32 v34, 16, v85
v_and_b32 v35, s42, v85
v_pk_add_f32 v[192:193], v[192:193], v[32:33]
v_pk_add_f32 v[194:195], v[194:195], v[34:35]
v_lshlrev_b32 v32, 16, v86
v_and_b32 v33, s42, v86
v_lshlrev_b32 v34, 16, v87
v_and_b32 v35, s42, v87
v_pk_add_f32 v[204:205], v[204:205], v[32:33]
v_pk_add_f32 v[206:207], v[206:207], v[34:35]
v_cvt_pk_bf16_f32 v156, v192, v193
v_cvt_pk_bf16_f32 v157, v194, v195
v_cvt_pk_bf16_f32 v158, v204, v205
v_cvt_pk_bf16_f32 v159, v206, v207
v_permlane32_swap_b32 v148, v150
v_permlane32_swap_b32 v149, v151
v_permlane32_swap_b32 v152, v154
v_permlane32_swap_b32 v153, v155
v_permlane32_swap_b32 v156, v158
v_permlane32_swap_b32 v157, v159
v_permlane16_swap_b32 v148, v150
v_permlane16_swap_b32 v149, v151
v_permlane16_swap_b32 v152, v154
v_permlane16_swap_b32 v153, v155
v_permlane16_swap_b32 v156, v158
v_permlane16_swap_b32 v157, v159
s_mov_b32 s41, 0
buffer_store_dwordx4 v[148:151], v22, s[28:31], s41 offen offset:64 nt
s_mov_b32 s41, 0x10000
buffer_store_dwordx4 v[152:155], v22, s[28:31], s41 offen offset:64 nt
s_mov_b32 s41, 0x20000
buffer_store_dwordx4 v[156:159], v22, s[28:31], s41 offen offset:64 nt
s_endpgm
f_hend:
fh_slow0:
s_waitcnt vmcnt(0) lgkmcnt(0)
v_and_b32 v2, 15, v1
v_lshrrev_b32 v3, 4, v1
v_lshlrev_b32 v5, 8, v2
v_lshl_add_u32 v5, v3, 4, v5
v_lshlrev_b32 v13, 10, v3
v_lshl_add_u32 v13, v2, 1, v13
v_mov_b32 v2, 0xff800000
v_mov_b32 v3, 0xff800000
v_mov_b32 v4, 0xff800000
s_mov_b32 s41, 0
fh_s10:
s_add_u32 s42, s41, 0
buffer_load_dwordx4 a[32:35], v5, s[12:15], s42 offen
buffer_load_dwordx4 a[36:39], v5, s[12:15], s42 offen offset:64
buffer_load_dwordx4 a[40:43], v5, s[12:15], s42 offen offset:128
buffer_load_dwordx4 a[44:47], v5, s[12:15], s42 offen offset:192
s_add_u32 s42, s41, 0x1000
buffer_load_dwordx4 a[48:51], v5, s[12:15], s42 offen
buffer_load_dwordx4 a[52:55], v5, s[12:15], s42 offen offset:64
buffer_load_dwordx4 a[56:59], v5, s[12:15], s42 offen offset:128
buffer_load_dwordx4 a[60:63], v5, s[12:15], s42 offen offset:192
s_waitcnt vmcnt(0)
Zvav 136,32,64
Zvav 144,32,68
Zvav 152,32,72
Mvav 136,36,76
Mvav 144,36,80
Mvav 152,36,84
Mvav 136,40,88
Mvav 144,40,92
Mvav 152,40,96
Mvav 136,44,100
Mvav 144,44,104
Mvav 152,44,108
Zvav 140,48,64
Zvav 148,48,68
Zvav 156,48,72
Mvav 140,52,76
Mvav 148,52,80
Mvav 156,52,84
Mvav 140,56,88
Mvav 148,56,92
Mvav 156,56,96
Mvav 140,60,100
Mvav 148,60,104
Mvav 156,60,108
s_nop 7
v_max3_f32 v2, v2, v136, v137
v_max3_f32 v2, v2, v138, v139
v_max3_f32 v2, v2, v140, v141
v_max3_f32 v2, v2, v142, v143
v_max3_f32 v3, v3, v144, v145
v_max3_f32 v3, v3, v146, v147
v_max3_f32 v3, v3, v148, v149
v_max3_f32 v3, v3, v150, v151
v_max3_f32 v4, v4, v152, v153
v_max3_f32 v4, v4, v154, v155
v_max3_f32 v4, v4, v156, v157
v_max3_f32 v4, v4, v158, v159
s_add_u32 s41, s41, 0x2000
s_cmp_lt_u32 s41, 0x20000
s_cbranch_scc1 fh_s10
v_mov_b32 v32, v2
s_nop 1
v_permlane32_swap_b32 v32, v2
v_max_f32 v2, v32, v2
v_mov_b32 v32, v2
s_nop 1
v_permlane16_swap_b32 v32, v2
v_max_f32 v2, v32, v2
v_mov_b32 v52, 0
v_mov_b32 v53, 0
v_mov_b32 v54, 0
v_mov_b32 v55, 0
v_mov_b32 v32, v3
s_nop 1
v_permlane32_swap_b32 v32, v3
v_max_f32 v3, v32, v3
v_mov_b32 v32, v3
s_nop 1
v_permlane16_swap_b32 v32, v3
v_max_f32 v3, v32, v3
v_mov_b32 v56, 0
v_mov_b32 v57, 0
v_mov_b32 v58, 0
v_mov_b32 v59, 0
v_mov_b32 v32, v4
s_nop 1
v_permlane32_swap_b32 v32, v4
v_max_f32 v4, v32, v4
v_mov_b32 v32, v4
s_nop 1
v_permlane16_swap_b32 v32, v4
v_max_f32 v4, v32, v4
v_mov_b32 v60, 0
v_mov_b32 v61, 0
v_mov_b32 v62, 0
v_mov_b32 v63, 0
v_mov_b32 v160, 0
v_mov_b32 v161, 0
v_mov_b32 v162, 0
v_mov_b32 v163, 0
v_mov_b32 v164, 0
v_mov_b32 v165, 0
v_mov_b32 v166, 0
v_mov_b32 v167, 0
v_mov_b32 v168, 0
v_mov_b32 v169, 0
v_mov_b32 v170, 0
v_mov_b32 v171, 0
v_mov_b32 v172, 0
v_mov_b32 v173, 0
v_mov_b32 v174, 0
v_mov_b32 v175, 0
v_mov_b32 v176, 0
v_mov_b32 v177, 0
v_mov_b32 v178, 0
v_mov_b32 v179, 0
v_mov_b32 v180, 0
v_mov_b32 v181, 0
v_mov_b32 v182, 0
v_mov_b32 v183, 0
v_mov_b32 v184, 0
v_mov_b32 v185, 0
v_mov_b32 v186, 0
v_mov_b32 v187, 0
v_mov_b32 v188, 0
v_mov_b32 v189, 0
v_mov_b32 v190, 0
v_mov_b32 v191, 0
v_mov_b32 v192, 0
v_mov_b32 v193, 0
v_mov_b32 v194, 0
v_mov_b32 v195, 0
v_mov_b32 v196, 0
v_mov_b32 v197, 0
v_mov_b32 v198, 0
v_mov_b32 v199, 0
v_mov_b32 v200, 0
v_mov_b32 v201, 0
v_mov_b32 v202, 0
v_mov_b32 v203, 0
v_mov_b32 v204, 0
v_mov_b32 v205, 0
v_mov_b32 v206, 0
v_mov_b32 v207, 0
v_mov_b32 v208, 0
v_mov_b32 v209, 0
v_mov_b32 v210, 0
v_mov_b32 v211, 0
v_mov_b32 v212, 0
v_mov_b32 v213, 0
v_mov_b32 v214, 0
v_mov_b32 v215, 0
v_mov_b32 v216, 0
v_mov_b32 v217, 0
v_mov_b32 v218, 0
v_mov_b32 v219, 0
v_mov_b32 v220, 0
v_mov_b32 v221, 0
v_mov_b32 v222, 0
v_mov_b32 v223, 0
v_mov_b32 v224, 0
v_mov_b32 v225, 0
v_mov_b32 v226, 0
v_mov_b32 v227, 0
v_mov_b32 v228, 0
v_mov_b32 v229, 0
v_mov_b32 v230, 0
v_mov_b32 v231, 0
v_mov_b32 v232, 0
v_mov_b32 v233, 0
v_mov_b32 v234, 0
v_mov_b32 v235, 0
v_mov_b32 v236, 0
v_mov_b32 v237, 0
v_mov_b32 v238, 0
v_mov_b32 v239, 0
v_mov_b32 v240, 0
v_mov_b32 v241, 0
v_mov_b32 v242, 0
v_mov_b32 v243, 0
v_mov_b32 v244, 0
v_mov_b32 v245, 0
v_mov_b32 v246, 0
v_mov_b32 v247, 0
v_mov_b32 v248, 0
v_mov_b32 v249, 0
v_mov_b32 v250, 0
v_mov_b32 v251, 0
v_mov_b32 v252, 0
v_mov_b32 v253, 0
v_mov_b32 v254, 0
v_mov_b32 v255, 0
s_mov_b32 s41, 0
fh_s20:
s_add_u32 s42, s41, 0
buffer_load_dwordx4 a[32:35], v5, s[12:15], s42 offen
buffer_load_dwordx4 a[36:39], v5, s[12:15], s42 offen offset:64
buffer_load_dwordx4 a[40:43], v5, s[12:15], s42 offen offset:128
buffer_load_dwordx4 a[44:47], v5, s[12:15], s42 offen offset:192
s_add_u32 s42, s41, 0x1000
buffer_load_dwordx4 a[48:51], v5, s[12:15], s42 offen
buffer_load_dwordx4 a[52:55], v5, s[12:15], s42 offen offset:64
buffer_load_dwordx4 a[56:59], v5, s[12:15], s42 offen offset:128
buffer_load_dwordx4 a[60:63], v5, s[12:15], s42 offen offset:192
s_waitcnt vmcnt(0)
Zvav 136,32,64
Zvav 144,32,68
Zvav 152,32,72
Mvav 136,36,76
Mvav 144,36,80
Mvav 152,36,84
Mvav 136,40,88
Mvav 144,40,92
Mvav 152,40,96
Mvav 136,44,100
Mvav 144,44,104
Mvav 152,44,108
Zvav 140,48,64
Zvav 148,48,68
Zvav 156,48,72
Mvav 140,52,76
Mvav 148,52,80
Mvav 156,52,84
Mvav 140,56,88
Mvav 148,56,92
Mvav 156,56,96
Mvav 140,60,100
Mvav 148,60,104
Mvav 156,60,108
s_nop 7
v_sub_f32 v136, v136, v2
v_sub_f32 v137, v137, v2
v_sub_f32 v138, v138, v2
v_sub_f32 v139, v139, v2
v_sub_f32 v140, v140, v2
v_sub_f32 v141, v141, v2
v_sub_f32 v142, v142, v2
v_sub_f32 v143, v143, v2
v_sub_f32 v144, v144, v3
v_sub_f32 v145, v145, v3
v_sub_f32 v146, v146, v3
v_sub_f32 v147, v147, v3
v_sub_f32 v148, v148, v3
v_sub_f32 v149, v149, v3
v_sub_f32 v150, v150, v3
v_sub_f32 v151, v151, v3
v_sub_f32 v152, v152, v4
v_sub_f32 v153, v153, v4
v_sub_f32 v154, v154, v4
v_sub_f32 v155, v155, v4
v_sub_f32 v156, v156, v4
v_sub_f32 v157, v157, v4
v_sub_f32 v158, v158, v4
v_sub_f32 v159, v159, v4
v_exp_f32 v136, v136
v_exp_f32 v137, v137
v_exp_f32 v138, v138
v_exp_f32 v139, v139
v_exp_f32 v144, v144
v_exp_f32 v145, v145
v_exp_f32 v146, v146
v_exp_f32 v147, v147
v_exp_f32 v152, v152
v_exp_f32 v153, v153
v_exp_f32 v154, v154
v_exp_f32 v155, v155
v_exp_f32 v140, v140
v_exp_f32 v141, v141
v_exp_f32 v142, v142
v_exp_f32 v143, v143
v_exp_f32 v148, v148
v_exp_f32 v149, v149
v_exp_f32 v150, v150
v_exp_f32 v151, v151
v_exp_f32 v156, v156
v_exp_f32 v157, v157
v_exp_f32 v158, v158
v_exp_f32 v159, v159
v_cvt_pk_bf16_f32 v139, v138, v139
v_cvt_pk_bf16_f32 v138, v136, v137
v_cvt_pk_bf16_f32 v140, v140, v141
v_cvt_pk_bf16_f32 v141, v142, v143
v_cvt_pk_bf16_f32 v147, v146, v147
v_cvt_pk_bf16_f32 v146, v144, v145
v_cvt_pk_bf16_f32 v148, v148, v149
v_cvt_pk_bf16_f32 v149, v150, v151
v_cvt_pk_bf16_f32 v155, v154, v155
v_cvt_pk_bf16_f32 v154, v152, v153
v_cvt_pk_bf16_f32 v156, v156, v157
v_cvt_pk_bf16_f32 v157, v158, v159
s_add_u32 s42, s41, 0
buffer_load_ushort v32, v13, s[16:19], s42 offen offset:0
buffer_load_ushort v33, v13, s[16:19], s42 offen offset:256
buffer_load_ushort v34, v13, s[16:19], s42 offen offset:512
buffer_load_ushort v35, v13, s[16:19], s42 offen offset:768
s_add_u32 s42, s41, 0x1000
buffer_load_ushort v36, v13, s[16:19], s42 offen offset:0
buffer_load_ushort v37, v13, s[16:19], s42 offen offset:256
buffer_load_ushort v38, v13, s[16:19], s42 offen offset:512
buffer_load_ushort v39, v13, s[16:19], s42 offen offset:768
s_waitcnt vmcnt(0)
v_lshl_or_b32 v6, v33, 16, v32
v_lshl_or_b32 v7, v35, 16, v34
v_lshl_or_b32 v8, v37, 16, v36
v_lshl_or_b32 v9, v39, 16, v38
s_nop 1
Mvvv 160,6,138
Mvvv 168,6,146
Mvvv 176,6,154
s_nop 7
s_add_u32 s42, s41, 0
buffer_load_ushort v32, v13, s[16:19], s42 offen offset:32
buffer_load_ushort v33, v13, s[16:19], s42 offen offset:288
buffer_load_ushort v34, v13, s[16:19], s42 offen offset:544
buffer_load_ushort v35, v13, s[16:19], s42 offen offset:800
s_add_u32 s42, s41, 0x1000
buffer_load_ushort v36, v13, s[16:19], s42 offen offset:32
buffer_load_ushort v37, v13, s[16:19], s42 offen offset:288
buffer_load_ushort v38, v13, s[16:19], s42 offen offset:544
buffer_load_ushort v39, v13, s[16:19], s42 offen offset:800
s_waitcnt vmcnt(0)
v_lshl_or_b32 v6, v33, 16, v32
v_lshl_or_b32 v7, v35, 16, v34
v_lshl_or_b32 v8, v37, 16, v36
v_lshl_or_b32 v9, v39, 16, v38
s_nop 1
Mvvv 164,6,138
Mvvv 172,6,146
Mvvv 180,6,154
s_nop 7
s_add_u32 s42, s41, 0
buffer_load_ushort v32, v13, s[16:19], s42 offen offset:64
buffer_load_ushort v33, v13, s[16:19], s42 offen offset:320
buffer_load_ushort v34, v13, s[16:19], s42 offen offset:576
buffer_load_ushort v35, v13, s[16:19], s42 offen offset:832
s_add_u32 s42, s41, 0x1000
buffer_load_ushort v36, v13, s[16:19], s42 offen offset:64
buffer_load_ushort v37, v13, s[16:19], s42 offen offset:320
buffer_load_ushort v38, v13, s[16:19], s42 offen offset:576
buffer_load_ushort v39, v13, s[16:19], s42 offen offset:832
s_waitcnt vmcnt(0)
v_lshl_or_b32 v6, v33, 16, v32
v_lshl_or_b32 v7, v35, 16, v34
v_lshl_or_b32 v8, v37, 16, v36
v_lshl_or_b32 v9, v39, 16, v38
s_nop 1
Mvvv 184,6,138
Mvvv 192,6,146
Mvvv 200,6,154
s_nop 7
s_add_u32 s42, s41, 0
buffer_load_ushort v32, v13, s[16:19], s42 offen offset:96
buffer_load_ushort v33, v13, s[16:19], s42 offen offset:352
buffer_load_ushort v34, v13, s[16:19], s42 offen offset:608
buffer_load_ushort v35, v13, s[16:19], s42 offen offset:864
s_add_u32 s42, s41, 0x1000
buffer_load_ushort v36, v13, s[16:19], s42 offen offset:96
buffer_load_ushort v37, v13, s[16:19], s42 offen offset:352
buffer_load_ushort v38, v13, s[16:19], s42 offen offset:608
buffer_load_ushort v39, v13, s[16:19], s42 offen offset:864
s_waitcnt vmcnt(0)
v_lshl_or_b32 v6, v33, 16, v32
v_lshl_or_b32 v7, v35, 16, v34
v_lshl_or_b32 v8, v37, 16, v36
v_lshl_or_b32 v9, v39, 16, v38
s_nop 1
Mvvv 188,6,138
Mvvv 196,6,146
Mvvv 204,6,154
s_nop 7
s_add_u32 s42, s41, 0
buffer_load_ushort v32, v13, s[16:19], s42 offen offset:128
buffer_load_ushort v33, v13, s[16:19], s42 offen offset:384
buffer_load_ushort v34, v13, s[16:19], s42 offen offset:640
buffer_load_ushort v35, v13, s[16:19], s42 offen offset:896
s_add_u32 s42, s41, 0x1000
buffer_load_ushort v36, v13, s[16:19], s42 offen offset:128
buffer_load_ushort v37, v13, s[16:19], s42 offen offset:384
buffer_load_ushort v38, v13, s[16:19], s42 offen offset:640
buffer_load_ushort v39, v13, s[16:19], s42 offen offset:896
s_waitcnt vmcnt(0)
v_lshl_or_b32 v6, v33, 16, v32
v_lshl_or_b32 v7, v35, 16, v34
v_lshl_or_b32 v8, v37, 16, v36
v_lshl_or_b32 v9, v39, 16, v38
s_nop 1
Mvvv 208,6,138
Mvvv 216,6,146
Mvvv 224,6,154
s_nop 7
s_add_u32 s42, s41, 0
buffer_load_ushort v32, v13, s[16:19], s42 offen offset:160
buffer_load_ushort v33, v13, s[16:19], s42 offen offset:416
buffer_load_ushort v34, v13, s[16:19], s42 offen offset:672
buffer_load_ushort v35, v13, s[16:19], s42 offen offset:928
s_add_u32 s42, s41, 0x1000
buffer_load_ushort v36, v13, s[16:19], s42 offen offset:160
buffer_load_ushort v37, v13, s[16:19], s42 offen offset:416
buffer_load_ushort v38, v13, s[16:19], s42 offen offset:672
buffer_load_ushort v39, v13, s[16:19], s42 offen offset:928
s_waitcnt vmcnt(0)
v_lshl_or_b32 v6, v33, 16, v32
v_lshl_or_b32 v7, v35, 16, v34
v_lshl_or_b32 v8, v37, 16, v36
v_lshl_or_b32 v9, v39, 16, v38
s_nop 1
Mvvv 212,6,138
Mvvv 220,6,146
Mvvv 228,6,154
s_nop 7
s_add_u32 s42, s41, 0
buffer_load_ushort v32, v13, s[16:19], s42 offen offset:192
buffer_load_ushort v33, v13, s[16:19], s42 offen offset:448
buffer_load_ushort v34, v13, s[16:19], s42 offen offset:704
buffer_load_ushort v35, v13, s[16:19], s42 offen offset:960
s_add_u32 s42, s41, 0x1000
buffer_load_ushort v36, v13, s[16:19], s42 offen offset:192
buffer_load_ushort v37, v13, s[16:19], s42 offen offset:448
buffer_load_ushort v38, v13, s[16:19], s42 offen offset:704
buffer_load_ushort v39, v13, s[16:19], s42 offen offset:960
s_waitcnt vmcnt(0)
v_lshl_or_b32 v6, v33, 16, v32
v_lshl_or_b32 v7, v35, 16, v34
v_lshl_or_b32 v8, v37, 16, v36
v_lshl_or_b32 v9, v39, 16, v38
s_nop 1
Mvvv 232,6,138
Mvvv 240,6,146
Mvvv 248,6,154
s_nop 7
s_add_u32 s42, s41, 0
buffer_load_ushort v32, v13, s[16:19], s42 offen offset:224
buffer_load_ushort v33, v13, s[16:19], s42 offen offset:480
buffer_load_ushort v34, v13, s[16:19], s42 offen offset:736
buffer_load_ushort v35, v13, s[16:19], s42 offen offset:992
s_add_u32 s42, s41, 0x1000
buffer_load_ushort v36, v13, s[16:19], s42 offen offset:224
buffer_load_ushort v37, v13, s[16:19], s42 offen offset:480
buffer_load_ushort v38, v13, s[16:19], s42 offen offset:736
buffer_load_ushort v39, v13, s[16:19], s42 offen offset:992
s_waitcnt vmcnt(0)
v_lshl_or_b32 v6, v33, 16, v32
v_lshl_or_b32 v7, v35, 16, v34
v_lshl_or_b32 v8, v37, 16, v36
v_lshl_or_b32 v9, v39, 16, v38
s_nop 1
Mvvv 236,6,138
Mvvv 244,6,146
Mvvv 252,6,154
s_nop 7
Mvvv 52,24,138
Mvvv 56,24,146
Mvvv 60,24,154
s_nop 7
s_add_u32 s41, s41, 0x2000
s_cmp_lt_u32 s41, 0x20000
s_cbranch_scc1 fh_s20
s_nop 7
v_rcp_f32 v32, v52
v_rcp_f32 v34, v56
v_rcp_f32 v36, v60
s_nop 1
s_branch fh_norm0
fh_slow1:
s_waitcnt vmcnt(0) lgkmcnt(0)
v_and_b32 v2, 15, v1
v_lshrrev_b32 v3, 4, v1
v_lshlrev_b32 v5, 8, v2
v_lshl_add_u32 v5, v3, 4, v5
v_lshlrev_b32 v13, 10, v3
v_lshl_add_u32 v13, v2, 1, v13
v_mov_b32 v2, 0xff800000
v_mov_b32 v3, 0xff800000
v_mov_b32 v4, 0xff800000
s_mov_b32 s41, 0x20000
fh_s11:
s_add_u32 s42, s41, 0
buffer_load_dwordx4 a[32:35], v5, s[12:15], s42 offen
buffer_load_dwordx4 a[36:39], v5, s[12:15], s42 offen offset:64
buffer_load_dwordx4 a[40:43], v5, s[12:15], s42 offen offset:128
buffer_load_dwordx4 a[44:47], v5, s[12:15], s42 offen offset:192
s_add_u32 s42, s41, 0x1000
buffer_load_dwordx4 a[48:51], v5, s[12:15], s42 offen
buffer_load_dwordx4 a[52:55], v5, s[12:15], s42 offen offset:64
buffer_load_dwordx4 a[56:59], v5, s[12:15], s42 offen offset:128
buffer_load_dwordx4 a[60:63], v5, s[12:15], s42 offen offset:192
s_waitcnt vmcnt(0)
Zvaa 136,32,80
Zvaa 144,32,84
Zvaa 152,32,88
Mvaa 136,36,92
Mvaa 144,36,96
Mvaa 152,36,100
Mvaa 136,40,104
Mvaa 144,40,108
Mvaa 152,40,112
Mvaa 136,44,116
Mvaa 144,44,120
Mvaa 152,44,124
Zvaa 140,48,80
Zvaa 148,48,84
Zvaa 156,48,88
Mvaa 140,52,92
Mvaa 148,52,96
Mvaa 156,52,100
Mvaa 140,56,104
Mvaa 148,56,108
Mvaa 156,56,112
Mvaa 140,60,116
Mvaa 148,60,120
Mvaa 156,60,124
s_nop 7
v_max3_f32 v2, v2, v136, v137
v_max3_f32 v2, v2, v138, v139
v_max3_f32 v2, v2, v140, v141
v_max3_f32 v2, v2, v142, v143
v_max3_f32 v3, v3, v144, v145
v_max3_f32 v3, v3, v146, v147
v_max3_f32 v3, v3, v148, v149
v_max3_f32 v3, v3, v150, v151
v_max3_f32 v4, v4, v152, v153
v_max3_f32 v4, v4, v154, v155
v_max3_f32 v4, v4, v156, v157
v_max3_f32 v4, v4, v158, v159
s_add_u32 s41, s41, 0x2000
s_cmp_lt_u32 s41, 0x40000
s_cbranch_scc1 fh_s11
v_mov_b32 v32, v2
s_nop 1
v_permlane32_swap_b32 v32, v2
v_max_f32 v2, v32, v2
v_mov_b32 v32, v2
s_nop 1
v_permlane16_swap_b32 v32, v2
v_max_f32 v2, v32, v2
v_mov_b32 v52, 0
v_mov_b32 v53, 0
v_mov_b32 v54, 0
v_mov_b32 v55, 0
v_mov_b32 v32, v3
s_nop 1
v_permlane32_swap_b32 v32, v3
v_max_f32 v3, v32, v3
v_mov_b32 v32, v3
s_nop 1
v_permlane16_swap_b32 v32, v3
v_max_f32 v3, v32, v3
v_mov_b32 v56, 0
v_mov_b32 v57, 0
v_mov_b32 v58, 0
v_mov_b32 v59, 0
v_mov_b32 v32, v4
s_nop 1
v_permlane32_swap_b32 v32, v4
v_max_f32 v4, v32, v4
v_mov_b32 v32, v4
s_nop 1
v_permlane16_swap_b32 v32, v4
v_max_f32 v4, v32, v4
v_mov_b32 v60, 0
v_mov_b32 v61, 0
v_mov_b32 v62, 0
v_mov_b32 v63, 0
v_mov_b32 v160, 0
v_mov_b32 v161, 0
v_mov_b32 v162, 0
v_mov_b32 v163, 0
v_mov_b32 v164, 0
v_mov_b32 v165, 0
v_mov_b32 v166, 0
v_mov_b32 v167, 0
v_mov_b32 v168, 0
v_mov_b32 v169, 0
v_mov_b32 v170, 0
v_mov_b32 v171, 0
v_mov_b32 v172, 0
v_mov_b32 v173, 0
v_mov_b32 v174, 0
v_mov_b32 v175, 0
v_mov_b32 v176, 0
v_mov_b32 v177, 0
v_mov_b32 v178, 0
v_mov_b32 v179, 0
v_mov_b32 v180, 0
v_mov_b32 v181, 0
v_mov_b32 v182, 0
v_mov_b32 v183, 0
v_mov_b32 v184, 0
v_mov_b32 v185, 0
v_mov_b32 v186, 0
v_mov_b32 v187, 0
v_mov_b32 v188, 0
v_mov_b32 v189, 0
v_mov_b32 v190, 0
v_mov_b32 v191, 0
v_mov_b32 v192, 0
v_mov_b32 v193, 0
v_mov_b32 v194, 0
v_mov_b32 v195, 0
v_mov_b32 v196, 0
v_mov_b32 v197, 0
v_mov_b32 v198, 0
v_mov_b32 v199, 0
v_mov_b32 v200, 0
v_mov_b32 v201, 0
v_mov_b32 v202, 0
v_mov_b32 v203, 0
v_mov_b32 v204, 0
v_mov_b32 v205, 0
v_mov_b32 v206, 0
v_mov_b32 v207, 0
v_mov_b32 v208, 0
v_mov_b32 v209, 0
v_mov_b32 v210, 0
v_mov_b32 v211, 0
v_mov_b32 v212, 0
v_mov_b32 v213, 0
v_mov_b32 v214, 0
v_mov_b32 v215, 0
v_mov_b32 v216, 0
v_mov_b32 v217, 0
v_mov_b32 v218, 0
v_mov_b32 v219, 0
v_mov_b32 v220, 0
v_mov_b32 v221, 0
v_mov_b32 v222, 0
v_mov_b32 v223, 0
v_mov_b32 v224, 0
v_mov_b32 v225, 0
v_mov_b32 v226, 0
v_mov_b32 v227, 0
v_mov_b32 v228, 0
v_mov_b32 v229, 0
v_mov_b32 v230, 0
v_mov_b32 v231, 0
v_mov_b32 v232, 0
v_mov_b32 v233, 0
v_mov_b32 v234, 0
v_mov_b32 v235, 0
v_mov_b32 v236, 0
v_mov_b32 v237, 0
v_mov_b32 v238, 0
v_mov_b32 v239, 0
v_mov_b32 v240, 0
v_mov_b32 v241, 0
v_mov_b32 v242, 0
v_mov_b32 v243, 0
v_mov_b32 v244, 0
v_mov_b32 v245, 0
v_mov_b32 v246, 0
v_mov_b32 v247, 0
v_mov_b32 v248, 0
v_mov_b32 v249, 0
v_mov_b32 v250, 0
v_mov_b32 v251, 0
v_mov_b32 v252, 0
v_mov_b32 v253, 0
v_mov_b32 v254, 0
v_mov_b32 v255, 0
s_mov_b32 s41, 0x20000
fh_s21:
s_add_u32 s42, s41, 0
buffer_load_dwordx4 a[32:35], v5, s[12:15], s42 offen
buffer_load_dwordx4 a[36:39], v5, s[12:15], s42 offen offset:64
buffer_load_dwordx4 a[40:43], v5, s[12:15], s42 offen offset:128
buffer_load_dwordx4 a[44:47], v5, s[12:15], s42 offen offset:192
s_add_u32 s42, s41, 0x1000
buffer_load_dwordx4 a[48:51], v5, s[12:15], s42 offen
buffer_load_dwordx4 a[52:55], v5, s[12:15], s42 offen offset:64
buffer_load_dwordx4 a[56:59], v5, s[12:15], s42 offen offset:128
buffer_load_dwordx4 a[60:63], v5, s[12:15], s42 offen offset:192
s_waitcnt vmcnt(0)
Zvaa 136,32,80
Zvaa 144,32,84
Zvaa 152,32,88
Mvaa 136,36,92
Mvaa 144,36,96
Mvaa 152,36,100
Mvaa 136,40,104
Mvaa 144,40,108
Mvaa 152,40,112
Mvaa 136,44,116
Mvaa 144,44,120
Mvaa 152,44,124
Zvaa 140,48,80
Zvaa 148,48,84
Zvaa 156,48,88
Mvaa 140,52,92
Mvaa 148,52,96
Mvaa 156,52,100
Mvaa 140,56,104
Mvaa 148,56,108
Mvaa 156,56,112
Mvaa 140,60,116
Mvaa 148,60,120
Mvaa 156,60,124
s_nop 7
v_sub_f32 v136, v136, v2
v_sub_f32 v137, v137, v2
v_sub_f32 v138, v138, v2
v_sub_f32 v139, v139, v2
v_sub_f32 v140, v140, v2
v_sub_f32 v141, v141, v2
v_sub_f32 v142, v142, v2
v_sub_f32 v143, v143, v2
v_sub_f32 v144, v144, v3
v_sub_f32 v145, v145, v3
v_sub_f32 v146, v146, v3
v_sub_f32 v147, v147, v3
v_sub_f32 v148, v148, v3
v_sub_f32 v149, v149, v3
v_sub_f32 v150, v150, v3
v_sub_f32 v151, v151, v3
v_sub_f32 v152, v152, v4
v_sub_f32 v153, v153, v4
v_sub_f32 v154, v154, v4
v_sub_f32 v155, v155, v4
v_sub_f32 v156, v156, v4
v_sub_f32 v157, v157, v4
v_sub_f32 v158, v158, v4
v_sub_f32 v159, v159, v4
v_exp_f32 v136, v136
v_exp_f32 v137, v137
v_exp_f32 v138, v138
v_exp_f32 v139, v139
v_exp_f32 v144, v144
v_exp_f32 v145, v145
v_exp_f32 v146, v146
v_exp_f32 v147, v147
v_exp_f32 v152, v152
v_exp_f32 v153, v153
v_exp_f32 v154, v154
v_exp_f32 v155, v155
v_exp_f32 v140, v140
v_exp_f32 v141, v141
v_exp_f32 v142, v142
v_exp_f32 v143, v143
v_exp_f32 v148, v148
v_exp_f32 v149, v149
v_exp_f32 v150, v150
v_exp_f32 v151, v151
v_exp_f32 v156, v156
v_exp_f32 v157, v157
v_exp_f32 v158, v158
v_exp_f32 v159, v159
v_cvt_pk_bf16_f32 v139, v138, v139
v_cvt_pk_bf16_f32 v138, v136, v137
v_cvt_pk_bf16_f32 v140, v140, v141
v_cvt_pk_bf16_f32 v141, v142, v143
v_cvt_pk_bf16_f32 v147, v146, v147
v_cvt_pk_bf16_f32 v146, v144, v145
v_cvt_pk_bf16_f32 v148, v148, v149
v_cvt_pk_bf16_f32 v149, v150, v151
v_cvt_pk_bf16_f32 v155, v154, v155
v_cvt_pk_bf16_f32 v154, v152, v153
v_cvt_pk_bf16_f32 v156, v156, v157
v_cvt_pk_bf16_f32 v157, v158, v159
s_add_u32 s42, s41, 0
buffer_load_ushort v32, v13, s[16:19], s42 offen offset:0
buffer_load_ushort v33, v13, s[16:19], s42 offen offset:256
buffer_load_ushort v34, v13, s[16:19], s42 offen offset:512
buffer_load_ushort v35, v13, s[16:19], s42 offen offset:768
s_add_u32 s42, s41, 0x1000
buffer_load_ushort v36, v13, s[16:19], s42 offen offset:0
buffer_load_ushort v37, v13, s[16:19], s42 offen offset:256
buffer_load_ushort v38, v13, s[16:19], s42 offen offset:512
buffer_load_ushort v39, v13, s[16:19], s42 offen offset:768
s_waitcnt vmcnt(0)
v_lshl_or_b32 v6, v33, 16, v32
v_lshl_or_b32 v7, v35, 16, v34
v_lshl_or_b32 v8, v37, 16, v36
v_lshl_or_b32 v9, v39, 16, v38
s_nop 1
Mvvv 160,6,138
Mvvv 168,6,146
Mvvv 176,6,154
s_nop 7
s_add_u32 s42, s41, 0
buffer_load_ushort v32, v13, s[16:19], s42 offen offset:32
buffer_load_ushort v33, v13, s[16:19], s42 offen offset:288
buffer_load_ushort v34, v13, s[16:19], s42 offen offset:544
buffer_load_ushort v35, v13, s[16:19], s42 offen offset:800
s_add_u32 s42, s41, 0x1000
buffer_load_ushort v36, v13, s[16:19], s42 offen offset:32
buffer_load_ushort v37, v13, s[16:19], s42 offen offset:288
buffer_load_ushort v38, v13, s[16:19], s42 offen offset:544
buffer_load_ushort v39, v13, s[16:19], s42 offen offset:800
s_waitcnt vmcnt(0)
v_lshl_or_b32 v6, v33, 16, v32
v_lshl_or_b32 v7, v35, 16, v34
v_lshl_or_b32 v8, v37, 16, v36
v_lshl_or_b32 v9, v39, 16, v38
s_nop 1
Mvvv 164,6,138
Mvvv 172,6,146
Mvvv 180,6,154
s_nop 7
s_add_u32 s42, s41, 0
buffer_load_ushort v32, v13, s[16:19], s42 offen offset:64
buffer_load_ushort v33, v13, s[16:19], s42 offen offset:320
buffer_load_ushort v34, v13, s[16:19], s42 offen offset:576
buffer_load_ushort v35, v13, s[16:19], s42 offen offset:832
s_add_u32 s42, s41, 0x1000
buffer_load_ushort v36, v13, s[16:19], s42 offen offset:64
buffer_load_ushort v37, v13, s[16:19], s42 offen offset:320
buffer_load_ushort v38, v13, s[16:19], s42 offen offset:576
buffer_load_ushort v39, v13, s[16:19], s42 offen offset:832
s_waitcnt vmcnt(0)
v_lshl_or_b32 v6, v33, 16, v32
v_lshl_or_b32 v7, v35, 16, v34
v_lshl_or_b32 v8, v37, 16, v36
v_lshl_or_b32 v9, v39, 16, v38
s_nop 1
Mvvv 184,6,138
Mvvv 192,6,146
Mvvv 200,6,154
s_nop 7
s_add_u32 s42, s41, 0
buffer_load_ushort v32, v13, s[16:19], s42 offen offset:96
buffer_load_ushort v33, v13, s[16:19], s42 offen offset:352
buffer_load_ushort v34, v13, s[16:19], s42 offen offset:608
buffer_load_ushort v35, v13, s[16:19], s42 offen offset:864
s_add_u32 s42, s41, 0x1000
buffer_load_ushort v36, v13, s[16:19], s42 offen offset:96
buffer_load_ushort v37, v13, s[16:19], s42 offen offset:352
buffer_load_ushort v38, v13, s[16:19], s42 offen offset:608
buffer_load_ushort v39, v13, s[16:19], s42 offen offset:864
s_waitcnt vmcnt(0)
v_lshl_or_b32 v6, v33, 16, v32
v_lshl_or_b32 v7, v35, 16, v34
v_lshl_or_b32 v8, v37, 16, v36
v_lshl_or_b32 v9, v39, 16, v38
s_nop 1
Mvvv 188,6,138
Mvvv 196,6,146
Mvvv 204,6,154
s_nop 7
s_add_u32 s42, s41, 0
buffer_load_ushort v32, v13, s[16:19], s42 offen offset:128
buffer_load_ushort v33, v13, s[16:19], s42 offen offset:384
buffer_load_ushort v34, v13, s[16:19], s42 offen offset:640
buffer_load_ushort v35, v13, s[16:19], s42 offen offset:896
s_add_u32 s42, s41, 0x1000
buffer_load_ushort v36, v13, s[16:19], s42 offen offset:128
buffer_load_ushort v37, v13, s[16:19], s42 offen offset:384
buffer_load_ushort v38, v13, s[16:19], s42 offen offset:640
buffer_load_ushort v39, v13, s[16:19], s42 offen offset:896
s_waitcnt vmcnt(0)
v_lshl_or_b32 v6, v33, 16, v32
v_lshl_or_b32 v7, v35, 16, v34
v_lshl_or_b32 v8, v37, 16, v36
v_lshl_or_b32 v9, v39, 16, v38
s_nop 1
Mvvv 208,6,138
Mvvv 216,6,146
Mvvv 224,6,154
s_nop 7
s_add_u32 s42, s41, 0
buffer_load_ushort v32, v13, s[16:19], s42 offen offset:160
buffer_load_ushort v33, v13, s[16:19], s42 offen offset:416
buffer_load_ushort v34, v13, s[16:19], s42 offen offset:672
buffer_load_ushort v35, v13, s[16:19], s42 offen offset:928
s_add_u32 s42, s41, 0x1000
buffer_load_ushort v36, v13, s[16:19], s42 offen offset:160
buffer_load_ushort v37, v13, s[16:19], s42 offen offset:416
buffer_load_ushort v38, v13, s[16:19], s42 offen offset:672
buffer_load_ushort v39, v13, s[16:19], s42 offen offset:928
s_waitcnt vmcnt(0)
v_lshl_or_b32 v6, v33, 16, v32
v_lshl_or_b32 v7, v35, 16, v34
v_lshl_or_b32 v8, v37, 16, v36
v_lshl_or_b32 v9, v39, 16, v38
s_nop 1
Mvvv 212,6,138
Mvvv 220,6,146
Mvvv 228,6,154
s_nop 7
s_add_u32 s42, s41, 0
buffer_load_ushort v32, v13, s[16:19], s42 offen offset:192
buffer_load_ushort v33, v13, s[16:19], s42 offen offset:448
buffer_load_ushort v34, v13, s[16:19], s42 offen offset:704
buffer_load_ushort v35, v13, s[16:19], s42 offen offset:960
s_add_u32 s42, s41, 0x1000
buffer_load_ushort v36, v13, s[16:19], s42 offen offset:192
buffer_load_ushort v37, v13, s[16:19], s42 offen offset:448
buffer_load_ushort v38, v13, s[16:19], s42 offen offset:704
buffer_load_ushort v39, v13, s[16:19], s42 offen offset:960
s_waitcnt vmcnt(0)
v_lshl_or_b32 v6, v33, 16, v32
v_lshl_or_b32 v7, v35, 16, v34
v_lshl_or_b32 v8, v37, 16, v36
v_lshl_or_b32 v9, v39, 16, v38
s_nop 1
Mvvv 232,6,138
Mvvv 240,6,146
Mvvv 248,6,154
s_nop 7
s_add_u32 s42, s41, 0
buffer_load_ushort v32, v13, s[16:19], s42 offen offset:224
buffer_load_ushort v33, v13, s[16:19], s42 offen offset:480
buffer_load_ushort v34, v13, s[16:19], s42 offen offset:736
buffer_load_ushort v35, v13, s[16:19], s42 offen offset:992
s_add_u32 s42, s41, 0x1000
buffer_load_ushort v36, v13, s[16:19], s42 offen offset:224
buffer_load_ushort v37, v13, s[16:19], s42 offen offset:480
buffer_load_ushort v38, v13, s[16:19], s42 offen offset:736
buffer_load_ushort v39, v13, s[16:19], s42 offen offset:992
s_waitcnt vmcnt(0)
v_lshl_or_b32 v6, v33, 16, v32
v_lshl_or_b32 v7, v35, 16, v34
v_lshl_or_b32 v8, v37, 16, v36
v_lshl_or_b32 v9, v39, 16, v38
s_nop 1
Mvvv 236,6,138
Mvvv 244,6,146
Mvvv 252,6,154
s_nop 7
Mvvv 52,24,138
Mvvv 56,24,146
Mvvv 60,24,154
s_nop 7
s_add_u32 s41, s41, 0x2000
s_cmp_lt_u32 s41, 0x40000
s_cbranch_scc1 fh_s21
s_nop 7
v_rcp_f32 v32, v52
v_rcp_f32 v34, v56
v_rcp_f32 v36, v60
s_nop 1
s_branch fh_norm1
fh_px_spin:
s_mov_b32 s42, 0
fh_px_l:
s_sleep 4
buffer_load_dword v30, v28, s[20:23], s61 offen sc1
s_waitcnt vmcnt(0)
v_readfirstlane_b32 s41, v30
s_add_u32 s42, s42, 1
s_cmp_ge_u32 s42, 0x30d40
s_cbranch_scc1 fh_px_ok
s_cmp_lt_u32 s41, 1
s_cbranch_scc1 fh_px_l
fh_px_ok:
buffer_load_dwordx4 v[64:67], v20, s[20:23], s60 offen sc1
buffer_load_dwordx4 v[68:71], v20, s[20:23], s60 offen offset:1024 sc1
buffer_load_dwordx4 v[72:75], v20, s[20:23], s60 offen offset:2048 sc1
buffer_load_dwordx4 v[76:79], v20, s[20:23], s60 offen offset:3072 sc1
buffer_load_dwordx4 v[80:83], v20, s[20:23], s44 offen sc1
buffer_load_dwordx4 v[84:87], v20, s[20:23], s44 offen offset:1024 sc1
s_branch fh_xgo
f_end:
s_endpgm
.section .rodata,"a"
.p2align 6
.amdhsa_kernel concat_heads__mha_block_cached__gqa_block_cached__near_ridge_kernel
  .amdhsa_next_free_vgpr 512
  .amdhsa_next_free_sgpr 102
  .amdhsa_accum_offset 256
  .amdhsa_group_segment_fixed_size 0
  .amdhsa_kernarg_size 104
  .amdhsa_user_sgpr_count 2
  .amdhsa_user_sgpr_kernarg_segment_ptr 1
  .amdhsa_system_sgpr_workgroup_id_x 1
.end_amdhsa_kernel
```
